```python
import torch

def _softmax(x, axis=-1):
    return torch.softmax(x, dim=axis)
def _gelu(x):
    return torch.nn.functional.gelu(x, approximate="tanh")
def _silu(x):
    return torch.nn.functional.silu(x)
def _sigmoid(x):
    return torch.sigmoid(x)
def _layernorm(x, axis=-1, eps=1e-5):
    m = x.mean(dim=axis, keepdim=True)
    v = x.var(dim=axis, keepdim=True, unbiased=False)
    return (x - m) / torch.sqrt(v + eps)
def _scatter_add(tgt, idx, src, axis=0):
    return tgt.clone().index_add_(axis, idx, src)
def _segment_sum(src, seg, n):
    out = torch.zeros((n,) + src.shape[1:], dtype=src.dtype)
    return out.index_add_(0, seg, src)
def _pad(x, pw):
    flat = tuple(v for pair in reversed(pw) for v in pair)
    return torch.nn.functional.pad(x, flat)

kernel_name = 'standalone__gqa_block_cached__near_ridge'

def setup_inputs():

    _w = (lambda a: (lambda t: t.to(torch.bfloat16) if t.is_floating_point() else t)(torch.as_tensor(a)))
    B, Sq, D = 16, 192, 512
    Hq, Hkv, Sk, Dh = 32, 32, 512, 128
    assert Hq % Hkv == 0, (Hq, Hkv)
    return {
        "x": _w((lambda *s: torch.randn(*s, dtype=torch.bfloat16) * 0.8)(B, Sq, D)),
        "k_cache": _w((lambda *s: torch.randn(*s, dtype=torch.bfloat16) * 0.8)(B, Hkv, Sk, Dh)),
        "v_cache": _w((lambda *s: torch.randn(*s, dtype=torch.bfloat16) * 0.05)(B, Hkv, Sk, Dh)),
        "wq": _w((lambda *s: torch.randn(*s, dtype=torch.bfloat16) * 0.8)(D, Hq * Dh) * (D ** -0.5)),
        "wo": _w((lambda *s: torch.randn(*s, dtype=torch.bfloat16) * 0.05)(Hq * Dh, D) * ((Hq * Dh) ** -0.5)),
    }

def reference(x, k_cache, v_cache, wq, wo):
    B, Sq, D = x.shape
    Hq, Dh = 32, 128
    Hkv = k_cache.shape[1]
    rep = Hq // Hkv
    q = (lambda x, *d: x.permute(*d))((x @ wq).reshape(B, Sq, Hq, Dh), 0, 2, 1, 3)
    k = (lambda x, n, axis: torch.repeat_interleave(x, n, dim=axis))(k_cache, rep, axis=1)
    v = (lambda x, n, axis: torch.repeat_interleave(x, n, dim=axis))(v_cache, rep, axis=1)
    scores = torch.einsum("bhqd,bhkd->bhqk", q, k) * (Dh ** -0.5)
    p = _softmax(scores, axis=-1)
    o = torch.einsum("bhqk,bhkd->bhqd", p, v)
    return (lambda x, *d: x.permute(*d))(o, 0, 2, 1, 3).reshape(B, Sq, Hq * Dh) @ wo
```

```asm
; @launch grid=(256,1,1) block=(256,1,1) lds=163840
.amdgcn_target "amdgcn-amd-amdhsa--gfx950"
.text
.globl standalone__gqa_block_cached__near_ridge_kernel
.p2align 8
.type standalone__gqa_block_cached__near_ridge_kernel,@function
standalone__gqa_block_cached__near_ridge_kernel:
    s_cmp_ge_u32 s2, 256
    s_cbranch_scc1 K_END
    s_load_dwordx16 s[4:19], s[0:1], 0
    v_lshrrev_b32 v168, 6, v0
    v_and_b32 v1, 63, v0
    v_readfirstlane_b32 s3, v168
    s_and_b32 s86, s2, 7
    s_lshr_b32 s87, s2, 3
    s_and_b32 s20, s86, 1
    s_lshl_b32 s20, s20, 3
    s_lshr_b32 s21, s86, 1
    s_lshl_b32 s21, s21, 2
    s_and_b32 s86, s87, 7
    s_lshr_b32 s93, s87, 3
    s_add_u32 s20, s20, s86
    s_add_u32 s21, s21, s93
    s_lshl_b32 s93, s93, 1
    s_add_u32 s86, s86, s93
    s_and_b32 s86, s86, 7
    s_lshl_b32 s59, s86, 7
    s_lshl_b32 s58, s86, 19
    v_bfe_u32 v169, v1, 4, 1
    v_lshrrev_b32 v170, 5, v1
    v_lshlrev_b32 v169, 17, v169
    v_lshl_add_u32 v169, v170, 15, v169
    v_and_b32 v170, 12, v1
    v_bfe_u32 v171, v1, 1, 1
    v_or_b32 v170, v170, v171
    v_and_b32 v171, 1, v1
    v_lshl_add_u32 v170, v171, 1, v170
    v_lshl_add_u32 v169, v170, 4, v169
    s_lshr_b32 s86, s3, 1
    s_lshl_b32 s86, s86, 16
    s_and_b32 s93, s3, 1
    s_lshl_b32 s93, s93, 14
    s_add_u32 s86, s86, s93
    v_add_u32 v10, s86, v169
    v_add_u32 v11, 7136, v10
    s_mul_i32 s56, s3, 2112
    v_lshrrev_b32 v169, 3, v1
    v_and_b32 v170, 7, v1
    v_xor_b32 v170, v170, v169
    v_lshlrev_b32 v170, 4, v170
    v_lshl_add_u32 v170, v169, 10, v170
    s_mul_i32 s86, s3, 49152
    v_add_u32 v164, s86, v170
    v_add_u32 v165, 7168, v164
    v_and_b32 v169, 15, v1
    s_lshl_b32 s86, s21, 9
    s_sub_u32 s93, 4194304, s86
    s_mul_i32 s96, s20, 196608
    s_waitcnt lgkmcnt(0)
    s_add_u32 s32, s10, s86
    s_addc_u32 s33, s11, 0
    s_mov_b32 s34, s93
    s_mov_b32 s35, 0x20000
    s_add_u32 s36, s4, s96
    s_addc_u32 s37, s5, 0
    s_mov_b32 s38, 196608
    s_mov_b32 s39, 0x20000
    s_add_u32 m0, s56, 0
    s_add_u32 s57, s58, 0
    s_and_b32 s57, s57, 0x3fffff
    buffer_load_dwordx4 v10, s[32:35], s57 offen offset:0 lds
    buffer_load_dwordx4 v11, s[32:35], s57 offen offset:1056 lds
    s_add_u32 m0, s56, 8448
    s_add_u32 s60, s59, 0
    s_and_b32 s60, s60, 1023
    buffer_load_dwordx4 v164, s[36:39], s60 offen offset:0 lds
    buffer_load_dwordx4 v165, s[36:39], s60 offen offset:1024 lds
    s_add_u32 m0, s56, 16896
    s_add_u32 s60, s60, 16384
    buffer_load_dwordx4 v164, s[36:39], s60 offen offset:0 lds
    buffer_load_dwordx4 v165, s[36:39], s60 offen offset:1024 lds
    s_add_u32 m0, s56, 25344
    s_add_u32 s60, s60, 16384
    buffer_load_dwordx4 v164, s[36:39], s60 offen offset:0 lds
    buffer_load_dwordx4 v165, s[36:39], s60 offen offset:1024 lds
    s_getpc_b64 s[94:95]
    s_lshl_b32 s87, s87, 2
    s_add_u32 s87, s87, s3
    s_lshl_b32 s87, s87, 9
    v_and_b32 v171, 3, v1
    v_lshlrev_b32 v171, 7, v171
    v_add_u32 v171, s87, v171
    global_load_dword v175, v171, s[94:95]
    s_add_u32 m0, s56, 33792
    s_add_u32 s57, s58, 256
    s_and_b32 s57, s57, 0x3fffff
    buffer_load_dwordx4 v10, s[32:35], s57 offen offset:0 lds
    buffer_load_dwordx4 v11, s[32:35], s57 offen offset:1056 lds
    s_add_u32 m0, s56, 42240
    s_add_u32 s60, s59, 128
    s_and_b32 s60, s60, 1023
    buffer_load_dwordx4 v164, s[36:39], s60 offen offset:0 lds
    buffer_load_dwordx4 v165, s[36:39], s60 offen offset:1024 lds
    s_add_u32 m0, s56, 50688
    s_add_u32 s60, s60, 16384
    buffer_load_dwordx4 v164, s[36:39], s60 offen offset:0 lds
    buffer_load_dwordx4 v165, s[36:39], s60 offen offset:1024 lds
    s_add_u32 m0, s56, 59136
    s_add_u32 s57, s58, 262144
    s_and_b32 s57, s57, 0x3fffff
    buffer_load_dwordx4 v10, s[32:35], s57 offen offset:0 lds
    buffer_load_dwordx4 v11, s[32:35], s57 offen offset:1056 lds
    s_lshl_b32 s86, s20, 4
    s_add_u32 s86, s86, s21
    s_lshl_b32 s86, s86, 18
    s_add_u32 s24, s6, s86
    s_addc_u32 s25, s7, 0
    s_sub_u32 s24, s24, 1024
    s_subb_u32 s25, s25, 0
    s_mov_b32 s26, 263168
    s_mov_b32 s27, 0x20000
    s_add_u32 s28, s8, s86
    s_addc_u32 s29, s9, 0
    s_sub_u32 s28, s28, 1024
    s_subb_u32 s29, s29, 0
    s_mov_b32 s30, 263168
    s_mov_b32 s31, 0x20000
    v_lshrrev_b32 v170, 4, v1
    v_lshlrev_b32 v170, 11, v170
    v_lshl_add_u32 v170, v169, 4, v170
    s_lshl_b32 s86, s3, 9
    s_add_u32 s86, s86, 1024
    v_add_u32 v8, s86, v170
    v_subrev_u32 v9, 800, v8
    s_mul_i32 s96, s3, 12288
    v_lshlrev_b32 v172, 4, v1
    v_add_u32 v12, s96, v172
    v_and_b32 v13, 15, v1
    s_lshr_b32 s22, s21, 2
    s_and_b32 s23, s21, 3
    s_mov_b32 s44, s18
    s_mov_b32 s45, s19
    s_mov_b32 s46, 100663296
    s_mov_b32 s47, 0x20000
    s_mov_b32 s48, s16
    s_mov_b32 s49, s17
    s_mov_b32 s50, 256
    s_mov_b32 s51, 0x20000
    v_accvgpr_write_b32 a252, -1
    v_accvgpr_write_b32 a253, -1
    v_accvgpr_write_b32 a254, -1
    v_accvgpr_write_b32 a255, -1
    s_lshl_b32 s96, s20, 4
    s_add_u32 s96, s96, s23
    s_mul_i32 s96, s96, 98304
    s_mul_i32 s97, s22, 393216
    s_add_u32 s72, s96, s97
    s_xor_b32 s97, s22, 3
    s_mul_i32 s97, s97, 393216
    s_add_u32 s97, s97, 0
    s_add_u32 s69, s96, s97
    s_xor_b32 s97, s22, 2
    s_mul_i32 s97, s97, 393216
    s_add_u32 s97, s97, 4096
    s_add_u32 s70, s96, s97
    s_xor_b32 s97, s22, 1
    s_mul_i32 s97, s97, 393216
    s_add_u32 s97, s97, 8192
    s_add_u32 s71, s96, s97
    s_lshl_b32 s74, s20, 4
    s_add_u32 s73, s74, s21
    s_lshl_b32 s97, s73, 2
    s_add_u32 s97, s97, s3
    s_lshl_b32 s97, s97, 7
    s_add_u32 s76, s97, 31457280
    s_lshl_b32 s97, s23, 9
    s_sub_u32 s75, s76, s97
    s_lshl_b32 s97, s23, 2
    s_add_u32 s97, s97, s74
    s_lshl_b32 s97, s97, 2
    s_add_u32 s97, s97, s3
    s_lshl_b32 s97, s97, 7
    s_add_u32 s16, s97, 31719424
    s_lshl_b32 s97, s22, 9
    s_add_u32 s17, s16, s97
    s_lshl_b32 s97, 1, s22
    s_andn2_b32 s18, 15, s97
    s_cmp_eq_u32 s3, 0
    s_cselect_b32 s80, 1, 0
    s_mov_b32 s81, 0
    v_bfe_u32 v170, v1, 2, 3
    v_mul_u32_u24 v170, 1056, v170
    v_lshrrev_b32 v171, 5, v1
    v_lshl_add_u32 v170, v171, 8, v170
    v_and_b32 v171, 3, v1
    v_lshl_add_u32 v2, v171, 3, v170
    v_and_b32 v170, 7, v1
    v_lshrrev_b32 v171, 4, v1
    v_xor_b32 v171, v171, v170
    v_lshlrev_b32 v171, 4, v171
    v_lshl_add_u32 v171, v169, 7, v171
    v_add_u32 v176, s56, v171
    v_xor_b32 v171, 64, v171
    v_add_u32 v179, s56, v171
    v_add_u32 v177, 67584, v176
    v_add_u32 v178, 135168, v176
    v_add_u32 v180, 67584, v179
    v_add_u32 v181, 135168, v179
    v_add_u32 v3, 67584, v2
    v_add_u32 v4, 135168, v2
    v_and_b32 v172, 7, v1
    v_mul_u32_u24 v172, 1056, v172
    v_bfe_u32 v173, v1, 3, 1
    v_lshl_add_u32 v172, v173, 8, v172
    v_lshrrev_b32 v173, 4, v1
    v_lshl_add_u32 v5, v173, 4, v172
    v_add_u32 v6, 67584, v5
    v_add_u32 v7, 135168, v5
    s_mov_b32 s84, 0x47800000
    s_mov_b32 s85, 0x3e0293ee
    v_and_b32 v172, 3, v1
    v_mov_b32 v173, 0x3f803f80
    v_cmp_eq_u32 vcc, 0, v172
    s_or_b32 vcc_lo, vcc_lo, 0x88888888
    s_or_b32 vcc_hi, vcc_hi, 0x88888888
    v_cndmask_b32 v174, 0, v173, vcc
    v_accvgpr_write_b32 a232, v174
    v_accvgpr_write_b32 a233, v174
    v_accvgpr_write_b32 a234, v174
    v_accvgpr_write_b32 a235, v174
    v_cmp_eq_u32 vcc, 1, v172
    s_or_b32 vcc_lo, vcc_lo, 0x88888888
    s_or_b32 vcc_hi, vcc_hi, 0x88888888
    v_cndmask_b32 v174, 0, v173, vcc
    v_accvgpr_write_b32 a236, v174
    v_accvgpr_write_b32 a237, v174
    v_accvgpr_write_b32 a238, v174
    v_accvgpr_write_b32 a239, v174
    v_cmp_eq_u32 vcc, 2, v172
    s_or_b32 vcc_lo, vcc_lo, 0x88888888
    s_or_b32 vcc_hi, vcc_hi, 0x88888888
    v_cndmask_b32 v174, 0, v173, vcc
    v_accvgpr_write_b32 a240, v174
    v_accvgpr_write_b32 a241, v174
    v_accvgpr_write_b32 a242, v174
    v_accvgpr_write_b32 a243, v174
    v_and_b32 v172, 1, v1
    v_lshlrev_b32 v172, 4, v172
    v_mov_b32 v173, 0x3f80
    v_lshlrev_b32 v173, v172, v173
    s_mov_b32 vcc_lo, 0x00300003
    s_mov_b32 vcc_hi, 0x30000300
    v_cndmask_b32 v174, 0, v173, vcc
    v_accvgpr_write_b32 a248, v174
    s_mov_b32 vcc_lo, 0x00c0000c
    s_mov_b32 vcc_hi, 0xc0000c00
    v_cndmask_b32 v174, 0, v173, vcc
    v_accvgpr_write_b32 a249, v174
    v_accvgpr_write_b32 a246, 0
    v_accvgpr_write_b32 a247, 0
    v_accvgpr_write_b32 a250, 0
    v_accvgpr_write_b32 a251, 0
    s_getreg_b32 s9, hwreg(HW_REG_XCC_ID, 0, 4)
    s_add_u32 s9, s9, 1
    s_mul_i32 s96, s20, 1572864
    s_and_b32 s98, s21, 12
    s_and_b32 s86, s22, 2
    s_lshl_b32 s86, s86, 6
    s_add_u32 s97, s21, 0
    s_and_b32 s97, s97, 3
    s_or_b32 s97, s97, s98
    s_lshl_b32 s4, s97, 18
    s_or_b32 s4, s4, s86
    s_xor_b32 s61, s4, 128
    s_mul_i32 s97, s97, 98304
    s_add_u32 s65, s96, s97
    s_add_u32 s97, s21, 1
    s_and_b32 s97, s97, 3
    s_or_b32 s97, s97, s98
    s_lshl_b32 s5, s97, 18
    s_or_b32 s5, s5, s86
    s_xor_b32 s62, s5, 128
    s_mul_i32 s97, s97, 98304
    s_add_u32 s66, s96, s97
    s_add_u32 s97, s21, 2
    s_and_b32 s97, s97, 3
    s_or_b32 s97, s97, s98
    s_lshl_b32 s6, s97, 18
    s_or_b32 s6, s6, s86
    s_xor_b32 s63, s6, 128
    s_mul_i32 s97, s97, 98304
    s_add_u32 s67, s96, s97
    s_add_u32 s97, s21, 3
    s_and_b32 s97, s97, 3
    s_or_b32 s97, s97, s98
    s_lshl_b32 s7, s97, 18
    s_or_b32 s7, s7, s86
    s_xor_b32 s64, s7, 128
    s_mul_i32 s97, s97, 98304
    s_add_u32 s68, s96, s97
    s_lshl_b32 s78, 15, s98
    s_lshl_b32 s77, 0x1111, s23
    s_or_b32 s77, s77, s78
    s_lshl_b32 s96, 1, s21
    s_andn2_b32 s77, s77, s96
    s_andn2_b32 s78, s78, s96
    s_lshl_b32 s96, 1, s23
    s_andn2_b32 s79, 15, s96
    s_lshl_b32 s96, s23, 8
    s_sub_u32 s97, 4195328, s96
    s_add_u32 s40, s12, s96
    s_addc_u32 s41, s13, 0
    s_sub_u32 s40, s40, 1024
    s_subb_u32 s41, s41, 0
    s_mov_b32 s42, s97
    s_mov_b32 s43, 0x20000
    s_mul_i32 s97, s20, 196608
    s_lshl_b32 s98, s22, 6
    s_add_u32 s96, s96, s98
    s_add_u32 s97, s97, s96
    s_sub_u32 s96, 196608, s96
    s_add_u32 s52, s14, s97
    s_addc_u32 s53, s15, 0
    s_mov_b32 s54, s96
    s_mov_b32 s55, 0x20000
    s_waitcnt vmcnt(9)
    s_barrier
    ds_read_b128 v[208:211], v176 offset:8448
    ds_read_b128 v[212:215], v176 offset:16896
    ds_read_b128 v[216:219], v176 offset:25344
    ds_read_b64_tr_b16 a[192:193], v2 offset:0
    ds_read_b64_tr_b16 a[194:195], v2 offset:512
    ds_read_b64_tr_b16 a[196:197], v2 offset:32
    ds_read_b64_tr_b16 a[198:199], v2 offset:544
    s_waitcnt lgkmcnt(2)
    v_mfma_f32_16x16x32_bf16 v[116:119], a[192:195], v[208:211], 0
    ds_read_b64_tr_b16 a[200:201], v2 offset:64
    ds_read_b64_tr_b16 a[202:203], v2 offset:576
    v_mfma_f32_16x16x32_bf16 v[120:123], a[192:195], v[212:215], 0
    s_add_u32 m0, s56, 67584
    s_add_u32 s60, s60, 16384
    v_mfma_f32_16x16x32_bf16 v[124:127], a[192:195], v[216:219], 0
    ds_read_b64_tr_b16 a[204:205], v2 offset:96
    s_waitcnt lgkmcnt(3)
    v_mfma_f32_16x16x32_bf16 v[136:139], a[196:199], v[216:219], 0
    ds_read_b64_tr_b16 a[206:207], v2 offset:608
    ds_read_b128 v[220:223], v179 offset:8448
    v_mfma_f32_16x16x32_bf16 v[132:135], a[196:199], v[212:215], 0
    ds_read_b64_tr_b16 a[208:209], v2 offset:128
    ds_read_b128 v[224:227], v179 offset:16896
    v_mfma_f32_16x16x32_bf16 v[128:131], a[196:199], v[208:211], 0
    ds_read_b64_tr_b16 a[210:211], v2 offset:640
    s_waitcnt lgkmcnt(6)
    v_mfma_f32_16x16x32_bf16 v[140:143], a[200:203], v[208:211], 0
    ds_read_b64_tr_b16 a[212:213], v2 offset:160
    buffer_load_dwordx4 v164, s[36:39], s60 offen offset:0 lds
    v_mfma_f32_16x16x32_bf16 v[144:147], a[200:203], v[212:215], 0
    ds_read_b64_tr_b16 a[214:215], v2 offset:672
    ds_read_b128 v[228:231], v179 offset:25344
    v_mfma_f32_16x16x32_bf16 v[148:151], a[200:203], v[216:219], 0
    ds_read_b64_tr_b16 a[216:217], v2 offset:192
    s_waitcnt lgkmcnt(8)
    v_mfma_f32_16x16x32_bf16 v[160:163], a[204:207], v[216:219], 0
    ds_read_b64_tr_b16 a[218:219], v2 offset:704
    v_mfma_f32_16x16x32_bf16 v[156:159], a[204:207], v[212:215], 0
    ds_read_b64_tr_b16 a[220:221], v2 offset:224
    v_mfma_f32_16x16x32_bf16 v[152:155], a[204:207], v[208:211], 0
    ds_read_b64_tr_b16 a[222:223], v2 offset:736
    s_waitcnt lgkmcnt(7)
    v_mfma_f32_16x16x32_bf16 v[20:23], a[208:211], v[208:211], 0
    s_waitcnt vmcnt(7) lgkmcnt(10)
    s_barrier
    v_mfma_f32_16x16x32_bf16 v[24:27], a[208:211], v[212:215], 0
    buffer_load_dwordx4 v165, s[36:39], s60 offen offset:1024 lds
    v_mfma_f32_16x16x32_bf16 v[28:31], a[208:211], v[216:219], 0
    ds_read_b64_tr_b16 a[224:225], v2 offset:33792
    s_waitcnt lgkmcnt(6)
    v_mfma_f32_16x16x32_bf16 v[40:43], a[212:215], v[216:219], 0
    s_add_u32 m0, s56, 8448
    s_add_u32 s60, s59, 256
    s_and_b32 s60, s60, 1023
    v_mfma_f32_16x16x32_bf16 v[36:39], a[212:215], v[212:215], 0
    buffer_load_dwordx4 v164, s[36:39], s60 offen offset:0 lds
    v_mfma_f32_16x16x32_bf16 v[32:35], a[212:215], v[208:211], 0
    ds_read_b64_tr_b16 a[226:227], v2 offset:34304
    s_waitcnt lgkmcnt(4)
    v_mfma_f32_16x16x32_bf16 v[44:47], a[216:219], v[208:211], 0
    ds_read_b64_tr_b16 a[228:229], v2 offset:33824
    v_mfma_f32_16x16x32_bf16 v[48:51], a[216:219], v[212:215], 0
    buffer_load_dwordx4 v165, s[36:39], s60 offen offset:1024 lds
    v_mfma_f32_16x16x32_bf16 v[52:55], a[216:219], v[216:219], 0
    ds_read_b64_tr_b16 a[230:231], v2 offset:34336
    s_waitcnt lgkmcnt(4)
    v_mfma_f32_16x16x32_bf16 v[64:67], a[220:223], v[216:219], 0
    s_add_u32 m0, s56, 16896
    s_add_u32 s57, s58, 262400
    s_and_b32 s57, s57, 0x3fffff
    v_mfma_f32_16x16x32_bf16 v[60:63], a[220:223], v[212:215], 0
    ds_read_b64_tr_b16 a[192:193], v2 offset:33856
    v_mfma_f32_16x16x32_bf16 v[56:59], a[220:223], v[208:211], 0
    ds_read_b64_tr_b16 a[194:195], v2 offset:34368
    s_waitcnt lgkmcnt(4)
    v_mfma_f32_16x16x32_bf16 a[0:3], a[224:227], v[208:211], 0
    ds_read_b64_tr_b16 a[196:197], v2 offset:33888
    v_mfma_f32_16x16x32_bf16 a[4:7], a[224:227], v[212:215], 0
    ds_read_b64_tr_b16 a[198:199], v2 offset:34400
    buffer_load_dwordx4 v10, s[32:35], s57 offen offset:0 lds
    v_mfma_f32_16x16x32_bf16 a[8:11], a[224:227], v[216:219], 0
    ds_read_b64_tr_b16 a[200:201], v2 offset:33920
    s_waitcnt lgkmcnt(5)
    v_mfma_f32_16x16x32_bf16 a[20:23], a[228:231], v[216:219], 0
    ds_read_b64_tr_b16 a[202:203], v2 offset:34432
    v_mfma_f32_16x16x32_bf16 a[16:19], a[228:231], v[212:215], 0
    ds_read_b64_tr_b16 a[204:205], v2 offset:33952
    v_mfma_f32_16x16x32_bf16 a[12:15], a[228:231], v[208:211], 0
    ds_read_b64_tr_b16 a[206:207], v2 offset:34464
    s_waitcnt lgkmcnt(6)
    v_mfma_f32_16x16x32_bf16 a[24:27], a[192:195], v[208:211], 0
    ds_read_b64_tr_b16 a[208:209], v2 offset:33984
    v_mfma_f32_16x16x32_bf16 a[28:31], a[192:195], v[212:215], 0
    ds_read_b64_tr_b16 a[210:211], v2 offset:34496
    buffer_load_dwordx4 v11, s[32:35], s57 offen offset:1056 lds
    v_mfma_f32_16x16x32_bf16 a[32:35], a[192:195], v[216:219], 0
    ds_read_b64_tr_b16 a[212:213], v2 offset:34016
    s_waitcnt lgkmcnt(7)
    v_mfma_f32_16x16x32_bf16 a[44:47], a[196:199], v[216:219], 0
    ds_read_b64_tr_b16 a[214:215], v2 offset:34528
    s_add_u32 m0, s56, 76032
    s_add_u32 s60, s60, 16384
    v_mfma_f32_16x16x32_bf16 a[40:43], a[196:199], v[212:215], 0
    buffer_load_dwordx4 v164, s[36:39], s60 offen offset:0 lds
    v_mfma_f32_16x16x32_bf16 a[36:39], a[196:199], v[208:211], 0
    s_waitcnt lgkmcnt(6)
    v_mfma_f32_16x16x32_bf16 a[48:51], a[200:203], v[208:211], 0
    s_waitcnt vmcnt(7) lgkmcnt(6)
    s_barrier
    v_mfma_f32_16x16x32_bf16 a[52:55], a[200:203], v[212:215], 0
    buffer_load_dwordx4 v165, s[36:39], s60 offen offset:1024 lds
    v_mfma_f32_16x16x32_bf16 a[56:59], a[200:203], v[216:219], 0
    ds_read_b64_tr_b16 a[216:217], v2 offset:59136
    s_waitcnt lgkmcnt(5)
    v_mfma_f32_16x16x32_bf16 a[68:71], a[204:207], v[216:219], 0
    s_add_u32 m0, s56, 0
    s_add_u32 s60, s60, 16384
    v_mfma_f32_16x16x32_bf16 a[64:67], a[204:207], v[212:215], 0
    buffer_load_dwordx4 v164, s[36:39], s60 offen offset:0 lds
    v_mfma_f32_16x16x32_bf16 a[60:63], a[204:207], v[208:211], 0
    ds_read_b64_tr_b16 a[218:219], v2 offset:59648
    s_waitcnt lgkmcnt(3)
    v_mfma_f32_16x16x32_bf16 a[72:75], a[208:211], v[208:211], 0
    ds_read_b64_tr_b16 a[220:221], v2 offset:59168
    v_mfma_f32_16x16x32_bf16 a[76:79], a[208:211], v[212:215], 0
    buffer_load_dwordx4 v165, s[36:39], s60 offen offset:1024 lds
    v_mfma_f32_16x16x32_bf16 a[80:83], a[208:211], v[216:219], 0
    ds_read_b64_tr_b16 a[222:223], v2 offset:59680
    s_waitcnt lgkmcnt(4)
    v_mfma_f32_16x16x32_bf16 a[92:95], a[212:215], v[216:219], 0
    s_add_u32 m0, s56, 25344
    s_add_u32 s57, s58, 524288
    s_and_b32 s57, s57, 0x3fffff
    v_mfma_f32_16x16x32_bf16 a[88:91], a[212:215], v[212:215], 0
    buffer_load_dwordx4 v10, s[32:35], s57 offen offset:0 lds
    v_mfma_f32_16x16x32_bf16 a[84:87], a[212:215], v[208:211], 0
    ds_read_b64_tr_b16 a[224:225], v2 offset:59200
    s_waitcnt lgkmcnt(3)
    v_mfma_f32_16x16x32_bf16 v[116:119], a[216:219], v[220:223], v[116:119]
    ds_read_b64_tr_b16 a[226:227], v2 offset:59712
    v_mfma_f32_16x16x32_bf16 v[120:123], a[216:219], v[224:227], v[120:123]
    buffer_load_dwordx4 v11, s[32:35], s57 offen offset:1056 lds
    v_mfma_f32_16x16x32_bf16 v[124:127], a[216:219], v[228:231], v[124:127]
    ds_read_b64_tr_b16 a[228:229], v2 offset:59232
    s_waitcnt lgkmcnt(3)
    v_mfma_f32_16x16x32_bf16 v[136:139], a[220:223], v[228:231], v[136:139]
    ds_read_b64_tr_b16 a[230:231], v2 offset:59744
    v_mfma_f32_16x16x32_bf16 v[132:135], a[220:223], v[224:227], v[132:135]
    ds_read_b64_tr_b16 a[192:193], v2 offset:59264
    v_mfma_f32_16x16x32_bf16 v[128:131], a[220:223], v[220:223], v[128:131]
    ds_read_b64_tr_b16 a[194:195], v2 offset:59776
    s_waitcnt lgkmcnt(4)
    v_mfma_f32_16x16x32_bf16 v[140:143], a[224:227], v[220:223], v[140:143]
    ds_read_b64_tr_b16 a[196:197], v2 offset:59296
    s_add_u32 m0, s56, 84480
    s_add_u32 s60, s59, 384
    s_and_b32 s60, s60, 1023
    v_mfma_f32_16x16x32_bf16 v[144:147], a[224:227], v[224:227], v[144:147]
    ds_read_b64_tr_b16 a[198:199], v2 offset:59808
    v_mfma_f32_16x16x32_bf16 v[148:151], a[224:227], v[228:231], v[148:151]
    ds_read_b64_tr_b16 a[200:201], v2 offset:59328
    s_waitcnt lgkmcnt(5)
    v_mfma_f32_16x16x32_bf16 v[160:163], a[228:231], v[228:231], v[160:163]
    ds_read_b64_tr_b16 a[202:203], v2 offset:59840
    v_mfma_f32_16x16x32_bf16 v[156:159], a[228:231], v[224:227], v[156:159]
    ds_read_b64_tr_b16 a[204:205], v2 offset:59360
    buffer_load_dwordx4 v164, s[36:39], s60 offen offset:0 lds
    v_mfma_f32_16x16x32_bf16 v[152:155], a[228:231], v[220:223], v[152:155]
    ds_read_b64_tr_b16 a[206:207], v2 offset:59872
    s_waitcnt lgkmcnt(6)
    v_mfma_f32_16x16x32_bf16 v[20:23], a[192:195], v[220:223], v[20:23]
    s_waitcnt vmcnt(7) lgkmcnt(8)
    s_barrier
    v_mfma_f32_16x16x32_bf16 v[24:27], a[192:195], v[224:227], v[24:27]
    buffer_load_dwordx4 v165, s[36:39], s60 offen offset:1024 lds
    v_mfma_f32_16x16x32_bf16 v[28:31], a[192:195], v[228:231], v[28:31]
    s_add_u32 m0, s56, 33792
    s_add_u32 s60, s60, 16384
    s_waitcnt lgkmcnt(4)
    v_mfma_f32_16x16x32_bf16 v[40:43], a[196:199], v[228:231], v[40:43]
    buffer_load_dwordx4 v164, s[36:39], s60 offen offset:0 lds
    v_mfma_f32_16x16x32_bf16 v[36:39], a[196:199], v[224:227], v[36:39]
    ds_read_b64_tr_b16 a[208:209], v2 offset:16896
    ds_read_b128 v[232:235], v176 offset:42240
    v_mfma_f32_16x16x32_bf16 v[32:35], a[196:199], v[220:223], v[32:35]
    ds_read_b64_tr_b16 a[210:211], v2 offset:17408
    s_waitcnt lgkmcnt(5)
    v_mfma_f32_16x16x32_bf16 v[44:47], a[200:203], v[220:223], v[44:47]
    buffer_load_dwordx4 v165, s[36:39], s60 offen offset:1024 lds
    v_mfma_f32_16x16x32_bf16 v[48:51], a[200:203], v[224:227], v[48:51]
    s_add_u32 m0, s56, 92928
    s_add_u32 s57, s58, 524544
    s_and_b32 s57, s57, 0x3fffff
    v_mfma_f32_16x16x32_bf16 v[52:55], a[200:203], v[228:231], v[52:55]
    ds_read_b64_tr_b16 a[212:213], v2 offset:16928
    s_waitcnt lgkmcnt(4)
    v_mfma_f32_16x16x32_bf16 v[64:67], a[204:207], v[228:231], v[64:67]
    ds_read_b64_tr_b16 a[214:215], v2 offset:17440
    ds_read_b128 v[236:239], v176 offset:50688
    v_mfma_f32_16x16x32_bf16 v[60:63], a[204:207], v[224:227], v[60:63]
    buffer_load_dwordx4 v10, s[32:35], s57 offen offset:0 lds
    v_mfma_f32_16x16x32_bf16 v[56:59], a[204:207], v[220:223], v[56:59]
    ds_read_b64_tr_b16 a[216:217], v2 offset:16960
    s_waitcnt lgkmcnt(4)
    v_mfma_f32_16x16x32_bf16 a[0:3], a[208:211], v[220:223], a[0:3]
    ds_read_b64_tr_b16 a[218:219], v2 offset:17472
    ds_read_b128 v[240:243], v177 offset:0
    v_mfma_f32_16x16x32_bf16 a[4:7], a[208:211], v[224:227], a[4:7]
    buffer_load_dwordx4 v11, s[32:35], s57 offen offset:1056 lds
    v_mfma_f32_16x16x32_bf16 a[8:11], a[208:211], v[228:231], a[8:11]
    ds_read_b64_tr_b16 a[220:221], v2 offset:16992
    s_waitcnt lgkmcnt(5)
    v_mfma_f32_16x16x32_bf16 a[20:23], a[212:215], v[228:231], a[20:23]
    ds_read_b64_tr_b16 a[222:223], v2 offset:17504
    s_add_u32 m0, s56, 101376
    s_add_u32 s60, s60, 16384
    v_mfma_f32_16x16x32_bf16 a[16:19], a[212:215], v[224:227], a[16:19]
    ds_read_b64_tr_b16 a[224:225], v2 offset:17024
    ds_read_b128 v[244:247], v179 offset:42240
    v_mfma_f32_16x16x32_bf16 a[12:15], a[212:215], v[220:223], a[12:15]
    ds_read_b64_tr_b16 a[226:227], v2 offset:17536
    s_waitcnt lgkmcnt(6)
    v_mfma_f32_16x16x32_bf16 a[24:27], a[216:219], v[220:223], a[24:27]
    ds_read_b64_tr_b16 a[228:229], v2 offset:17056
    ds_read_b128 v[248:251], v179 offset:50688
    v_mfma_f32_16x16x32_bf16 a[28:31], a[216:219], v[224:227], a[28:31]
    ds_read_b64_tr_b16 a[230:231], v2 offset:17568
    buffer_load_dwordx4 v164, s[36:39], s60 offen offset:0 lds
    v_mfma_f32_16x16x32_bf16 a[32:35], a[216:219], v[228:231], a[32:35]
    ds_read_b64_tr_b16 a[192:193], v2 offset:17088
    s_waitcnt lgkmcnt(7)
    v_mfma_f32_16x16x32_bf16 a[44:47], a[220:223], v[228:231], a[44:47]
    ds_read_b64_tr_b16 a[194:195], v2 offset:17600
    ds_read_b128 v[252:255], v180 offset:0
    v_mfma_f32_16x16x32_bf16 a[40:43], a[220:223], v[224:227], a[40:43]
    buffer_load_dwordx4 v165, s[36:39], s60 offen offset:1024 lds
    v_mfma_f32_16x16x32_bf16 a[36:39], a[220:223], v[220:223], a[36:39]
    ds_read_b64_tr_b16 a[196:197], v2 offset:17120
    s_waitcnt lgkmcnt(7)
    v_mfma_f32_16x16x32_bf16 a[48:51], a[224:227], v[220:223], a[48:51]
    s_waitcnt vmcnt(6) lgkmcnt(10)
    s_barrier
    v_mfma_f32_16x16x32_bf16 a[52:55], a[224:227], v[224:227], a[52:55]
    ds_read_b64_tr_b16 a[198:199], v2 offset:17632
    ds_read_b128 v[68:71], v176 offset:8448
    v_mfma_f32_16x16x32_bf16 a[56:59], a[224:227], v[228:231], a[56:59]
    s_add_u32 m0, s56, 42240
    s_add_u32 s60, s59, 512
    s_and_b32 s60, s60, 1023
    s_waitcnt lgkmcnt(6)
    v_mfma_f32_16x16x32_bf16 a[68:71], a[228:231], v[228:231], a[68:71]
    buffer_load_dwordx4 v164, s[36:39], s60 offen offset:0 lds
    v_mfma_f32_16x16x32_bf16 a[64:67], a[228:231], v[224:227], a[64:67]
    ds_read_b64_tr_b16 a[200:201], v2 offset:25344
    ds_read_b128 v[72:75], v177 offset:8448
    v_mfma_f32_16x16x32_bf16 a[60:63], a[228:231], v[220:223], a[60:63]
    ds_read_b64_tr_b16 a[202:203], v2 offset:25856
    s_waitcnt lgkmcnt(7)
    v_mfma_f32_16x16x32_bf16 a[72:75], a[192:195], v[220:223], a[72:75]
    buffer_load_dwordx4 v165, s[36:39], s60 offen offset:1024 lds
    v_mfma_f32_16x16x32_bf16 a[76:79], a[192:195], v[224:227], a[76:79]
    s_add_u32 m0, s56, 59136
    s_add_u32 s57, s58, 786432
    s_and_b32 s57, s57, 0x3fffff
    v_mfma_f32_16x16x32_bf16 a[80:83], a[192:195], v[228:231], a[80:83]
    ds_read_b64_tr_b16 a[204:205], v2 offset:25376
    s_waitcnt lgkmcnt(5)
    v_mfma_f32_16x16x32_bf16 a[92:95], a[196:199], v[228:231], a[92:95]
    ds_read_b64_tr_b16 a[206:207], v2 offset:25888
    ds_read_b128 v[76:79], v176 offset:0
    v_mfma_f32_16x16x32_bf16 a[88:91], a[196:199], v[224:227], a[88:91]
    ds_read_b128 v[80:83], v179 offset:8448
    ds_read_b64_tr_b16 a[208:209], v2 offset:25408
    v_mfma_f32_16x16x32_bf16 a[84:87], a[196:199], v[220:223], a[84:87]
    buffer_load_dwordx4 v10, s[32:35], s57 offen offset:0 lds
    s_waitcnt lgkmcnt(5)
    v_mfma_f32_16x16x32_bf16 v[116:119], a[200:203], v[232:235], v[116:119]
    ds_read_b64_tr_b16 a[210:211], v2 offset:25920
    ds_read_b128 v[84:87], v180 offset:8448
    v_mfma_f32_16x16x32_bf16 v[120:123], a[200:203], v[236:239], v[120:123]
    ds_read_b64_tr_b16 a[212:213], v2 offset:25440
    ds_read_b128 v[88:91], v179 offset:0
    v_mfma_f32_16x16x32_bf16 v[124:127], a[200:203], v[240:243], v[124:127]
    ds_read_b64_tr_b16 a[214:215], v2 offset:25952
    s_waitcnt lgkmcnt(8)
    v_mfma_f32_16x16x32_bf16 v[136:139], a[204:207], v[240:243], v[136:139]
    buffer_load_dwordx4 v11, s[32:35], s57 offen offset:1056 lds
    v_mfma_f32_16x16x32_bf16 v[132:135], a[204:207], v[236:239], v[132:135]
    s_add_u32 m0, s56, 109824
    s_add_u32 s60, s60, 16384
    v_mfma_f32_16x16x32_bf16 v[128:131], a[204:207], v[232:235], v[128:131]
    ds_read_b64_tr_b16 a[216:217], v2 offset:25472
    s_waitcnt lgkmcnt(5)
    v_mfma_f32_16x16x32_bf16 v[140:143], a[208:211], v[232:235], v[140:143]
    ds_read_b64_tr_b16 a[218:219], v2 offset:25984
    ds_read_b128 v[92:95], v177 offset:16896
    v_mfma_f32_16x16x32_bf16 v[144:147], a[208:211], v[236:239], v[144:147]
    ds_read_b64_tr_b16 a[220:221], v2 offset:25504
    v_mfma_f32_16x16x32_bf16 v[148:151], a[208:211], v[240:243], v[148:151]
    ds_read_b64_tr_b16 a[222:223], v2 offset:26016
    s_waitcnt lgkmcnt(5)
    v_mfma_f32_16x16x32_bf16 v[160:163], a[212:215], v[240:243], v[160:163]
    buffer_load_dwordx4 v164, s[36:39], s60 offen offset:0 lds
    v_mfma_f32_16x16x32_bf16 v[156:159], a[212:215], v[236:239], v[156:159]
    ds_read_b64_tr_b16 a[224:225], v2 offset:25536
    v_mfma_f32_16x16x32_bf16 v[152:155], a[212:215], v[232:235], v[152:155]
    ds_read_b64_tr_b16 a[226:227], v2 offset:26048
    s_waitcnt lgkmcnt(5)
    v_mfma_f32_16x16x32_bf16 v[20:23], a[216:219], v[232:235], v[20:23]
    s_waitcnt vmcnt(5) lgkmcnt(7)
    s_barrier
    v_mfma_f32_16x16x32_bf16 v[24:27], a[216:219], v[236:239], v[24:27]
    buffer_load_dwordx4 v165, s[36:39], s60 offen offset:1024 lds
    v_mfma_f32_16x16x32_bf16 v[28:31], a[216:219], v[240:243], v[28:31]
    s_add_u32 m0, s56, 0
    s_add_u32 s60, s60, 16384
    s_waitcnt lgkmcnt(2)
    v_mfma_f32_16x16x32_bf16 v[40:43], a[220:223], v[240:243], v[40:43]
    ds_read_b64_tr_b16 a[228:229], v2 offset:25568
    ds_read_b64_tr_b16 a[230:231], v2 offset:26080
    v_mfma_f32_16x16x32_bf16 v[36:39], a[220:223], v[236:239], v[36:39]
    buffer_load_dwordx4 v164, s[36:39], s60 offen offset:0 lds
    v_mfma_f32_16x16x32_bf16 v[32:35], a[220:223], v[232:235], v[32:35]
    ds_read_b64_tr_b16 a[192:193], v3 offset:25344
    s_waitcnt lgkmcnt(3)
    v_mfma_f32_16x16x32_bf16 v[44:47], a[224:227], v[232:235], v[44:47]
    ds_read_b64_tr_b16 a[194:195], v3 offset:25856
    ds_read_b128 v[96:99], v176 offset:33792
    v_mfma_f32_16x16x32_bf16 v[48:51], a[224:227], v[236:239], v[48:51]
    buffer_load_dwordx4 v165, s[36:39], s60 offen offset:1024 lds
    v_mfma_f32_16x16x32_bf16 v[52:55], a[224:227], v[240:243], v[52:55]
    s_add_u32 m0, s56, 8448
    s_add_u32 s57, s58, 786688
    s_and_b32 s57, s57, 0x3fffff
    s_waitcnt lgkmcnt(3)
    v_mfma_f32_16x16x32_bf16 v[64:67], a[228:231], v[240:243], v[64:67]
    ds_read_b64_tr_b16 a[196:197], v3 offset:25376
    ds_read_b64_tr_b16 a[198:199], v3 offset:25888
    v_mfma_f32_16x16x32_bf16 v[60:63], a[228:231], v[236:239], v[60:63]
    buffer_load_dwordx4 v10, s[32:35], s57 offen offset:0 lds
    v_mfma_f32_16x16x32_bf16 v[56:59], a[228:231], v[232:235], v[56:59]
    ds_read_b64_tr_b16 a[200:201], v3 offset:25408
    s_waitcnt lgkmcnt(4)
    v_mfma_f32_16x16x32_bf16 a[0:3], a[192:195], v[232:235], a[0:3]
    ds_read_b64_tr_b16 a[202:203], v3 offset:25920
    ds_read_b128 v[100:103], v177 offset:33792
    v_mfma_f32_16x16x32_bf16 a[4:7], a[192:195], v[236:239], a[4:7]
    ds_read_b128 v[104:107], v180 offset:16896
    ds_read_b64_tr_b16 a[204:205], v3 offset:25440
    v_mfma_f32_16x16x32_bf16 a[8:11], a[192:195], v[240:243], a[8:11]
    ds_read_b64_tr_b16 a[206:207], v3 offset:25952
    s_waitcnt lgkmcnt(6)
    v_mfma_f32_16x16x32_bf16 a[20:23], a[196:199], v[240:243], a[20:23]
    buffer_load_dwordx4 v11, s[32:35], s57 offen offset:1056 lds
    v_mfma_f32_16x16x32_bf16 a[16:19], a[196:199], v[236:239], a[16:19]
    s_add_u32 m0, s56, 16896
    s_add_u32 s60, s59, 640
    s_and_b32 s60, s60, 1023
    v_mfma_f32_16x16x32_bf16 a[12:15], a[196:199], v[232:235], a[12:15]
    ds_read_b64_tr_b16 a[208:209], v3 offset:25472
    s_waitcnt lgkmcnt(5)
    v_mfma_f32_16x16x32_bf16 a[24:27], a[200:203], v[232:235], a[24:27]
    ds_read_b64_tr_b16 a[210:211], v3 offset:25984
    ds_read_b128 v[108:111], v179 offset:33792
    v_mfma_f32_16x16x32_bf16 a[28:31], a[200:203], v[236:239], a[28:31]
    buffer_load_dwordx4 v164, s[36:39], s60 offen offset:0 lds
    v_mfma_f32_16x16x32_bf16 a[32:35], a[200:203], v[240:243], a[32:35]
    ds_read_b64_tr_b16 a[212:213], v3 offset:25504
    s_waitcnt lgkmcnt(4)
    v_mfma_f32_16x16x32_bf16 a[44:47], a[204:207], v[240:243], a[44:47]
    ds_read_b64_tr_b16 a[214:215], v3 offset:26016
    ds_read_b128 v[112:115], v180 offset:33792
    v_mfma_f32_16x16x32_bf16 a[40:43], a[204:207], v[236:239], a[40:43]
    buffer_load_dwordx4 v165, s[36:39], s60 offen offset:1024 lds
    v_mfma_f32_16x16x32_bf16 a[36:39], a[204:207], v[232:235], a[36:39]
    s_add_u32 m0, s56, 50688
    s_add_u32 s60, s60, 16384
    s_waitcnt lgkmcnt(4)
    v_mfma_f32_16x16x32_bf16 a[48:51], a[208:211], v[232:235], a[48:51]
    ds_read_b64_tr_b16 a[216:217], v3 offset:25536
    ds_read_b64_tr_b16 a[218:219], v3 offset:26048
    s_waitcnt vmcnt(4) lgkmcnt(8)
    s_barrier
    v_mfma_f32_16x16x32_bf16 a[52:55], a[208:211], v[236:239], a[52:55]
    ds_read_b64_tr_b16 a[220:221], v3 offset:25568
    ds_read_b128 a[144:147], v176 offset:42240
    v_mfma_f32_16x16x32_bf16 a[56:59], a[208:211], v[240:243], a[56:59]
    ds_read_b64_tr_b16 a[222:223], v3 offset:26080
    s_waitcnt lgkmcnt(6)
    v_mfma_f32_16x16x32_bf16 a[68:71], a[212:215], v[240:243], a[68:71]
    buffer_load_dwordx4 v164, s[36:39], s60 offen offset:0 lds
    v_mfma_f32_16x16x32_bf16 a[64:67], a[212:215], v[236:239], a[64:67]
    ds_read_b64_tr_b16 a[224:225], v2 offset:59136
    ds_read_b128 a[148:151], v177 offset:42240
    v_mfma_f32_16x16x32_bf16 a[60:63], a[212:215], v[232:235], a[60:63]
    ds_read_b64_tr_b16 a[226:227], v2 offset:59648
    s_waitcnt lgkmcnt(6)
    v_mfma_f32_16x16x32_bf16 a[72:75], a[216:219], v[232:235], a[72:75]
    buffer_load_dwordx4 v165, s[36:39], s60 offen offset:1024 lds
    v_mfma_f32_16x16x32_bf16 a[76:79], a[216:219], v[236:239], a[76:79]
    s_add_u32 m0, s56, 25344
    s_add_u32 s57, s58, 1048576
    s_and_b32 s57, s57, 0x3fffff
    v_mfma_f32_16x16x32_bf16 a[80:83], a[216:219], v[240:243], a[80:83]
    ds_read_b64_tr_b16 a[228:229], v2 offset:59168
    s_waitcnt lgkmcnt(4)
    v_mfma_f32_16x16x32_bf16 a[92:95], a[220:223], v[240:243], a[92:95]
    ds_read_b64_tr_b16 a[230:231], v2 offset:59680
    ds_read_b128 a[152:155], v176 offset:0
    v_mfma_f32_16x16x32_bf16 a[88:91], a[220:223], v[236:239], a[88:91]
    buffer_load_dwordx4 v10, s[32:35], s57 offen offset:0 lds
    v_mfma_f32_16x16x32_bf16 a[84:87], a[220:223], v[232:235], a[84:87]
    ds_read_b64_tr_b16 a[192:193], v2 offset:59200
    s_waitcnt lgkmcnt(4)
    v_mfma_f32_16x16x32_bf16 v[116:119], a[224:227], v[244:247], v[116:119]
    ds_read_b64_tr_b16 a[194:195], v2 offset:59712
    ds_read_b128 a[156:159], v179 offset:42240
    v_mfma_f32_16x16x32_bf16 v[120:123], a[224:227], v[248:251], v[120:123]
    buffer_load_dwordx4 v11, s[32:35], s57 offen offset:1056 lds
    v_mfma_f32_16x16x32_bf16 v[124:127], a[224:227], v[252:255], v[124:127]
    s_add_u32 m0, s56, 67584
    s_add_u32 s60, s60, 16384
    s_waitcnt lgkmcnt(4)
    v_mfma_f32_16x16x32_bf16 v[136:139], a[228:231], v[252:255], v[136:139]
    ds_read_b64_tr_b16 a[196:197], v2 offset:59232
    ds_read_b64_tr_b16 a[198:199], v2 offset:59744
    v_mfma_f32_16x16x32_bf16 v[132:135], a[228:231], v[248:251], v[132:135]
    buffer_load_dwordx4 v164, s[36:39], s60 offen offset:0 lds
    v_mfma_f32_16x16x32_bf16 v[128:131], a[228:231], v[244:247], v[128:131]
    ds_read_b64_tr_b16 a[200:201], v2 offset:59264
    s_waitcnt lgkmcnt(4)
    v_mfma_f32_16x16x32_bf16 v[140:143], a[192:195], v[244:247], v[140:143]
    ds_read_b64_tr_b16 a[202:203], v2 offset:59776
    ds_read_b128 a[160:163], v180 offset:42240
    v_mfma_f32_16x16x32_bf16 v[144:147], a[192:195], v[248:251], v[144:147]
    buffer_load_dwordx4 v165, s[36:39], s60 offen offset:1024 lds
    v_mfma_f32_16x16x32_bf16 v[148:151], a[192:195], v[252:255], v[148:151]
    s_add_u32 m0, s56, 76032
    s_add_u32 s60, s59, 768
    s_and_b32 s60, s60, 1023
    s_waitcnt lgkmcnt(3)
    v_mfma_f32_16x16x32_bf16 v[160:163], a[196:199], v[252:255], v[160:163]
    ds_read_b64_tr_b16 a[204:205], v2 offset:59296
    ds_read_b64_tr_b16 a[206:207], v2 offset:59808
    v_mfma_f32_16x16x32_bf16 v[156:159], a[196:199], v[248:251], v[156:159]
    ds_read_b64_tr_b16 a[208:209], v2 offset:59328
    ds_read_b128 a[164:167], v179 offset:0
    v_mfma_f32_16x16x32_bf16 v[152:155], a[196:199], v[244:247], v[152:155]
    ds_read_b64_tr_b16 a[210:211], v2 offset:59840
    s_waitcnt lgkmcnt(6)
    v_mfma_f32_16x16x32_bf16 v[20:23], a[200:203], v[244:247], v[20:23]
    s_waitcnt vmcnt(4) lgkmcnt(8)
    s_barrier
    v_mfma_f32_16x16x32_bf16 v[24:27], a[200:203], v[248:251], v[24:27]
    buffer_load_dwordx4 v164, s[36:39], s60 offen offset:0 lds
    v_mfma_f32_16x16x32_bf16 v[28:31], a[200:203], v[252:255], v[28:31]
    ds_read_b64_tr_b16 a[212:213], v2 offset:59360
    s_waitcnt lgkmcnt(4)
    v_mfma_f32_16x16x32_bf16 v[40:43], a[204:207], v[252:255], v[40:43]
    ds_read_b64_tr_b16 a[214:215], v2 offset:59872
    ds_read_b128 a[168:171], v176 offset:16896
    v_mfma_f32_16x16x32_bf16 v[36:39], a[204:207], v[248:251], v[36:39]
    buffer_load_dwordx4 v165, s[36:39], s60 offen offset:1024 lds
    v_mfma_f32_16x16x32_bf16 v[32:35], a[204:207], v[244:247], v[32:35]
    s_add_u32 m0, s56, 33792
    s_add_u32 s57, s58, 1310720
    s_and_b32 s57, s57, 0x3fffff
    s_waitcnt lgkmcnt(3)
    v_mfma_f32_16x16x32_bf16 v[44:47], a[208:211], v[244:247], v[44:47]
    ds_read_b64_tr_b16 a[216:217], v2 offset:8448
    ds_read_b64_tr_b16 a[218:219], v2 offset:8960
    v_mfma_f32_16x16x32_bf16 v[48:51], a[208:211], v[248:251], v[48:51]
    buffer_load_dwordx4 v10, s[32:35], s57 offen offset:0 lds
    v_mfma_f32_16x16x32_bf16 v[52:55], a[208:211], v[252:255], v[52:55]
    ds_read_b64_tr_b16 a[220:221], v2 offset:8480
    s_waitcnt lgkmcnt(4)
    v_mfma_f32_16x16x32_bf16 v[64:67], a[212:215], v[252:255], v[64:67]
    ds_read_b64_tr_b16 a[222:223], v2 offset:8992
    ds_read_b128 a[172:175], v176 offset:50688
    v_mfma_f32_16x16x32_bf16 v[60:63], a[212:215], v[248:251], v[60:63]
    buffer_load_dwordx4 v11, s[32:35], s57 offen offset:1056 lds
    v_mfma_f32_16x16x32_bf16 v[56:59], a[212:215], v[244:247], v[56:59]
    s_add_u32 m0, s56, 42240
    s_add_u32 s60, s60, 16384
    s_waitcnt lgkmcnt(3)
    v_mfma_f32_16x16x32_bf16 a[0:3], a[216:219], v[244:247], a[0:3]
    ds_read_b64_tr_b16 a[224:225], v2 offset:8512
    ds_read_b64_tr_b16 a[226:227], v2 offset:9024
    v_mfma_f32_16x16x32_bf16 a[4:7], a[216:219], v[248:251], a[4:7]
    buffer_load_dwordx4 v164, s[36:39], s60 offen offset:0 lds
    v_mfma_f32_16x16x32_bf16 a[8:11], a[216:219], v[252:255], a[8:11]
    ds_read_b64_tr_b16 a[228:229], v2 offset:8544
    s_waitcnt lgkmcnt(4)
    v_mfma_f32_16x16x32_bf16 a[20:23], a[220:223], v[252:255], a[20:23]
    ds_read_b64_tr_b16 a[230:231], v2 offset:9056
    v_mfma_f32_16x16x32_bf16 a[16:19], a[220:223], v[248:251], a[16:19]
    buffer_load_dwordx4 v165, s[36:39], s60 offen offset:1024 lds
    v_mfma_f32_16x16x32_bf16 a[12:15], a[220:223], v[244:247], a[12:15]
    s_add_u32 m0, s56, 84480
    s_add_u32 s60, s60, 16384
    s_waitcnt lgkmcnt(2)
    v_mfma_f32_16x16x32_bf16 a[24:27], a[224:227], v[244:247], a[24:27]
    ds_read_b64_tr_b16 a[192:193], v2 offset:8576
    ds_read_b64_tr_b16 a[194:195], v2 offset:9088
    v_mfma_f32_16x16x32_bf16 a[28:31], a[224:227], v[248:251], a[28:31]
    buffer_load_dwordx4 v164, s[36:39], s60 offen offset:0 lds
    v_mfma_f32_16x16x32_bf16 a[32:35], a[224:227], v[252:255], a[32:35]
    ds_read_b64_tr_b16 a[196:197], v2 offset:8608
    s_waitcnt lgkmcnt(3)
    v_mfma_f32_16x16x32_bf16 a[44:47], a[228:231], v[252:255], a[44:47]
    ds_read_b64_tr_b16 a[198:199], v2 offset:9120
    v_mfma_f32_16x16x32_bf16 a[40:43], a[228:231], v[248:251], a[40:43]
    buffer_load_dwordx4 v165, s[36:39], s60 offen offset:1024 lds
    v_mfma_f32_16x16x32_bf16 a[36:39], a[228:231], v[244:247], a[36:39]
    ds_read_b64_tr_b16 a[200:201], v2 offset:8640
    s_waitcnt lgkmcnt(3)
    v_mfma_f32_16x16x32_bf16 a[48:51], a[192:195], v[244:247], a[48:51]
    ds_read_b64_tr_b16 a[202:203], v2 offset:9152
    s_waitcnt vmcnt(4) lgkmcnt(6)
    s_barrier
    v_mfma_f32_16x16x32_bf16 a[52:55], a[192:195], v[248:251], a[52:55]
    s_add_u32 m0, s56, 0
    s_add_u32 s57, s58, 1572864
    s_and_b32 s57, s57, 0x3fffff
    v_mfma_f32_16x16x32_bf16 a[56:59], a[192:195], v[252:255], a[56:59]
    ds_read_b64_tr_b16 a[204:205], v2 offset:8672
    s_waitcnt lgkmcnt(3)
    v_mfma_f32_16x16x32_bf16 a[68:71], a[196:199], v[252:255], a[68:71]
    ds_read_b64_tr_b16 a[206:207], v2 offset:9184
    ds_read_b128 a[176:179], v177 offset:0
    v_mfma_f32_16x16x32_bf16 a[64:67], a[196:199], v[248:251], a[64:67]
    buffer_load_dwordx4 v10, s[32:35], s57 offen offset:0 lds
    v_mfma_f32_16x16x32_bf16 a[60:63], a[196:199], v[244:247], a[60:63]
    ds_read_b128 a[180:183], v179 offset:16896
    s_waitcnt lgkmcnt(4)
    v_mfma_f32_16x16x32_bf16 a[72:75], a[200:203], v[244:247], a[72:75]
    ds_read_b64_tr_b16 a[208:209], v2 offset:25344
    ds_read_b64_tr_b16 a[210:211], v2 offset:25856
    v_mfma_f32_16x16x32_bf16 a[76:79], a[200:203], v[248:251], a[76:79]
    ds_read_b64_tr_b16 a[212:213], v2 offset:33792
    ds_read_b64_tr_b16 a[214:215], v2 offset:34304
    v_mfma_f32_16x16x32_bf16 a[80:83], a[200:203], v[252:255], a[80:83]
    ds_read_b128 a[184:187], v179 offset:50688
    s_waitcnt lgkmcnt(7)
    v_mfma_f32_16x16x32_bf16 a[92:95], a[204:207], v[252:255], a[92:95]
    buffer_load_dwordx4 v11, s[32:35], s57 offen offset:1056 lds
    v_mfma_f32_16x16x32_bf16 a[88:91], a[204:207], v[248:251], a[88:91]
    s_add_u32 m0, s56, 59136
    s_add_u32 s60, s59, 896
    s_and_b32 s60, s60, 1023
    v_mfma_f32_16x16x32_bf16 a[84:87], a[204:207], v[244:247], a[84:87]
    ds_read_b64_tr_b16 a[216:217], v2 offset:25376
    s_waitcnt lgkmcnt(4)
    v_mfma_f32_16x16x32_bf16 v[116:119], a[208:211], v[68:71], v[116:119]
    ds_read_b64_tr_b16 a[218:219], v2 offset:25888
    s_waitcnt lgkmcnt(3)
    v_mfma_f32_16x16x32_bf16 v[116:119], a[212:215], v[80:83], v[116:119]
    ds_read_b64_tr_b16 a[220:221], v2 offset:33824
    ds_read_b64_tr_b16 a[222:223], v2 offset:34336
    v_mfma_f32_16x16x32_bf16 v[120:123], a[212:215], v[84:87], v[120:123]
    buffer_load_dwordx4 v164, s[36:39], s60 offen offset:0 lds
    v_mfma_f32_16x16x32_bf16 v[120:123], a[208:211], v[72:75], v[120:123]
    ds_read_b64_tr_b16 a[224:225], v2 offset:25408
    ds_read_b128 a[188:191], v180 offset:0
    v_mfma_f32_16x16x32_bf16 v[124:127], a[208:211], v[76:79], v[124:127]
    ds_read_b64_tr_b16 a[226:227], v2 offset:25920
    ds_read_b128 a[96:99], v177 offset:8448
    v_mfma_f32_16x16x32_bf16 v[124:127], a[212:215], v[88:91], v[124:127]
    ds_read_b64_tr_b16 a[228:229], v2 offset:33856
    s_waitcnt lgkmcnt(7)
    v_mfma_f32_16x16x32_bf16 v[128:131], a[216:219], v[68:71], v[128:131]
    ds_read_b64_tr_b16 a[230:231], v2 offset:34368
    s_waitcnt lgkmcnt(6)
    v_mfma_f32_16x16x32_bf16 v[128:131], a[220:223], v[80:83], v[128:131]
    buffer_load_dwordx4 v165, s[36:39], s60 offen offset:1024 lds
    v_mfma_f32_16x16x32_bf16 v[132:135], a[220:223], v[84:87], v[132:135]
    s_add_u32 m0, s56, 92928
    s_add_u32 s60, s60, 16384
    v_mfma_f32_16x16x32_bf16 v[132:135], a[216:219], v[72:75], v[132:135]
    buffer_load_dwordx4 v164, s[36:39], s60 offen offset:0 lds
    v_mfma_f32_16x16x32_bf16 v[136:139], a[216:219], v[76:79], v[136:139]
    ds_read_b64_tr_b16 a[192:193], v2 offset:25440
    v_mfma_f32_16x16x32_bf16 v[136:139], a[220:223], v[88:91], v[136:139]
    ds_read_b64_tr_b16 a[194:195], v2 offset:25952
    s_waitcnt lgkmcnt(5)
    v_mfma_f32_16x16x32_bf16 v[140:143], a[224:227], v[68:71], v[140:143]
    s_waitcnt vmcnt(5) lgkmcnt(2)
    s_barrier
    v_mfma_f32_16x16x32_bf16 v[140:143], a[228:231], v[80:83], v[140:143]
    ds_read_b64_tr_b16 a[196:197], v2 offset:33888
    ds_read_b64_tr_b16 a[198:199], v2 offset:34400
    v_mfma_f32_16x16x32_bf16 v[144:147], a[228:231], v[84:87], v[144:147]
    buffer_load_dwordx4 v165, s[36:39], s60 offen offset:1024 lds
    v_mfma_f32_16x16x32_bf16 v[144:147], a[224:227], v[72:75], v[144:147]
    s_add_u32 m0, s56, 8448
    s_add_u32 s57, s58, 1835008
    s_and_b32 s57, s57, 0x3fffff
    v_mfma_f32_16x16x32_bf16 v[148:151], a[224:227], v[76:79], v[148:151]
    buffer_load_dwordx4 v10, s[32:35], s57 offen offset:0 lds
    v_mfma_f32_16x16x32_bf16 v[148:151], a[228:231], v[88:91], v[148:151]
    ds_read_b64_tr_b16 a[200:201], v2 offset:25472
    s_waitcnt lgkmcnt(3)
    v_mfma_f32_16x16x32_bf16 v[152:155], a[192:195], v[68:71], v[152:155]
    ds_read_b64_tr_b16 a[202:203], v2 offset:25984
    s_waitcnt lgkmcnt(2)
    v_mfma_f32_16x16x32_bf16 v[152:155], a[196:199], v[80:83], v[152:155]
    ds_read_b64_tr_b16 a[204:205], v2 offset:33920
    ds_read_b64_tr_b16 a[206:207], v2 offset:34432
    v_mfma_f32_16x16x32_bf16 v[156:159], a[196:199], v[84:87], v[156:159]
    buffer_load_dwordx4 v11, s[32:35], s57 offen offset:1056 lds
    v_mfma_f32_16x16x32_bf16 v[156:159], a[192:195], v[72:75], v[156:159]
    s_add_u32 m0, s56, 16896
    s_add_u32 s60, s60, 16384
    v_mfma_f32_16x16x32_bf16 v[160:163], a[192:195], v[76:79], v[160:163]
    s_mov_b64 exec, 1
    buffer_store_byte a246, v13, s[44:47], s76 offen offset:0 sc1
    buffer_store_byte a246, v13, s[44:47], s17 offen offset:0 sc1
    s_mov_b64 exec, -1
    v_mfma_f32_16x16x32_bf16 v[160:163], a[196:199], v[88:91], v[160:163]
    ds_read_b64_tr_b16 a[208:209], v2 offset:25504
    s_waitcnt lgkmcnt(3)
    v_mfma_f32_16x16x32_bf16 v[20:23], a[200:203], v[68:71], v[20:23]
    ds_read_b64_tr_b16 a[210:211], v2 offset:26016
    s_waitcnt lgkmcnt(2)
    v_mfma_f32_16x16x32_bf16 v[20:23], a[204:207], v[80:83], v[20:23]
    ds_read_b64_tr_b16 a[212:213], v2 offset:33952
    ds_read_b64_tr_b16 a[214:215], v2 offset:34464
    v_mfma_f32_16x16x32_bf16 v[24:27], a[204:207], v[84:87], v[24:27]
    buffer_load_dwordx4 v164, s[36:39], s60 offen offset:0 lds
    v_mfma_f32_16x16x32_bf16 v[24:27], a[200:203], v[72:75], v[24:27]
    ds_read_b64_tr_b16 a[216:217], v2 offset:25536
    ds_read_b128 a[100:103], v176 offset:42240
    v_mfma_f32_16x16x32_bf16 v[28:31], a[200:203], v[76:79], v[28:31]
    ds_read_b64_tr_b16 a[218:219], v2 offset:26048
    ds_read_b128 a[104:107], v177 offset:16896
    v_mfma_f32_16x16x32_bf16 v[28:31], a[204:207], v[88:91], v[28:31]
    ds_read_b128 a[108:111], v180 offset:8448
    s_waitcnt lgkmcnt(7)
    v_mfma_f32_16x16x32_bf16 v[32:35], a[208:211], v[68:71], v[32:35]
    ds_read_b64_tr_b16 a[220:221], v2 offset:33984
    s_waitcnt lgkmcnt(6)
    v_mfma_f32_16x16x32_bf16 v[32:35], a[212:215], v[80:83], v[32:35]
    ds_read_b64_tr_b16 a[222:223], v2 offset:34496
    ds_read_b128 a[112:115], v179 offset:42240
    v_mfma_f32_16x16x32_bf16 v[36:39], a[212:215], v[84:87], v[36:39]
    buffer_load_dwordx4 v165, s[36:39], s60 offen offset:1024 lds
    v_mfma_f32_16x16x32_bf16 v[36:39], a[208:211], v[72:75], v[36:39]
    s_add_u32 m0, s56, 50688
    s_add_u32 s57, s58, 2097152
    s_and_b32 s57, s57, 0x3fffff
    v_mfma_f32_16x16x32_bf16 v[40:43], a[208:211], v[76:79], v[40:43]
    buffer_load_dwordx4 v10, s[32:35], s57 offen offset:0 lds
    v_mfma_f32_16x16x32_bf16 v[40:43], a[212:215], v[88:91], v[40:43]
    ds_read_b64_tr_b16 a[224:225], v2 offset:25568
    s_waitcnt lgkmcnt(6)
    v_mfma_f32_16x16x32_bf16 v[44:47], a[216:219], v[68:71], v[44:47]
    ds_read_b64_tr_b16 a[226:227], v2 offset:26080
    s_waitcnt vmcnt(5) lgkmcnt(3)
    s_barrier
    v_mfma_f32_16x16x32_bf16 v[44:47], a[220:223], v[80:83], v[44:47]
    ds_read_b64_tr_b16 a[228:229], v2 offset:34016
    ds_read_b64_tr_b16 a[230:231], v2 offset:34528
    v_mfma_f32_16x16x32_bf16 v[48:51], a[220:223], v[84:87], v[48:51]
    buffer_load_dwordx4 v11, s[32:35], s57 offen offset:1056 lds
    v_mfma_f32_16x16x32_bf16 v[48:51], a[216:219], v[72:75], v[48:51]
    s_add_u32 m0, s56, 67584
    s_add_u32 s57, s58, 2359296
    s_and_b32 s57, s57, 0x3fffff
    v_mfma_f32_16x16x32_bf16 v[52:55], a[216:219], v[76:79], v[52:55]
    buffer_load_dwordx4 v10, s[32:35], s57 offen offset:0 lds
    v_mfma_f32_16x16x32_bf16 v[52:55], a[220:223], v[88:91], v[52:55]
    ds_read_b128 a[116:119], v180 offset:16896
    s_waitcnt lgkmcnt(3)
    v_mfma_f32_16x16x32_bf16 v[56:59], a[224:227], v[68:71], v[56:59]
    ds_read_b64_tr_b16 a[192:193], v2 offset:0
    ds_read_b64_tr_b16 a[194:195], v2 offset:512
    s_waitcnt lgkmcnt(3)
    v_mfma_f32_16x16x32_bf16 v[56:59], a[228:231], v[80:83], v[56:59]
    ds_read_b64_tr_b16 a[196:197], v2 offset:8448
    ds_read_b64_tr_b16 a[198:199], v2 offset:8960
    v_mfma_f32_16x16x32_bf16 v[60:63], a[228:231], v[84:87], v[60:63]
    buffer_load_dwordx4 v11, s[32:35], s57 offen offset:1056 lds
    v_mfma_f32_16x16x32_bf16 v[60:63], a[224:227], v[72:75], v[60:63]
    s_add_u32 m0, s56, 76032
    s_add_u32 s57, s58, 2621440
    s_and_b32 s57, s57, 0x3fffff
    v_mfma_f32_16x16x32_bf16 v[64:67], a[224:227], v[76:79], v[64:67]
    buffer_load_dwordx4 v10, s[32:35], s57 offen offset:0 lds
    v_mfma_f32_16x16x32_bf16 v[64:67], a[228:231], v[88:91], v[64:67]
    ds_read_b64_tr_b16 a[200:201], v2 offset:32
    s_waitcnt lgkmcnt(3)
    v_mfma_f32_16x16x32_bf16 v[116:119], a[192:195], v[92:95], v[116:119]
    ds_read_b64_tr_b16 a[202:203], v2 offset:544
    s_waitcnt lgkmcnt(2)
    v_mfma_f32_16x16x32_bf16 v[116:119], a[196:199], v[104:107], v[116:119]
    ds_read_b64_tr_b16 a[204:205], v2 offset:8480
    ds_read_b64_tr_b16 a[206:207], v2 offset:8992
    v_mfma_f32_16x16x32_bf16 v[120:123], a[196:199], v[108:111], v[120:123]
    buffer_load_dwordx4 v11, s[32:35], s57 offen offset:1056 lds
    v_mfma_f32_16x16x32_bf16 v[120:123], a[192:195], v[96:99], v[120:123]
    s_add_u32 m0, s56, 101376
    s_add_u32 s57, s58, 2883584
    s_and_b32 s57, s57, 0x3fffff
    v_mfma_f32_16x16x32_bf16 v[124:127], a[192:195], v[100:103], v[124:127]
    buffer_load_dwordx4 v10, s[32:35], s57 offen offset:0 lds
    v_mfma_f32_16x16x32_bf16 v[124:127], a[196:199], v[112:115], v[124:127]
    ds_read_b64_tr_b16 a[208:209], v2 offset:64
    s_waitcnt lgkmcnt(3)
    v_mfma_f32_16x16x32_bf16 v[128:131], a[200:203], v[92:95], v[128:131]
    ds_read_b64_tr_b16 a[210:211], v2 offset:576
    s_waitcnt lgkmcnt(2)
    v_mfma_f32_16x16x32_bf16 v[128:131], a[204:207], v[104:107], v[128:131]
    ds_read_b64_tr_b16 a[212:213], v2 offset:8512
    ds_read_b64_tr_b16 a[214:215], v2 offset:9024
    v_mfma_f32_16x16x32_bf16 v[132:135], a[204:207], v[108:111], v[132:135]
    buffer_load_dwordx4 v11, s[32:35], s57 offen offset:1056 lds
    v_mfma_f32_16x16x32_bf16 v[132:135], a[200:203], v[96:99], v[132:135]
    s_add_u32 m0, s56, 109824
    s_add_u32 s57, s58, 3145728
    s_and_b32 s57, s57, 0x3fffff
    v_mfma_f32_16x16x32_bf16 v[136:139], a[200:203], v[100:103], v[136:139]
    buffer_load_dwordx4 v10, s[32:35], s57 offen offset:0 lds
    v_mfma_f32_16x16x32_bf16 v[136:139], a[204:207], v[112:115], v[136:139]
    ds_read_b64_tr_b16 a[216:217], v2 offset:96
    s_waitcnt lgkmcnt(3)
    v_mfma_f32_16x16x32_bf16 v[140:143], a[208:211], v[92:95], v[140:143]
    ds_read_b64_tr_b16 a[218:219], v2 offset:608
    s_waitcnt vmcnt(9) lgkmcnt(2)
    s_barrier
    v_mfma_f32_16x16x32_bf16 v[140:143], a[212:215], v[104:107], v[140:143]
    ds_read_b64_tr_b16 a[220:221], v2 offset:8544
    ds_read_b64_tr_b16 a[222:223], v2 offset:9056
    v_mfma_f32_16x16x32_bf16 v[144:147], a[212:215], v[108:111], v[144:147]
    buffer_load_dwordx4 v11, s[32:35], s57 offen offset:1056 lds
    v_mfma_f32_16x16x32_bf16 v[144:147], a[208:211], v[96:99], v[144:147]
    s_add_u32 m0, s56, 25344
    s_mov_b32 s57, 0
    v_mfma_f32_16x16x32_bf16 v[148:151], a[208:211], v[100:103], v[148:151]
    buffer_load_dwordx4 v8, s[24:27], s57 offen offset:0 nt lds
    v_mfma_f32_16x16x32_bf16 v[148:151], a[212:215], v[112:115], v[148:151]
    ds_read_b128 a[120:123], v176 offset:59136
    s_waitcnt lgkmcnt(3)
    v_mfma_f32_16x16x32_bf16 v[152:155], a[216:219], v[92:95], v[152:155]
    ds_read_b64_tr_b16 a[224:225], v2 offset:128
    ds_read_b64_tr_b16 a[226:227], v2 offset:640
    s_waitcnt lgkmcnt(3)
    v_mfma_f32_16x16x32_bf16 v[152:155], a[220:223], v[104:107], v[152:155]
    ds_read_b64_tr_b16 a[228:229], v2 offset:8576
    ds_read_b64_tr_b16 a[230:231], v2 offset:9088
    v_mfma_f32_16x16x32_bf16 v[156:159], a[220:223], v[108:111], v[156:159]
    buffer_load_dwordx4 v9, s[24:27], s57 offen offset:1056 nt lds
    v_mfma_f32_16x16x32_bf16 v[156:159], a[216:219], v[96:99], v[156:159]
    s_add_u32 m0, s56, 33792
    s_add_u32 s57, s58, 3407872
    s_and_b32 s57, s57, 0x3fffff
    v_mfma_f32_16x16x32_bf16 v[160:163], a[216:219], v[100:103], v[160:163]
    buffer_load_dwordx4 v10, s[32:35], s57 offen offset:0 lds
    v_mfma_f32_16x16x32_bf16 v[160:163], a[220:223], v[112:115], v[160:163]
    ds_read_b128 a[124:127], v177 offset:25344
    s_waitcnt lgkmcnt(3)
    v_mfma_f32_16x16x32_bf16 v[20:23], a[224:227], v[92:95], v[20:23]
    ds_read_b64_tr_b16 a[192:193], v2 offset:160
    ds_read_b64_tr_b16 a[194:195], v2 offset:672
    s_waitcnt lgkmcnt(3)
    v_mfma_f32_16x16x32_bf16 v[20:23], a[228:231], v[104:107], v[20:23]
    ds_read_b64_tr_b16 a[196:197], v2 offset:8608
    ds_read_b64_tr_b16 a[198:199], v2 offset:9120
    v_mfma_f32_16x16x32_bf16 v[24:27], a[228:231], v[108:111], v[24:27]
    buffer_load_dwordx4 v11, s[32:35], s57 offen offset:1056 lds
    v_mfma_f32_16x16x32_bf16 v[24:27], a[224:227], v[96:99], v[24:27]
    s_add_u32 m0, s56, 42240
    s_mov_b32 s57, 8192
    v_mfma_f32_16x16x32_bf16 v[28:31], a[224:227], v[100:103], v[28:31]
    buffer_load_dwordx4 v8, s[24:27], s57 offen offset:0 nt lds
    v_mfma_f32_16x16x32_bf16 v[28:31], a[228:231], v[112:115], v[28:31]
    ds_read_b64_tr_b16 a[200:201], v2 offset:192
    s_waitcnt lgkmcnt(3)
    v_mfma_f32_16x16x32_bf16 v[32:35], a[192:195], v[92:95], v[32:35]
    ds_read_b64_tr_b16 a[202:203], v2 offset:704
    s_waitcnt lgkmcnt(2)
    v_mfma_f32_16x16x32_bf16 v[32:35], a[196:199], v[104:107], v[32:35]
    ds_read_b64_tr_b16 a[204:205], v2 offset:8640
    ds_read_b64_tr_b16 a[206:207], v2 offset:9152
    v_mfma_f32_16x16x32_bf16 v[36:39], a[196:199], v[108:111], v[36:39]
    buffer_load_dwordx4 v9, s[24:27], s57 offen offset:1056 nt lds
    v_mfma_f32_16x16x32_bf16 v[36:39], a[192:195], v[96:99], v[36:39]
    s_add_u32 m0, s56, 84480
    s_add_u32 s57, s58, 3670016
    s_and_b32 s57, s57, 0x3fffff
    v_mfma_f32_16x16x32_bf16 v[40:43], a[192:195], v[100:103], v[40:43]
    buffer_load_dwordx4 v10, s[32:35], s57 offen offset:0 lds
    v_mfma_f32_16x16x32_bf16 v[40:43], a[196:199], v[112:115], v[40:43]
    ds_read_b64_tr_b16 a[208:209], v2 offset:224
    s_waitcnt lgkmcnt(3)
    v_mfma_f32_16x16x32_bf16 v[44:47], a[200:203], v[92:95], v[44:47]
    ds_read_b64_tr_b16 a[210:211], v2 offset:736
    s_waitcnt vmcnt(13) lgkmcnt(2)
    s_barrier
    v_mfma_f32_16x16x32_bf16 v[44:47], a[204:207], v[104:107], v[44:47]
    ds_read_b64_tr_b16 a[212:213], v2 offset:8672
    ds_read_b64_tr_b16 a[214:215], v2 offset:9184
    v_mfma_f32_16x16x32_bf16 v[48:51], a[204:207], v[108:111], v[48:51]
    buffer_load_dwordx4 v11, s[32:35], s57 offen offset:1056 lds
    v_mfma_f32_16x16x32_bf16 v[48:51], a[200:203], v[96:99], v[48:51]
    s_add_u32 m0, s56, 118272
    s_mov_b32 s57, 0
    v_mfma_f32_16x16x32_bf16 v[52:55], a[200:203], v[100:103], v[52:55]
    buffer_load_dwordx4 v8, s[28:31], s57 offen offset:0 nt lds
    v_mfma_f32_16x16x32_bf16 v[52:55], a[204:207], v[112:115], v[52:55]
    ds_read_b128 a[128:131], v176 offset:16896
    s_waitcnt lgkmcnt(3)
    v_mfma_f32_16x16x32_bf16 v[56:59], a[208:211], v[92:95], v[56:59]
    ds_read_b64_tr_b16 a[216:217], v2 offset:50688
    ds_read_b64_tr_b16 a[218:219], v2 offset:51200
    s_waitcnt lgkmcnt(3)
    v_mfma_f32_16x16x32_bf16 v[56:59], a[212:215], v[104:107], v[56:59]
    ds_read_b64_tr_b16 a[220:221], v3 offset:0
    ds_read_b64_tr_b16 a[222:223], v3 offset:512
    v_mfma_f32_16x16x32_bf16 v[60:63], a[212:215], v[108:111], v[60:63]
    ds_read_b128 a[132:135], v179 offset:59136
    ds_read_b128 a[136:139], v180 offset:25344
    v_mfma_f32_16x16x32_bf16 v[60:63], a[208:211], v[96:99], v[60:63]
    buffer_load_dwordx4 v9, s[28:31], s57 offen offset:1056 nt lds
    v_mfma_f32_16x16x32_bf16 v[64:67], a[208:211], v[100:103], v[64:67]
    s_add_u32 m0, s56, 126720
    s_mov_b32 s57, 16384
    v_mfma_f32_16x16x32_bf16 v[64:67], a[212:215], v[112:115], v[64:67]
    ds_read_b128 a[140:143], v179 offset:16896
    s_waitcnt lgkmcnt(5)
    v_mfma_f32_16x16x32_bf16 v[116:119], a[216:219], a[144:147], v[116:119]
    ds_read_b64_tr_b16 a[224:225], v2 offset:50720
    ds_read_b64_tr_b16 a[226:227], v2 offset:51232
    s_waitcnt lgkmcnt(5)
    v_mfma_f32_16x16x32_bf16 v[116:119], a[220:223], a[156:159], v[116:119]
    ds_read_b64_tr_b16 a[228:229], v3 offset:32
    ds_read_b64_tr_b16 a[230:231], v3 offset:544
    v_mfma_f32_16x16x32_bf16 v[120:123], a[220:223], a[160:163], v[120:123]
    buffer_load_dwordx4 v8, s[24:27], s57 offen offset:0 nt lds
    v_mfma_f32_16x16x32_bf16 v[120:123], a[216:219], a[148:151], v[120:123]
    ds_read_b64_tr_b16 a[192:193], v2 offset:50752
    v_mfma_f32_16x16x32_bf16 v[124:127], a[216:219], a[152:155], v[124:127]
    ds_read_b64_tr_b16 a[194:195], v2 offset:51264
    v_mfma_f32_16x16x32_bf16 v[124:127], a[220:223], a[164:167], v[124:127]
    ds_read_b64_tr_b16 a[196:197], v3 offset:64
    s_waitcnt lgkmcnt(5)
    v_mfma_f32_16x16x32_bf16 v[128:131], a[224:227], a[144:147], v[128:131]
    ds_read_b64_tr_b16 a[198:199], v3 offset:576
    s_waitcnt lgkmcnt(4)
    v_mfma_f32_16x16x32_bf16 v[128:131], a[228:231], a[156:159], v[128:131]
    buffer_load_dwordx4 v9, s[24:27], s57 offen offset:1056 nt lds
    v_mfma_f32_16x16x32_bf16 v[132:135], a[228:231], a[160:163], v[132:135]
    s_add_u32 m0, s56, 135168
    s_add_u32 s57, s58, 3932160
    s_and_b32 s57, s57, 0x3fffff
    v_mfma_f32_16x16x32_bf16 v[132:135], a[224:227], a[148:151], v[132:135]
    buffer_load_dwordx4 v10, s[32:35], s57 offen offset:0 lds
    v_mfma_f32_16x16x32_bf16 v[136:139], a[224:227], a[152:155], v[136:139]
    ds_read_b64_tr_b16 a[200:201], v2 offset:50784
    v_mfma_f32_16x16x32_bf16 v[136:139], a[228:231], a[164:167], v[136:139]
    ds_read_b64_tr_b16 a[202:203], v2 offset:51296
    s_waitcnt lgkmcnt(4)
    v_mfma_f32_16x16x32_bf16 v[140:143], a[192:195], a[144:147], v[140:143]
    ds_read_b64_tr_b16 a[204:205], v3 offset:96
    s_waitcnt lgkmcnt(3)
    v_mfma_f32_16x16x32_bf16 v[140:143], a[196:199], a[156:159], v[140:143]
    ds_read_b64_tr_b16 a[206:207], v3 offset:608
    v_mfma_f32_16x16x32_bf16 v[144:147], a[196:199], a[160:163], v[144:147]
    buffer_load_dwordx4 v11, s[32:35], s57 offen offset:1056 lds
    v_mfma_f32_16x16x32_bf16 v[144:147], a[192:195], a[148:151], v[144:147]
    s_add_u32 m0, s56, 143616
    s_add_u32 s57, s58, 1048832
    s_and_b32 s57, s57, 0x3fffff
    v_mfma_f32_16x16x32_bf16 v[148:151], a[192:195], a[152:155], v[148:151]
    buffer_load_dwordx4 v10, s[32:35], s57 offen offset:0 lds
    v_mfma_f32_16x16x32_bf16 v[148:151], a[196:199], a[164:167], v[148:151]
    ds_read_b64_tr_b16 a[208:209], v2 offset:50816
    s_waitcnt lgkmcnt(3)
    v_mfma_f32_16x16x32_bf16 v[152:155], a[200:203], a[144:147], v[152:155]
    ds_read_b64_tr_b16 a[210:211], v2 offset:51328
    s_waitcnt lgkmcnt(2)
    v_mfma_f32_16x16x32_bf16 v[152:155], a[204:207], a[156:159], v[152:155]
    ds_read_b64_tr_b16 a[212:213], v3 offset:128
    ds_read_b64_tr_b16 a[214:215], v3 offset:640
    v_mfma_f32_16x16x32_bf16 v[156:159], a[204:207], a[160:163], v[156:159]
    buffer_load_dwordx4 v11, s[32:35], s57 offen offset:1056 lds
    v_mfma_f32_16x16x32_bf16 v[156:159], a[200:203], a[148:151], v[156:159]
    s_add_u32 m0, s56, 152064
    s_add_u32 s57, s58, 1310976
    s_and_b32 s57, s57, 0x3fffff
    v_mfma_f32_16x16x32_bf16 v[160:163], a[200:203], a[152:155], v[160:163]
    buffer_load_dwordx4 v10, s[32:35], s57 offen offset:0 lds
    v_mfma_f32_16x16x32_bf16 v[160:163], a[204:207], a[164:167], v[160:163]
    ds_read_b64_tr_b16 a[216:217], v2 offset:50848
    s_waitcnt lgkmcnt(3)
    v_mfma_f32_16x16x32_bf16 v[20:23], a[208:211], a[144:147], v[20:23]
    ds_read_b64_tr_b16 a[218:219], v2 offset:51360
    s_waitcnt lgkmcnt(2)
    v_mfma_f32_16x16x32_bf16 v[20:23], a[212:215], a[156:159], v[20:23]
    ds_read_b64_tr_b16 a[220:221], v3 offset:160
    ds_read_b64_tr_b16 a[222:223], v3 offset:672
    v_mfma_f32_16x16x32_bf16 v[24:27], a[212:215], a[160:163], v[24:27]
    buffer_load_dwordx4 v11, s[32:35], s57 offen offset:1056 lds
    v_mfma_f32_16x16x32_bf16 v[24:27], a[208:211], a[148:151], v[24:27]
    ds_read_b64_tr_b16 a[224:225], v2 offset:50880
    v_mfma_f32_16x16x32_bf16 v[28:31], a[208:211], a[152:155], v[28:31]
    ds_read_b64_tr_b16 a[226:227], v2 offset:51392
    v_mfma_f32_16x16x32_bf16 v[28:31], a[212:215], a[164:167], v[28:31]
    ds_read_b64_tr_b16 a[228:229], v3 offset:192
    s_waitcnt lgkmcnt(5)
    v_mfma_f32_16x16x32_bf16 v[32:35], a[216:219], a[144:147], v[32:35]
    ds_read_b64_tr_b16 a[230:231], v3 offset:704
    s_waitcnt lgkmcnt(4)
    v_mfma_f32_16x16x32_bf16 v[32:35], a[220:223], a[156:159], v[32:35]
    ds_read_b64_tr_b16 a[192:193], v2 offset:50912
    v_mfma_f32_16x16x32_bf16 v[36:39], a[220:223], a[160:163], v[36:39]
    ds_read_b64_tr_b16 a[194:195], v2 offset:51424
    v_mfma_f32_16x16x32_bf16 v[36:39], a[216:219], a[148:151], v[36:39]
    ds_read_b64_tr_b16 a[196:197], v3 offset:224
    v_mfma_f32_16x16x32_bf16 v[40:43], a[216:219], a[152:155], v[40:43]
    ds_read_b64_tr_b16 a[198:199], v3 offset:736
    v_mfma_f32_16x16x32_bf16 v[40:43], a[220:223], a[164:167], v[40:43]
    s_waitcnt lgkmcnt(6)
    v_mfma_f32_16x16x32_bf16 v[44:47], a[224:227], a[144:147], v[44:47]
    s_waitcnt vmcnt(20) lgkmcnt(4)
    s_barrier
    v_mfma_f32_16x16x32_bf16 v[44:47], a[228:231], a[156:159], v[44:47]
    s_add_u32 m0, s56, 0
    s_mov_b32 s57, 8192
    v_mfma_f32_16x16x32_bf16 v[48:51], a[228:231], a[160:163], v[48:51]
    buffer_load_dwordx4 v8, s[28:31], s57 offen offset:0 nt lds
    v_mfma_f32_16x16x32_bf16 v[48:51], a[224:227], a[148:151], v[48:51]
    v_mov_b32 v14, s9
    s_mov_b64 exec, s[80:81]
    buffer_store_byte v14, v13, s[48:51], s73 offen sc1
    s_mov_b64 exec, -1
    v_mfma_f32_16x16x32_bf16 v[52:55], a[224:227], a[152:155], v[52:55]
    ds_read_b64_tr_b16 a[200:201], v3 offset:8448
    v_mfma_f32_16x16x32_bf16 v[52:55], a[228:231], a[164:167], v[52:55]
    ds_read_b64_tr_b16 a[202:203], v3 offset:8960
    s_waitcnt lgkmcnt(4)
    v_mfma_f32_16x16x32_bf16 v[56:59], a[192:195], a[144:147], v[56:59]
    ds_read_b64_tr_b16 a[204:205], v3 offset:33792
    s_waitcnt lgkmcnt(3)
    v_mfma_f32_16x16x32_bf16 v[56:59], a[196:199], a[156:159], v[56:59]
    ds_read_b64_tr_b16 a[206:207], v3 offset:34304
    v_mfma_f32_16x16x32_bf16 v[60:63], a[196:199], a[160:163], v[60:63]
    buffer_load_dwordx4 v9, s[28:31], s57 offen offset:1056 nt lds
    v_mfma_f32_16x16x32_bf16 v[60:63], a[192:195], a[148:151], v[60:63]
    s_add_u32 m0, s56, 8448
    s_mov_b32 s57, 24576
    v_mfma_f32_16x16x32_bf16 v[64:67], a[192:195], a[152:155], v[64:67]
    buffer_load_dwordx4 v8, s[24:27], s57 offen offset:0 nt lds
    v_mfma_f32_16x16x32_bf16 v[64:67], a[196:199], a[164:167], v[64:67]
    ds_read_b64_tr_b16 a[208:209], v3 offset:8480
    s_waitcnt lgkmcnt(3)
    v_mfma_f32_16x16x32_bf16 v[116:119], a[200:203], a[168:171], v[116:119]
    ds_read_b64_tr_b16 a[210:211], v3 offset:8992
    s_waitcnt lgkmcnt(2)
    v_mfma_f32_16x16x32_bf16 v[116:119], a[204:207], a[180:183], v[116:119]
    ds_read_b64_tr_b16 a[212:213], v3 offset:33824
    ds_read_b64_tr_b16 a[214:215], v3 offset:34336
    v_mfma_f32_16x16x32_bf16 v[120:123], a[204:207], a[184:187], v[120:123]
    buffer_load_dwordx4 v9, s[24:27], s57 offen offset:1056 nt lds
    v_mfma_f32_16x16x32_bf16 v[120:123], a[200:203], a[172:175], v[120:123]
    s_add_u32 m0, s56, 16896
    s_mov_b32 s57, 16384
    v_mfma_f32_16x16x32_bf16 v[124:127], a[200:203], a[176:179], v[124:127]
    buffer_load_dwordx4 v8, s[28:31], s57 offen offset:0 nt lds
    v_mfma_f32_16x16x32_bf16 v[124:127], a[204:207], a[188:191], v[124:127]
    ds_read_b64_tr_b16 a[216:217], v3 offset:8512
    s_waitcnt lgkmcnt(3)
    v_mfma_f32_16x16x32_bf16 v[128:131], a[208:211], a[168:171], v[128:131]
    ds_read_b64_tr_b16 a[218:219], v3 offset:9024
    s_waitcnt lgkmcnt(2)
    v_mfma_f32_16x16x32_bf16 v[128:131], a[212:215], a[180:183], v[128:131]
    ds_read_b64_tr_b16 a[220:221], v3 offset:33856
    ds_read_b64_tr_b16 a[222:223], v3 offset:34368
    v_mfma_f32_16x16x32_bf16 v[132:135], a[212:215], a[184:187], v[132:135]
    buffer_load_dwordx4 v9, s[28:31], s57 offen offset:1056 nt lds
    v_mfma_f32_16x16x32_bf16 v[132:135], a[208:211], a[172:175], v[132:135]
    s_add_u32 m0, s56, 59136
    s_add_u32 s57, s58, 1573120
    s_and_b32 s57, s57, 0x3fffff
    v_mfma_f32_16x16x32_bf16 v[136:139], a[208:211], a[176:179], v[136:139]
    buffer_load_dwordx4 v10, s[32:35], s57 offen offset:0 lds
    v_mfma_f32_16x16x32_bf16 v[136:139], a[212:215], a[188:191], v[136:139]
    ds_read_b64_tr_b16 a[224:225], v3 offset:8544
    s_waitcnt lgkmcnt(3)
    v_mfma_f32_16x16x32_bf16 v[140:143], a[216:219], a[168:171], v[140:143]
    ds_read_b64_tr_b16 a[226:227], v3 offset:9056
    s_waitcnt lgkmcnt(2)
    v_mfma_f32_16x16x32_bf16 v[140:143], a[220:223], a[180:183], v[140:143]
    ds_read_b64_tr_b16 a[228:229], v3 offset:33888
    ds_read_b64_tr_b16 a[230:231], v3 offset:34400
    v_mfma_f32_16x16x32_bf16 v[144:147], a[220:223], a[184:187], v[144:147]
    buffer_load_dwordx4 v11, s[32:35], s57 offen offset:1056 lds
    v_mfma_f32_16x16x32_bf16 v[144:147], a[216:219], a[172:175], v[144:147]
    s_add_u32 m0, s56, 92928
    s_add_u32 s57, s58, 1835264
    s_and_b32 s57, s57, 0x3fffff
    v_mfma_f32_16x16x32_bf16 v[148:151], a[216:219], a[176:179], v[148:151]
    buffer_load_dwordx4 v10, s[32:35], s57 offen offset:0 lds
    v_mfma_f32_16x16x32_bf16 v[148:151], a[220:223], a[188:191], v[148:151]
    ds_read_b64_tr_b16 a[192:193], v3 offset:8576
    s_waitcnt lgkmcnt(3)
    v_mfma_f32_16x16x32_bf16 v[152:155], a[224:227], a[168:171], v[152:155]
    ds_read_b64_tr_b16 a[194:195], v3 offset:9088
    s_waitcnt lgkmcnt(2)
    v_mfma_f32_16x16x32_bf16 v[152:155], a[228:231], a[180:183], v[152:155]
    ds_read_b64_tr_b16 a[196:197], v3 offset:33920
    ds_read_b64_tr_b16 a[198:199], v3 offset:34432
    v_mfma_f32_16x16x32_bf16 v[156:159], a[228:231], a[184:187], v[156:159]
    buffer_load_dwordx4 v11, s[32:35], s57 offen offset:1056 lds
    v_mfma_f32_16x16x32_bf16 v[156:159], a[224:227], a[172:175], v[156:159]
    ds_read_b64_tr_b16 a[200:201], v3 offset:8608
    v_mfma_f32_16x16x32_bf16 v[160:163], a[224:227], a[176:179], v[160:163]
    ds_read_b64_tr_b16 a[202:203], v3 offset:9120
    v_mfma_f32_16x16x32_bf16 v[160:163], a[228:231], a[188:191], v[160:163]
    ds_read_b64_tr_b16 a[204:205], v3 offset:33952
    s_waitcnt lgkmcnt(5)
    v_mfma_f32_16x16x32_bf16 v[20:23], a[192:195], a[168:171], v[20:23]
    ds_read_b64_tr_b16 a[206:207], v3 offset:34464
    s_waitcnt lgkmcnt(4)
    v_mfma_f32_16x16x32_bf16 v[20:23], a[196:199], a[180:183], v[20:23]
    ds_read_b64_tr_b16 a[208:209], v3 offset:8640
    v_mfma_f32_16x16x32_bf16 v[24:27], a[196:199], a[184:187], v[24:27]
    ds_read_b64_tr_b16 a[210:211], v3 offset:9152
    v_mfma_f32_16x16x32_bf16 v[24:27], a[192:195], a[172:175], v[24:27]
    ds_read_b64_tr_b16 a[212:213], v3 offset:33984
    v_mfma_f32_16x16x32_bf16 v[28:31], a[192:195], a[176:179], v[28:31]
    ds_read_b64_tr_b16 a[214:215], v3 offset:34496
    v_mfma_f32_16x16x32_bf16 v[28:31], a[196:199], a[188:191], v[28:31]
    ds_read_b64_tr_b16 a[216:217], v3 offset:8672
    s_waitcnt lgkmcnt(7)
    v_mfma_f32_16x16x32_bf16 v[32:35], a[200:203], a[168:171], v[32:35]
    ds_read_b64_tr_b16 a[218:219], v3 offset:9184
    s_waitcnt lgkmcnt(6)
    v_mfma_f32_16x16x32_bf16 v[32:35], a[204:207], a[180:183], v[32:35]
    ds_read_b64_tr_b16 a[220:221], v3 offset:34016
    v_mfma_f32_16x16x32_bf16 v[36:39], a[204:207], a[184:187], v[36:39]
    ds_read_b64_tr_b16 a[222:223], v3 offset:34528
    v_mfma_f32_16x16x32_bf16 v[36:39], a[200:203], a[172:175], v[36:39]
    v_mfma_f32_16x16x32_bf16 v[40:43], a[200:203], a[176:179], v[40:43]
    v_mfma_f32_16x16x32_bf16 v[40:43], a[204:207], a[188:191], v[40:43]
    s_waitcnt lgkmcnt(6)
    v_mfma_f32_16x16x32_bf16 v[44:47], a[208:211], a[168:171], v[44:47]
    s_waitcnt vmcnt(14) lgkmcnt(4)
    s_barrier
    v_mfma_f32_16x16x32_bf16 v[44:47], a[212:215], a[180:183], v[44:47]
    ds_read_b64_tr_b16 a[224:225], v3 offset:42240
    v_mfma_f32_16x16x32_bf16 v[48:51], a[212:215], a[184:187], v[48:51]
    ds_read_b64_tr_b16 a[226:227], v3 offset:42752
    v_mfma_f32_16x16x32_bf16 v[48:51], a[208:211], a[172:175], v[48:51]
    ds_read_b64_tr_b16 a[228:229], v2 offset:33792
    v_mfma_f32_16x16x32_bf16 v[52:55], a[208:211], a[176:179], v[52:55]
    ds_read_b64_tr_b16 a[230:231], v2 offset:34304
    v_mfma_f32_16x16x32_bf16 v[52:55], a[212:215], a[188:191], v[52:55]
    ds_read_b64_tr_b16 a[192:193], v3 offset:16896
    s_waitcnt lgkmcnt(5)
    v_mfma_f32_16x16x32_bf16 v[56:59], a[216:219], a[168:171], v[56:59]
    ds_read_b64_tr_b16 a[194:195], v3 offset:17408
    v_mfma_f32_16x16x32_bf16 v[56:59], a[220:223], a[180:183], v[56:59]
    ds_read_b64_tr_b16 a[196:197], v4 offset:0
    v_mfma_f32_16x16x32_bf16 v[60:63], a[220:223], a[184:187], v[60:63]
    ds_read_b64_tr_b16 a[198:199], v4 offset:512
    v_mfma_f32_16x16x32_bf16 v[60:63], a[216:219], a[172:175], v[60:63]
    ds_read_b64_tr_b16 a[200:201], v3 offset:42272
    v_mfma_f32_16x16x32_bf16 v[64:67], a[216:219], a[176:179], v[64:67]
    ds_read_b64_tr_b16 a[202:203], v3 offset:42784
    v_mfma_f32_16x16x32_bf16 v[64:67], a[220:223], a[188:191], v[64:67]
    ds_read_b64_tr_b16 a[204:205], v2 offset:33824
    s_waitcnt lgkmcnt(9)
    v_mfma_f32_16x16x32_bf16 v[116:119], a[224:227], a[96:99], v[116:119]
    ds_read_b64_tr_b16 a[206:207], v2 offset:34336
    s_waitcnt lgkmcnt(8)
    v_mfma_f32_16x16x32_bf16 v[116:119], a[228:231], a[108:111], v[116:119]
    ds_read_b64_tr_b16 a[208:209], v3 offset:16928
    s_waitcnt lgkmcnt(7)
    v_mfma_f32_16x16x32_bf16 v[116:119], a[192:195], a[120:123], v[116:119]
    ds_read_b64_tr_b16 a[210:211], v3 offset:17440
    s_waitcnt lgkmcnt(6)
    v_mfma_f32_16x16x32_bf16 v[116:119], a[196:199], a[132:135], v[116:119]
    ds_read_b64_tr_b16 a[212:213], v4 offset:32
    v_mfma_f32_16x16x32_bf16 v[120:123], a[196:199], a[136:139], v[120:123]
    ds_read_b64_tr_b16 a[214:215], v4 offset:544
    v_mfma_f32_16x16x32_bf16 v[120:123], a[192:195], a[124:127], v[120:123]
    ds_read_b64_tr_b16 a[216:217], v3 offset:42304
    v_mfma_f32_16x16x32_bf16 v[120:123], a[228:231], a[112:115], v[120:123]
    ds_read_b64_tr_b16 a[218:219], v3 offset:42816
    v_mfma_f32_16x16x32_bf16 v[120:123], a[224:227], a[100:103], v[120:123]
    ds_read_b64_tr_b16 a[220:221], v2 offset:33856
    v_mfma_f32_16x16x32_bf16 v[124:127], a[224:227], a[104:107], v[124:127]
    ds_read_b64_tr_b16 a[222:223], v2 offset:34368
    v_mfma_f32_16x16x32_bf16 v[124:127], a[228:231], a[116:119], v[124:127]
    ds_read_b64_tr_b16 a[224:225], v3 offset:16960
    v_mfma_f32_16x16x32_bf16 v[124:127], a[192:195], a[128:131], v[124:127]
    ds_read_b64_tr_b16 a[226:227], v3 offset:17472
    v_mfma_f32_16x16x32_bf16 v[124:127], a[196:199], a[140:143], v[124:127]
    ds_read_b64_tr_b16 a[228:229], v4 offset:64
    s_waitcnt lgkmcnt(9)
    v_mfma_f32_16x16x32_bf16 v[128:131], a[200:203], a[96:99], v[128:131]
    ds_read_b64_tr_b16 a[230:231], v4 offset:576
    v_mfma_f32_16x16x32_bf16 v[128:131], a[204:207], a[108:111], v[128:131]
    ds_read_b64_tr_b16 a[192:193], v3 offset:42336
    v_mfma_f32_16x16x32_bf16 v[128:131], a[208:211], a[120:123], v[128:131]
    ds_read_b64_tr_b16 a[194:195], v3 offset:42848
    s_waitcnt lgkmcnt(9)
    v_mfma_f32_16x16x32_bf16 v[128:131], a[212:215], a[132:135], v[128:131]
    ds_read_b64_tr_b16 a[196:197], v2 offset:33888
    v_mfma_f32_16x16x32_bf16 v[132:135], a[212:215], a[136:139], v[132:135]
    ds_read_b64_tr_b16 a[198:199], v2 offset:34400
    v_mfma_f32_16x16x32_bf16 v[132:135], a[208:211], a[124:127], v[132:135]
    v_mfma_f32_16x16x32_bf16 v[132:135], a[204:207], a[112:115], v[132:135]
    v_mfma_f32_16x16x32_bf16 v[132:135], a[200:203], a[100:103], v[132:135]
    v_mfma_f32_16x16x32_bf16 v[136:139], a[200:203], a[104:107], v[136:139]
    v_mul_f32 v116, s85, v116
    v_mul_f32 v117, s85, v117
    v_mfma_f32_16x16x32_bf16 v[136:139], a[204:207], a[116:119], v[136:139]
    v_mul_f32 v118, s85, v118
    v_mul_f32 v119, s85, v119
    v_mfma_f32_16x16x32_bf16 v[136:139], a[208:211], a[128:131], v[136:139]
    ds_read_b64_tr_b16 a[200:201], v3 offset:16992
    v_mul_f32 v128, s85, v128
    v_mfma_f32_16x16x32_bf16 v[136:139], a[212:215], a[140:143], v[136:139]
    ds_read_b64_tr_b16 a[202:203], v3 offset:17504
    s_waitcnt lgkmcnt(4)
    v_mfma_f32_16x16x32_bf16 v[140:143], a[216:219], a[96:99], v[140:143]
    ds_read_b64_tr_b16 a[204:205], v4 offset:96
    v_mul_f32 v129, s85, v129
    v_mfma_f32_16x16x32_bf16 v[140:143], a[220:223], a[108:111], v[140:143]
    ds_read_b64_tr_b16 a[206:207], v4 offset:608
    v_mul_f32 v130, s85, v130
    v_mfma_f32_16x16x32_bf16 v[140:143], a[224:227], a[120:123], v[140:143]
    ds_read_b64_tr_b16 a[208:209], v3 offset:42368
    v_mul_f32 v131, s85, v131
    v_mfma_f32_16x16x32_bf16 v[140:143], a[228:231], a[132:135], v[140:143]
    ds_read_b64_tr_b16 a[210:211], v3 offset:42880
    v_cvt_pk_bf16_f32 v208, v116, v117
    v_mfma_f32_16x16x32_bf16 v[144:147], a[228:231], a[136:139], v[144:147]
    ds_read_b64_tr_b16 a[212:213], v2 offset:33920
    v_cvt_pk_bf16_f32 v210, v128, v129
    v_mfma_f32_16x16x32_bf16 v[144:147], a[224:227], a[124:127], v[144:147]
    ds_read_b64_tr_b16 a[214:215], v2 offset:34432
    v_cvt_pk_bf16_f32 v209, v118, v119
    v_mfma_f32_16x16x32_bf16 v[144:147], a[220:223], a[112:115], v[144:147]
    v_cvt_pk_bf16_f32 v211, v130, v131
    v_mul_f32 v120, s85, v120
    v_mfma_f32_16x16x32_bf16 v[144:147], a[216:219], a[100:103], v[144:147]
    s_add_u32 m0, s56, 50688
    s_add_u32 s57, s58, 2097408
    s_and_b32 s57, s57, 0x3fffff
    v_mfma_f32_16x16x32_bf16 v[148:151], a[216:219], a[104:107], v[148:151]
    v_mul_f32 v121, s85, v121
    v_mul_f32 v122, s85, v122
    v_mfma_f32_16x16x32_bf16 v[148:151], a[220:223], a[116:119], v[148:151]
    v_mul_f32 v123, s85, v123
    v_mul_f32 v132, s85, v132
    v_mfma_f32_16x16x32_bf16 v[148:151], a[224:227], a[128:131], v[148:151]
    buffer_load_dwordx4 v10, s[32:35], s57 offen offset:0 lds
    v_mfma_f32_16x16x32_bf16 v[148:151], a[228:231], a[140:143], v[148:151]
    v_mul_f32 v133, s85, v133
    v_mul_f32 v134, s85, v134
    v_mfma_f32_16x16x32_bf16 v[152:155], a[192:195], a[96:99], v[152:155]
    s_waitcnt lgkmcnt(2)
    s_barrier
    v_mfma_f32_16x16x32_bf16 v[152:155], a[196:199], a[108:111], v[152:155]
    buffer_load_dwordx4 v11, s[32:35], s57 offen offset:1056 lds
    v_mfma_f32_16x16x32_bf16 v[152:155], a[200:203], a[120:123], v[152:155]
    s_add_u32 m0, s56, 67584
    s_mov_b32 s57, 32768
    v_mfma_f32_16x16x32_bf16 v[152:155], a[204:207], a[132:135], v[152:155]
    buffer_load_dwordx4 v8, s[24:27], s57 offen offset:0 nt lds
    v_mfma_f32_16x16x32_bf16 v[156:159], a[204:207], a[136:139], v[156:159]
    ds_read_b64_tr_b16 a[216:217], v3 offset:17024
    v_mul_f32 v135, s85, v135
    v_mfma_f32_16x16x32_bf16 v[156:159], a[200:203], a[124:127], v[156:159]
    ds_read_b64_tr_b16 a[218:219], v3 offset:17536
    v_cvt_pk_bf16_f32 v212, v120, v121
    v_mfma_f32_16x16x32_bf16 v[156:159], a[196:199], a[112:115], v[156:159]
    buffer_load_dwordx4 v9, s[24:27], s57 offen offset:1056 nt lds
    v_mfma_f32_16x16x32_bf16 v[156:159], a[192:195], a[100:103], v[156:159]
    ds_read_b64_tr_b16 a[220:221], v4 offset:128
    v_cvt_pk_bf16_f32 v214, v132, v133
    v_mfma_f32_16x16x32_bf16 v[160:163], a[192:195], a[104:107], v[160:163]
    ds_read_b64_tr_b16 a[222:223], v4 offset:640
    v_cvt_pk_bf16_f32 v213, v122, v123
    v_mfma_f32_16x16x32_bf16 v[160:163], a[196:199], a[116:119], v[160:163]
    ds_read_b64_tr_b16 a[224:225], v3 offset:42400
    v_cvt_pk_bf16_f32 v215, v134, v135
    v_mfma_f32_16x16x32_bf16 v[160:163], a[200:203], a[128:131], v[160:163]
    ds_read_b64_tr_b16 a[226:227], v3 offset:42912
    v_permlane16_swap_b32 v208, v210
    v_mfma_f32_16x16x32_bf16 v[160:163], a[204:207], a[140:143], v[160:163]
    ds_read_b64_tr_b16 a[228:229], v2 offset:33952
    v_permlane16_swap_b32 v209, v211
    v_mfma_f32_16x16x32_bf16 v[20:23], a[208:211], a[96:99], v[20:23]
    ds_read_b64_tr_b16 a[230:231], v2 offset:34464
    s_waitcnt lgkmcnt(8)
    v_mfma_f32_16x16x32_bf16 v[20:23], a[212:215], a[108:111], v[20:23]
    v_mul_f32 v124, s85, v124
    s_waitcnt lgkmcnt(6)
    v_mfma_f32_16x16x32_bf16 v[20:23], a[216:219], a[120:123], v[20:23]
    v_mul_f32 v125, s85, v125
    s_waitcnt lgkmcnt(4)
    v_mfma_f32_16x16x32_bf16 v[20:23], a[220:223], a[132:135], v[20:23]
    v_mul_f32 v126, s85, v126
    v_mul_f32 v127, s85, v127
    v_mfma_f32_16x16x32_bf16 v[24:27], a[220:223], a[136:139], v[24:27]
    v_mul_f32 v136, s85, v136
    v_mul_f32 v137, s85, v137
    v_mfma_f32_16x16x32_bf16 v[24:27], a[216:219], a[124:127], v[24:27]
    v_mul_f32 v138, s85, v138
    v_mul_f32 v139, s85, v139
    v_mfma_f32_16x16x32_bf16 v[24:27], a[212:215], a[112:115], v[24:27]
    v_cvt_pk_bf16_f32 v216, v124, v125
    v_cvt_pk_bf16_f32 v218, v136, v137
    v_mfma_f32_16x16x32_bf16 v[24:27], a[208:211], a[100:103], v[24:27]
    ds_read_b64_tr_b16 a[192:193], v3 offset:17056
    v_cvt_pk_bf16_f32 v217, v126, v127
    v_mfma_f32_16x16x32_bf16 v[28:31], a[208:211], a[104:107], v[28:31]
    ds_read_b64_tr_b16 a[194:195], v3 offset:17568
    v_cvt_pk_bf16_f32 v219, v138, v139
    v_mfma_f32_16x16x32_bf16 v[28:31], a[212:215], a[116:119], v[28:31]
    ds_read_b64_tr_b16 a[196:197], v4 offset:160
    ds_read_b64_tr_b16 a[198:199], v4 offset:672
    v_mfma_f32_16x16x32_bf16 v[28:31], a[216:219], a[128:131], v[28:31]
    ds_read_b64_tr_b16 a[200:201], v3 offset:42432
    v_permlane16_swap_b32 v212, v214
    v_mfma_f32_16x16x32_bf16 v[28:31], a[220:223], a[140:143], v[28:31]
    ds_read_b64_tr_b16 a[202:203], v3 offset:42944
    s_waitcnt lgkmcnt(6)
    v_mfma_f32_16x16x32_bf16 v[32:35], a[224:227], a[96:99], v[32:35]
    s_add_u32 m0, s56, 76032
    s_add_u32 s57, s58, 2359552
    s_and_b32 s57, s57, 0x3fffff
    v_mfma_f32_16x16x32_bf16 v[32:35], a[228:231], a[108:111], v[32:35]
    v_permlane16_swap_b32 v213, v215
    s_waitcnt lgkmcnt(4)
    v_mfma_f32_16x16x32_bf16 v[32:35], a[192:195], a[120:123], v[32:35]
    ds_read_b64_tr_b16 a[204:205], v2 offset:33984
    s_waitcnt lgkmcnt(3)
    v_mfma_f32_16x16x32_bf16 v[32:35], a[196:199], a[132:135], v[32:35]
    ds_read_b64_tr_b16 a[206:207], v2 offset:34496
    v_permlane16_swap_b32 v216, v218
    v_mfma_f32_16x16x32_bf16 v[36:39], a[196:199], a[136:139], v[36:39]
    v_permlane16_swap_b32 v217, v219
    v_mul_f32 v140, s85, v140
    v_mfma_f32_16x16x32_bf16 v[36:39], a[192:195], a[124:127], v[36:39]
    v_mul_f32 v141, s85, v141
    v_mul_f32 v142, s85, v142
    v_mfma_f32_16x16x32_bf16 v[36:39], a[228:231], a[112:115], v[36:39]
    buffer_load_dwordx4 v10, s[32:35], s57 offen offset:0 lds
    v_mfma_f32_16x16x32_bf16 v[36:39], a[224:227], a[100:103], v[36:39]
    v_mul_f32 v143, s85, v143
    v_mul_f32 v152, s85, v152
    v_mfma_f32_16x16x32_bf16 v[40:43], a[224:227], a[104:107], v[40:43]
    ds_read_b64_tr_b16 a[208:209], v3 offset:17088
    ds_read_b64_tr_b16 a[210:211], v3 offset:17600
    v_mfma_f32_16x16x32_bf16 v[40:43], a[228:231], a[116:119], v[40:43]
    ds_read_b64_tr_b16 a[212:213], v4 offset:192
    ds_read_b64_tr_b16 a[214:215], v4 offset:704
    v_mfma_f32_16x16x32_bf16 v[40:43], a[192:195], a[128:131], v[40:43]
    buffer_load_dwordx4 v11, s[32:35], s57 offen offset:1056 lds
    v_mfma_f32_16x16x32_bf16 v[40:43], a[196:199], a[140:143], v[40:43]
    s_add_u32 m0, s56, 101376
    s_mov_b32 s57, 24576
    s_waitcnt lgkmcnt(5)
    v_mfma_f32_16x16x32_bf16 v[44:47], a[200:203], a[96:99], v[44:47]
    v_mul_f32 v153, s85, v153
    s_waitcnt lgkmcnt(4)
    v_mfma_f32_16x16x32_bf16 v[44:47], a[204:207], a[108:111], v[44:47]
    v_mul_f32 v154, s85, v154
    s_waitcnt lgkmcnt(2)
    v_mfma_f32_16x16x32_bf16 v[44:47], a[208:211], a[120:123], v[44:47]
    v_mul_f32 v155, s85, v155
    s_waitcnt lgkmcnt(0)
    v_mfma_f32_16x16x32_bf16 v[44:47], a[212:215], a[132:135], v[44:47]
    buffer_load_dwordx4 v8, s[28:31], s57 offen offset:0 nt lds
    v_mfma_f32_16x16x32_bf16 v[48:51], a[212:215], a[136:139], v[48:51]
    v_cvt_pk_bf16_f32 v220, v140, v141
    v_cvt_pk_bf16_f32 v222, v152, v153
    v_mfma_f32_16x16x32_bf16 v[48:51], a[208:211], a[124:127], v[48:51]
    v_cvt_pk_bf16_f32 v221, v142, v143
    v_cvt_pk_bf16_f32 v223, v154, v155
    v_mfma_f32_16x16x32_bf16 v[48:51], a[204:207], a[112:115], v[48:51]
    ds_read_b64_tr_b16 a[216:217], v3 offset:42464
    ds_read_b64_tr_b16 a[218:219], v3 offset:42976
    v_mfma_f32_16x16x32_bf16 v[48:51], a[200:203], a[100:103], v[48:51]
    ds_read_b64_tr_b16 a[220:221], v2 offset:34016
    ds_read_b64_tr_b16 a[222:223], v2 offset:34528
    v_mfma_f32_16x16x32_bf16 v[52:55], a[200:203], a[104:107], v[52:55]
    ds_read_b64_tr_b16 a[224:225], v3 offset:17120
    ds_read_b64_tr_b16 a[226:227], v3 offset:17632
    v_mfma_f32_16x16x32_bf16 v[52:55], a[204:207], a[116:119], v[52:55]
    ds_read_b64_tr_b16 a[228:229], v4 offset:224
    ds_read_b64_tr_b16 a[230:231], v4 offset:736
    v_mfma_f32_16x16x32_bf16 v[52:55], a[208:211], a[128:131], v[52:55]
    buffer_load_dwordx4 v9, s[28:31], s57 offen offset:1056 nt lds
    v_mfma_f32_16x16x32_bf16 v[52:55], a[212:215], a[140:143], v[52:55]
    v_mul_f32 v144, s85, v144
    s_waitcnt lgkmcnt(6)
    v_mfma_f32_16x16x32_bf16 v[56:59], a[216:219], a[96:99], v[56:59]
    s_waitcnt vmcnt(8) lgkmcnt(4)
    s_barrier
    v_mfma_f32_16x16x32_bf16 v[56:59], a[220:223], a[108:111], v[56:59]
    s_add_u32 m0, s56, 33792
    s_mov_b32 s57, 40960
    s_waitcnt lgkmcnt(2)
    v_mfma_f32_16x16x32_bf16 v[56:59], a[224:227], a[120:123], v[56:59]
    v_mul_f32 v145, s85, v145
    s_waitcnt lgkmcnt(0)
    v_mfma_f32_16x16x32_bf16 v[56:59], a[228:231], a[132:135], v[56:59]
    buffer_load_dwordx4 v8, s[24:27], s57 offen offset:0 nt lds
    v_mfma_f32_16x16x32_bf16 v[60:63], a[228:231], a[136:139], v[60:63]
    v_mul_f32 v146, s85, v146
    v_mul_f32 v147, s85, v147
    v_mfma_f32_16x16x32_bf16 v[60:63], a[224:227], a[124:127], v[60:63]
    v_mul_f32 v156, s85, v156
    v_mul_f32 v157, s85, v157
    v_mfma_f32_16x16x32_bf16 v[60:63], a[220:223], a[112:115], v[60:63]
    ds_read_b64_tr_b16 a[192:193], v4 offset:8448
    ds_read_b64_tr_b16 a[194:195], v4 offset:8960
    v_mfma_f32_16x16x32_bf16 v[60:63], a[216:219], a[100:103], v[60:63]
    ds_read_b64_tr_b16 a[196:197], v4 offset:16896
    ds_read_b64_tr_b16 a[198:199], v4 offset:17408
    v_mfma_f32_16x16x32_bf16 v[64:67], a[216:219], a[104:107], v[64:67]
    ds_read_b64_tr_b16 a[200:201], v2 offset:59136
    ds_read_b64_tr_b16 a[202:203], v2 offset:59648
    v_mfma_f32_16x16x32_bf16 v[64:67], a[220:223], a[116:119], v[64:67]
    ds_read_b64_tr_b16 a[204:205], v3 offset:25344
    ds_read_b64_tr_b16 a[206:207], v3 offset:25856
    v_mfma_f32_16x16x32_bf16 v[64:67], a[224:227], a[128:131], v[64:67]
    buffer_load_dwordx4 v9, s[24:27], s57 offen offset:1056 nt lds
    v_mfma_f32_16x16x32_bf16 v[64:67], a[228:231], a[140:143], v[64:67]
    s_add_u32 m0, s56, 109824
    s_mov_b32 s57, 32768
    s_waitcnt lgkmcnt(6)
    v_mfma_f32_16x16x32_bf16 a[0:3], a[192:195], v[68:71], a[0:3]
    v_mul_f32 v158, s85, v158
    s_waitcnt lgkmcnt(4)
    v_mfma_f32_16x16x32_bf16 a[0:3], a[196:199], v[80:83], a[0:3]
    v_mul_f32 v159, s85, v159
    s_waitcnt lgkmcnt(2)
    v_mfma_f32_16x16x32_bf16 a[0:3], a[200:203], v[92:95], a[0:3]
    v_cvt_pk_bf16_f32 v224, v144, v145
    s_waitcnt lgkmcnt(0)
    v_mfma_f32_16x16x32_bf16 a[0:3], a[204:207], v[104:107], a[0:3]
    buffer_load_dwordx4 v8, s[28:31], s57 offen offset:0 nt lds
    v_mfma_f32_16x16x32_bf16 a[4:7], a[204:207], v[108:111], a[4:7]
    v_cvt_pk_bf16_f32 v226, v156, v157
    v_cvt_pk_bf16_f32 v225, v146, v147
    v_mfma_f32_16x16x32_bf16 a[4:7], a[200:203], v[96:99], a[4:7]
    v_cvt_pk_bf16_f32 v227, v158, v159
    v_permlane16_swap_b32 v220, v222
    v_mfma_f32_16x16x32_bf16 a[4:7], a[196:199], v[84:87], a[4:7]
    ds_read_b64_tr_b16 a[208:209], v4 offset:8480
    ds_read_b64_tr_b16 a[210:211], v4 offset:8992
    v_mfma_f32_16x16x32_bf16 a[4:7], a[192:195], v[72:75], a[4:7]
    ds_read_b64_tr_b16 a[212:213], v4 offset:16928
    ds_read_b64_tr_b16 a[214:215], v4 offset:17440
    v_mfma_f32_16x16x32_bf16 a[8:11], a[192:195], v[76:79], a[8:11]
    ds_read_b64_tr_b16 a[216:217], v2 offset:59168
    ds_read_b64_tr_b16 a[218:219], v2 offset:59680
    v_mfma_f32_16x16x32_bf16 a[8:11], a[196:199], v[88:91], a[8:11]
    ds_read_b64_tr_b16 a[220:221], v3 offset:25376
    ds_read_b64_tr_b16 a[222:223], v3 offset:25888
    v_mfma_f32_16x16x32_bf16 a[8:11], a[200:203], v[100:103], a[8:11]
    buffer_load_dwordx4 v9, s[28:31], s57 offen offset:1056 nt lds
    v_mfma_f32_16x16x32_bf16 a[8:11], a[204:207], v[112:115], a[8:11]
    v_permlane16_swap_b32 v221, v223
    s_waitcnt lgkmcnt(6)
    v_mfma_f32_16x16x32_bf16 a[12:15], a[208:211], v[68:71], a[12:15]
    v_mul_f32 v148, s85, v148
    s_waitcnt lgkmcnt(4)
    v_mfma_f32_16x16x32_bf16 a[12:15], a[212:215], v[80:83], a[12:15]
    v_mul_f32 v149, s85, v149
    s_waitcnt lgkmcnt(2)
    v_mfma_f32_16x16x32_bf16 a[12:15], a[216:219], v[92:95], a[12:15]
    v_mul_f32 v150, s85, v150
    s_waitcnt lgkmcnt(0)
    v_mfma_f32_16x16x32_bf16 a[12:15], a[220:223], v[104:107], a[12:15]
    v_mul_f32 v151, s85, v151
    v_mul_f32 v160, s85, v160
    v_mfma_f32_16x16x32_bf16 a[16:19], a[220:223], v[108:111], a[16:19]
    v_mul_f32 v161, s85, v161
    v_mul_f32 v162, s85, v162
    v_mfma_f32_16x16x32_bf16 a[16:19], a[216:219], v[96:99], a[16:19]
    v_mul_f32 v163, s85, v163
    v_cvt_pk_bf16_f32 v228, v148, v149
    v_mfma_f32_16x16x32_bf16 a[16:19], a[212:215], v[84:87], a[16:19]
    ds_read_b64_tr_b16 a[224:225], v4 offset:8512
    ds_read_b64_tr_b16 a[226:227], v4 offset:9024
    v_mfma_f32_16x16x32_bf16 a[16:19], a[208:211], v[72:75], a[16:19]
    ds_read_b64_tr_b16 a[228:229], v4 offset:16960
    ds_read_b64_tr_b16 a[230:231], v4 offset:17472
    v_mfma_f32_16x16x32_bf16 a[20:23], a[208:211], v[76:79], a[20:23]
    ds_read_b64_tr_b16 a[192:193], v2 offset:59200
    ds_read_b64_tr_b16 a[194:195], v2 offset:59712
    v_mfma_f32_16x16x32_bf16 a[20:23], a[212:215], v[88:91], a[20:23]
    ds_read_b64_tr_b16 a[196:197], v3 offset:25408
    ds_read_b64_tr_b16 a[198:199], v3 offset:25920
    v_mfma_f32_16x16x32_bf16 a[20:23], a[216:219], v[100:103], a[20:23]
    v_cvt_pk_bf16_f32 v230, v160, v161
    v_cvt_pk_bf16_f32 v229, v150, v151
    v_mfma_f32_16x16x32_bf16 a[20:23], a[220:223], v[112:115], a[20:23]
    v_cvt_pk_bf16_f32 v231, v162, v163
    s_waitcnt lgkmcnt(6)
    v_mfma_f32_16x16x32_bf16 a[24:27], a[224:227], v[68:71], a[24:27]
    v_permlane16_swap_b32 v224, v226
    s_waitcnt lgkmcnt(4)
    v_mfma_f32_16x16x32_bf16 a[24:27], a[228:231], v[80:83], a[24:27]
    v_permlane16_swap_b32 v225, v227
    s_waitcnt lgkmcnt(2)
    v_mfma_f32_16x16x32_bf16 a[24:27], a[192:195], v[92:95], a[24:27]
    v_permlane16_swap_b32 v228, v230
    s_waitcnt lgkmcnt(0)
    v_mfma_f32_16x16x32_bf16 a[24:27], a[196:199], v[104:107], a[24:27]
    v_permlane16_swap_b32 v229, v231
    v_mul_f32 v20, s85, v20
    v_mfma_f32_16x16x32_bf16 a[28:31], a[196:199], v[108:111], a[28:31]
    v_mul_f32 v21, s85, v21
    v_mul_f32 v22, s85, v22
    v_mfma_f32_16x16x32_bf16 a[28:31], a[192:195], v[96:99], a[28:31]
    v_mul_f32 v23, s85, v23
    v_mul_f32 v32, s85, v32
    v_mfma_f32_16x16x32_bf16 a[28:31], a[228:231], v[84:87], a[28:31]
    ds_read_b64_tr_b16 a[200:201], v4 offset:8544
    ds_read_b64_tr_b16 a[202:203], v4 offset:9056
    v_mfma_f32_16x16x32_bf16 a[28:31], a[224:227], v[72:75], a[28:31]
    ds_read_b64_tr_b16 a[204:205], v4 offset:16992
    ds_read_b64_tr_b16 a[206:207], v4 offset:17504
    v_mfma_f32_16x16x32_bf16 a[32:35], a[224:227], v[76:79], a[32:35]
    ds_read_b64_tr_b16 a[208:209], v2 offset:59232
    ds_read_b64_tr_b16 a[210:211], v2 offset:59744
    v_mfma_f32_16x16x32_bf16 a[32:35], a[228:231], v[88:91], a[32:35]
    ds_read_b64_tr_b16 a[212:213], v3 offset:25440
    ds_read_b64_tr_b16 a[214:215], v3 offset:25952
    v_mfma_f32_16x16x32_bf16 a[32:35], a[192:195], v[100:103], a[32:35]
    v_mul_f32 v33, s85, v33
    v_mul_f32 v34, s85, v34
    v_mfma_f32_16x16x32_bf16 a[32:35], a[196:199], v[112:115], a[32:35]
    v_mul_f32 v35, s85, v35
    s_waitcnt lgkmcnt(6)
    v_mfma_f32_16x16x32_bf16 a[36:39], a[200:203], v[68:71], a[36:39]
    s_waitcnt lgkmcnt(4)
    s_barrier
    v_mfma_f32_16x16x32_bf16 a[36:39], a[204:207], v[80:83], a[36:39]
    s_add_u32 m0, s56, 84480
    s_mov_b32 s57, 49152
    s_waitcnt lgkmcnt(2)
    v_mfma_f32_16x16x32_bf16 a[36:39], a[208:211], v[92:95], a[36:39]
    v_cvt_pk_bf16_f32 v232, v20, v21
    s_waitcnt lgkmcnt(0)
    v_mfma_f32_16x16x32_bf16 a[36:39], a[212:215], v[104:107], a[36:39]
    buffer_load_dwordx4 v8, s[24:27], s57 offen offset:0 nt lds
    v_mfma_f32_16x16x32_bf16 a[40:43], a[212:215], v[108:111], a[40:43]
    v_cvt_pk_bf16_f32 v234, v32, v33
    v_cvt_pk_bf16_f32 v233, v22, v23
    v_mfma_f32_16x16x32_bf16 a[40:43], a[208:211], v[96:99], a[40:43]
    v_cvt_pk_bf16_f32 v235, v34, v35
    v_mul_f32 v24, s85, v24
    v_mfma_f32_16x16x32_bf16 a[40:43], a[204:207], v[84:87], a[40:43]
    ds_read_b64_tr_b16 a[216:217], v4 offset:8576
    ds_read_b64_tr_b16 a[218:219], v4 offset:9088
    v_mfma_f32_16x16x32_bf16 a[40:43], a[200:203], v[72:75], a[40:43]
    ds_read_b64_tr_b16 a[220:221], v4 offset:17024
    ds_read_b64_tr_b16 a[222:223], v4 offset:17536
    v_mfma_f32_16x16x32_bf16 a[44:47], a[200:203], v[76:79], a[44:47]
    ds_read_b64_tr_b16 a[224:225], v2 offset:59264
    ds_read_b64_tr_b16 a[226:227], v2 offset:59776
    v_mfma_f32_16x16x32_bf16 a[44:47], a[204:207], v[88:91], a[44:47]
    ds_read_b64_tr_b16 a[228:229], v3 offset:25472
    ds_read_b64_tr_b16 a[230:231], v3 offset:25984
    v_mfma_f32_16x16x32_bf16 a[44:47], a[208:211], v[100:103], a[44:47]
    buffer_load_dwordx4 v9, s[24:27], s57 offen offset:1056 nt lds
    v_mfma_f32_16x16x32_bf16 a[44:47], a[212:215], v[112:115], a[44:47]
    s_add_u32 m0, s56, 135168
    s_mov_b32 s57, 40960
    s_waitcnt lgkmcnt(6)
    v_mfma_f32_16x16x32_bf16 a[48:51], a[216:219], v[68:71], a[48:51]
    v_mul_f32 v25, s85, v25
    s_waitcnt lgkmcnt(4)
    v_mfma_f32_16x16x32_bf16 a[48:51], a[220:223], v[80:83], a[48:51]
    v_mul_f32 v26, s85, v26
    s_waitcnt lgkmcnt(2)
    v_mfma_f32_16x16x32_bf16 a[48:51], a[224:227], v[92:95], a[48:51]
    v_mul_f32 v27, s85, v27
    s_waitcnt lgkmcnt(0)
    v_mfma_f32_16x16x32_bf16 a[48:51], a[228:231], v[104:107], a[48:51]
    buffer_load_dwordx4 v8, s[28:31], s57 offen offset:0 nt lds
    v_mfma_f32_16x16x32_bf16 a[52:55], a[228:231], v[108:111], a[52:55]
    v_mul_f32 v36, s85, v36
    v_mul_f32 v37, s85, v37
    v_mfma_f32_16x16x32_bf16 a[52:55], a[224:227], v[96:99], a[52:55]
    v_mul_f32 v38, s85, v38
    v_mul_f32 v39, s85, v39
    v_mfma_f32_16x16x32_bf16 a[52:55], a[220:223], v[84:87], a[52:55]
    ds_read_b128 a[192:195], v5 offset:25344
    v_cvt_pk_bf16_f32 v236, v24, v25
    v_mfma_f32_16x16x32_bf16 a[52:55], a[216:219], v[72:75], a[52:55]
    buffer_load_dwordx4 v9, s[28:31], s57 offen offset:1056 nt lds
    v_mfma_f32_16x16x32_bf16 a[56:59], a[216:219], v[76:79], a[56:59]
    v_cvt_pk_bf16_f32 v238, v36, v37
    v_cvt_pk_bf16_f32 v237, v26, v27
    v_mfma_f32_16x16x32_bf16 a[56:59], a[220:223], v[88:91], a[56:59]
    ds_read_b128 a[196:199], v5 offset:25408
    v_cvt_pk_bf16_f32 v239, v38, v39
    v_mfma_f32_16x16x32_bf16 a[56:59], a[224:227], v[100:103], a[56:59]
    v_permlane16_swap_b32 v232, v234
    v_permlane16_swap_b32 v233, v235
    v_mfma_f32_16x16x32_bf16 a[56:59], a[228:231], v[112:115], a[56:59]
    v_mul_f32 v28, s85, v28
    s_waitcnt lgkmcnt(1)
    v_mfma_f32_16x16x32_bf16 v[124:127], a[192:195], v[216:219], 0
    ds_read_b128 a[200:203], v5 offset:25472
    v_mul_f32 v29, s85, v29
    v_mfma_f32_16x16x32_bf16 v[120:123], a[192:195], v[212:215], 0
    v_mul_f32 v30, s85, v30
    v_mul_f32 v31, s85, v31
    v_mfma_f32_16x16x32_bf16 v[116:119], a[192:195], v[208:211], 0
    v_mul_f32 v40, s85, v40
    s_waitcnt lgkmcnt(1)
    v_mfma_f32_16x16x32_bf16 v[116:119], a[196:199], v[220:223], v[116:119]
    ds_read_b128 a[204:207], v5 offset:25536
    v_mul_f32 v41, s85, v41
    v_mul_f32 v42, s85, v42
    v_mul_f32 v43, s85, v43
    v_cvt_pk_bf16_f32 v240, v28, v29
    v_cvt_pk_bf16_f32 v242, v40, v41
    v_cvt_pk_bf16_f32 v241, v30, v31
    v_cvt_pk_bf16_f32 v243, v42, v43
    v_permlane16_swap_b32 v236, v238
    v_permlane16_swap_b32 v237, v239
    v_permlane16_swap_b32 v240, v242
    v_permlane16_swap_b32 v241, v243
    v_mfma_f32_16x16x32_bf16 v[120:123], a[196:199], v[224:227], v[120:123]
    v_mul_f32 v44, s85, v44
    v_mul_f32 v45, s85, v45
    v_mfma_f32_16x16x32_bf16 v[124:127], a[196:199], v[228:231], v[124:127]
    v_mul_f32 v46, s85, v46
    s_waitcnt lgkmcnt(1)
    v_mfma_f32_16x16x32_bf16 v[124:127], a[200:203], v[240:243], v[124:127]
    ds_read_b128 a[208:211], v5 offset:25856
    v_mul_f32 v47, s85, v47
    v_mul_f32 v56, s85, v56
    v_mul_f32 v57, s85, v57
    v_mul_f32 v58, s85, v58
    v_mul_f32 v59, s85, v59
    v_cvt_pk_bf16_f32 v244, v44, v45
    v_cvt_pk_bf16_f32 v246, v56, v57
    v_cvt_pk_bf16_f32 v245, v46, v47
    v_cvt_pk_bf16_f32 v247, v58, v59
    v_mul_f32 v48, s85, v48
    v_mul_f32 v49, s85, v49
    v_mul_f32 v50, s85, v50
    v_mul_f32 v51, s85, v51
    v_mul_f32 v60, s85, v60
    v_mul_f32 v61, s85, v61
    v_mul_f32 v62, s85, v62
    v_mul_f32 v63, s85, v63
    v_cvt_pk_bf16_f32 v248, v48, v49
    v_cvt_pk_bf16_f32 v250, v60, v61
    v_cvt_pk_bf16_f32 v249, v50, v51
    v_cvt_pk_bf16_f32 v251, v62, v63
    v_permlane16_swap_b32 v244, v246
    v_permlane16_swap_b32 v245, v247
    v_mfma_f32_16x16x32_bf16 v[120:123], a[200:203], v[236:239], v[120:123]
    v_mul_f32 v52, s85, v52
    v_mul_f32 v53, s85, v53
    v_mul_f32 v54, s85, v54
    v_mul_f32 v55, s85, v55
    v_mul_f32 v64, s85, v64
    v_mul_f32 v65, s85, v65
    v_mul_f32 v66, s85, v66
    v_mul_f32 v67, s85, v67
    v_cvt_pk_bf16_f32 v252, v52, v53
    v_cvt_pk_bf16_f32 v254, v64, v65
    v_cvt_pk_bf16_f32 v253, v54, v55
    v_cvt_pk_bf16_f32 v255, v66, v67
    v_permlane16_swap_b32 v248, v250
    v_permlane16_swap_b32 v249, v251
    v_mfma_f32_16x16x32_bf16 v[116:119], a[200:203], v[232:235], v[116:119]
    v_permlane16_swap_b32 v252, v254
    v_permlane16_swap_b32 v253, v255
    s_waitcnt lgkmcnt(1)
    v_mfma_f32_16x16x32_bf16 v[116:119], a[204:207], v[244:247], v[116:119]
    ds_read_b128 a[212:215], v5 offset:25920
    ds_read_b128 a[216:219], v5 offset:25984
    v_mfma_f32_16x16x32_bf16 v[120:123], a[204:207], v[248:251], v[120:123]
    buffer_load_ubyte v14, v13, s[48:51], s74 offen offset:0 sc1
    v_mfma_f32_16x16x32_bf16 v[124:127], a[204:207], v[252:255], v[124:127]
    ds_read_b128 a[220:223], v5 offset:26048
    s_waitcnt lgkmcnt(3)
    v_mfma_f32_16x16x32_bf16 v[136:139], a[208:211], v[216:219], 0
    s_waitcnt lgkmcnt(4)
    s_barrier
    v_mfma_f32_16x16x32_bf16 v[132:135], a[208:211], v[212:215], 0
    ds_read_b64_tr_b16 a[224:225], v4 offset:8608
    v_mov_b32 v204, 0
    v_mfma_f32_16x16x32_bf16 v[128:131], a[208:211], v[208:211], 0
    ds_read_b64_tr_b16 a[226:227], v4 offset:9120
    s_waitcnt lgkmcnt(4)
    v_mfma_f32_16x16x32_bf16 v[128:131], a[212:215], v[220:223], v[128:131]
    ds_read_b64_tr_b16 a[228:229], v4 offset:17056
    ds_read_b64_tr_b16 a[230:231], v4 offset:17568
    v_mfma_f32_16x16x32_bf16 v[132:135], a[212:215], v[224:227], v[132:135]
    ds_read_b64_tr_b16 a[192:193], v2 offset:59296
    v_mov_b32 v205, 0
    v_mfma_f32_16x16x32_bf16 v[136:139], a[212:215], v[228:231], v[136:139]
    ds_read_b64_tr_b16 a[194:195], v2 offset:59808
    s_waitcnt lgkmcnt(7)
    v_mfma_f32_16x16x32_bf16 v[136:139], a[216:219], v[240:243], v[136:139]
    ds_read_b64_tr_b16 a[196:197], v3 offset:25504
    v_mov_b32 v206, 0
    v_mfma_f32_16x16x32_bf16 v[132:135], a[216:219], v[236:239], v[132:135]
    ds_read_b64_tr_b16 a[198:199], v3 offset:26016
    v_mov_b32 v207, 0
    v_mfma_f32_16x16x32_bf16 v[128:131], a[216:219], v[232:235], v[128:131]
    ds_read_b64_tr_b16 a[200:201], v4 offset:8640
    s_waitcnt lgkmcnt(9)
    v_mfma_f32_16x16x32_bf16 v[128:131], a[220:223], v[244:247], v[128:131]
    ds_read_b64_tr_b16 a[202:203], v4 offset:9152
    v_max3_f32 v166, v116, v117, v118
    v_mfma_f32_16x16x32_bf16 v[132:135], a[220:223], v[248:251], v[132:135]
    v_max3_f32 v170, v120, v121, v122
    v_max3_f32 v174, v124, v125, v126
    v_mfma_f32_16x16x32_bf16 v[136:139], a[220:223], v[252:255], v[136:139]
    v_max_f32 v166, v166, v119
    s_waitcnt lgkmcnt(8)
    v_mfma_f32_16x16x32_bf16 a[60:63], a[224:227], v[68:71], a[60:63]
    v_max_f32 v170, v170, v123
    s_waitcnt lgkmcnt(6)
    v_mfma_f32_16x16x32_bf16 a[60:63], a[228:231], v[80:83], a[60:63]
    ds_read_b64_tr_b16 a[204:205], v4 offset:17088
    s_waitcnt lgkmcnt(5)
    v_mfma_f32_16x16x32_bf16 a[60:63], a[192:195], v[92:95], a[60:63]
    ds_read_b64_tr_b16 a[206:207], v4 offset:17600
    s_waitcnt lgkmcnt(4)
    v_mfma_f32_16x16x32_bf16 a[60:63], a[196:199], v[104:107], a[60:63]
    v_max_f32 v174, v174, v127
    v_mov_b32 v167, v166
    v_mfma_f32_16x16x32_bf16 a[64:67], a[196:199], v[108:111], a[64:67]
    v_mov_b32 v171, v170
    v_mov_b32 v175, v174
    v_mfma_f32_16x16x32_bf16 a[64:67], a[192:195], v[96:99], a[64:67]
    v_permlane16_swap_b32 v166, v167
    v_permlane16_swap_b32 v170, v171
    v_mfma_f32_16x16x32_bf16 a[64:67], a[228:231], v[84:87], a[64:67]
    ds_read_b64_tr_b16 a[208:209], v2 offset:59328
    ds_read_b64_tr_b16 a[210:211], v2 offset:59840
    v_mfma_f32_16x16x32_bf16 a[64:67], a[224:227], v[72:75], a[64:67]
    v_permlane16_swap_b32 v174, v175
    v_max_f32 v166, v166, v167
    v_mfma_f32_16x16x32_bf16 a[68:71], a[224:227], v[76:79], a[68:71]
    v_max_f32 v170, v170, v171
    v_max_f32 v174, v174, v175
    v_mfma_f32_16x16x32_bf16 a[68:71], a[228:231], v[88:91], a[68:71]
    ds_read_b64_tr_b16 a[212:213], v3 offset:25536
    ds_read_b64_tr_b16 a[214:215], v3 offset:26048
    v_mfma_f32_16x16x32_bf16 a[68:71], a[192:195], v[100:103], a[68:71]
    v_mov_b32 v167, v166
    v_mov_b32 v171, v170
    v_mfma_f32_16x16x32_bf16 a[68:71], a[196:199], v[112:115], a[68:71]
    v_mov_b32 v175, v174
    s_waitcnt lgkmcnt(4)
    v_mfma_f32_16x16x32_bf16 a[72:75], a[200:203], v[68:71], a[72:75]
    v_permlane32_swap_b32 v166, v167
    v_permlane32_swap_b32 v170, v171
    v_mfma_f32_16x16x32_bf16 a[72:75], a[204:207], v[80:83], a[72:75]
    v_permlane32_swap_b32 v174, v175
    s_waitcnt lgkmcnt(2)
    v_mfma_f32_16x16x32_bf16 a[72:75], a[208:211], v[92:95], a[72:75]
    v_min_f32 v188, -v166, -v167
    s_waitcnt lgkmcnt(0)
    v_mfma_f32_16x16x32_bf16 a[72:75], a[212:215], v[104:107], a[72:75]
    v_min_f32 v189, -v166, -v167
    v_min_f32 v190, -v166, -v167
    v_mfma_f32_16x16x32_bf16 a[76:79], a[212:215], v[108:111], a[76:79]
    v_min_f32 v191, -v166, -v167
    v_min_f32 v192, -v170, -v171
    v_mfma_f32_16x16x32_bf16 a[76:79], a[208:211], v[96:99], a[76:79]
    v_min_f32 v193, -v170, -v171
    v_min_f32 v194, -v170, -v171
    v_mfma_f32_16x16x32_bf16 a[76:79], a[204:207], v[84:87], a[76:79]
    ds_read_b64_tr_b16 a[216:217], v4 offset:8672
    ds_read_b64_tr_b16 a[218:219], v4 offset:9184
    v_mfma_f32_16x16x32_bf16 a[76:79], a[200:203], v[72:75], a[76:79]
    ds_read_b64_tr_b16 a[220:221], v4 offset:17120
    ds_read_b64_tr_b16 a[222:223], v4 offset:17632
    v_mfma_f32_16x16x32_bf16 a[80:83], a[200:203], v[76:79], a[80:83]
    ds_read_b64_tr_b16 a[224:225], v2 offset:59360
    ds_read_b64_tr_b16 a[226:227], v2 offset:59872
    v_mfma_f32_16x16x32_bf16 a[80:83], a[204:207], v[88:91], a[80:83]
    ds_read_b64_tr_b16 a[228:229], v3 offset:25568
    ds_read_b64_tr_b16 a[230:231], v3 offset:26080
    v_mfma_f32_16x16x32_bf16 a[80:83], a[208:211], v[100:103], a[80:83]
    v_min_f32 v195, -v170, -v171
    v_min_f32 v196, -v174, -v175
    v_mfma_f32_16x16x32_bf16 a[80:83], a[212:215], v[112:115], a[80:83]
    v_min_f32 v197, -v174, -v175
    s_waitcnt lgkmcnt(6)
    v_mfma_f32_16x16x32_bf16 a[84:87], a[216:219], v[68:71], a[84:87]
    s_waitcnt lgkmcnt(4)
    s_barrier
    v_mfma_f32_16x16x32_bf16 a[84:87], a[220:223], v[80:83], a[84:87]
    s_add_u32 m0, s56, 25344
    s_mov_b32 s57, 57344
    s_waitcnt lgkmcnt(2)
    v_mfma_f32_16x16x32_bf16 a[84:87], a[224:227], v[92:95], a[84:87]
    v_min_f32 v198, -v174, -v175
    s_waitcnt lgkmcnt(0)
    v_mfma_f32_16x16x32_bf16 a[84:87], a[228:231], v[104:107], a[84:87]
    buffer_load_dwordx4 v8, s[24:27], s57 offen offset:0 nt lds
    v_mfma_f32_16x16x32_bf16 a[88:91], a[228:231], v[108:111], a[88:91]
    v_min_f32 v199, -v174, -v175
    v_add_f32 v116, v116, v188
    v_mfma_f32_16x16x32_bf16 a[88:91], a[224:227], v[96:99], a[88:91]
    ds_read_b128 a[192:195], v5 offset:42240
    v_add_f32 v117, v117, v188
    v_mfma_f32_16x16x32_bf16 a[88:91], a[220:223], v[84:87], a[88:91]
    buffer_load_dwordx4 v9, s[24:27], s57 offen offset:1056 nt lds
    v_mfma_f32_16x16x32_bf16 a[88:91], a[216:219], v[72:75], a[88:91]
    ds_read_b128 a[196:199], v5 offset:42304
    ds_read_b128 a[200:203], v5 offset:42368
    v_mfma_f32_16x16x32_bf16 a[92:95], a[216:219], v[76:79], a[92:95]
    v_exp_f32 v16, v116
    v_mfma_f32_16x16x32_bf16 a[92:95], a[220:223], v[88:91], a[92:95]
    ds_read_b128 a[204:207], v5 offset:42432
    v_add_f32 v118, v118, v188
    v_mfma_f32_16x16x32_bf16 a[92:95], a[224:227], v[100:103], a[92:95]
    v_exp_f32 v17, v117
    v_mfma_f32_16x16x32_bf16 a[92:95], a[228:231], v[112:115], a[92:95]
    v_add_f32 v119, v119, v188
    s_waitcnt lgkmcnt(3)
    v_mfma_f32_16x16x32_bf16 v[140:143], a[192:195], v[208:211], v[188:191]
    ds_read_b128 a[208:211], v5 offset:42752
    s_waitcnt lgkmcnt(3)
    v_mfma_f32_16x16x32_bf16 v[140:143], a[196:199], v[220:223], v[140:143]
    ds_read_b128 a[212:215], v5 offset:42816
    s_waitcnt lgkmcnt(3)
    v_mfma_f32_16x16x32_bf16 v[140:143], a[200:203], v[232:235], v[140:143]
    ds_read_b128 a[216:219], v5 offset:42880
    s_waitcnt lgkmcnt(3)
    v_mfma_f32_16x16x32_bf16 v[140:143], a[204:207], v[244:247], v[140:143]
    v_exp_f32 v18, v118
    v_mfma_f32_16x16x32_bf16 v[144:147], a[204:207], v[248:251], v[192:195]
    v_cvt_pk_bf16_f32 v164, v16, v17
    v_add_f32 v120, v120, v192
    v_mfma_f32_16x16x32_bf16 v[144:147], a[200:203], v[236:239], v[144:147]
    v_exp_f32 v19, v119
    v_mfma_f32_16x16x32_bf16 v[144:147], a[196:199], v[224:227], v[144:147]
    ds_read_b128 a[220:223], v5 offset:42944
    v_add_f32 v121, v121, v192
    v_mfma_f32_16x16x32_bf16 v[144:147], a[192:195], v[212:215], v[144:147]
    v_exp_f32 v16, v120
    v_mfma_f32_16x16x32_bf16 v[148:151], a[192:195], v[216:219], v[196:199]
    v_cvt_pk_bf16_f32 v165, v18, v19
    v_add_f32 v122, v122, v192
    v_mfma_f32_16x16x32_bf16 v[148:151], a[196:199], v[228:231], v[148:151]
    v_exp_f32 v17, v121
    v_mfma_f32_16x16x32_bf16 v[148:151], a[200:203], v[240:243], v[148:151]
    ds_read_b64_tr_b16 a[224:225], v3 offset:50688
    v_add_f32 v123, v123, v192
    v_mfma_f32_16x16x32_bf16 v[148:151], a[204:207], v[252:255], v[148:151]
    ds_read_b64_tr_b16 a[226:227], v3 offset:51200
    s_waitcnt lgkmcnt(3)
    v_mfma_f32_16x16x32_bf16 v[152:155], a[208:211], v[208:211], v[188:191]
    v_exp_f32 v18, v122
    v_mfma_f32_16x16x32_bf16 v[152:155], a[212:215], v[220:223], v[152:155]
    v_cvt_pk_bf16_f32 v168, v16, v17
    v_add_f32 v124, v124, v196
    v_mfma_f32_16x16x32_bf16 v[152:155], a[216:219], v[232:235], v[152:155]
    ds_read_b64_tr_b16 a[228:229], v3 offset:50720
    s_waitcnt lgkmcnt(3)
    v_mfma_f32_16x16x32_bf16 v[152:155], a[220:223], v[244:247], v[152:155]
    v_exp_f32 v19, v123
    v_mfma_f32_16x16x32_bf16 v[156:159], a[220:223], v[248:251], v[192:195]
    ds_read_b64_tr_b16 a[230:231], v3 offset:51232
    v_add_f32 v125, v125, v196
    v_mfma_f32_16x16x32_bf16 v[156:159], a[216:219], v[236:239], v[156:159]
    v_exp_f32 v16, v124
    v_cvt_pk_bf16_f32 v169, v18, v19
    v_add_f32 v126, v126, v196
    v_exp_f32 v17, v125
    v_add_f32 v127, v127, v196
    v_exp_f32 v18, v126
    v_cvt_pk_bf16_f32 v172, v16, v17
    v_add_f32 v128, v128, v188
    v_exp_f32 v19, v127
    v_add_f32 v129, v129, v188
    v_exp_f32 v16, v128
    v_cvt_pk_bf16_f32 v173, v18, v19
    v_add_f32 v130, v130, v188
    v_exp_f32 v17, v129
    v_add_f32 v131, v131, v188
    v_exp_f32 v18, v130
    v_cvt_pk_bf16_f32 v166, v16, v17
    v_add_f32 v132, v132, v192
    v_exp_f32 v19, v131
    v_add_f32 v133, v133, v192
    v_exp_f32 v16, v132
    v_cvt_pk_bf16_f32 v167, v18, v19
    v_mfma_f32_16x16x32_bf16 v[156:159], a[212:215], v[224:227], v[156:159]
    v_add_f32 v134, v134, v192
    v_exp_f32 v17, v133
    v_add_f32 v135, v135, v192
    v_exp_f32 v18, v134
    v_cvt_pk_bf16_f32 v170, v16, v17
    v_add_f32 v136, v136, v196
    v_exp_f32 v19, v135
    v_add_f32 v137, v137, v196
    v_exp_f32 v16, v136
    v_cvt_pk_bf16_f32 v171, v18, v19
    v_mfma_f32_16x16x32_bf16 v[156:159], a[208:211], v[212:215], v[156:159]
    v_add_f32 v138, v138, v196
    v_exp_f32 v17, v137
    v_add_f32 v139, v139, v196
    v_exp_f32 v18, v138
    v_cvt_pk_bf16_f32 v174, v16, v17
    v_exp_f32 v19, v139
    s_nop 0
    v_cvt_pk_bf16_f32 v175, v18, v19
    v_mfma_f32_16x16x32_bf16 v[200:203], a[232:235], v[164:167], v[204:207]
    s_add_u32 m0, s56, 143616
    s_add_u32 s57, s58, 2621696
    s_and_b32 s57, s57, 0x3fffff
    v_mfma_f32_16x16x32_bf16 v[200:203], a[236:239], v[168:171], v[200:203]
    ds_read_b64_tr_b16 a[192:193], v3 offset:50752
    ds_read_b64_tr_b16 a[194:195], v3 offset:51264
    v_mfma_f32_16x16x32_bf16 v[200:203], a[240:243], v[172:175], v[200:203]
    ds_read_b64_tr_b16 a[196:197], v3 offset:50784
    ds_read_b64_tr_b16 a[198:199], v3 offset:51296
    v_mfma_f32_16x16x32_bf16 v[160:163], a[208:211], v[216:219], v[196:199]
    buffer_load_dwordx4 v10, s[32:35], s57 offen offset:0 lds
    v_mfma_f32_16x16x32_bf16 v[160:163], a[212:215], v[228:231], v[160:163]
    s_nop 1
    v_mfma_f32_16x16x32_bf16 v[160:163], a[216:219], v[240:243], v[160:163]
    v_cmp_nge_f32 vcc, s84, v203
    s_waitcnt vmcnt(14) lgkmcnt(4)
    s_barrier
    v_mfma_f32_16x16x32_bf16 v[160:163], a[220:223], v[252:255], v[160:163]
    s_cbranch_vccnz K_R0_0
K_R0_0_ret:
    ds_read_b64_tr_b16 a[200:201], v2 offset:50688
    v_mfma_f32_16x16x32_bf16 v[28:31], a[224:227], v[172:175], 0
    buffer_load_dwordx4 v11, s[32:35], s57 offen offset:1056 lds
    v_mfma_f32_16x16x32_bf16 v[24:27], a[224:227], v[168:171], 0
    s_add_u32 m0, s56, 42240
    s_mov_b32 s57, 49152
    v_mfma_f32_16x16x32_bf16 v[20:23], a[224:227], v[164:167], 0
    v_exp_f32 v16, v140
    v_mfma_f32_16x16x32_bf16 v[32:35], a[228:231], v[164:167], 0
    v_exp_f32 v17, v141
    v_mfma_f32_16x16x32_bf16 v[36:39], a[228:231], v[168:171], 0
    buffer_load_dwordx4 v8, s[28:31], s57 offen offset:0 nt lds
    v_mfma_f32_16x16x32_bf16 v[40:43], a[228:231], v[172:175], 0
    ds_read_b64_tr_b16 a[202:203], v2 offset:51200
    s_waitcnt lgkmcnt(2)
    v_mfma_f32_16x16x32_bf16 v[52:55], a[192:195], v[172:175], 0
    ds_read_b64_tr_b16 a[204:205], v3 offset:8448
    ds_read_b64_tr_b16 a[206:207], v3 offset:8960
    v_mfma_f32_16x16x32_bf16 v[48:51], a[192:195], v[168:171], 0
    ds_read_b64_tr_b16 a[208:209], v2 offset:50720
    ds_read_b64_tr_b16 a[210:211], v2 offset:51232
    v_mfma_f32_16x16x32_bf16 v[44:47], a[192:195], v[164:167], 0
    buffer_load_dwordx4 v9, s[28:31], s57 offen offset:1056 nt lds
    v_mfma_f32_16x16x32_bf16 v[56:59], a[196:199], v[164:167], 0
    s_add_u32 m0, s56, 59136
    s_mov_b32 s57, 65536
    v_mfma_f32_16x16x32_bf16 v[60:63], a[196:199], v[168:171], 0
    ds_read_b64_tr_b16 a[212:213], v3 offset:8480
    ds_read_b64_tr_b16 a[214:215], v3 offset:8992
    v_mfma_f32_16x16x32_bf16 v[64:67], a[196:199], v[172:175], 0
    ds_read_b64_tr_b16 a[216:217], v3 offset:50816
    s_waitcnt lgkmcnt(7)
    v_mfma_f32_16x16x32_bf16 a[0:3], a[200:203], a[144:147], a[0:3]
    ds_read_b64_tr_b16 a[218:219], v3 offset:51328
    s_waitcnt lgkmcnt(6)
    v_mfma_f32_16x16x32_bf16 a[0:3], a[204:207], a[156:159], a[0:3]
    buffer_load_dwordx4 v8, s[24:27], s57 offen offset:0 nt lds
    v_mfma_f32_16x16x32_bf16 a[4:7], a[204:207], a[160:163], a[4:7]
    ds_read_b64_tr_b16 a[220:221], v3 offset:50848
    ds_read_b64_tr_b16 a[222:223], v3 offset:51360
    v_mfma_f32_16x16x32_bf16 a[4:7], a[200:203], a[148:151], a[4:7]
    v_exp_f32 v18, v142
    v_mfma_f32_16x16x32_bf16 a[8:11], a[200:203], a[152:155], a[8:11]
    ds_read_b64_tr_b16 a[224:225], v3 offset:50880
    v_cvt_pk_bf16_f32 v176, v16, v17
    v_mfma_f32_16x16x32_bf16 a[8:11], a[204:207], a[164:167], a[8:11]
    ds_read_b64_tr_b16 a[226:227], v3 offset:51392
    s_waitcnt lgkmcnt(8)
    v_mfma_f32_16x16x32_bf16 a[12:15], a[208:211], a[144:147], a[12:15]
    ds_read_b64_tr_b16 a[228:229], v3 offset:50912
    s_waitcnt lgkmcnt(7)
    v_mfma_f32_16x16x32_bf16 a[12:15], a[212:215], a[156:159], a[12:15]
    buffer_load_dwordx4 v9, s[24:27], s57 offen offset:1056 nt lds
    v_mfma_f32_16x16x32_bf16 a[16:19], a[212:215], a[160:163], a[16:19]
    s_add_u32 m0, s56, 92928
    s_add_u32 s57, s58, 2883840
    s_and_b32 s57, s57, 0x3fffff
    v_mfma_f32_16x16x32_bf16 a[16:19], a[208:211], a[148:151], a[16:19]
    v_exp_f32 v19, v143
    v_mfma_f32_16x16x32_bf16 a[20:23], a[208:211], a[152:155], a[20:23]
    v_exp_f32 v16, v144
    v_mfma_f32_16x16x32_bf16 a[20:23], a[212:215], a[164:167], a[20:23]
    ds_read_b64_tr_b16 a[230:231], v3 offset:51424
    s_waitcnt lgkmcnt(4)
    v_mfma_f32_16x16x32_bf16 v[76:79], a[216:219], v[172:175], 0
    buffer_load_dwordx4 v10, s[32:35], s57 offen offset:0 lds
    v_mfma_f32_16x16x32_bf16 v[72:75], a[216:219], v[168:171], 0
    ds_read_b128 a[192:195], v6 offset:59136
    v_cvt_pk_bf16_f32 v177, v18, v19
    v_mfma_f32_16x16x32_bf16 v[68:71], a[216:219], v[164:167], 0
    v_exp_f32 v17, v145
    v_mfma_f32_16x16x32_bf16 v[80:83], a[220:223], v[164:167], 0
    v_exp_f32 v18, v146
    v_mfma_f32_16x16x32_bf16 v[84:87], a[220:223], v[168:171], 0
    buffer_load_dwordx4 v11, s[32:35], s57 offen offset:1056 lds
    v_mfma_f32_16x16x32_bf16 v[88:91], a[220:223], v[172:175], 0
    s_add_u32 m0, s56, 152064
    s_mov_b32 s57, 57344
    s_waitcnt lgkmcnt(2)
    v_mfma_f32_16x16x32_bf16 v[100:103], a[224:227], v[172:175], 0
    ds_read_b128 a[196:199], v6 offset:59200
    v_cvt_pk_bf16_f32 v180, v16, v17
    v_mfma_f32_16x16x32_bf16 v[96:99], a[224:227], v[168:171], 0
    v_exp_f32 v19, v147
    v_mfma_f32_16x16x32_bf16 v[92:95], a[224:227], v[164:167], 0
    ds_read_b128 a[200:203], v6 offset:59264
    s_waitcnt lgkmcnt(3)
    v_mfma_f32_16x16x32_bf16 v[104:107], a[228:231], v[164:167], 0
    ds_read_b128 a[204:207], v6 offset:59328
    buffer_load_dwordx4 v8, s[28:31], s57 offen offset:0 nt lds
    v_mfma_f32_16x16x32_bf16 v[108:111], a[228:231], v[168:171], 0
    v_exp_f32 v16, v148
    v_mfma_f32_16x16x32_bf16 v[112:115], a[228:231], v[172:175], 0
    v_cvt_pk_bf16_f32 v181, v18, v19
    s_waitcnt lgkmcnt(3)
    v_mfma_f32_16x16x32_bf16 v[116:119], a[192:195], v[208:211], v[188:191]
    ds_read_b128 a[208:211], v6 offset:59648
    s_waitcnt lgkmcnt(3)
    v_mfma_f32_16x16x32_bf16 v[116:119], a[196:199], v[220:223], v[116:119]
    ds_read_b128 a[212:215], v6 offset:59712
    s_waitcnt lgkmcnt(3)
    v_mfma_f32_16x16x32_bf16 v[116:119], a[200:203], v[232:235], v[116:119]
    ds_read_b128 a[216:219], v6 offset:59776
    s_waitcnt lgkmcnt(3)
    v_mfma_f32_16x16x32_bf16 v[116:119], a[204:207], v[244:247], v[116:119]
    buffer_load_dwordx4 v9, s[28:31], s57 offen offset:1056 nt lds
    v_mfma_f32_16x16x32_bf16 v[120:123], a[204:207], v[248:251], v[192:195]
    v_exp_f32 v17, v149
    v_mfma_f32_16x16x32_bf16 v[120:123], a[200:203], v[236:239], v[120:123]
    v_exp_f32 v18, v150
    v_mfma_f32_16x16x32_bf16 v[120:123], a[196:199], v[224:227], v[120:123]
    v_cvt_pk_bf16_f32 v184, v16, v17
    v_mov_b32 v203, 0
    v_mfma_f32_16x16x32_bf16 v[120:123], a[192:195], v[212:215], v[120:123]
    v_exp_f32 v19, v151
    v_mfma_f32_16x16x32_bf16 v[124:127], a[192:195], v[216:219], v[196:199]
    v_exp_f32 v16, v152
    v_mfma_f32_16x16x32_bf16 v[124:127], a[196:199], v[228:231], v[124:127]
    ds_read_b128 a[220:223], v6 offset:59840
    v_cvt_pk_bf16_f32 v185, v18, v19
    v_mfma_f32_16x16x32_bf16 v[124:127], a[200:203], v[240:243], v[124:127]
    v_exp_f32 v17, v153
    v_mfma_f32_16x16x32_bf16 v[124:127], a[204:207], v[252:255], v[124:127]
    ds_read_b64_tr_b16 a[224:225], v2 offset:0
    s_waitcnt lgkmcnt(2)
    v_mfma_f32_16x16x32_bf16 v[128:131], a[208:211], v[208:211], v[188:191]
    v_exp_f32 v18, v154
    v_mfma_f32_16x16x32_bf16 v[128:131], a[212:215], v[220:223], v[128:131]
    ds_read_b64_tr_b16 a[226:227], v2 offset:512
    v_cvt_pk_bf16_f32 v178, v16, v17
    v_mfma_f32_16x16x32_bf16 v[128:131], a[216:219], v[232:235], v[128:131]
    ds_read_b64_tr_b16 a[228:229], v2 offset:32
    s_waitcnt lgkmcnt(3)
    v_mfma_f32_16x16x32_bf16 v[128:131], a[220:223], v[244:247], v[128:131]
    v_exp_f32 v19, v155
    v_mfma_f32_16x16x32_bf16 v[132:135], a[220:223], v[248:251], v[192:195]
    v_exp_f32 v16, v156
    v_mfma_f32_16x16x32_bf16 v[132:135], a[216:219], v[236:239], v[132:135]
    ds_read_b64_tr_b16 a[230:231], v2 offset:544
    v_cvt_pk_bf16_f32 v179, v18, v19
    v_mfma_f32_16x16x32_bf16 v[132:135], a[212:215], v[224:227], v[132:135]
    v_exp_f32 v17, v157
    v_exp_f32 v18, v158
    v_cvt_pk_bf16_f32 v182, v16, v17
    v_exp_f32 v19, v159
    v_exp_f32 v16, v160
    v_cvt_pk_bf16_f32 v183, v18, v19
    v_mfma_f32_16x16x32_bf16 v[132:135], a[208:211], v[212:215], v[132:135]
    v_exp_f32 v17, v161
    v_exp_f32 v18, v162
    v_cvt_pk_bf16_f32 v186, v16, v17
    v_exp_f32 v19, v163
    s_nop 0
    v_cvt_pk_bf16_f32 v187, v18, v19
    v_mfma_f32_16x16x32_bf16 v[204:207], a[232:235], v[176:179], v[200:203]
    ds_read_b64_tr_b16 a[192:193], v2 offset:64
    ds_read_b64_tr_b16 a[194:195], v2 offset:576
    v_mfma_f32_16x16x32_bf16 v[204:207], a[236:239], v[180:183], v[204:207]
    ds_read_b64_tr_b16 a[196:197], v2 offset:96
    ds_read_b64_tr_b16 a[198:199], v2 offset:608
    v_mfma_f32_16x16x32_bf16 v[204:207], a[240:243], v[184:187], v[204:207]
    ds_read_b64_tr_b16 a[200:201], v2 offset:50752
    ds_read_b64_tr_b16 a[202:203], v2 offset:51264
    v_mfma_f32_16x16x32_bf16 v[136:139], a[208:211], v[216:219], v[196:199]
    s_waitcnt vmcnt(12)
    v_cmp_gt_u32 vcc, 1, v14
    s_and_b32 s87, vcc_lo, s77
    s_cbranch_scc1 K_PX
K_PX_ret:
    v_mfma_f32_16x16x32_bf16 v[136:139], a[212:215], v[228:231], v[136:139]
    ds_read_b64_tr_b16 a[204:205], v3 offset:8512
    ds_read_b64_tr_b16 a[206:207], v3 offset:9024
    v_mfma_f32_16x16x32_bf16 v[136:139], a[216:219], v[240:243], v[136:139]
    v_cmp_nge_f32 vcc, s84, v207
    s_waitcnt lgkmcnt(9)
    s_barrier
    v_mfma_f32_16x16x32_bf16 v[136:139], a[220:223], v[252:255], v[136:139]
    s_cbranch_vccnz K_R0_1
K_R0_1_ret:
    s_add_u32 m0, s56, 118272
    s_mov_b32 s57, 73728
    v_mfma_f32_16x16x32_bf16 v[28:31], a[224:227], v[184:187], v[28:31]
    buffer_load_dwordx4 v8, s[24:27], s57 offen offset:0 nt lds
    v_mfma_f32_16x16x32_bf16 v[24:27], a[224:227], v[180:183], v[24:27]
    v_cmp_eq_u32 vcc, s9, v14
    s_andn2_b32 s8, s78, vcc_lo
    v_mfma_f32_16x16x32_bf16 v[20:23], a[224:227], v[176:179], v[20:23]
    ds_read_b64_tr_b16 a[208:209], v2 offset:50784
    s_waitcnt lgkmcnt(7)
    v_mfma_f32_16x16x32_bf16 v[32:35], a[228:231], v[176:179], v[32:35]
    ds_read_b64_tr_b16 a[210:211], v2 offset:51296
    ds_read_b64_tr_b16 a[212:213], v3 offset:8544
    v_mfma_f32_16x16x32_bf16 v[36:39], a[228:231], v[180:183], v[36:39]
    buffer_load_dwordx4 v9, s[24:27], s57 offen offset:1056 nt lds
    v_mfma_f32_16x16x32_bf16 v[40:43], a[228:231], v[184:187], v[40:43]
    s_add_u32 m0, s56, 126720
    s_mov_b32 s57, 65536
    v_mfma_f32_16x16x32_bf16 v[52:55], a[192:195], v[184:187], v[52:55]
    v_exp_f32 v16, v116
    v_mfma_f32_16x16x32_bf16 v[48:51], a[192:195], v[180:183], v[48:51]
    ds_read_b64_tr_b16 a[214:215], v3 offset:9056
    ds_read_b64_tr_b16 a[216:217], v2 offset:128
    v_mfma_f32_16x16x32_bf16 v[44:47], a[192:195], v[176:179], v[44:47]
    ds_read_b64_tr_b16 a[218:219], v2 offset:640
    s_waitcnt lgkmcnt(6)
    v_mfma_f32_16x16x32_bf16 v[56:59], a[196:199], v[176:179], v[56:59]
    buffer_load_dwordx4 v8, s[28:31], s57 offen offset:0 nt lds
    v_mfma_f32_16x16x32_bf16 v[60:63], a[196:199], v[180:183], v[60:63]
    v_exp_f32 v17, v117
    v_mfma_f32_16x16x32_bf16 v[64:67], a[196:199], v[184:187], v[64:67]
    ds_read_b64_tr_b16 a[220:221], v2 offset:160
    ds_read_b64_tr_b16 a[222:223], v2 offset:672
    v_mfma_f32_16x16x32_bf16 a[24:27], a[200:203], a[144:147], a[24:27]
    v_exp_f32 v18, v118
    v_mfma_f32_16x16x32_bf16 a[24:27], a[204:207], a[156:159], a[24:27]
    buffer_load_dwordx4 v9, s[28:31], s57 offen offset:1056 nt lds
    v_mfma_f32_16x16x32_bf16 a[28:31], a[204:207], a[160:163], a[28:31]
    ds_read_b64_tr_b16 a[224:225], v2 offset:192
    v_cvt_pk_bf16_f32 v164, v16, v17
    v_mfma_f32_16x16x32_bf16 a[28:31], a[200:203], a[148:151], a[28:31]
    ds_read_b64_tr_b16 a[226:227], v2 offset:704
    ds_read_b64_tr_b16 a[228:229], v2 offset:224
    v_mfma_f32_16x16x32_bf16 a[32:35], a[200:203], a[152:155], a[32:35]
    v_exp_f32 v19, v119
    v_mfma_f32_16x16x32_bf16 a[32:35], a[204:207], a[164:167], a[32:35]
    ds_read_b64_tr_b16 a[230:231], v2 offset:736
    s_waitcnt lgkmcnt(6)
    v_mfma_f32_16x16x32_bf16 a[36:39], a[208:211], a[144:147], a[36:39]
    v_exp_f32 v16, v120
    v_mfma_f32_16x16x32_bf16 a[36:39], a[212:215], a[156:159], a[36:39]
    ds_read_b128 a[192:195], v5 offset:8448
    v_cvt_pk_bf16_f32 v165, v18, v19
    v_mfma_f32_16x16x32_bf16 a[40:43], a[212:215], a[160:163], a[40:43]
    v_exp_f32 v17, v121
    v_mfma_f32_16x16x32_bf16 a[40:43], a[208:211], a[148:151], a[40:43]
    v_exp_f32 v18, v122
    v_mfma_f32_16x16x32_bf16 a[44:47], a[208:211], a[152:155], a[44:47]
    ds_read_b128 a[196:199], v5 offset:8512
    v_cvt_pk_bf16_f32 v168, v16, v17
    v_mfma_f32_16x16x32_bf16 a[44:47], a[212:215], a[164:167], a[44:47]
    v_exp_f32 v19, v123
    v_mfma_f32_16x16x32_bf16 v[76:79], a[216:219], v[184:187], v[76:79]
    v_exp_f32 v16, v124
    v_mfma_f32_16x16x32_bf16 v[72:75], a[216:219], v[180:183], v[72:75]
    ds_read_b128 a[200:203], v5 offset:8576
    v_cvt_pk_bf16_f32 v169, v18, v19
    v_mfma_f32_16x16x32_bf16 v[68:71], a[216:219], v[176:179], v[68:71]
    ds_read_b128 a[204:207], v5 offset:8640
    s_waitcnt lgkmcnt(4)
    v_mfma_f32_16x16x32_bf16 v[80:83], a[220:223], v[176:179], v[80:83]
    v_exp_f32 v17, v125
    v_mfma_f32_16x16x32_bf16 v[84:87], a[220:223], v[180:183], v[84:87]
    v_exp_f32 v18, v126
    v_mfma_f32_16x16x32_bf16 v[88:91], a[220:223], v[184:187], v[88:91]
    ds_read_b128 a[208:211], v5 offset:8960
    v_cvt_pk_bf16_f32 v172, v16, v17
    v_mfma_f32_16x16x32_bf16 v[100:103], a[224:227], v[184:187], v[100:103]
    v_exp_f32 v19, v127
    v_mfma_f32_16x16x32_bf16 v[96:99], a[224:227], v[180:183], v[96:99]
    v_exp_f32 v16, v128
    v_mfma_f32_16x16x32_bf16 v[92:95], a[224:227], v[176:179], v[92:95]
    ds_read_b128 a[212:215], v5 offset:9024
    v_cvt_pk_bf16_f32 v173, v18, v19
    v_mfma_f32_16x16x32_bf16 v[104:107], a[228:231], v[176:179], v[104:107]
    v_exp_f32 v17, v129
    v_mfma_f32_16x16x32_bf16 v[108:111], a[228:231], v[180:183], v[108:111]
    ds_read_b128 a[216:219], v5 offset:9088
    v_mov_b32 v207, 0
    v_mfma_f32_16x16x32_bf16 v[112:115], a[228:231], v[184:187], v[112:115]
    ds_read_b128 a[220:223], v5 offset:9152
    s_waitcnt lgkmcnt(4)
    v_mfma_f32_16x16x32_bf16 v[140:143], a[192:195], v[208:211], v[188:191]
    v_exp_f32 v18, v130
    v_mfma_f32_16x16x32_bf16 v[140:143], a[196:199], v[220:223], v[140:143]
    ds_read_b64_tr_b16 a[224:225], v2 offset:16896
    v_cvt_pk_bf16_f32 v166, v16, v17
    v_mfma_f32_16x16x32_bf16 v[140:143], a[200:203], v[232:235], v[140:143]
    v_exp_f32 v19, v131
    v_mfma_f32_16x16x32_bf16 v[140:143], a[204:207], v[244:247], v[140:143]
    v_exp_f32 v16, v132
    v_mfma_f32_16x16x32_bf16 v[144:147], a[204:207], v[248:251], v[192:195]
    ds_read_b64_tr_b16 a[226:227], v2 offset:17408
    v_cvt_pk_bf16_f32 v167, v18, v19
    v_mfma_f32_16x16x32_bf16 v[144:147], a[200:203], v[236:239], v[144:147]
    v_exp_f32 v17, v133
    v_mfma_f32_16x16x32_bf16 v[144:147], a[196:199], v[224:227], v[144:147]
    ds_read_b64_tr_b16 a[228:229], v2 offset:16928
    ds_read_b64_tr_b16 a[230:231], v2 offset:17440
    v_mfma_f32_16x16x32_bf16 v[144:147], a[192:195], v[212:215], v[144:147]
    v_exp_f32 v18, v134
    v_mfma_f32_16x16x32_bf16 v[148:151], a[192:195], v[216:219], v[196:199]
    ds_read_b64_tr_b16 a[192:193], v2 offset:16960
    v_cvt_pk_bf16_f32 v170, v16, v17
    v_mfma_f32_16x16x32_bf16 v[148:151], a[196:199], v[228:231], v[148:151]
    v_exp_f32 v19, v135
    v_mfma_f32_16x16x32_bf16 v[148:151], a[200:203], v[240:243], v[148:151]
    v_exp_f32 v16, v136
    v_mfma_f32_16x16x32_bf16 v[148:151], a[204:207], v[252:255], v[148:151]
    v_cvt_pk_bf16_f32 v171, v18, v19
    s_waitcnt lgkmcnt(4)
    v_mfma_f32_16x16x32_bf16 v[152:155], a[208:211], v[208:211], v[188:191]
    v_exp_f32 v17, v137
    v_mfma_f32_16x16x32_bf16 v[152:155], a[212:215], v[220:223], v[152:155]
    ds_read_b64_tr_b16 a[194:195], v2 offset:17472
    ds_read_b64_tr_b16 a[196:197], v2 offset:16992
    v_mfma_f32_16x16x32_bf16 v[152:155], a[216:219], v[232:235], v[152:155]
    v_exp_f32 v18, v138
    v_mfma_f32_16x16x32_bf16 v[152:155], a[220:223], v[244:247], v[152:155]
    ds_read_b64_tr_b16 a[198:199], v2 offset:17504
    ds_read_b64_tr_b16 a[200:201], v2 offset:50816
    v_mfma_f32_16x16x32_bf16 v[156:159], a[220:223], v[248:251], v[192:195]
    ds_read_b64_tr_b16 a[202:203], v2 offset:51328
    v_cvt_pk_bf16_f32 v174, v16, v17
    v_mfma_f32_16x16x32_bf16 v[156:159], a[216:219], v[236:239], v[156:159]
    ds_read_b64_tr_b16 a[204:205], v3 offset:8576
    ds_read_b64_tr_b16 a[206:207], v3 offset:9088
    v_mfma_f32_16x16x32_bf16 v[156:159], a[212:215], v[224:227], v[156:159]
    v_exp_f32 v19, v139
    v_mfma_f32_16x16x32_bf16 v[156:159], a[208:211], v[212:215], v[156:159]
    v_cvt_pk_bf16_f32 v175, v18, v19
    v_mfma_f32_16x16x32_bf16 v[200:203], a[232:235], v[164:167], v[204:207]
    v_mfma_f32_16x16x32_bf16 v[200:203], a[236:239], v[168:171], v[200:203]
    v_mfma_f32_16x16x32_bf16 v[200:203], a[240:243], v[172:175], v[200:203]
    s_nop 1
    v_mfma_f32_16x16x32_bf16 v[160:163], a[208:211], v[216:219], v[196:199]
    ds_read_b64_tr_b16 a[208:209], v2 offset:50848
    ds_read_b64_tr_b16 a[210:211], v2 offset:51360
    v_mfma_f32_16x16x32_bf16 v[160:163], a[212:215], v[228:231], v[160:163]
    ds_read_b64_tr_b16 a[212:213], v3 offset:8608
    ds_read_b64_tr_b16 a[214:215], v3 offset:9120
    v_mfma_f32_16x16x32_bf16 v[160:163], a[216:219], v[240:243], v[160:163]
    v_cmp_nge_f32 vcc, s84, v203
    s_waitcnt lgkmcnt(6)
    s_barrier
    v_mfma_f32_16x16x32_bf16 v[160:163], a[220:223], v[252:255], v[160:163]
    s_cbranch_vccnz K_R0_2
K_R0_2_ret:
    s_add_u32 m0, s56, 0
    s_mov_b32 s57, 81920
    v_mfma_f32_16x16x32_bf16 v[28:31], a[224:227], v[172:175], v[28:31]
    buffer_load_dwordx4 v8, s[24:27], s57 offen offset:0 nt lds
    v_mfma_f32_16x16x32_bf16 v[24:27], a[224:227], v[168:171], v[24:27]
    v_exp_f32 v16, v140
    v_mfma_f32_16x16x32_bf16 v[20:23], a[224:227], v[164:167], v[20:23]
    ds_read_b64_tr_b16 a[216:217], v2 offset:50880
    ds_read_b64_tr_b16 a[218:219], v2 offset:51392
    v_mfma_f32_16x16x32_bf16 v[32:35], a[228:231], v[164:167], v[32:35]
    v_exp_f32 v17, v141
    v_mfma_f32_16x16x32_bf16 v[36:39], a[228:231], v[168:171], v[36:39]
    buffer_load_dwordx4 v9, s[24:27], s57 offen offset:1056 nt lds
    v_mfma_f32_16x16x32_bf16 v[40:43], a[228:231], v[172:175], v[40:43]
    s_add_u32 m0, s56, 8448
    s_mov_b32 s57, 73728
    v_mfma_f32_16x16x32_bf16 v[52:55], a[192:195], v[172:175], v[52:55]
    ds_read_b64_tr_b16 a[220:221], v3 offset:8640
    ds_read_b64_tr_b16 a[222:223], v3 offset:9152
    v_mfma_f32_16x16x32_bf16 v[48:51], a[192:195], v[168:171], v[48:51]
    v_exp_f32 v18, v142
    v_mfma_f32_16x16x32_bf16 v[44:47], a[192:195], v[164:167], v[44:47]
    buffer_load_dwordx4 v8, s[28:31], s57 offen offset:0 nt lds
    v_mfma_f32_16x16x32_bf16 v[56:59], a[196:199], v[164:167], v[56:59]
    ds_read_b64_tr_b16 a[224:225], v2 offset:17024
    ds_read_b64_tr_b16 a[226:227], v2 offset:17536
    v_mfma_f32_16x16x32_bf16 v[60:63], a[196:199], v[168:171], v[60:63]
    ds_read_b64_tr_b16 a[228:229], v2 offset:17056
    v_cvt_pk_bf16_f32 v176, v16, v17
    v_mfma_f32_16x16x32_bf16 v[64:67], a[196:199], v[172:175], v[64:67]
    v_exp_f32 v19, v143
    v_mfma_f32_16x16x32_bf16 a[48:51], a[200:203], a[144:147], a[48:51]
    ds_read_b64_tr_b16 a[230:231], v2 offset:17568
    s_waitcnt lgkmcnt(6)
    v_mfma_f32_16x16x32_bf16 a[48:51], a[204:207], a[156:159], a[48:51]
    buffer_load_dwordx4 v9, s[28:31], s57 offen offset:1056 nt lds
    v_mfma_f32_16x16x32_bf16 a[52:55], a[204:207], a[160:163], a[52:55]
    v_exp_f32 v16, v144
    v_mfma_f32_16x16x32_bf16 a[52:55], a[200:203], a[148:151], a[52:55]
    ds_read_b64_tr_b16 a[192:193], v2 offset:17088
    v_cvt_pk_bf16_f32 v177, v18, v19
    v_mfma_f32_16x16x32_bf16 a[56:59], a[200:203], a[152:155], a[56:59]
    ds_read_b64_tr_b16 a[194:195], v2 offset:17600
    ds_read_b64_tr_b16 a[196:197], v2 offset:17120
    v_mfma_f32_16x16x32_bf16 a[56:59], a[204:207], a[164:167], a[56:59]
    v_exp_f32 v17, v145
    v_mfma_f32_16x16x32_bf16 a[60:63], a[208:211], a[144:147], a[60:63]
    v_exp_f32 v18, v146
    v_mfma_f32_16x16x32_bf16 a[60:63], a[212:215], a[156:159], a[60:63]
    ds_read_b64_tr_b16 a[198:199], v2 offset:17632
    v_cvt_pk_bf16_f32 v180, v16, v17
    v_mfma_f32_16x16x32_bf16 a[64:67], a[212:215], a[160:163], a[64:67]
    v_exp_f32 v19, v147
    v_mfma_f32_16x16x32_bf16 a[64:67], a[208:211], a[148:151], a[64:67]
    v_exp_f32 v16, v148
    v_mfma_f32_16x16x32_bf16 a[68:71], a[208:211], a[152:155], a[68:71]
    ds_read_b128 a[200:203], v6 offset:0
    ds_read_b128 a[204:207], v6 offset:64
    v_mfma_f32_16x16x32_bf16 a[68:71], a[212:215], a[164:167], a[68:71]
    ds_read_b128 a[208:211], v6 offset:128
    v_cvt_pk_bf16_f32 v181, v18, v19
    v_mfma_f32_16x16x32_bf16 a[72:75], a[216:219], a[144:147], a[72:75]
    ds_read_b128 a[212:215], v6 offset:192
    s_waitcnt lgkmcnt(7)
    v_mfma_f32_16x16x32_bf16 a[72:75], a[220:223], a[156:159], a[72:75]
    v_exp_f32 v17, v149
    v_mfma_f32_16x16x32_bf16 a[76:79], a[220:223], a[160:163], a[76:79]
    v_exp_f32 v18, v150
    v_mfma_f32_16x16x32_bf16 a[76:79], a[216:219], a[148:151], a[76:79]
    v_cvt_pk_bf16_f32 v184, v16, v17
    v_mov_b32 v203, 0
    v_mfma_f32_16x16x32_bf16 a[80:83], a[216:219], a[152:155], a[80:83]
    v_exp_f32 v19, v151
    v_mfma_f32_16x16x32_bf16 a[80:83], a[220:223], a[164:167], a[80:83]
    v_exp_f32 v16, v152
    v_mfma_f32_16x16x32_bf16 v[76:79], a[224:227], v[172:175], v[76:79]
    ds_read_b128 a[216:219], v6 offset:512
    v_cvt_pk_bf16_f32 v185, v18, v19
    v_mfma_f32_16x16x32_bf16 v[72:75], a[224:227], v[168:171], v[72:75]
    v_exp_f32 v17, v153
    v_mfma_f32_16x16x32_bf16 v[68:71], a[224:227], v[164:167], v[68:71]
    ds_read_b128 a[220:223], v6 offset:576
    ds_read_b128 a[224:227], v6 offset:640
    v_mfma_f32_16x16x32_bf16 v[80:83], a[228:231], v[164:167], v[80:83]
    v_exp_f32 v18, v154
    v_mfma_f32_16x16x32_bf16 v[84:87], a[228:231], v[168:171], v[84:87]
    v_cvt_pk_bf16_f32 v178, v16, v17
    v_mfma_f32_16x16x32_bf16 v[88:91], a[228:231], v[172:175], v[88:91]
    ds_read_b128 a[228:231], v6 offset:704
    s_waitcnt lgkmcnt(4)
    v_mfma_f32_16x16x32_bf16 v[100:103], a[192:195], v[172:175], v[100:103]
    v_exp_f32 v19, v155
    v_mfma_f32_16x16x32_bf16 v[96:99], a[192:195], v[168:171], v[96:99]
    v_exp_f32 v16, v156
    v_mfma_f32_16x16x32_bf16 v[92:95], a[192:195], v[164:167], v[92:95]
    ds_read_b64_tr_b16 a[192:193], v3 offset:33792
    v_cvt_pk_bf16_f32 v179, v18, v19
    v_mfma_f32_16x16x32_bf16 v[104:107], a[196:199], v[164:167], v[104:107]
    ds_read_b64_tr_b16 a[194:195], v3 offset:34304
    v_mfma_f32_16x16x32_bf16 v[108:111], a[196:199], v[168:171], v[108:111]
    v_exp_f32 v17, v157
    v_mfma_f32_16x16x32_bf16 v[112:115], a[196:199], v[172:175], v[112:115]
    v_exp_f32 v18, v158
    v_mfma_f32_16x16x32_bf16 v[116:119], a[200:203], v[208:211], v[188:191]
    ds_read_b64_tr_b16 a[196:197], v3 offset:33824
    ds_read_b64_tr_b16 a[198:199], v3 offset:34336
    v_mfma_f32_16x16x32_bf16 v[116:119], a[204:207], v[220:223], v[116:119]
    v_cvt_pk_bf16_f32 v182, v16, v17
    v_mfma_f32_16x16x32_bf16 v[116:119], a[208:211], v[232:235], v[116:119]
    v_exp_f32 v19, v159
    v_mfma_f32_16x16x32_bf16 v[116:119], a[212:215], v[244:247], v[116:119]
    v_exp_f32 v16, v160
    v_mfma_f32_16x16x32_bf16 v[120:123], a[212:215], v[248:251], v[192:195]
    v_cvt_pk_bf16_f32 v183, v18, v19
    v_mfma_f32_16x16x32_bf16 v[120:123], a[208:211], v[236:239], v[120:123]
    v_exp_f32 v17, v161
    v_mfma_f32_16x16x32_bf16 v[120:123], a[204:207], v[224:227], v[120:123]
    v_exp_f32 v18, v162
    v_mfma_f32_16x16x32_bf16 v[120:123], a[200:203], v[212:215], v[120:123]
    v_cvt_pk_bf16_f32 v186, v16, v17
    v_mfma_f32_16x16x32_bf16 v[124:127], a[200:203], v[216:219], v[196:199]
    ds_read_b64_tr_b16 a[200:201], v3 offset:33856
    ds_read_b64_tr_b16 a[202:203], v3 offset:34368
    v_mfma_f32_16x16x32_bf16 v[124:127], a[204:207], v[228:231], v[124:127]
    ds_read_b64_tr_b16 a[204:205], v3 offset:33888
    ds_read_b64_tr_b16 a[206:207], v3 offset:34400
    v_mfma_f32_16x16x32_bf16 v[124:127], a[208:211], v[240:243], v[124:127]
    ds_read_b64_tr_b16 a[208:209], v2 offset:50912
    ds_read_b64_tr_b16 a[210:211], v2 offset:51424
    v_mfma_f32_16x16x32_bf16 v[124:127], a[212:215], v[252:255], v[124:127]
    ds_read_b64_tr_b16 a[212:213], v3 offset:8672
    s_waitcnt lgkmcnt(7)
    v_mfma_f32_16x16x32_bf16 v[128:131], a[216:219], v[208:211], v[188:191]
    ds_read_b64_tr_b16 a[214:215], v3 offset:9184
    v_mfma_f32_16x16x32_bf16 v[128:131], a[220:223], v[220:223], v[128:131]
    v_exp_f32 v19, v163
    v_mfma_f32_16x16x32_bf16 v[128:131], a[224:227], v[232:235], v[128:131]
    v_cvt_pk_bf16_f32 v187, v18, v19
    v_mfma_f32_16x16x32_bf16 v[128:131], a[228:231], v[244:247], v[128:131]
    v_mfma_f32_16x16x32_bf16 v[132:135], a[228:231], v[248:251], v[192:195]
    v_mfma_f32_16x16x32_bf16 v[132:135], a[224:227], v[236:239], v[132:135]
    v_mfma_f32_16x16x32_bf16 v[132:135], a[220:223], v[224:227], v[132:135]
    v_mfma_f32_16x16x32_bf16 v[132:135], a[216:219], v[212:215], v[132:135]
    v_mfma_f32_16x16x32_bf16 v[204:207], a[232:235], v[176:179], v[200:203]
    v_mfma_f32_16x16x32_bf16 v[204:207], a[236:239], v[180:183], v[204:207]
    v_mfma_f32_16x16x32_bf16 v[204:207], a[240:243], v[184:187], v[204:207]
    s_nop 1
    v_mfma_f32_16x16x32_bf16 v[136:139], a[216:219], v[216:219], v[196:199]
    s_nop 1
    v_mfma_f32_16x16x32_bf16 v[136:139], a[220:223], v[228:231], v[136:139]
    s_nop 0
    v_mfma_f32_16x16x32_bf16 v[136:139], a[224:227], v[240:243], v[136:139]
    v_cmp_nge_f32 vcc, s84, v207
    s_waitcnt vmcnt(10) lgkmcnt(0)
    s_barrier
    v_mfma_f32_16x16x32_bf16 v[136:139], a[228:231], v[252:255], v[136:139]
    s_cbranch_vccnz K_R0_3
K_R0_3_ret:
    s_add_u32 m0, s56, 16896
    s_mov_b32 s57, 90112
    v_mfma_f32_16x16x32_bf16 v[28:31], a[192:195], v[184:187], v[28:31]
    buffer_load_dwordx4 v8, s[24:27], s57 offen offset:0 nt lds
    v_mfma_f32_16x16x32_bf16 v[24:27], a[192:195], v[180:183], v[24:27]
    v_exp_f32 v16, v116
    v_mfma_f32_16x16x32_bf16 v[20:23], a[192:195], v[176:179], v[20:23]
    v_exp_f32 v17, v117
    v_mfma_f32_16x16x32_bf16 v[32:35], a[196:199], v[176:179], v[32:35]
    ds_read_b64_tr_b16 a[216:217], v4 offset:8448
    ds_read_b64_tr_b16 a[218:219], v4 offset:8960
    v_mfma_f32_16x16x32_bf16 v[36:39], a[196:199], v[180:183], v[36:39]
    buffer_load_dwordx4 v9, s[24:27], s57 offen offset:1056 nt lds
    v_mfma_f32_16x16x32_bf16 v[40:43], a[196:199], v[184:187], v[40:43]
    s_add_u32 m0, s56, 50688
    s_mov_b32 s57, 81920
    v_mfma_f32_16x16x32_bf16 v[52:55], a[200:203], v[184:187], v[52:55]
    ds_read_b64_tr_b16 a[220:221], v3 offset:25344
    ds_read_b64_tr_b16 a[222:223], v3 offset:25856
    v_mfma_f32_16x16x32_bf16 v[48:51], a[200:203], v[180:183], v[48:51]
    ds_read_b64_tr_b16 a[224:225], v3 offset:33920
    ds_read_b64_tr_b16 a[226:227], v3 offset:34432
    v_mfma_f32_16x16x32_bf16 v[44:47], a[200:203], v[176:179], v[44:47]
    buffer_load_dwordx4 v8, s[28:31], s57 offen offset:0 nt lds
    v_mfma_f32_16x16x32_bf16 v[56:59], a[204:207], v[176:179], v[56:59]
    ds_read_b64_tr_b16 a[228:229], v3 offset:33952
    ds_read_b64_tr_b16 a[230:231], v3 offset:34464
    v_mfma_f32_16x16x32_bf16 v[60:63], a[204:207], v[180:183], v[60:63]
    v_exp_f32 v18, v118
    v_mfma_f32_16x16x32_bf16 v[64:67], a[204:207], v[184:187], v[64:67]
    ds_read_b64_tr_b16 a[192:193], v3 offset:33984
    v_cvt_pk_bf16_f32 v164, v16, v17
    v_mfma_f32_16x16x32_bf16 a[84:87], a[208:211], a[144:147], a[84:87]
    buffer_load_dwordx4 v9, s[28:31], s57 offen offset:1056 nt lds
    v_mfma_f32_16x16x32_bf16 a[84:87], a[212:215], a[156:159], a[84:87]
    s_add_u32 m0, s56, 67584
    s_add_u32 s57, s58, 3145984
    s_and_b32 s57, s57, 0x3fffff
    v_mfma_f32_16x16x32_bf16 a[88:91], a[212:215], a[160:163], a[88:91]
    ds_read_b64_tr_b16 a[194:195], v3 offset:34496
    ds_read_b64_tr_b16 a[196:197], v3 offset:34016
    v_mfma_f32_16x16x32_bf16 a[88:91], a[208:211], a[148:151], a[88:91]
    v_exp_f32 v19, v119
    v_mfma_f32_16x16x32_bf16 a[92:95], a[208:211], a[152:155], a[92:95]
    v_exp_f32 v16, v120
    v_mfma_f32_16x16x32_bf16 a[92:95], a[212:215], a[164:167], a[92:95]
    ds_read_b64_tr_b16 a[198:199], v3 offset:34528
    s_waitcnt lgkmcnt(6)
    v_mfma_f32_16x16x32_bf16 a[0:3], a[216:219], a[168:171], a[0:3]
    buffer_load_dwordx4 v10, s[32:35], s57 offen offset:0 lds
    v_mfma_f32_16x16x32_bf16 a[0:3], a[220:223], a[180:183], a[0:3]
    ds_read_b128 a[200:203], v5 offset:33792
    v_cvt_pk_bf16_f32 v165, v18, v19
    v_mfma_f32_16x16x32_bf16 a[4:7], a[220:223], a[184:187], a[4:7]
    v_exp_f32 v17, v121
    v_mfma_f32_16x16x32_bf16 a[4:7], a[216:219], a[172:175], a[4:7]
    v_exp_f32 v18, v122
    v_mfma_f32_16x16x32_bf16 a[8:11], a[216:219], a[176:179], a[8:11]
    buffer_load_dwordx4 v11, s[32:35], s57 offen offset:1056 lds
    v_mfma_f32_16x16x32_bf16 a[8:11], a[220:223], a[188:191], a[8:11]
    ds_read_b128 a[204:207], v5 offset:33856
    v_cvt_pk_bf16_f32 v168, v16, v17
    v_mfma_f32_16x16x32_bf16 v[76:79], a[224:227], v[184:187], v[76:79]
    v_exp_f32 v19, v123
    v_mfma_f32_16x16x32_bf16 v[72:75], a[224:227], v[180:183], v[72:75]
    v_exp_f32 v16, v124
    v_mfma_f32_16x16x32_bf16 v[68:71], a[224:227], v[176:179], v[68:71]
    v_cvt_pk_bf16_f32 v169, v18, v19
    s_waitcnt lgkmcnt(2)
    v_mfma_f32_16x16x32_bf16 v[80:83], a[228:231], v[176:179], v[80:83]
    v_exp_f32 v17, v125
    v_mfma_f32_16x16x32_bf16 v[84:87], a[228:231], v[180:183], v[84:87]
    ds_read_b128 a[208:211], v5 offset:33920
    ds_read_b128 a[212:215], v5 offset:33984
    v_mfma_f32_16x16x32_bf16 v[88:91], a[228:231], v[184:187], v[88:91]
    v_exp_f32 v18, v126
    v_mfma_f32_16x16x32_bf16 v[100:103], a[192:195], v[184:187], v[100:103]
    ds_read_b128 a[216:219], v5 offset:34304
    v_cvt_pk_bf16_f32 v172, v16, v17
    v_mfma_f32_16x16x32_bf16 v[96:99], a[192:195], v[180:183], v[96:99]
    v_exp_f32 v19, v127
    v_mfma_f32_16x16x32_bf16 v[92:95], a[192:195], v[176:179], v[92:95]
    s_add_u32 m0, s56, 76032
    s_add_u32 s57, s58, 3408128
    s_and_b32 s57, s57, 0x3fffff
    v_mfma_f32_16x16x32_bf16 v[104:107], a[196:199], v[176:179], v[104:107]
    v_exp_f32 v16, v128
    v_mfma_f32_16x16x32_bf16 v[108:111], a[196:199], v[180:183], v[108:111]
    ds_read_b128 a[220:223], v5 offset:34368
    v_cvt_pk_bf16_f32 v173, v18, v19
    v_mfma_f32_16x16x32_bf16 v[112:115], a[196:199], v[184:187], v[112:115]
    ds_read_b128 a[224:227], v5 offset:34432
    s_waitcnt lgkmcnt(5)
    v_mfma_f32_16x16x32_bf16 v[140:143], a[200:203], v[208:211], v[188:191]
    v_exp_f32 v17, v129
    v_mfma_f32_16x16x32_bf16 v[140:143], a[204:207], v[220:223], v[140:143]
    buffer_load_dwordx4 v10, s[32:35], s57 offen offset:0 lds
    s_waitcnt lgkmcnt(3)
    v_mfma_f32_16x16x32_bf16 v[140:143], a[208:211], v[232:235], v[140:143]
    v_exp_f32 v18, v130
    v_mfma_f32_16x16x32_bf16 v[140:143], a[212:215], v[244:247], v[140:143]
    v_mov_b32 v207, 0
    v_cvt_pk_bf16_f32 v166, v16, v17
    v_mfma_f32_16x16x32_bf16 v[144:147], a[212:215], v[248:251], v[192:195]
    ds_read_b128 a[228:231], v5 offset:34496
    ds_read_b64_tr_b16 a[192:193], v3 offset:42240
    v_mfma_f32_16x16x32_bf16 v[144:147], a[208:211], v[236:239], v[144:147]
    buffer_load_dwordx4 v11, s[32:35], s57 offen offset:1056 lds
    v_mfma_f32_16x16x32_bf16 v[144:147], a[204:207], v[224:227], v[144:147]
    v_exp_f32 v19, v131
    v_mfma_f32_16x16x32_bf16 v[144:147], a[200:203], v[212:215], v[144:147]
    v_exp_f32 v16, v132
    v_mfma_f32_16x16x32_bf16 v[148:151], a[200:203], v[216:219], v[196:199]
    ds_read_b64_tr_b16 a[194:195], v3 offset:42752
    v_cvt_pk_bf16_f32 v167, v18, v19
    v_mfma_f32_16x16x32_bf16 v[148:151], a[204:207], v[228:231], v[148:151]
    v_exp_f32 v17, v133
    v_mfma_f32_16x16x32_bf16 v[148:151], a[208:211], v[240:243], v[148:151]
    ds_read_b64_tr_b16 a[196:197], v3 offset:42272
    ds_read_b64_tr_b16 a[198:199], v3 offset:42784
    v_mfma_f32_16x16x32_bf16 v[148:151], a[212:215], v[252:255], v[148:151]
    ds_read_b64_tr_b16 a[200:201], v3 offset:42304
    s_waitcnt lgkmcnt(6)
    v_mfma_f32_16x16x32_bf16 v[152:155], a[216:219], v[208:211], v[188:191]
    v_exp_f32 v18, v134
    v_mfma_f32_16x16x32_bf16 v[152:155], a[220:223], v[220:223], v[152:155]
    ds_read_b64_tr_b16 a[202:203], v3 offset:42816
    v_cvt_pk_bf16_f32 v170, v16, v17
    v_mfma_f32_16x16x32_bf16 v[152:155], a[224:227], v[232:235], v[152:155]
    ds_read_b64_tr_b16 a[204:205], v3 offset:42336
    s_waitcnt lgkmcnt(6)
    v_mfma_f32_16x16x32_bf16 v[152:155], a[228:231], v[244:247], v[152:155]
    v_exp_f32 v19, v135
    v_mfma_f32_16x16x32_bf16 v[156:159], a[228:231], v[248:251], v[192:195]
    v_exp_f32 v16, v136
    v_mfma_f32_16x16x32_bf16 v[156:159], a[224:227], v[236:239], v[156:159]
    ds_read_b64_tr_b16 a[206:207], v3 offset:42848
    v_cvt_pk_bf16_f32 v171, v18, v19
    v_mfma_f32_16x16x32_bf16 v[156:159], a[220:223], v[224:227], v[156:159]
    v_exp_f32 v17, v137
    v_mfma_f32_16x16x32_bf16 v[156:159], a[216:219], v[212:215], v[156:159]
    v_exp_f32 v18, v138
    v_cvt_pk_bf16_f32 v174, v16, v17
    v_exp_f32 v19, v139
    s_nop 0
    v_cvt_pk_bf16_f32 v175, v18, v19
    v_mfma_f32_16x16x32_bf16 v[200:203], a[232:235], v[164:167], v[204:207]
    ds_read_b64_tr_b16 a[208:209], v4 offset:8480
    ds_read_b64_tr_b16 a[210:211], v4 offset:8992
    v_mfma_f32_16x16x32_bf16 v[200:203], a[236:239], v[168:171], v[200:203]
    ds_read_b64_tr_b16 a[212:213], v3 offset:25376
    ds_read_b64_tr_b16 a[214:215], v3 offset:25888
    v_mfma_f32_16x16x32_bf16 v[200:203], a[240:243], v[172:175], v[200:203]
    s_nop 1
    v_mfma_f32_16x16x32_bf16 v[160:163], a[216:219], v[216:219], v[196:199]
    ds_read_b64_tr_b16 a[216:217], v4 offset:8512
    ds_read_b64_tr_b16 a[218:219], v4 offset:9024
    v_mfma_f32_16x16x32_bf16 v[160:163], a[220:223], v[228:231], v[160:163]
    ds_read_b64_tr_b16 a[220:221], v3 offset:25408
    ds_read_b64_tr_b16 a[222:223], v3 offset:25920
    v_mfma_f32_16x16x32_bf16 v[160:163], a[224:227], v[240:243], v[160:163]
    v_cmp_nge_f32 vcc, s84, v203
    s_waitcnt lgkmcnt(9)
    s_barrier
    v_mfma_f32_16x16x32_bf16 v[160:163], a[228:231], v[252:255], v[160:163]
    s_cbranch_vccnz K_R0_4
K_R0_4_ret:
    s_add_u32 m0, s56, 33792
    s_add_u32 s57, s58, 3670272
    s_and_b32 s57, s57, 0x3fffff
    v_mfma_f32_16x16x32_bf16 v[28:31], a[192:195], v[172:175], v[28:31]
    buffer_load_dwordx4 v10, s[32:35], s57 offen offset:0 lds
    v_mfma_f32_16x16x32_bf16 v[24:27], a[192:195], v[168:171], v[24:27]
    v_exp_f32 v16, v140
    v_mfma_f32_16x16x32_bf16 v[20:23], a[192:195], v[164:167], v[20:23]
    ds_read_b64_tr_b16 a[224:225], v4 offset:8544
    ds_read_b64_tr_b16 a[226:227], v4 offset:9056
    v_mfma_f32_16x16x32_bf16 v[32:35], a[196:199], v[164:167], v[32:35]
    v_exp_f32 v17, v141
    v_mfma_f32_16x16x32_bf16 v[36:39], a[196:199], v[168:171], v[36:39]
    buffer_load_dwordx4 v11, s[32:35], s57 offen offset:1056 lds
    v_mfma_f32_16x16x32_bf16 v[40:43], a[196:199], v[172:175], v[40:43]
    s_add_u32 m0, s56, 101376
    s_add_u32 s57, s58, 3932416
    s_and_b32 s57, s57, 0x3fffff
    v_mfma_f32_16x16x32_bf16 v[52:55], a[200:203], v[172:175], v[52:55]
    ds_read_b64_tr_b16 a[228:229], v3 offset:25440
    ds_read_b64_tr_b16 a[230:231], v3 offset:25952
    v_mfma_f32_16x16x32_bf16 v[48:51], a[200:203], v[168:171], v[48:51]
    v_exp_f32 v18, v142
    v_mfma_f32_16x16x32_bf16 v[44:47], a[200:203], v[164:167], v[44:47]
    ds_read_b64_tr_b16 a[192:193], v3 offset:42368
    s_waitcnt lgkmcnt(5)
    v_mfma_f32_16x16x32_bf16 v[56:59], a[204:207], v[164:167], v[56:59]
    ds_read_b64_tr_b16 a[194:195], v3 offset:42880
    v_cvt_pk_bf16_f32 v176, v16, v17
    v_mfma_f32_16x16x32_bf16 v[60:63], a[204:207], v[168:171], v[60:63]
    buffer_load_dwordx4 v10, s[32:35], s57 offen offset:0 lds
    v_mfma_f32_16x16x32_bf16 v[64:67], a[204:207], v[172:175], v[64:67]
    v_exp_f32 v19, v143
    v_mfma_f32_16x16x32_bf16 a[12:15], a[208:211], a[168:171], a[12:15]
    ds_read_b64_tr_b16 a[196:197], v3 offset:42400
    ds_read_b64_tr_b16 a[198:199], v3 offset:42912
    v_mfma_f32_16x16x32_bf16 a[12:15], a[212:215], a[180:183], a[12:15]
    v_exp_f32 v16, v144
    v_mfma_f32_16x16x32_bf16 a[16:19], a[212:215], a[184:187], a[16:19]
    buffer_load_dwordx4 v11, s[32:35], s57 offen offset:1056 lds
    v_mfma_f32_16x16x32_bf16 a[16:19], a[208:211], a[172:175], a[16:19]
    ds_read_b64_tr_b16 a[200:201], v3 offset:42432
    v_cvt_pk_bf16_f32 v177, v18, v19
    v_mfma_f32_16x16x32_bf16 a[20:23], a[208:211], a[176:179], a[20:23]
    ds_read_b64_tr_b16 a[202:203], v3 offset:42944
    ds_read_b64_tr_b16 a[204:205], v3 offset:42464
    v_mfma_f32_16x16x32_bf16 a[20:23], a[212:215], a[188:191], a[20:23]
    v_exp_f32 v17, v145
    v_mfma_f32_16x16x32_bf16 a[24:27], a[216:219], a[168:171], a[24:27]
    v_exp_f32 v18, v146
    v_mfma_f32_16x16x32_bf16 a[24:27], a[220:223], a[180:183], a[24:27]
    ds_read_b64_tr_b16 a[206:207], v3 offset:42976
    v_cvt_pk_bf16_f32 v180, v16, v17
    v_mfma_f32_16x16x32_bf16 a[28:31], a[220:223], a[184:187], a[28:31]
    v_exp_f32 v19, v147
    v_mfma_f32_16x16x32_bf16 a[28:31], a[216:219], a[172:175], a[28:31]
    v_exp_f32 v16, v148
    v_mfma_f32_16x16x32_bf16 a[32:35], a[216:219], a[176:179], a[32:35]
    ds_read_b128 a[208:211], v6 offset:16896
    ds_read_b128 a[212:215], v6 offset:16960
    v_mfma_f32_16x16x32_bf16 a[32:35], a[220:223], a[188:191], a[32:35]
    v_cvt_pk_bf16_f32 v181, v18, v19
    s_waitcnt lgkmcnt(6)
    v_mfma_f32_16x16x32_bf16 a[36:39], a[224:227], a[168:171], a[36:39]
    v_exp_f32 v17, v149
    v_mfma_f32_16x16x32_bf16 a[36:39], a[228:231], a[180:183], a[36:39]
    v_exp_f32 v18, v150
    v_mfma_f32_16x16x32_bf16 a[40:43], a[228:231], a[184:187], a[40:43]
    ds_read_b128 a[216:219], v6 offset:17024
    v_cvt_pk_bf16_f32 v184, v16, v17
    v_mfma_f32_16x16x32_bf16 a[40:43], a[224:227], a[172:175], a[40:43]
    ds_read_b128 a[220:223], v6 offset:17088
    v_mov_b32 v203, 0
    v_mfma_f32_16x16x32_bf16 a[44:47], a[224:227], a[176:179], a[44:47]
    v_exp_f32 v19, v151
    v_mfma_f32_16x16x32_bf16 a[44:47], a[228:231], a[188:191], a[44:47]
    v_exp_f32 v16, v152
    v_mfma_f32_16x16x32_bf16 v[76:79], a[192:195], v[172:175], v[76:79]
    ds_read_b128 a[224:227], v6 offset:17408
    v_cvt_pk_bf16_f32 v185, v18, v19
    v_mfma_f32_16x16x32_bf16 v[72:75], a[192:195], v[168:171], v[72:75]
    v_exp_f32 v17, v153
    v_mfma_f32_16x16x32_bf16 v[68:71], a[192:195], v[164:167], v[68:71]
    ds_read_b128 a[228:231], v6 offset:17472
    ds_read_b128 a[192:195], v6 offset:17536
    v_mfma_f32_16x16x32_bf16 v[80:83], a[196:199], v[164:167], v[80:83]
    v_exp_f32 v18, v154
    v_mfma_f32_16x16x32_bf16 v[84:87], a[196:199], v[168:171], v[84:87]
    v_cvt_pk_bf16_f32 v178, v16, v17
    v_mfma_f32_16x16x32_bf16 v[88:91], a[196:199], v[172:175], v[88:91]
    ds_read_b128 a[196:199], v6 offset:17600
    s_waitcnt lgkmcnt(5)
    v_mfma_f32_16x16x32_bf16 v[100:103], a[200:203], v[172:175], v[100:103]
    v_exp_f32 v19, v155
    v_mfma_f32_16x16x32_bf16 v[96:99], a[200:203], v[168:171], v[96:99]
    v_exp_f32 v16, v156
    v_mfma_f32_16x16x32_bf16 v[92:95], a[200:203], v[164:167], v[92:95]
    ds_read_b64_tr_b16 a[200:201], v4 offset:0
    v_cvt_pk_bf16_f32 v179, v18, v19
    v_mfma_f32_16x16x32_bf16 v[104:107], a[204:207], v[164:167], v[104:107]
    ds_read_b64_tr_b16 a[202:203], v4 offset:512
    v_mfma_f32_16x16x32_bf16 v[108:111], a[204:207], v[168:171], v[108:111]
    v_exp_f32 v17, v157
    v_mfma_f32_16x16x32_bf16 v[112:115], a[204:207], v[172:175], v[112:115]
    v_exp_f32 v18, v158
    v_mfma_f32_16x16x32_bf16 v[116:119], a[208:211], v[208:211], v[188:191]
    ds_read_b64_tr_b16 a[204:205], v4 offset:32
    ds_read_b64_tr_b16 a[206:207], v4 offset:544
    v_mfma_f32_16x16x32_bf16 v[116:119], a[212:215], v[220:223], v[116:119]
    v_cvt_pk_bf16_f32 v182, v16, v17
    v_mfma_f32_16x16x32_bf16 v[116:119], a[216:219], v[232:235], v[116:119]
    s_waitcnt lgkmcnt(4)
    v_mfma_f32_16x16x32_bf16 v[116:119], a[220:223], v[244:247], v[116:119]
    v_exp_f32 v19, v159
    v_mfma_f32_16x16x32_bf16 v[120:123], a[220:223], v[248:251], v[192:195]
    v_exp_f32 v16, v160
    v_mfma_f32_16x16x32_bf16 v[120:123], a[216:219], v[236:239], v[120:123]
    v_cvt_pk_bf16_f32 v183, v18, v19
    v_mfma_f32_16x16x32_bf16 v[120:123], a[212:215], v[224:227], v[120:123]
    v_exp_f32 v17, v161
    v_mfma_f32_16x16x32_bf16 v[120:123], a[208:211], v[212:215], v[120:123]
    v_exp_f32 v18, v162
    v_mfma_f32_16x16x32_bf16 v[124:127], a[208:211], v[216:219], v[196:199]
    ds_read_b64_tr_b16 a[208:209], v4 offset:64
    ds_read_b64_tr_b16 a[210:211], v4 offset:576
    v_mfma_f32_16x16x32_bf16 v[124:127], a[212:215], v[228:231], v[124:127]
    ds_read_b64_tr_b16 a[212:213], v4 offset:96
    ds_read_b64_tr_b16 a[214:215], v4 offset:608
    v_mfma_f32_16x16x32_bf16 v[124:127], a[216:219], v[240:243], v[124:127]
    ds_read_b64_tr_b16 a[216:217], v4 offset:8576
    ds_read_b64_tr_b16 a[218:219], v4 offset:9088
    v_mfma_f32_16x16x32_bf16 v[124:127], a[220:223], v[252:255], v[124:127]
    ds_read_b64_tr_b16 a[220:221], v3 offset:25472
    v_cvt_pk_bf16_f32 v186, v16, v17
    v_mfma_f32_16x16x32_bf16 v[128:131], a[224:227], v[208:211], v[188:191]
    ds_read_b64_tr_b16 a[222:223], v3 offset:25984
    v_mfma_f32_16x16x32_bf16 v[128:131], a[228:231], v[220:223], v[128:131]
    v_exp_f32 v19, v163
    v_mfma_f32_16x16x32_bf16 v[128:131], a[192:195], v[232:235], v[128:131]
    v_cvt_pk_bf16_f32 v187, v18, v19
    v_mfma_f32_16x16x32_bf16 v[128:131], a[196:199], v[244:247], v[128:131]
    v_mfma_f32_16x16x32_bf16 v[132:135], a[196:199], v[248:251], v[192:195]
    v_mfma_f32_16x16x32_bf16 v[132:135], a[192:195], v[236:239], v[132:135]
    v_mfma_f32_16x16x32_bf16 v[132:135], a[228:231], v[224:227], v[132:135]
    v_mfma_f32_16x16x32_bf16 v[132:135], a[224:227], v[212:215], v[132:135]
    v_mfma_f32_16x16x32_bf16 v[204:207], a[232:235], v[176:179], v[200:203]
    v_mfma_f32_16x16x32_bf16 v[204:207], a[236:239], v[180:183], v[204:207]
    v_mfma_f32_16x16x32_bf16 v[204:207], a[240:243], v[184:187], v[204:207]
    s_nop 1
    v_mfma_f32_16x16x32_bf16 v[136:139], a[224:227], v[216:219], v[196:199]
    ds_read_b64_tr_b16 a[224:225], v4 offset:8608
    ds_read_b64_tr_b16 a[226:227], v4 offset:9120
    v_mfma_f32_16x16x32_bf16 v[136:139], a[228:231], v[228:231], v[136:139]
    ds_read_b64_tr_b16 a[228:229], v3 offset:25504
    ds_read_b64_tr_b16 a[230:231], v3 offset:26016
    v_mfma_f32_16x16x32_bf16 v[136:139], a[192:195], v[240:243], v[136:139]
    v_cmp_nge_f32 vcc, s84, v207
    s_waitcnt lgkmcnt(4)
    s_barrier
    v_mfma_f32_16x16x32_bf16 v[136:139], a[196:199], v[252:255], v[136:139]
    s_cbranch_vccnz K_R0_5
K_R0_5_ret:
    s_add_u32 m0, s56, 84480
    s_mov_b32 s57, 98304
    v_mfma_f32_16x16x32_bf16 v[28:31], a[200:203], v[184:187], v[28:31]
    buffer_load_dwordx4 v8, s[24:27], s57 offen offset:0 nt lds
    v_mfma_f32_16x16x32_bf16 v[24:27], a[200:203], v[180:183], v[24:27]
    v_exp_f32 v16, v116
    v_mfma_f32_16x16x32_bf16 v[20:23], a[200:203], v[176:179], v[20:23]
    v_exp_f32 v17, v117
    v_mfma_f32_16x16x32_bf16 v[32:35], a[204:207], v[176:179], v[32:35]
    ds_read_b64_tr_b16 a[192:193], v4 offset:128
    ds_read_b64_tr_b16 a[194:195], v4 offset:640
    v_mfma_f32_16x16x32_bf16 v[36:39], a[204:207], v[180:183], v[36:39]
    buffer_load_dwordx4 v9, s[24:27], s57 offen offset:1056 nt lds
    v_mfma_f32_16x16x32_bf16 v[40:43], a[204:207], v[184:187], v[40:43]
    s_add_u32 m0, s56, 109824
    s_mov_b32 s57, 90112
    v_mfma_f32_16x16x32_bf16 v[52:55], a[208:211], v[184:187], v[52:55]
    ds_read_b64_tr_b16 a[196:197], v4 offset:160
    ds_read_b64_tr_b16 a[198:199], v4 offset:672
    v_mfma_f32_16x16x32_bf16 v[48:51], a[208:211], v[180:183], v[48:51]
    v_exp_f32 v18, v118
    v_mfma_f32_16x16x32_bf16 v[44:47], a[208:211], v[176:179], v[44:47]
    buffer_load_dwordx4 v8, s[28:31], s57 offen offset:0 nt lds
    v_mfma_f32_16x16x32_bf16 v[56:59], a[212:215], v[176:179], v[56:59]
    ds_read_b64_tr_b16 a[200:201], v4 offset:192
    v_cvt_pk_bf16_f32 v164, v16, v17
    v_mfma_f32_16x16x32_bf16 v[60:63], a[212:215], v[180:183], v[60:63]
    ds_read_b64_tr_b16 a[202:203], v4 offset:704
    ds_read_b64_tr_b16 a[204:205], v4 offset:224
    v_mfma_f32_16x16x32_bf16 v[64:67], a[212:215], v[184:187], v[64:67]
    v_exp_f32 v19, v119
    v_mfma_f32_16x16x32_bf16 a[48:51], a[216:219], a[168:171], a[48:51]
    buffer_load_dwordx4 v9, s[28:31], s57 offen offset:1056 nt lds
    v_mfma_f32_16x16x32_bf16 a[48:51], a[220:223], a[180:183], a[48:51]
    v_exp_f32 v16, v120
    v_mfma_f32_16x16x32_bf16 a[52:55], a[220:223], a[184:187], a[52:55]
    ds_read_b64_tr_b16 a[206:207], v4 offset:736
    v_cvt_pk_bf16_f32 v165, v18, v19
    v_mfma_f32_16x16x32_bf16 a[52:55], a[216:219], a[172:175], a[52:55]
    v_exp_f32 v17, v121
    v_mfma_f32_16x16x32_bf16 a[56:59], a[216:219], a[176:179], a[56:59]
    ds_read_b128 a[208:211], v5 offset:25344
    ds_read_b128 a[212:215], v5 offset:25408
    v_mfma_f32_16x16x32_bf16 a[56:59], a[220:223], a[188:191], a[56:59]
    ds_read_b128 a[216:219], v5 offset:25472
    s_waitcnt lgkmcnt(7)
    v_mfma_f32_16x16x32_bf16 a[60:63], a[224:227], a[168:171], a[60:63]
    v_exp_f32 v18, v122
    v_mfma_f32_16x16x32_bf16 a[60:63], a[228:231], a[180:183], a[60:63]
    ds_read_b128 a[220:223], v5 offset:25536
    v_cvt_pk_bf16_f32 v168, v16, v17
    v_mfma_f32_16x16x32_bf16 a[64:67], a[228:231], a[184:187], a[64:67]
    v_exp_f32 v19, v123
    v_mfma_f32_16x16x32_bf16 a[64:67], a[224:227], a[172:175], a[64:67]
    v_exp_f32 v16, v124
    v_mfma_f32_16x16x32_bf16 a[68:71], a[224:227], a[176:179], a[68:71]
    ds_read_b128 a[224:227], v5 offset:25856
    v_cvt_pk_bf16_f32 v169, v18, v19
    v_mfma_f32_16x16x32_bf16 a[68:71], a[228:231], a[188:191], a[68:71]
    v_exp_f32 v17, v125
    v_mfma_f32_16x16x32_bf16 v[76:79], a[192:195], v[184:187], v[76:79]
    v_exp_f32 v18, v126
    v_mfma_f32_16x16x32_bf16 v[72:75], a[192:195], v[180:183], v[72:75]
    ds_read_b128 a[228:231], v5 offset:25920
    v_cvt_pk_bf16_f32 v172, v16, v17
    v_mfma_f32_16x16x32_bf16 v[68:71], a[192:195], v[176:179], v[68:71]
    v_exp_f32 v19, v127
    v_mfma_f32_16x16x32_bf16 v[80:83], a[196:199], v[176:179], v[80:83]
    v_exp_f32 v16, v128
    v_mfma_f32_16x16x32_bf16 v[84:87], a[196:199], v[180:183], v[84:87]
    ds_read_b128 a[192:195], v5 offset:25984
    v_cvt_pk_bf16_f32 v173, v18, v19
    v_mfma_f32_16x16x32_bf16 v[88:91], a[196:199], v[184:187], v[88:91]
    v_mov_b32 v207, 0
    s_waitcnt lgkmcnt(3)
    v_mfma_f32_16x16x32_bf16 v[100:103], a[200:203], v[184:187], v[100:103]
    v_exp_f32 v17, v129
    v_mfma_f32_16x16x32_bf16 v[96:99], a[200:203], v[180:183], v[96:99]
    v_exp_f32 v18, v130
    v_mfma_f32_16x16x32_bf16 v[92:95], a[200:203], v[176:179], v[92:95]
    ds_read_b128 a[196:199], v5 offset:26048
    v_cvt_pk_bf16_f32 v166, v16, v17
    v_mfma_f32_16x16x32_bf16 v[104:107], a[204:207], v[176:179], v[104:107]
    v_exp_f32 v19, v131
    v_mfma_f32_16x16x32_bf16 v[108:111], a[204:207], v[180:183], v[108:111]
    v_exp_f32 v16, v132
    v_mfma_f32_16x16x32_bf16 v[112:115], a[204:207], v[184:187], v[112:115]
    ds_read_b64_tr_b16 a[200:201], v2 offset:42240
    ds_read_b64_tr_b16 a[202:203], v2 offset:42752
    v_mfma_f32_16x16x32_bf16 v[140:143], a[208:211], v[208:211], v[188:191]
    ds_read_b64_tr_b16 a[204:205], v2 offset:42272
    v_cvt_pk_bf16_f32 v167, v18, v19
    v_mfma_f32_16x16x32_bf16 v[140:143], a[212:215], v[220:223], v[140:143]
    v_exp_f32 v17, v133
    v_mfma_f32_16x16x32_bf16 v[140:143], a[216:219], v[232:235], v[140:143]
    ds_read_b64_tr_b16 a[206:207], v2 offset:42784
    v_mfma_f32_16x16x32_bf16 v[140:143], a[220:223], v[244:247], v[140:143]
    v_exp_f32 v18, v134
    v_mfma_f32_16x16x32_bf16 v[144:147], a[220:223], v[248:251], v[192:195]
    v_cvt_pk_bf16_f32 v170, v16, v17
    v_mfma_f32_16x16x32_bf16 v[144:147], a[216:219], v[236:239], v[144:147]
    v_exp_f32 v19, v135
    v_mfma_f32_16x16x32_bf16 v[144:147], a[212:215], v[224:227], v[144:147]
    v_exp_f32 v16, v136
    v_mfma_f32_16x16x32_bf16 v[144:147], a[208:211], v[212:215], v[144:147]
    v_cvt_pk_bf16_f32 v171, v18, v19
    v_mfma_f32_16x16x32_bf16 v[148:151], a[208:211], v[216:219], v[196:199]
    v_exp_f32 v17, v137
    v_mfma_f32_16x16x32_bf16 v[148:151], a[212:215], v[228:231], v[148:151]
    ds_read_b64_tr_b16 a[208:209], v2 offset:42304
    ds_read_b64_tr_b16 a[210:211], v2 offset:42816
    v_mfma_f32_16x16x32_bf16 v[148:151], a[216:219], v[240:243], v[148:151]
    v_exp_f32 v18, v138
    v_mfma_f32_16x16x32_bf16 v[148:151], a[220:223], v[252:255], v[148:151]
    ds_read_b64_tr_b16 a[212:213], v2 offset:42336
    s_waitcnt lgkmcnt(3)
    v_mfma_f32_16x16x32_bf16 v[152:155], a[224:227], v[208:211], v[188:191]
    ds_read_b64_tr_b16 a[214:215], v2 offset:42848
    ds_read_b64_tr_b16 a[216:217], v4 offset:8640
    v_mfma_f32_16x16x32_bf16 v[152:155], a[228:231], v[220:223], v[152:155]
    ds_read_b64_tr_b16 a[218:219], v4 offset:9152
    v_cvt_pk_bf16_f32 v174, v16, v17
    v_mfma_f32_16x16x32_bf16 v[152:155], a[192:195], v[232:235], v[152:155]
    ds_read_b64_tr_b16 a[220:221], v3 offset:25536
    ds_read_b64_tr_b16 a[222:223], v3 offset:26048
    v_mfma_f32_16x16x32_bf16 v[152:155], a[196:199], v[244:247], v[152:155]
    v_exp_f32 v19, v139
    v_mfma_f32_16x16x32_bf16 v[156:159], a[196:199], v[248:251], v[192:195]
    v_cvt_pk_bf16_f32 v175, v18, v19
    v_mfma_f32_16x16x32_bf16 v[156:159], a[192:195], v[236:239], v[156:159]
    v_mfma_f32_16x16x32_bf16 v[156:159], a[228:231], v[224:227], v[156:159]
    v_mfma_f32_16x16x32_bf16 v[156:159], a[224:227], v[212:215], v[156:159]
    v_mfma_f32_16x16x32_bf16 v[200:203], a[232:235], v[164:167], v[204:207]
    v_mfma_f32_16x16x32_bf16 v[200:203], a[236:239], v[168:171], v[200:203]
    v_mfma_f32_16x16x32_bf16 v[200:203], a[240:243], v[172:175], v[200:203]
    s_nop 1
    v_mfma_f32_16x16x32_bf16 v[160:163], a[224:227], v[216:219], v[196:199]
    ds_read_b64_tr_b16 a[224:225], v4 offset:8672
    ds_read_b64_tr_b16 a[226:227], v4 offset:9184
    v_mfma_f32_16x16x32_bf16 v[160:163], a[228:231], v[228:231], v[160:163]
    ds_read_b64_tr_b16 a[228:229], v3 offset:25568
    ds_read_b64_tr_b16 a[230:231], v3 offset:26080
    v_mfma_f32_16x16x32_bf16 v[160:163], a[192:195], v[240:243], v[160:163]
    v_cmp_nge_f32 vcc, s84, v203
    s_waitcnt vmcnt(24) lgkmcnt(4)
    s_barrier
    v_mfma_f32_16x16x32_bf16 v[160:163], a[196:199], v[252:255], v[160:163]
    s_cbranch_vccnz K_R0_6
K_R0_6_ret:
    s_add_u32 m0, s56, 25344
    s_mov_b32 s57, 106496
    v_mfma_f32_16x16x32_bf16 v[28:31], a[200:203], v[172:175], v[28:31]
    buffer_load_dwordx4 v8, s[24:27], s57 offen offset:0 nt lds
    v_mfma_f32_16x16x32_bf16 v[24:27], a[200:203], v[168:171], v[24:27]
    v_exp_f32 v16, v140
    v_mfma_f32_16x16x32_bf16 v[20:23], a[200:203], v[164:167], v[20:23]
    v_exp_f32 v17, v141
    v_mfma_f32_16x16x32_bf16 v[32:35], a[204:207], v[164:167], v[32:35]
    ds_read_b64_tr_b16 a[192:193], v2 offset:42368
    ds_read_b64_tr_b16 a[194:195], v2 offset:42880
    v_mfma_f32_16x16x32_bf16 v[36:39], a[204:207], v[168:171], v[36:39]
    buffer_load_dwordx4 v9, s[24:27], s57 offen offset:1056 nt lds
    v_mfma_f32_16x16x32_bf16 v[40:43], a[204:207], v[172:175], v[40:43]
    s_add_u32 m0, s56, 135168
    s_mov_b32 s57, 98304
    v_mfma_f32_16x16x32_bf16 v[52:55], a[208:211], v[172:175], v[52:55]
    ds_read_b64_tr_b16 a[196:197], v2 offset:42400
    ds_read_b64_tr_b16 a[198:199], v2 offset:42912
    v_mfma_f32_16x16x32_bf16 v[48:51], a[208:211], v[168:171], v[48:51]
    v_exp_f32 v18, v142
    v_mfma_f32_16x16x32_bf16 v[44:47], a[208:211], v[164:167], v[44:47]
    buffer_load_dwordx4 v8, s[28:31], s57 offen offset:0 nt lds
    v_mfma_f32_16x16x32_bf16 v[56:59], a[212:215], v[164:167], v[56:59]
    ds_read_b64_tr_b16 a[200:201], v2 offset:42432
    v_cvt_pk_bf16_f32 v176, v16, v17
    v_mfma_f32_16x16x32_bf16 v[60:63], a[212:215], v[168:171], v[60:63]
    ds_read_b64_tr_b16 a[202:203], v2 offset:42944
    ds_read_b64_tr_b16 a[204:205], v2 offset:42464
    v_mfma_f32_16x16x32_bf16 v[64:67], a[212:215], v[172:175], v[64:67]
    v_exp_f32 v19, v143
    v_mfma_f32_16x16x32_bf16 a[72:75], a[216:219], a[168:171], a[72:75]
    buffer_load_dwordx4 v9, s[28:31], s57 offen offset:1056 nt lds
    v_mfma_f32_16x16x32_bf16 a[72:75], a[220:223], a[180:183], a[72:75]
    v_exp_f32 v16, v144
    v_mfma_f32_16x16x32_bf16 a[76:79], a[220:223], a[184:187], a[76:79]
    ds_read_b64_tr_b16 a[206:207], v2 offset:42976
    v_cvt_pk_bf16_f32 v177, v18, v19
    v_mfma_f32_16x16x32_bf16 a[76:79], a[216:219], a[172:175], a[76:79]
    v_exp_f32 v17, v145
    v_mfma_f32_16x16x32_bf16 a[80:83], a[216:219], a[176:179], a[80:83]
    ds_read_b128 a[208:211], v5 offset:59136
    ds_read_b128 a[212:215], v5 offset:59200
    v_mfma_f32_16x16x32_bf16 a[80:83], a[220:223], a[188:191], a[80:83]
    ds_read_b128 a[216:219], v5 offset:59264
    s_waitcnt lgkmcnt(7)
    v_mfma_f32_16x16x32_bf16 a[84:87], a[224:227], a[168:171], a[84:87]
    v_exp_f32 v18, v146
    v_mfma_f32_16x16x32_bf16 a[84:87], a[228:231], a[180:183], a[84:87]
    ds_read_b128 a[220:223], v5 offset:59328
    v_cvt_pk_bf16_f32 v180, v16, v17
    v_mfma_f32_16x16x32_bf16 a[88:91], a[228:231], a[184:187], a[88:91]
    v_exp_f32 v19, v147
    v_mfma_f32_16x16x32_bf16 a[88:91], a[224:227], a[172:175], a[88:91]
    v_exp_f32 v16, v148
    v_mfma_f32_16x16x32_bf16 a[92:95], a[224:227], a[176:179], a[92:95]
    ds_read_b128 a[224:227], v5 offset:59648
    v_cvt_pk_bf16_f32 v181, v18, v19
    v_mfma_f32_16x16x32_bf16 a[92:95], a[228:231], a[188:191], a[92:95]
    v_exp_f32 v17, v149
    v_mfma_f32_16x16x32_bf16 v[76:79], a[192:195], v[172:175], v[76:79]
    v_exp_f32 v18, v150
    v_mfma_f32_16x16x32_bf16 v[72:75], a[192:195], v[168:171], v[72:75]
    ds_read_b128 a[228:231], v5 offset:59712
    v_cvt_pk_bf16_f32 v184, v16, v17
    v_mfma_f32_16x16x32_bf16 v[68:71], a[192:195], v[164:167], v[68:71]
    v_exp_f32 v19, v151
    v_mfma_f32_16x16x32_bf16 v[80:83], a[196:199], v[164:167], v[80:83]
    v_exp_f32 v16, v152
    v_mfma_f32_16x16x32_bf16 v[84:87], a[196:199], v[168:171], v[84:87]
    ds_read_b128 a[192:195], v5 offset:59776
    v_cvt_pk_bf16_f32 v185, v18, v19
    v_mfma_f32_16x16x32_bf16 v[88:91], a[196:199], v[172:175], v[88:91]
    v_mov_b32 v203, 0
    s_waitcnt lgkmcnt(3)
    v_mfma_f32_16x16x32_bf16 v[100:103], a[200:203], v[172:175], v[100:103]
    v_exp_f32 v17, v153
    v_mfma_f32_16x16x32_bf16 v[96:99], a[200:203], v[168:171], v[96:99]
    v_exp_f32 v18, v154
    v_mfma_f32_16x16x32_bf16 v[92:95], a[200:203], v[164:167], v[92:95]
    ds_read_b128 a[196:199], v5 offset:59840
    v_cvt_pk_bf16_f32 v178, v16, v17
    v_mfma_f32_16x16x32_bf16 v[104:107], a[204:207], v[164:167], v[104:107]
    v_exp_f32 v19, v155
    v_mfma_f32_16x16x32_bf16 v[108:111], a[204:207], v[168:171], v[108:111]
    v_exp_f32 v16, v156
    v_mfma_f32_16x16x32_bf16 v[112:115], a[204:207], v[172:175], v[112:115]
    ds_read_b64_tr_b16 a[200:201], v4 offset:16896
    ds_read_b64_tr_b16 a[202:203], v4 offset:17408
    v_mfma_f32_16x16x32_bf16 v[116:119], a[208:211], v[208:211], v[188:191]
    ds_read_b64_tr_b16 a[204:205], v4 offset:16928
    v_cvt_pk_bf16_f32 v179, v18, v19
    v_mfma_f32_16x16x32_bf16 v[116:119], a[212:215], v[220:223], v[116:119]
    v_exp_f32 v17, v157
    v_mfma_f32_16x16x32_bf16 v[116:119], a[216:219], v[232:235], v[116:119]
    ds_read_b64_tr_b16 a[206:207], v4 offset:17440
    v_mfma_f32_16x16x32_bf16 v[116:119], a[220:223], v[244:247], v[116:119]
    v_exp_f32 v18, v158
    v_mfma_f32_16x16x32_bf16 v[120:123], a[220:223], v[248:251], v[192:195]
    v_cvt_pk_bf16_f32 v182, v16, v17
    v_mfma_f32_16x16x32_bf16 v[120:123], a[216:219], v[236:239], v[120:123]
    v_exp_f32 v19, v159
    v_mfma_f32_16x16x32_bf16 v[120:123], a[212:215], v[224:227], v[120:123]
    v_exp_f32 v16, v160
    v_mfma_f32_16x16x32_bf16 v[120:123], a[208:211], v[212:215], v[120:123]
    v_cvt_pk_bf16_f32 v183, v18, v19
    v_mfma_f32_16x16x32_bf16 v[124:127], a[208:211], v[216:219], v[196:199]
    v_exp_f32 v17, v161
    v_mfma_f32_16x16x32_bf16 v[124:127], a[212:215], v[228:231], v[124:127]
    ds_read_b64_tr_b16 a[208:209], v4 offset:16960
    ds_read_b64_tr_b16 a[210:211], v4 offset:17472
    v_mfma_f32_16x16x32_bf16 v[124:127], a[216:219], v[240:243], v[124:127]
    v_exp_f32 v18, v162
    v_mfma_f32_16x16x32_bf16 v[124:127], a[220:223], v[252:255], v[124:127]
    ds_read_b64_tr_b16 a[212:213], v4 offset:16992
    s_waitcnt lgkmcnt(3)
    v_mfma_f32_16x16x32_bf16 v[128:131], a[224:227], v[208:211], v[188:191]
    ds_read_b64_tr_b16 a[214:215], v4 offset:17504
    v_cvt_pk_bf16_f32 v186, v16, v17
    v_mfma_f32_16x16x32_bf16 v[128:131], a[228:231], v[220:223], v[128:131]
    v_exp_f32 v19, v163
    v_mfma_f32_16x16x32_bf16 v[128:131], a[192:195], v[232:235], v[128:131]
    v_cvt_pk_bf16_f32 v187, v18, v19
    v_mfma_f32_16x16x32_bf16 v[128:131], a[196:199], v[244:247], v[128:131]
    v_mfma_f32_16x16x32_bf16 v[132:135], a[196:199], v[248:251], v[192:195]
    v_mfma_f32_16x16x32_bf16 v[132:135], a[192:195], v[236:239], v[132:135]
    v_mfma_f32_16x16x32_bf16 v[132:135], a[228:231], v[224:227], v[132:135]
    v_mfma_f32_16x16x32_bf16 v[132:135], a[224:227], v[212:215], v[132:135]
    v_mfma_f32_16x16x32_bf16 v[204:207], a[232:235], v[176:179], v[200:203]
    v_mfma_f32_16x16x32_bf16 v[204:207], a[236:239], v[180:183], v[204:207]
    v_mfma_f32_16x16x32_bf16 v[204:207], a[240:243], v[184:187], v[204:207]
    s_nop 1
    v_mfma_f32_16x16x32_bf16 v[136:139], a[224:227], v[216:219], v[196:199]
    s_nop 1
    v_mfma_f32_16x16x32_bf16 v[136:139], a[228:231], v[228:231], v[136:139]
    s_nop 0
    v_mfma_f32_16x16x32_bf16 v[136:139], a[192:195], v[240:243], v[136:139]
    v_cmp_nge_f32 vcc, s84, v207
    s_waitcnt vmcnt(8) lgkmcnt(0)
    s_barrier
    v_mfma_f32_16x16x32_bf16 v[136:139], a[196:199], v[252:255], v[136:139]
    s_cbranch_vccnz K_R0_7
K_R0_7_ret:
    s_add_u32 m0, s56, 42240
    s_mov_b32 s57, 114688
    v_mfma_f32_16x16x32_bf16 v[28:31], a[200:203], v[184:187], v[28:31]
    buffer_load_dwordx4 v8, s[24:27], s57 offen offset:0 nt lds
    v_mfma_f32_16x16x32_bf16 v[24:27], a[200:203], v[180:183], v[24:27]
    v_exp_f32 v16, v116
    v_mfma_f32_16x16x32_bf16 v[20:23], a[200:203], v[176:179], v[20:23]
    v_exp_f32 v17, v117
    v_mfma_f32_16x16x32_bf16 v[32:35], a[204:207], v[176:179], v[32:35]
    ds_read_b64_tr_b16 a[216:217], v3 offset:0
    ds_read_b64_tr_b16 a[218:219], v3 offset:512
    v_mfma_f32_16x16x32_bf16 v[36:39], a[204:207], v[180:183], v[36:39]
    buffer_load_dwordx4 v9, s[24:27], s57 offen offset:1056 nt lds
    v_mfma_f32_16x16x32_bf16 v[40:43], a[204:207], v[184:187], v[40:43]
    s_add_u32 m0, s56, 59136
    s_mov_b32 s57, 106496
    v_mfma_f32_16x16x32_bf16 v[52:55], a[208:211], v[184:187], v[52:55]
    ds_read_b64_tr_b16 a[220:221], v3 offset:8448
    ds_read_b64_tr_b16 a[222:223], v3 offset:8960
    v_mfma_f32_16x16x32_bf16 v[48:51], a[208:211], v[180:183], v[48:51]
    ds_read_b64_tr_b16 a[224:225], v2 offset:33792
    ds_read_b64_tr_b16 a[226:227], v2 offset:34304
    v_mfma_f32_16x16x32_bf16 v[44:47], a[208:211], v[176:179], v[44:47]
    buffer_load_dwordx4 v8, s[28:31], s57 offen offset:0 nt lds
    v_mfma_f32_16x16x32_bf16 v[56:59], a[212:215], v[176:179], v[56:59]
    ds_read_b64_tr_b16 a[228:229], v3 offset:33792
    ds_read_b64_tr_b16 a[230:231], v3 offset:34304
    v_mfma_f32_16x16x32_bf16 v[60:63], a[212:215], v[180:183], v[60:63]
    ds_read_b64_tr_b16 a[192:193], v4 offset:17024
    ds_read_b64_tr_b16 a[194:195], v4 offset:17536
    v_mfma_f32_16x16x32_bf16 v[64:67], a[212:215], v[184:187], v[64:67]
    ds_read_b64_tr_b16 a[196:197], v4 offset:17056
    s_waitcnt lgkmcnt(9)
    v_mfma_f32_16x16x32_bf16 a[0:3], a[216:219], a[96:99], a[0:3]
    ds_read_b64_tr_b16 a[198:199], v4 offset:17568
    s_waitcnt lgkmcnt(8)
    v_mfma_f32_16x16x32_bf16 a[0:3], a[220:223], a[108:111], a[0:3]
    ds_read_b64_tr_b16 a[200:201], v4 offset:17088
    s_waitcnt lgkmcnt(7)
    v_mfma_f32_16x16x32_bf16 a[0:3], a[224:227], a[120:123], a[0:3]
    buffer_load_dwordx4 v9, s[28:31], s57 offen offset:1056 nt lds
    s_waitcnt lgkmcnt(5)
    v_mfma_f32_16x16x32_bf16 a[0:3], a[228:231], a[132:135], a[0:3]
    s_add_u32 m0, s56, 92928
    s_mov_b32 s57, 122880
    v_mfma_f32_16x16x32_bf16 a[4:7], a[228:231], a[136:139], a[4:7]
    v_exp_f32 v18, v118
    v_mfma_f32_16x16x32_bf16 a[4:7], a[224:227], a[124:127], a[4:7]
    ds_read_b64_tr_b16 a[202:203], v4 offset:17600
    v_cvt_pk_bf16_f32 v164, v16, v17
    v_mfma_f32_16x16x32_bf16 a[4:7], a[220:223], a[112:115], a[4:7]
    buffer_load_dwordx4 v8, s[24:27], s57 offen offset:0 nt lds
    v_mfma_f32_16x16x32_bf16 a[4:7], a[216:219], a[100:103], a[4:7]
    v_exp_f32 v19, v119
    v_mfma_f32_16x16x32_bf16 a[8:11], a[216:219], a[104:107], a[8:11]
    v_exp_f32 v16, v120
    v_mfma_f32_16x16x32_bf16 a[8:11], a[220:223], a[116:119], a[8:11]
    ds_read_b64_tr_b16 a[204:205], v4 offset:17120
    ds_read_b64_tr_b16 a[206:207], v4 offset:17632
    v_mfma_f32_16x16x32_bf16 a[8:11], a[224:227], a[128:131], a[8:11]
    buffer_load_dwordx4 v9, s[24:27], s57 offen offset:1056 nt lds
    v_mfma_f32_16x16x32_bf16 a[8:11], a[228:231], a[140:143], a[8:11]
    s_add_u32 m0, s56, 143616
    s_mov_b32 s57, 114688
    s_waitcnt lgkmcnt(3)
    v_mfma_f32_16x16x32_bf16 v[76:79], a[192:195], v[184:187], v[76:79]
    ds_read_b128 a[208:211], v6 offset:50688
    v_cvt_pk_bf16_f32 v165, v18, v19
    v_mfma_f32_16x16x32_bf16 v[72:75], a[192:195], v[180:183], v[72:75]
    v_exp_f32 v17, v121
    v_mfma_f32_16x16x32_bf16 v[68:71], a[192:195], v[176:179], v[68:71]
    buffer_load_dwordx4 v8, s[28:31], s57 offen offset:0 nt lds
    v_mfma_f32_16x16x32_bf16 v[80:83], a[196:199], v[176:179], v[80:83]
    v_exp_f32 v18, v122
    v_mfma_f32_16x16x32_bf16 v[84:87], a[196:199], v[180:183], v[84:87]
    ds_read_b128 a[212:215], v6 offset:50752
    v_cvt_pk_bf16_f32 v168, v16, v17
    v_mfma_f32_16x16x32_bf16 v[88:91], a[196:199], v[184:187], v[88:91]
    ds_read_b128 a[216:219], v6 offset:50816
    s_waitcnt lgkmcnt(5)
    v_mfma_f32_16x16x32_bf16 v[100:103], a[200:203], v[184:187], v[100:103]
    buffer_load_dwordx4 v9, s[28:31], s57 offen offset:1056 nt lds
    v_mfma_f32_16x16x32_bf16 v[96:99], a[200:203], v[180:183], v[96:99]
    v_exp_f32 v19, v123
    v_mfma_f32_16x16x32_bf16 v[92:95], a[200:203], v[176:179], v[92:95]
    ds_read_b128 a[220:223], v6 offset:50880
    s_waitcnt lgkmcnt(4)
    v_mfma_f32_16x16x32_bf16 v[104:107], a[204:207], v[176:179], v[104:107]
    v_exp_f32 v16, v124
    v_mfma_f32_16x16x32_bf16 v[108:111], a[204:207], v[180:183], v[108:111]
    ds_read_b128 a[224:227], v6 offset:51200
    v_cvt_pk_bf16_f32 v169, v18, v19
    v_mfma_f32_16x16x32_bf16 v[112:115], a[204:207], v[184:187], v[112:115]
    ds_read_b128 a[228:231], v6 offset:51264
    s_waitcnt lgkmcnt(5)
    v_mfma_f32_16x16x32_bf16 v[140:143], a[208:211], v[208:211], v[188:191]
    ds_read_b128 a[192:195], v6 offset:51328
    s_waitcnt lgkmcnt(5)
    v_mfma_f32_16x16x32_bf16 v[140:143], a[212:215], v[220:223], v[140:143]
    v_mov_b32 v207, 0
    s_waitcnt lgkmcnt(4)
    v_mfma_f32_16x16x32_bf16 v[140:143], a[216:219], v[232:235], v[140:143]
    ds_read_b128 a[196:199], v6 offset:51392
    s_waitcnt lgkmcnt(4)
    v_mfma_f32_16x16x32_bf16 v[140:143], a[220:223], v[244:247], v[140:143]
    v_exp_f32 v17, v125
    v_mfma_f32_16x16x32_bf16 v[144:147], a[220:223], v[248:251], v[192:195]
    v_exp_f32 v18, v126
    v_mfma_f32_16x16x32_bf16 v[144:147], a[216:219], v[236:239], v[144:147]
    ds_read_b64_tr_b16 a[200:201], v3 offset:59136
    v_cvt_pk_bf16_f32 v172, v16, v17
    v_mfma_f32_16x16x32_bf16 v[144:147], a[212:215], v[224:227], v[144:147]
    v_exp_f32 v19, v127
    v_mfma_f32_16x16x32_bf16 v[144:147], a[208:211], v[212:215], v[144:147]
    v_exp_f32 v16, v128
    v_mfma_f32_16x16x32_bf16 v[148:151], a[208:211], v[216:219], v[196:199]
    ds_read_b64_tr_b16 a[202:203], v3 offset:59648
    v_cvt_pk_bf16_f32 v173, v18, v19
    v_mfma_f32_16x16x32_bf16 v[148:151], a[212:215], v[228:231], v[148:151]
    v_exp_f32 v17, v129
    v_mfma_f32_16x16x32_bf16 v[148:151], a[216:219], v[240:243], v[148:151]
    v_exp_f32 v18, v130
    v_mfma_f32_16x16x32_bf16 v[148:151], a[220:223], v[252:255], v[148:151]
    v_cvt_pk_bf16_f32 v166, v16, v17
    s_waitcnt lgkmcnt(2)
    v_mfma_f32_16x16x32_bf16 v[152:155], a[224:227], v[208:211], v[188:191]
    v_exp_f32 v19, v131
    v_mfma_f32_16x16x32_bf16 v[152:155], a[228:231], v[220:223], v[152:155]
    v_exp_f32 v16, v132
    v_mfma_f32_16x16x32_bf16 v[152:155], a[192:195], v[232:235], v[152:155]
    ds_read_b64_tr_b16 a[204:205], v3 offset:59168
    v_cvt_pk_bf16_f32 v167, v18, v19
    v_mfma_f32_16x16x32_bf16 v[152:155], a[196:199], v[244:247], v[152:155]
    v_exp_f32 v17, v133
    v_mfma_f32_16x16x32_bf16 v[156:159], a[196:199], v[248:251], v[192:195]
    ds_read_b64_tr_b16 a[206:207], v3 offset:59680
    ds_read_b64_tr_b16 a[208:209], v3 offset:59200
    v_mfma_f32_16x16x32_bf16 v[156:159], a[192:195], v[236:239], v[156:159]
    v_exp_f32 v18, v134
    v_mfma_f32_16x16x32_bf16 v[156:159], a[228:231], v[224:227], v[156:159]
    v_cvt_pk_bf16_f32 v170, v16, v17
    v_exp_f32 v19, v135
    v_exp_f32 v16, v136
    v_cvt_pk_bf16_f32 v171, v18, v19
    v_mfma_f32_16x16x32_bf16 v[156:159], a[224:227], v[212:215], v[156:159]
    v_exp_f32 v17, v137
    v_exp_f32 v18, v138
    v_cvt_pk_bf16_f32 v174, v16, v17
    v_exp_f32 v19, v139
    s_nop 0
    v_cvt_pk_bf16_f32 v175, v18, v19
    v_mfma_f32_16x16x32_bf16 v[200:203], a[232:235], v[164:167], v[204:207]
    ds_read_b64_tr_b16 a[210:211], v3 offset:59712
    ds_read_b64_tr_b16 a[212:213], v3 offset:59232
    v_mfma_f32_16x16x32_bf16 v[200:203], a[236:239], v[168:171], v[200:203]
    ds_read_b64_tr_b16 a[214:215], v3 offset:59744
    ds_read_b64_tr_b16 a[216:217], v3 offset:32
    v_mfma_f32_16x16x32_bf16 v[200:203], a[240:243], v[172:175], v[200:203]
    ds_read_b64_tr_b16 a[218:219], v3 offset:544
    ds_read_b64_tr_b16 a[220:221], v3 offset:8480
    v_mfma_f32_16x16x32_bf16 v[160:163], a[224:227], v[216:219], v[196:199]
    ds_read_b64_tr_b16 a[222:223], v3 offset:8992
    ds_read_b64_tr_b16 a[224:225], v2 offset:33824
    v_mfma_f32_16x16x32_bf16 v[160:163], a[228:231], v[228:231], v[160:163]
    ds_read_b64_tr_b16 a[226:227], v2 offset:34336
    ds_read_b64_tr_b16 a[228:229], v3 offset:33824
    v_mfma_f32_16x16x32_bf16 v[160:163], a[192:195], v[240:243], v[160:163]
    v_cmp_nge_f32 vcc, s84, v203
    s_waitcnt lgkmcnt(10)
    s_barrier
    v_mfma_f32_16x16x32_bf16 v[160:163], a[196:199], v[252:255], v[160:163]
    s_cbranch_vccnz K_R0_8
K_R0_8_ret:
    s_add_u32 m0, s56, 118272
    s_mov_b32 s57, 131072
    v_mfma_f32_16x16x32_bf16 v[28:31], a[200:203], v[172:175], v[28:31]
    buffer_load_dwordx4 v8, s[24:27], s57 offen offset:0 nt lds
    v_mfma_f32_16x16x32_bf16 v[24:27], a[200:203], v[168:171], v[24:27]
    v_exp_f32 v16, v140
    v_mfma_f32_16x16x32_bf16 v[20:23], a[200:203], v[164:167], v[20:23]
    ds_read_b64_tr_b16 a[230:231], v3 offset:34336
    ds_read_b64_tr_b16 a[192:193], v3 offset:59264
    v_mfma_f32_16x16x32_bf16 v[32:35], a[204:207], v[164:167], v[32:35]
    v_exp_f32 v17, v141
    v_mfma_f32_16x16x32_bf16 v[36:39], a[204:207], v[168:171], v[36:39]
    buffer_load_dwordx4 v9, s[24:27], s57 offen offset:1056 nt lds
    v_mfma_f32_16x16x32_bf16 v[40:43], a[204:207], v[172:175], v[40:43]
    s_add_u32 m0, s56, 152064
    s_mov_b32 s57, 122880
    s_waitcnt lgkmcnt(4)
    v_mfma_f32_16x16x32_bf16 v[52:55], a[208:211], v[172:175], v[52:55]
    ds_read_b64_tr_b16 a[194:195], v3 offset:59776
    ds_read_b64_tr_b16 a[196:197], v3 offset:59296
    v_mfma_f32_16x16x32_bf16 v[48:51], a[208:211], v[168:171], v[48:51]
    ds_read_b64_tr_b16 a[198:199], v3 offset:59808
    ds_read_b64_tr_b16 a[200:201], v3 offset:59328
    v_mfma_f32_16x16x32_bf16 v[44:47], a[208:211], v[164:167], v[44:47]
    buffer_load_dwordx4 v8, s[28:31], s57 offen offset:0 nt lds
    v_mfma_f32_16x16x32_bf16 v[56:59], a[212:215], v[164:167], v[56:59]
    v_exp_f32 v18, v142
    v_mfma_f32_16x16x32_bf16 v[60:63], a[212:215], v[168:171], v[60:63]
    ds_read_b64_tr_b16 a[202:203], v3 offset:59840
    v_cvt_pk_bf16_f32 v176, v16, v17
    v_mfma_f32_16x16x32_bf16 v[64:67], a[212:215], v[172:175], v[64:67]
    v_exp_f32 v19, v143
    v_mfma_f32_16x16x32_bf16 a[12:15], a[216:219], a[96:99], a[12:15]
    buffer_load_dwordx4 v9, s[28:31], s57 offen offset:1056 nt lds
    v_mfma_f32_16x16x32_bf16 a[12:15], a[220:223], a[108:111], a[12:15]
    ds_read_b64_tr_b16 a[204:205], v3 offset:59360
    s_waitcnt lgkmcnt(6)
    v_mfma_f32_16x16x32_bf16 a[12:15], a[224:227], a[120:123], a[12:15]
    v_exp_f32 v16, v144
    v_mfma_f32_16x16x32_bf16 a[12:15], a[228:231], a[132:135], a[12:15]
    ds_read_b64_tr_b16 a[206:207], v3 offset:59872
    v_cvt_pk_bf16_f32 v177, v18, v19
    v_mfma_f32_16x16x32_bf16 a[16:19], a[228:231], a[136:139], a[16:19]
    v_exp_f32 v17, v145
    v_mfma_f32_16x16x32_bf16 a[16:19], a[224:227], a[124:127], a[16:19]
    ds_read_b128 a[208:211], v5 offset:0
    ds_read_b128 a[212:215], v5 offset:64
    v_mfma_f32_16x16x32_bf16 a[16:19], a[220:223], a[112:115], a[16:19]
    v_exp_f32 v18, v146
    v_mfma_f32_16x16x32_bf16 a[16:19], a[216:219], a[100:103], a[16:19]
    v_cvt_pk_bf16_f32 v180, v16, v17
    v_mov_b32 v203, 0
    v_mfma_f32_16x16x32_bf16 a[20:23], a[216:219], a[104:107], a[20:23]
    v_exp_f32 v19, v147
    v_mfma_f32_16x16x32_bf16 a[20:23], a[220:223], a[116:119], a[20:23]
    v_exp_f32 v16, v148
    v_mfma_f32_16x16x32_bf16 a[20:23], a[224:227], a[128:131], a[20:23]
    v_cvt_pk_bf16_f32 v181, v18, v19
    v_accvgpr_read_b32 v13, a0
    v_mfma_f32_16x16x32_bf16 a[20:23], a[228:231], a[140:143], a[20:23]
    v_accvgpr_read_b32 v14, a1
    s_waitcnt lgkmcnt(3)
    v_mfma_f32_16x16x32_bf16 v[76:79], a[192:195], v[172:175], v[76:79]
    v_exp_f32 v17, v149
    v_mfma_f32_16x16x32_bf16 v[72:75], a[192:195], v[168:171], v[72:75]
    v_exp_f32 v18, v150
    v_mfma_f32_16x16x32_bf16 v[68:71], a[192:195], v[164:167], v[68:71]
    v_cvt_pk_bf16_f32 v184, v16, v17
    v_mul_f32 v13, s85, v13
    v_mfma_f32_16x16x32_bf16 v[80:83], a[196:199], v[164:167], v[80:83]
    ds_read_b128 a[216:219], v5 offset:128
    v_mul_f32 v14, s85, v14
    v_mfma_f32_16x16x32_bf16 v[84:87], a[196:199], v[168:171], v[84:87]
    v_exp_f32 v19, v151
    v_mfma_f32_16x16x32_bf16 v[88:91], a[196:199], v[172:175], v[88:91]
    ds_read_b128 a[220:223], v5 offset:192
    v_cvt_pk_bf16_f32 v13, v13, v14
    v_mfma_f32_16x16x32_bf16 v[100:103], a[200:203], v[172:175], v[100:103]
    ds_read_b128 a[224:227], v5 offset:512
    ds_read_b128 a[228:231], v5 offset:576
    v_mfma_f32_16x16x32_bf16 v[96:99], a[200:203], v[168:171], v[96:99]
    v_exp_f32 v16, v152
    v_mfma_f32_16x16x32_bf16 v[92:95], a[200:203], v[164:167], v[92:95]
    v_accvgpr_read_b32 v14, a2
    s_waitcnt lgkmcnt(4)
    v_mfma_f32_16x16x32_bf16 v[104:107], a[204:207], v[164:167], v[104:107]
    v_cvt_pk_bf16_f32 v185, v18, v19
    v_accvgpr_read_b32 v15, a3
    v_mfma_f32_16x16x32_bf16 v[108:111], a[204:207], v[168:171], v[108:111]
    v_exp_f32 v17, v153
    v_mfma_f32_16x16x32_bf16 v[112:115], a[204:207], v[172:175], v[112:115]
    ds_read_b128 a[192:195], v5 offset:640
    v_mul_f32 v14, s85, v14
    v_mfma_f32_16x16x32_bf16 v[116:119], a[208:211], v[208:211], v[188:191]
    v_exp_f32 v18, v154
    v_mfma_f32_16x16x32_bf16 v[116:119], a[212:215], v[220:223], v[116:119]
    v_mul_f32 v15, s85, v15
    s_waitcnt lgkmcnt(4)
    v_mfma_f32_16x16x32_bf16 v[116:119], a[216:219], v[232:235], v[116:119]
    v_cvt_pk_bf16_f32 v14, v14, v15
    s_waitcnt lgkmcnt(3)
    v_mfma_f32_16x16x32_bf16 v[116:119], a[220:223], v[244:247], v[116:119]
    ds_read_b128 a[196:199], v5 offset:704
    v_cvt_pk_bf16_f32 v178, v16, v17
    v_mfma_f32_16x16x32_bf16 v[120:123], a[220:223], v[248:251], v[192:195]
    v_exp_f32 v19, v155
    v_mfma_f32_16x16x32_bf16 v[120:123], a[216:219], v[236:239], v[120:123]
    v_accvgpr_write_b32 a1, v14
    v_accvgpr_read_b32 v14, a12
    v_mfma_f32_16x16x32_bf16 v[120:123], a[212:215], v[224:227], v[120:123]
    v_exp_f32 v16, v156
    v_mfma_f32_16x16x32_bf16 v[120:123], a[208:211], v[212:215], v[120:123]
    ds_read_b64_tr_b16 a[200:201], v2 offset:8448
    v_accvgpr_read_b32 v15, a13
    v_mfma_f32_16x16x32_bf16 v[124:127], a[208:211], v[216:219], v[196:199]
    ds_read_b64_tr_b16 a[202:203], v2 offset:8960
    v_cvt_pk_bf16_f32 v179, v18, v19
    v_mfma_f32_16x16x32_bf16 v[124:127], a[212:215], v[228:231], v[124:127]
    v_mul_f32 v14, s85, v14
    v_mul_f32 v15, s85, v15
    v_mfma_f32_16x16x32_bf16 v[124:127], a[216:219], v[240:243], v[124:127]
    v_exp_f32 v17, v157
    v_mfma_f32_16x16x32_bf16 v[124:127], a[220:223], v[252:255], v[124:127]
    ds_read_b64_tr_b16 a[204:205], v2 offset:8480
    s_waitcnt lgkmcnt(4)
    v_mfma_f32_16x16x32_bf16 v[128:131], a[224:227], v[208:211], v[188:191]
    ds_read_b64_tr_b16 a[206:207], v2 offset:8992
    v_cvt_pk_bf16_f32 v14, v14, v15
    v_mfma_f32_16x16x32_bf16 v[128:131], a[228:231], v[220:223], v[128:131]
    v_exp_f32 v18, v158
    v_mfma_f32_16x16x32_bf16 v[128:131], a[192:195], v[232:235], v[128:131]
    v_permlane16_swap_b32 v13, v14
    s_waitcnt lgkmcnt(4)
    v_mfma_f32_16x16x32_bf16 v[128:131], a[196:199], v[244:247], v[128:131]
    v_cvt_pk_bf16_f32 v182, v16, v17
    v_accvgpr_write_b32 a0, v13
    v_mfma_f32_16x16x32_bf16 v[132:135], a[196:199], v[248:251], v[192:195]
    v_exp_f32 v19, v159
    v_mfma_f32_16x16x32_bf16 v[132:135], a[192:195], v[236:239], v[132:135]
    v_accvgpr_write_b32 a2, v14
    v_accvgpr_read_b32 v14, a14
    v_mfma_f32_16x16x32_bf16 v[132:135], a[228:231], v[224:227], v[132:135]
    v_exp_f32 v16, v160
    v_cvt_pk_bf16_f32 v183, v18, v19
    v_mfma_f32_16x16x32_bf16 v[132:135], a[224:227], v[212:215], v[132:135]
    v_exp_f32 v17, v161
    v_exp_f32 v18, v162
    v_cvt_pk_bf16_f32 v186, v16, v17
    v_exp_f32 v19, v163
    s_nop 0
    v_cvt_pk_bf16_f32 v187, v18, v19
    v_mfma_f32_16x16x32_bf16 v[204:207], a[232:235], v[176:179], v[200:203]
    v_accvgpr_read_b32 v15, a15
    v_mul_f32 v14, s85, v14
    v_mfma_f32_16x16x32_bf16 v[204:207], a[236:239], v[180:183], v[204:207]
    ds_read_b64_tr_b16 a[208:209], v2 offset:8512
    ds_read_b64_tr_b16 a[210:211], v2 offset:9024
    v_mfma_f32_16x16x32_bf16 v[204:207], a[240:243], v[184:187], v[204:207]
    ds_read_b64_tr_b16 a[212:213], v2 offset:8544
    v_mul_f32 v15, s85, v15
    v_mfma_f32_16x16x32_bf16 v[136:139], a[224:227], v[216:219], v[196:199]
    ds_read_b64_tr_b16 a[214:215], v2 offset:9056
    v_cvt_pk_bf16_f32 v14, v14, v15
    v_mfma_f32_16x16x32_bf16 v[136:139], a[228:231], v[228:231], v[136:139]
    ds_read_b64_tr_b16 a[216:217], v3 offset:64
    ds_read_b64_tr_b16 a[218:219], v3 offset:576
    v_mfma_f32_16x16x32_bf16 v[136:139], a[192:195], v[240:243], v[136:139]
    v_cmp_nge_f32 vcc, s84, v207
    s_waitcnt lgkmcnt(6)
    s_barrier
    v_mfma_f32_16x16x32_bf16 v[136:139], a[196:199], v[252:255], v[136:139]
    s_cbranch_vccnz K_R0_9
K_R0_9_ret:
    s_add_u32 m0, s56, 0
    s_mov_b32 s57, 139264
    v_mfma_f32_16x16x32_bf16 v[28:31], a[200:203], v[184:187], v[28:31]
    buffer_load_dwordx4 v8, s[24:27], s57 offen offset:0 nt lds
    v_mfma_f32_16x16x32_bf16 v[24:27], a[200:203], v[180:183], v[24:27]
    ds_read_b64_tr_b16 a[220:221], v3 offset:8512
    v_accvgpr_read_b32 v13, a1
    v_mfma_f32_16x16x32_bf16 v[20:23], a[200:203], v[176:179], v[20:23]
    ds_read_b64_tr_b16 a[222:223], v3 offset:9024
    v_permlane16_swap_b32 v13, v14
    v_mfma_f32_16x16x32_bf16 v[32:35], a[204:207], v[176:179], v[32:35]
    v_accvgpr_write_b32 a1, v13
    v_accvgpr_write_b32 a3, v14
    v_mfma_f32_16x16x32_bf16 v[36:39], a[204:207], v[180:183], v[36:39]
    buffer_load_dwordx4 v9, s[24:27], s57 offen offset:1056 nt lds
    v_mfma_f32_16x16x32_bf16 v[40:43], a[204:207], v[184:187], v[40:43]
    s_add_u32 m0, s56, 126720
    s_mov_b32 s57, 131072
    s_waitcnt lgkmcnt(4)
    v_mfma_f32_16x16x32_bf16 v[52:55], a[208:211], v[184:187], v[52:55]
    v_accvgpr_read_b32 v13, a4
    v_accvgpr_read_b32 v14, a5
    v_mfma_f32_16x16x32_bf16 v[48:51], a[208:211], v[180:183], v[48:51]
    v_mul_f32 v13, s85, v13
    v_mul_f32 v14, s85, v14
    v_mfma_f32_16x16x32_bf16 v[44:47], a[208:211], v[176:179], v[44:47]
    ds_read_b64_tr_b16 a[224:225], v2 offset:33856
    ds_read_b64_tr_b16 a[226:227], v2 offset:34368
    v_mfma_f32_16x16x32_bf16 v[56:59], a[212:215], v[176:179], v[56:59]
    ds_read_b64_tr_b16 a[228:229], v3 offset:33856
    ds_read_b64_tr_b16 a[230:231], v3 offset:34368
    v_mfma_f32_16x16x32_bf16 v[60:63], a[212:215], v[180:183], v[60:63]
    buffer_load_dwordx4 v8, s[28:31], s57 offen offset:0 nt lds
    v_mfma_f32_16x16x32_bf16 v[64:67], a[212:215], v[184:187], v[64:67]
    v_cvt_pk_bf16_f32 v13, v13, v14
    s_waitcnt lgkmcnt(4)
    v_mfma_f32_16x16x32_bf16 a[24:27], a[216:219], a[96:99], a[24:27]
    v_accvgpr_read_b32 v14, a6
    v_accvgpr_read_b32 v15, a7
    v_mfma_f32_16x16x32_bf16 a[24:27], a[220:223], a[108:111], a[24:27]
    v_mul_f32 v14, s85, v14
    s_waitcnt lgkmcnt(2)
    v_mfma_f32_16x16x32_bf16 a[24:27], a[224:227], a[120:123], a[24:27]
    ds_read_b64_tr_b16 a[192:193], v3 offset:96
    s_waitcnt lgkmcnt(1)
    v_mfma_f32_16x16x32_bf16 a[24:27], a[228:231], a[132:135], a[24:27]
    buffer_load_dwordx4 v9, s[28:31], s57 offen offset:1056 nt lds
    v_mfma_f32_16x16x32_bf16 a[28:31], a[228:231], a[136:139], a[28:31]
    v_exp_f32 v16, v116
    v_mfma_f32_16x16x32_bf16 a[28:31], a[224:227], a[124:127], a[28:31]
    ds_read_b64_tr_b16 a[194:195], v3 offset:608
    v_mul_f32 v15, s85, v15
    v_mfma_f32_16x16x32_bf16 a[28:31], a[220:223], a[112:115], a[28:31]
    v_exp_f32 v17, v117
    v_mfma_f32_16x16x32_bf16 a[28:31], a[216:219], a[100:103], a[28:31]
    ds_read_b64_tr_b16 a[196:197], v3 offset:8544
    ds_read_b64_tr_b16 a[198:199], v3 offset:9056
    v_mfma_f32_16x16x32_bf16 a[32:35], a[216:219], a[104:107], a[32:35]
    ds_read_b64_tr_b16 a[200:201], v2 offset:33888
    ds_read_b64_tr_b16 a[202:203], v2 offset:34400
    v_mfma_f32_16x16x32_bf16 a[32:35], a[220:223], a[116:119], a[32:35]
    ds_read_b64_tr_b16 a[204:205], v3 offset:33888
    ds_read_b64_tr_b16 a[206:207], v3 offset:34400
    v_mfma_f32_16x16x32_bf16 a[32:35], a[224:227], a[128:131], a[32:35]
    v_cvt_pk_bf16_f32 v14, v14, v15
    v_accvgpr_write_b32 a5, v14
    v_mfma_f32_16x16x32_bf16 a[32:35], a[228:231], a[140:143], a[32:35]
    v_accvgpr_read_b32 v14, a16
    s_waitcnt lgkmcnt(6)
    v_mfma_f32_16x16x32_bf16 a[36:39], a[192:195], a[96:99], a[36:39]
    v_accvgpr_read_b32 v15, a17
    s_waitcnt lgkmcnt(4)
    v_mfma_f32_16x16x32_bf16 a[36:39], a[196:199], a[108:111], a[36:39]
    v_mul_f32 v14, s85, v14
    s_waitcnt lgkmcnt(2)
    v_mfma_f32_16x16x32_bf16 a[36:39], a[200:203], a[120:123], a[36:39]
    v_mul_f32 v15, s85, v15
    s_waitcnt lgkmcnt(0)
    v_mfma_f32_16x16x32_bf16 a[36:39], a[204:207], a[132:135], a[36:39]
    v_exp_f32 v18, v118
    v_mfma_f32_16x16x32_bf16 a[40:43], a[204:207], a[136:139], a[40:43]
    v_cvt_pk_bf16_f32 v164, v16, v17
    v_cvt_pk_bf16_f32 v14, v14, v15
    v_mfma_f32_16x16x32_bf16 a[40:43], a[200:203], a[124:127], a[40:43]
    v_exp_f32 v19, v119
    v_mfma_f32_16x16x32_bf16 a[40:43], a[196:199], a[112:115], a[40:43]
    ds_read_b64_tr_b16 a[208:209], v2 offset:8576
    ds_read_b64_tr_b16 a[210:211], v2 offset:9088
    v_mfma_f32_16x16x32_bf16 a[40:43], a[192:195], a[100:103], a[40:43]
    v_exp_f32 v16, v120
    v_mfma_f32_16x16x32_bf16 a[44:47], a[192:195], a[104:107], a[44:47]
    v_cvt_pk_bf16_f32 v165, v18, v19
    v_permlane16_swap_b32 v13, v14
    v_mfma_f32_16x16x32_bf16 a[44:47], a[196:199], a[116:119], a[44:47]
    ds_read_b64_tr_b16 a[212:213], v2 offset:8608
    ds_read_b64_tr_b16 a[214:215], v2 offset:9120
    v_mfma_f32_16x16x32_bf16 a[44:47], a[200:203], a[128:131], a[44:47]
    v_exp_f32 v17, v121
    v_mfma_f32_16x16x32_bf16 a[44:47], a[204:207], a[140:143], a[44:47]
    v_accvgpr_write_b32 a4, v13
    s_waitcnt lgkmcnt(2)
    v_mfma_f32_16x16x32_bf16 v[76:79], a[208:211], v[184:187], v[76:79]
    ds_read_b64_tr_b16 a[216:217], v2 offset:8640
    ds_read_b64_tr_b16 a[218:219], v2 offset:9152
    v_mfma_f32_16x16x32_bf16 v[72:75], a[208:211], v[180:183], v[72:75]
    v_accvgpr_write_b32 a6, v14
    v_accvgpr_read_b32 v14, a18
    v_mfma_f32_16x16x32_bf16 v[68:71], a[208:211], v[176:179], v[68:71]
    v_accvgpr_read_b32 v15, a19
    s_waitcnt lgkmcnt(2)
    v_mfma_f32_16x16x32_bf16 v[80:83], a[212:215], v[176:179], v[80:83]
    ds_read_b64_tr_b16 a[220:221], v2 offset:8672
    ds_read_b64_tr_b16 a[222:223], v2 offset:9184
    v_mfma_f32_16x16x32_bf16 v[84:87], a[212:215], v[180:183], v[84:87]
    v_exp_f32 v18, v122
    v_mfma_f32_16x16x32_bf16 v[88:91], a[212:215], v[184:187], v[88:91]
    v_cvt_pk_bf16_f32 v168, v16, v17
    s_waitcnt lgkmcnt(2)
    v_mfma_f32_16x16x32_bf16 v[100:103], a[216:219], v[184:187], v[100:103]
    ds_read_b128 a[224:227], v5 offset:16896
    v_mul_f32 v14, s85, v14
    v_mfma_f32_16x16x32_bf16 v[96:99], a[216:219], v[180:183], v[96:99]
    ds_read_b128 a[228:231], v5 offset:16960
    v_mul_f32 v15, s85, v15
    v_mfma_f32_16x16x32_bf16 v[92:95], a[216:219], v[176:179], v[92:95]
    ds_read_b128 a[192:195], v5 offset:17024
    s_waitcnt lgkmcnt(3)
    v_mfma_f32_16x16x32_bf16 v[104:107], a[220:223], v[176:179], v[104:107]
    ds_read_b128 a[196:199], v5 offset:17088
    v_cvt_pk_bf16_f32 v14, v14, v15
    v_mfma_f32_16x16x32_bf16 v[108:111], a[220:223], v[180:183], v[108:111]
    v_exp_f32 v19, v123
    v_mfma_f32_16x16x32_bf16 v[112:115], a[220:223], v[184:187], v[112:115]
    v_accvgpr_read_b32 v13, a5
    s_waitcnt lgkmcnt(3)
    v_mfma_f32_16x16x32_bf16 v[140:143], a[224:227], v[208:211], v[188:191]
    v_permlane16_swap_b32 v13, v14
    s_waitcnt lgkmcnt(2)
    v_mfma_f32_16x16x32_bf16 v[140:143], a[228:231], v[220:223], v[140:143]
    v_accvgpr_write_b32 a5, v13
    s_waitcnt lgkmcnt(1)
    v_mfma_f32_16x16x32_bf16 v[140:143], a[192:195], v[232:235], v[140:143]
    v_accvgpr_write_b32 a7, v14
    s_waitcnt lgkmcnt(0)
    v_mfma_f32_16x16x32_bf16 v[140:143], a[196:199], v[244:247], v[140:143]
    v_exp_f32 v16, v124
    v_mfma_f32_16x16x32_bf16 v[144:147], a[196:199], v[248:251], v[192:195]
    v_cvt_pk_bf16_f32 v169, v18, v19
    v_accvgpr_read_b32 v13, a8
    v_mfma_f32_16x16x32_bf16 v[144:147], a[192:195], v[236:239], v[144:147]
    v_exp_f32 v17, v125
    v_mfma_f32_16x16x32_bf16 v[144:147], a[228:231], v[224:227], v[144:147]
    ds_read_b128 a[200:203], v5 offset:17408
    v_accvgpr_read_b32 v14, a9
    v_mfma_f32_16x16x32_bf16 v[144:147], a[224:227], v[212:215], v[144:147]
    ds_read_b128 a[204:207], v5 offset:17472
    v_mul_f32 v13, s85, v13
    v_mfma_f32_16x16x32_bf16 v[148:151], a[224:227], v[216:219], v[196:199]
    ds_read_b128 a[208:211], v5 offset:17536
    v_mov_b32 v207, 0
    v_mfma_f32_16x16x32_bf16 v[148:151], a[228:231], v[228:231], v[148:151]
    ds_read_b128 a[212:215], v5 offset:17600
    v_mul_f32 v14, s85, v14
    v_mfma_f32_16x16x32_bf16 v[148:151], a[192:195], v[240:243], v[148:151]
    v_exp_f32 v18, v126
    v_mfma_f32_16x16x32_bf16 v[148:151], a[196:199], v[252:255], v[148:151]
    v_cvt_pk_bf16_f32 v172, v16, v17
    s_waitcnt lgkmcnt(3)
    v_mfma_f32_16x16x32_bf16 v[152:155], a[200:203], v[208:211], v[188:191]
    v_cvt_pk_bf16_f32 v13, v13, v14
    s_waitcnt lgkmcnt(2)
    v_mfma_f32_16x16x32_bf16 v[152:155], a[204:207], v[220:223], v[152:155]
    v_accvgpr_read_b32 v14, a10
    s_waitcnt lgkmcnt(1)
    v_mfma_f32_16x16x32_bf16 v[152:155], a[208:211], v[232:235], v[152:155]
    v_accvgpr_read_b32 v15, a11
    s_waitcnt lgkmcnt(0)
    v_mfma_f32_16x16x32_bf16 v[152:155], a[212:215], v[244:247], v[152:155]
    v_exp_f32 v19, v127
    v_mfma_f32_16x16x32_bf16 v[156:159], a[212:215], v[248:251], v[192:195]
    v_exp_f32 v16, v128
    v_mfma_f32_16x16x32_bf16 v[156:159], a[208:211], v[236:239], v[156:159]
    v_cvt_pk_bf16_f32 v173, v18, v19
    v_exp_f32 v17, v129
    v_exp_f32 v18, v130
    v_cvt_pk_bf16_f32 v166, v16, v17
    v_exp_f32 v19, v131
    v_exp_f32 v16, v132
    v_cvt_pk_bf16_f32 v167, v18, v19
    v_mfma_f32_16x16x32_bf16 v[156:159], a[204:207], v[224:227], v[156:159]
    v_exp_f32 v17, v133
    v_exp_f32 v18, v134
    v_cvt_pk_bf16_f32 v170, v16, v17
    v_exp_f32 v19, v135
    v_exp_f32 v16, v136
    v_cvt_pk_bf16_f32 v171, v18, v19
    v_mfma_f32_16x16x32_bf16 v[156:159], a[200:203], v[212:215], v[156:159]
    v_exp_f32 v17, v137
    v_exp_f32 v18, v138
    v_cvt_pk_bf16_f32 v174, v16, v17
    v_exp_f32 v19, v139
    s_nop 0
    v_cvt_pk_bf16_f32 v175, v18, v19
    v_mfma_f32_16x16x32_bf16 v[200:203], a[232:235], v[164:167], v[204:207]
    v_mul_f32 v14, s85, v14
    v_mul_f32 v15, s85, v15
    v_mfma_f32_16x16x32_bf16 v[200:203], a[236:239], v[168:171], v[200:203]
    ds_read_b64_tr_b16 a[216:217], v2 offset:50688
    ds_read_b64_tr_b16 a[218:219], v2 offset:51200
    v_mfma_f32_16x16x32_bf16 v[200:203], a[240:243], v[172:175], v[200:203]
    v_cvt_pk_bf16_f32 v14, v14, v15
    v_accvgpr_write_b32 a9, v14
    v_mfma_f32_16x16x32_bf16 v[160:163], a[200:203], v[216:219], v[196:199]
    v_accvgpr_read_b32 v14, a20
    v_accvgpr_read_b32 v15, a21
    v_mfma_f32_16x16x32_bf16 v[160:163], a[204:207], v[228:231], v[160:163]
    ds_read_b64_tr_b16 a[220:221], v2 offset:50720
    ds_read_b64_tr_b16 a[222:223], v2 offset:51232
    v_mfma_f32_16x16x32_bf16 v[160:163], a[208:211], v[240:243], v[160:163]
    v_cmp_nge_f32 vcc, s84, v203
    s_waitcnt vmcnt(20) lgkmcnt(4)
    s_barrier
    v_mfma_f32_16x16x32_bf16 v[160:163], a[212:215], v[252:255], v[160:163]
    s_cbranch_vccnz K_R0_10
K_R0_10_ret:
    s_waitcnt lgkmcnt(2)
    v_mfma_f32_16x16x32_bf16 v[28:31], a[216:219], v[172:175], v[28:31]
    ds_read_b64_tr_b16 a[224:225], v2 offset:50752
    ds_read_b64_tr_b16 a[226:227], v2 offset:51264
    v_mfma_f32_16x16x32_bf16 v[24:27], a[216:219], v[168:171], v[24:27]
    s_add_u32 m0, s56, 8448
    s_mov_b32 s57, 147456
    v_mfma_f32_16x16x32_bf16 v[20:23], a[216:219], v[164:167], v[20:23]
    v_mul_f32 v14, s85, v14
    s_waitcnt lgkmcnt(2)
    v_mfma_f32_16x16x32_bf16 v[32:35], a[220:223], v[164:167], v[32:35]
    ds_read_b64_tr_b16 a[228:229], v2 offset:50784
    ds_read_b64_tr_b16 a[230:231], v2 offset:51296
    v_mfma_f32_16x16x32_bf16 v[36:39], a[220:223], v[168:171], v[36:39]
    buffer_load_dwordx4 v8, s[24:27], s57 offen offset:0 nt lds
    v_mfma_f32_16x16x32_bf16 v[40:43], a[220:223], v[172:175], v[40:43]
    v_mul_f32 v15, s85, v15
    s_waitcnt lgkmcnt(2)
    v_mfma_f32_16x16x32_bf16 v[52:55], a[224:227], v[172:175], v[52:55]
    ds_read_b64_tr_b16 a[192:193], v3 offset:128
    ds_read_b64_tr_b16 a[194:195], v3 offset:640
    v_mfma_f32_16x16x32_bf16 v[48:51], a[224:227], v[168:171], v[48:51]
    ds_read_b64_tr_b16 a[196:197], v3 offset:8576
    ds_read_b64_tr_b16 a[198:199], v3 offset:9088
    v_mfma_f32_16x16x32_bf16 v[44:47], a[224:227], v[164:167], v[44:47]
    ds_read_b64_tr_b16 a[200:201], v2 offset:33920
    ds_read_b64_tr_b16 a[202:203], v2 offset:34432
    s_waitcnt lgkmcnt(6)
    v_mfma_f32_16x16x32_bf16 v[56:59], a[228:231], v[164:167], v[56:59]
    ds_read_b64_tr_b16 a[204:205], v3 offset:33920
    ds_read_b64_tr_b16 a[206:207], v3 offset:34432
    v_mfma_f32_16x16x32_bf16 v[60:63], a[228:231], v[168:171], v[60:63]
    buffer_load_dwordx4 v9, s[24:27], s57 offen offset:1056 nt lds
    v_mfma_f32_16x16x32_bf16 v[64:67], a[228:231], v[172:175], v[64:67]
    s_add_u32 m0, s56, 16896
    s_mov_b32 s57, 139264
    s_waitcnt lgkmcnt(6)
    v_mfma_f32_16x16x32_bf16 a[48:51], a[192:195], a[96:99], a[48:51]
    v_cvt_pk_bf16_f32 v14, v14, v15
    s_waitcnt lgkmcnt(4)
    v_mfma_f32_16x16x32_bf16 a[48:51], a[196:199], a[108:111], a[48:51]
    v_permlane16_swap_b32 v13, v14
    s_waitcnt lgkmcnt(2)
    v_mfma_f32_16x16x32_bf16 a[48:51], a[200:203], a[120:123], a[48:51]
    v_accvgpr_write_b32 a8, v13
    s_waitcnt lgkmcnt(0)
    v_mfma_f32_16x16x32_bf16 a[48:51], a[204:207], a[132:135], a[48:51]
    buffer_load_dwordx4 v8, s[28:31], s57 offen offset:0 nt lds
    v_mfma_f32_16x16x32_bf16 a[52:55], a[204:207], a[136:139], a[52:55]
    v_accvgpr_write_b32 a10, v14
    v_accvgpr_read_b32 v14, a22
    v_mfma_f32_16x16x32_bf16 a[52:55], a[200:203], a[124:127], a[52:55]
    v_accvgpr_read_b32 v15, a23
    v_mul_f32 v14, s85, v14
    v_mfma_f32_16x16x32_bf16 a[52:55], a[196:199], a[112:115], a[52:55]
    ds_read_b64_tr_b16 a[208:209], v2 offset:50816
    ds_read_b64_tr_b16 a[210:211], v2 offset:51328
    v_mfma_f32_16x16x32_bf16 a[52:55], a[192:195], a[100:103], a[52:55]
    buffer_load_dwordx4 v9, s[28:31], s57 offen offset:1056 nt lds
    v_mfma_f32_16x16x32_bf16 a[56:59], a[192:195], a[104:107], a[56:59]
    v_mul_f32 v15, s85, v15
    v_cvt_pk_bf16_f32 v14, v14, v15
    v_mfma_f32_16x16x32_bf16 a[56:59], a[196:199], a[116:119], a[56:59]
    ds_read_b64_tr_b16 a[212:213], v2 offset:50848
    ds_read_b64_tr_b16 a[214:215], v2 offset:51360
    v_mfma_f32_16x16x32_bf16 a[56:59], a[200:203], a[128:131], a[56:59]
    v_accvgpr_read_b32 v13, a9
    s_nop 1
    v_permlane16_swap_b32 v13, v14
    v_mfma_f32_16x16x32_bf16 a[56:59], a[204:207], a[140:143], a[56:59]
    v_accvgpr_write_b32 a9, v13
    s_waitcnt lgkmcnt(2)
    v_mfma_f32_16x16x32_bf16 v[76:79], a[208:211], v[172:175], v[76:79]
    ds_read_b64_tr_b16 a[216:217], v2 offset:50880
    ds_read_b64_tr_b16 a[218:219], v2 offset:51392
    v_mfma_f32_16x16x32_bf16 v[72:75], a[208:211], v[168:171], v[72:75]
    v_accvgpr_write_b32 a11, v14
    v_accvgpr_read_b32 v13, a24
    v_mfma_f32_16x16x32_bf16 v[68:71], a[208:211], v[164:167], v[68:71]
    v_accvgpr_read_b32 v14, a25
    s_waitcnt lgkmcnt(2)
    v_mfma_f32_16x16x32_bf16 v[80:83], a[212:215], v[164:167], v[80:83]
    ds_read_b64_tr_b16 a[220:221], v2 offset:50912
    ds_read_b64_tr_b16 a[222:223], v2 offset:51424
    v_mfma_f32_16x16x32_bf16 v[84:87], a[212:215], v[168:171], v[84:87]
    v_mul_f32 v13, s85, v13
    v_mul_f32 v14, s85, v14
    v_mfma_f32_16x16x32_bf16 v[88:91], a[212:215], v[172:175], v[88:91]
    v_cvt_pk_bf16_f32 v13, v13, v14
    s_waitcnt lgkmcnt(2)
    v_mfma_f32_16x16x32_bf16 v[100:103], a[216:219], v[172:175], v[100:103]
    ds_read_b128 a[224:227], v6 offset:16896
    v_accvgpr_read_b32 v14, a36
    v_mfma_f32_16x16x32_bf16 v[96:99], a[216:219], v[168:171], v[96:99]
    ds_read_b128 a[228:231], v6 offset:16960
    v_accvgpr_read_b32 v15, a37
    v_mfma_f32_16x16x32_bf16 v[92:95], a[216:219], v[164:167], v[92:95]
    ds_read_b128 a[192:195], v6 offset:17024
    s_waitcnt lgkmcnt(3)
    v_mfma_f32_16x16x32_bf16 v[104:107], a[220:223], v[164:167], v[104:107]
    ds_read_b128 a[196:199], v6 offset:17088
    v_mul_f32 v14, s85, v14
    v_mfma_f32_16x16x32_bf16 v[108:111], a[220:223], v[168:171], v[108:111]
    v_mul_f32 v15, s85, v15
    v_cvt_pk_bf16_f32 v14, v14, v15
    v_mfma_f32_16x16x32_bf16 v[112:115], a[220:223], v[172:175], v[112:115]
    s_nop 0
    v_permlane16_swap_b32 v13, v14
    s_waitcnt lgkmcnt(3)
    v_mfma_f32_16x16x32_bf16 v[116:119], a[224:227], v[208:211], v[188:191]
    v_accvgpr_write_b32 a12, v13
    s_waitcnt lgkmcnt(2)
    v_mfma_f32_16x16x32_bf16 v[116:119], a[228:231], v[220:223], v[116:119]
    v_accvgpr_write_b32 a14, v14
    s_waitcnt lgkmcnt(1)
    v_mfma_f32_16x16x32_bf16 v[116:119], a[192:195], v[232:235], v[116:119]
    v_accvgpr_read_b32 v13, a26
    s_waitcnt lgkmcnt(0)
    v_mfma_f32_16x16x32_bf16 v[116:119], a[196:199], v[244:247], v[116:119]
    v_accvgpr_read_b32 v14, a27
    v_mul_f32 v13, s85, v13
    v_mfma_f32_16x16x32_bf16 v[120:123], a[196:199], v[248:251], v[192:195]
    v_mul_f32 v14, s85, v14
    v_cvt_pk_bf16_f32 v13, v13, v14
    v_mfma_f32_16x16x32_bf16 v[120:123], a[192:195], v[236:239], v[120:123]
    v_accvgpr_read_b32 v14, a38
    v_accvgpr_read_b32 v15, a39
    v_mfma_f32_16x16x32_bf16 v[120:123], a[228:231], v[224:227], v[120:123]
    ds_read_b128 a[200:203], v6 offset:17408
    v_mul_f32 v14, s85, v14
    v_mfma_f32_16x16x32_bf16 v[120:123], a[224:227], v[212:215], v[120:123]
    ds_read_b128 a[204:207], v6 offset:17472
    v_mul_f32 v15, s85, v15
    v_mfma_f32_16x16x32_bf16 v[124:127], a[224:227], v[216:219], v[196:199]
    ds_read_b128 a[208:211], v6 offset:17536
    v_cvt_pk_bf16_f32 v14, v14, v15
    v_mfma_f32_16x16x32_bf16 v[124:127], a[228:231], v[228:231], v[124:127]
    ds_read_b128 a[212:215], v6 offset:17600
    v_permlane16_swap_b32 v13, v14
    v_mfma_f32_16x16x32_bf16 v[124:127], a[192:195], v[240:243], v[124:127]
    v_accvgpr_write_b32 a13, v13
    v_accvgpr_write_b32 a15, v14
    v_mfma_f32_16x16x32_bf16 v[124:127], a[196:199], v[252:255], v[124:127]
    v_accvgpr_read_b32 v13, a28
    s_waitcnt lgkmcnt(3)
    v_mfma_f32_16x16x32_bf16 v[128:131], a[200:203], v[208:211], v[188:191]
    v_accvgpr_read_b32 v14, a29
    s_waitcnt lgkmcnt(2)
    v_mfma_f32_16x16x32_bf16 v[128:131], a[204:207], v[220:223], v[128:131]
    v_mul_f32 v13, s85, v13
    s_waitcnt lgkmcnt(1)
    v_mfma_f32_16x16x32_bf16 v[128:131], a[208:211], v[232:235], v[128:131]
    v_mul_f32 v14, s85, v14
    s_waitcnt lgkmcnt(0)
    v_mfma_f32_16x16x32_bf16 v[128:131], a[212:215], v[244:247], v[128:131]
    v_cvt_pk_bf16_f32 v13, v13, v14
    v_accvgpr_read_b32 v14, a40
    v_mfma_f32_16x16x32_bf16 v[132:135], a[212:215], v[248:251], v[192:195]
    v_exp_f32 v16, v140
    v_mfma_f32_16x16x32_bf16 v[132:135], a[208:211], v[236:239], v[132:135]
    v_exp_f32 v17, v141
    v_exp_f32 v18, v142
    v_cvt_pk_bf16_f32 v176, v16, v17
    v_exp_f32 v19, v143
    v_exp_f32 v16, v144
    v_cvt_pk_bf16_f32 v177, v18, v19
    v_exp_f32 v17, v145
    v_exp_f32 v18, v146
    v_cvt_pk_bf16_f32 v180, v16, v17
    v_exp_f32 v19, v147
    v_exp_f32 v16, v148
    v_cvt_pk_bf16_f32 v181, v18, v19
    v_exp_f32 v17, v149
    v_exp_f32 v18, v150
    v_cvt_pk_bf16_f32 v184, v16, v17
    v_exp_f32 v19, v151
    v_exp_f32 v16, v152
    v_cvt_pk_bf16_f32 v185, v18, v19
    v_exp_f32 v17, v153
    v_exp_f32 v18, v154
    v_cvt_pk_bf16_f32 v178, v16, v17
    v_exp_f32 v19, v155
    v_exp_f32 v16, v156
    v_cvt_pk_bf16_f32 v179, v18, v19
    v_mov_b32 v203, 0
    v_mfma_f32_16x16x32_bf16 v[132:135], a[204:207], v[224:227], v[132:135]
    v_exp_f32 v17, v157
    v_exp_f32 v18, v158
    v_cvt_pk_bf16_f32 v182, v16, v17
    v_exp_f32 v19, v159
    v_exp_f32 v16, v160
    v_cvt_pk_bf16_f32 v183, v18, v19
    v_mfma_f32_16x16x32_bf16 v[132:135], a[200:203], v[212:215], v[132:135]
    v_exp_f32 v17, v161
    v_exp_f32 v18, v162
    v_cvt_pk_bf16_f32 v186, v16, v17
    v_exp_f32 v19, v163
    s_nop 0
    v_cvt_pk_bf16_f32 v187, v18, v19
    v_mfma_f32_16x16x32_bf16 v[204:207], a[232:235], v[176:179], v[200:203]
    v_accvgpr_read_b32 v15, a41
    v_mul_f32 v14, s85, v14
    v_mfma_f32_16x16x32_bf16 v[204:207], a[236:239], v[180:183], v[204:207]
    ds_read_b64_tr_b16 a[216:217], v3 offset:42240
    ds_read_b64_tr_b16 a[218:219], v3 offset:42752
    v_mfma_f32_16x16x32_bf16 v[204:207], a[240:243], v[184:187], v[204:207]
    v_mul_f32 v15, s85, v15
    v_cvt_pk_bf16_f32 v14, v14, v15
    v_mfma_f32_16x16x32_bf16 v[136:139], a[200:203], v[216:219], v[196:199]
    s_nop 0
    v_permlane16_swap_b32 v13, v14
    v_accvgpr_write_b32 a16, v13
    v_mfma_f32_16x16x32_bf16 v[136:139], a[204:207], v[228:231], v[136:139]
    ds_read_b64_tr_b16 a[220:221], v3 offset:42272
    ds_read_b64_tr_b16 a[222:223], v3 offset:42784
    v_mfma_f32_16x16x32_bf16 v[136:139], a[208:211], v[240:243], v[136:139]
    v_cmp_nge_f32 vcc, s84, v207
    s_waitcnt vmcnt(20) lgkmcnt(4)
    s_barrier
    v_mfma_f32_16x16x32_bf16 v[136:139], a[212:215], v[252:255], v[136:139]
    s_cbranch_vccnz K_R0_11
K_R0_11_ret:
    s_waitcnt lgkmcnt(2)
    v_mfma_f32_16x16x32_bf16 v[28:31], a[216:219], v[184:187], v[28:31]
    ds_read_b64_tr_b16 a[224:225], v3 offset:42304
    ds_read_b64_tr_b16 a[226:227], v3 offset:42816
    v_mfma_f32_16x16x32_bf16 v[24:27], a[216:219], v[180:183], v[24:27]
    s_add_u32 m0, s56, 50688
    s_mov_b32 s57, 155648
    v_mfma_f32_16x16x32_bf16 v[20:23], a[216:219], v[176:179], v[20:23]
    v_accvgpr_write_b32 a18, v14
    s_waitcnt lgkmcnt(2)
    v_mfma_f32_16x16x32_bf16 v[32:35], a[220:223], v[176:179], v[32:35]
    ds_read_b64_tr_b16 a[228:229], v3 offset:42336
    ds_read_b64_tr_b16 a[230:231], v3 offset:42848
    v_mfma_f32_16x16x32_bf16 v[36:39], a[220:223], v[180:183], v[36:39]
    buffer_load_dwordx4 v8, s[24:27], s57 offen offset:0 nt lds
    v_mfma_f32_16x16x32_bf16 v[40:43], a[220:223], v[184:187], v[40:43]
    v_accvgpr_read_b32 v13, a30
    s_waitcnt lgkmcnt(2)
    v_mfma_f32_16x16x32_bf16 v[52:55], a[224:227], v[184:187], v[52:55]
    ds_read_b64_tr_b16 a[192:193], v3 offset:160
    ds_read_b64_tr_b16 a[194:195], v3 offset:672
    v_mfma_f32_16x16x32_bf16 v[48:51], a[224:227], v[180:183], v[48:51]
    ds_read_b64_tr_b16 a[196:197], v3 offset:8608
    ds_read_b64_tr_b16 a[198:199], v3 offset:9120
    v_mfma_f32_16x16x32_bf16 v[44:47], a[224:227], v[176:179], v[44:47]
    ds_read_b64_tr_b16 a[200:201], v2 offset:33952
    ds_read_b64_tr_b16 a[202:203], v2 offset:34464
    s_waitcnt lgkmcnt(6)
    v_mfma_f32_16x16x32_bf16 v[56:59], a[228:231], v[176:179], v[56:59]
    ds_read_b64_tr_b16 a[204:205], v3 offset:33952
    ds_read_b64_tr_b16 a[206:207], v3 offset:34464
    v_mfma_f32_16x16x32_bf16 v[60:63], a[228:231], v[180:183], v[60:63]
    buffer_load_dwordx4 v9, s[24:27], s57 offen offset:1056 nt lds
    v_mfma_f32_16x16x32_bf16 v[64:67], a[228:231], v[184:187], v[64:67]
    s_add_u32 m0, s56, 84480
    s_mov_b32 s57, 147456
    s_waitcnt lgkmcnt(6)
    v_mfma_f32_16x16x32_bf16 a[60:63], a[192:195], a[96:99], a[60:63]
    v_accvgpr_read_b32 v14, a31
    s_waitcnt lgkmcnt(4)
    v_mfma_f32_16x16x32_bf16 a[60:63], a[196:199], a[108:111], a[60:63]
    v_mul_f32 v13, s85, v13
    s_waitcnt lgkmcnt(2)
    v_mfma_f32_16x16x32_bf16 a[60:63], a[200:203], a[120:123], a[60:63]
    v_mul_f32 v14, s85, v14
    s_waitcnt lgkmcnt(0)
    v_mfma_f32_16x16x32_bf16 a[60:63], a[204:207], a[132:135], a[60:63]
    buffer_load_dwordx4 v8, s[28:31], s57 offen offset:0 nt lds
    v_mfma_f32_16x16x32_bf16 a[64:67], a[204:207], a[136:139], a[64:67]
    v_cvt_pk_bf16_f32 v13, v13, v14
    v_accvgpr_read_b32 v14, a42
    v_mfma_f32_16x16x32_bf16 a[64:67], a[200:203], a[124:127], a[64:67]
    v_accvgpr_read_b32 v15, a43
    v_mul_f32 v14, s85, v14
    v_mfma_f32_16x16x32_bf16 a[64:67], a[196:199], a[112:115], a[64:67]
    ds_read_b64_tr_b16 a[208:209], v3 offset:42368
    ds_read_b64_tr_b16 a[210:211], v3 offset:42880
    v_mfma_f32_16x16x32_bf16 a[64:67], a[192:195], a[100:103], a[64:67]
    buffer_load_dwordx4 v9, s[28:31], s57 offen offset:1056 nt lds
    v_mfma_f32_16x16x32_bf16 a[68:71], a[192:195], a[104:107], a[68:71]
    v_mul_f32 v15, s85, v15
    v_cvt_pk_bf16_f32 v14, v14, v15
    v_mfma_f32_16x16x32_bf16 a[68:71], a[196:199], a[116:119], a[68:71]
    ds_read_b64_tr_b16 a[212:213], v3 offset:42400
    ds_read_b64_tr_b16 a[214:215], v3 offset:42912
    v_mfma_f32_16x16x32_bf16 a[68:71], a[200:203], a[128:131], a[68:71]
    v_permlane16_swap_b32 v13, v14
    v_accvgpr_write_b32 a17, v13
    v_mfma_f32_16x16x32_bf16 a[68:71], a[204:207], a[140:143], a[68:71]
    v_accvgpr_write_b32 a19, v14
    s_waitcnt lgkmcnt(2)
    v_mfma_f32_16x16x32_bf16 v[76:79], a[208:211], v[184:187], v[76:79]
    ds_read_b64_tr_b16 a[216:217], v3 offset:42432
    ds_read_b64_tr_b16 a[218:219], v3 offset:42944
    v_mfma_f32_16x16x32_bf16 v[72:75], a[208:211], v[180:183], v[72:75]
    v_accvgpr_read_b32 v13, a32
    v_accvgpr_read_b32 v14, a33
    v_mfma_f32_16x16x32_bf16 v[68:71], a[208:211], v[176:179], v[68:71]
    v_mul_f32 v13, s85, v13
    s_waitcnt lgkmcnt(2)
    v_mfma_f32_16x16x32_bf16 v[80:83], a[212:215], v[176:179], v[80:83]
    ds_read_b64_tr_b16 a[220:221], v3 offset:42464
    ds_read_b64_tr_b16 a[222:223], v3 offset:42976
    v_mfma_f32_16x16x32_bf16 v[84:87], a[212:215], v[180:183], v[84:87]
    v_mul_f32 v14, s85, v14
    v_cvt_pk_bf16_f32 v13, v13, v14
    v_mfma_f32_16x16x32_bf16 v[88:91], a[212:215], v[184:187], v[88:91]
    v_accvgpr_read_b32 v14, a44
    s_waitcnt lgkmcnt(2)
    v_mfma_f32_16x16x32_bf16 v[100:103], a[216:219], v[184:187], v[100:103]
    ds_read_b128 a[224:227], v5 offset:25344
    v_accvgpr_read_b32 v15, a45
    v_mfma_f32_16x16x32_bf16 v[96:99], a[216:219], v[180:183], v[96:99]
    ds_read_b128 a[228:231], v5 offset:25408
    v_mul_f32 v14, s85, v14
    v_mfma_f32_16x16x32_bf16 v[92:95], a[216:219], v[176:179], v[92:95]
    ds_read_b128 a[192:195], v5 offset:25472
    s_waitcnt lgkmcnt(3)
    v_mfma_f32_16x16x32_bf16 v[104:107], a[220:223], v[176:179], v[104:107]
    ds_read_b128 a[196:199], v5 offset:25536
    v_mul_f32 v15, s85, v15
    v_mfma_f32_16x16x32_bf16 v[108:111], a[220:223], v[180:183], v[108:111]
    v_cvt_pk_bf16_f32 v14, v14, v15
    s_nop 1
    v_permlane16_swap_b32 v13, v14
    v_mfma_f32_16x16x32_bf16 v[112:115], a[220:223], v[184:187], v[112:115]
    v_accvgpr_write_b32 a20, v13
    s_waitcnt lgkmcnt(3)
    v_mfma_f32_16x16x32_bf16 v[140:143], a[224:227], v[208:211], v[188:191]
    v_accvgpr_write_b32 a22, v14
    s_waitcnt lgkmcnt(2)
    v_mfma_f32_16x16x32_bf16 v[140:143], a[228:231], v[220:223], v[140:143]
    v_accvgpr_read_b32 v13, a34
    s_waitcnt lgkmcnt(1)
    v_mfma_f32_16x16x32_bf16 v[140:143], a[192:195], v[232:235], v[140:143]
    v_accvgpr_read_b32 v14, a35
    s_waitcnt lgkmcnt(0)
    v_mfma_f32_16x16x32_bf16 v[140:143], a[196:199], v[244:247], v[140:143]
    v_mul_f32 v13, s85, v13
    v_mul_f32 v14, s85, v14
    v_mfma_f32_16x16x32_bf16 v[144:147], a[196:199], v[248:251], v[192:195]
    v_cvt_pk_bf16_f32 v13, v13, v14
    v_accvgpr_read_b32 v14, a46
    v_mfma_f32_16x16x32_bf16 v[144:147], a[192:195], v[236:239], v[144:147]
    v_accvgpr_read_b32 v15, a47
    v_mul_f32 v14, s85, v14
    v_mfma_f32_16x16x32_bf16 v[144:147], a[228:231], v[224:227], v[144:147]
    ds_read_b128 a[200:203], v5 offset:25856
    v_mul_f32 v15, s85, v15
    v_mfma_f32_16x16x32_bf16 v[144:147], a[224:227], v[212:215], v[144:147]
    ds_read_b128 a[204:207], v5 offset:25920
    v_cvt_pk_bf16_f32 v14, v14, v15
    v_mfma_f32_16x16x32_bf16 v[148:151], a[224:227], v[216:219], v[196:199]
    ds_read_b128 a[208:211], v5 offset:25984
    v_permlane16_swap_b32 v13, v14
    v_mfma_f32_16x16x32_bf16 v[148:151], a[228:231], v[228:231], v[148:151]
    ds_read_b128 a[212:215], v5 offset:26048
    v_accvgpr_write_b32 a21, v13
    v_mfma_f32_16x16x32_bf16 v[148:151], a[192:195], v[240:243], v[148:151]
    v_accvgpr_write_b32 a23, v14
    v_accvgpr_read_b32 v13, a48
    v_mfma_f32_16x16x32_bf16 v[148:151], a[196:199], v[252:255], v[148:151]
    v_accvgpr_read_b32 v14, a49
    s_waitcnt lgkmcnt(3)
    v_mfma_f32_16x16x32_bf16 v[152:155], a[200:203], v[208:211], v[188:191]
    v_mul_f32 v13, s85, v13
    s_waitcnt lgkmcnt(2)
    v_mfma_f32_16x16x32_bf16 v[152:155], a[204:207], v[220:223], v[152:155]
    v_mul_f32 v14, s85, v14
    s_waitcnt lgkmcnt(1)
    v_mfma_f32_16x16x32_bf16 v[152:155], a[208:211], v[232:235], v[152:155]
    v_cvt_pk_bf16_f32 v13, v13, v14
    s_waitcnt lgkmcnt(0)
    v_mfma_f32_16x16x32_bf16 v[152:155], a[212:215], v[244:247], v[152:155]
    v_exp_f32 v16, v116
    v_mfma_f32_16x16x32_bf16 v[156:159], a[212:215], v[248:251], v[192:195]
    v_exp_f32 v17, v117
    v_mfma_f32_16x16x32_bf16 v[156:159], a[208:211], v[236:239], v[156:159]
    v_exp_f32 v18, v118
    v_cvt_pk_bf16_f32 v164, v16, v17
    v_exp_f32 v19, v119
    v_exp_f32 v16, v120
    v_cvt_pk_bf16_f32 v165, v18, v19
    v_exp_f32 v17, v121
    v_exp_f32 v18, v122
    v_cvt_pk_bf16_f32 v168, v16, v17
    v_exp_f32 v19, v123
    v_exp_f32 v16, v124
    v_cvt_pk_bf16_f32 v169, v18, v19
    v_exp_f32 v17, v125
    v_exp_f32 v18, v126
    v_cvt_pk_bf16_f32 v172, v16, v17
    v_exp_f32 v19, v127
    v_exp_f32 v16, v128
    v_cvt_pk_bf16_f32 v173, v18, v19
    v_exp_f32 v17, v129
    v_exp_f32 v18, v130
    v_cvt_pk_bf16_f32 v166, v16, v17
    v_exp_f32 v19, v131
    v_exp_f32 v16, v132
    v_cvt_pk_bf16_f32 v167, v18, v19
    v_mov_b32 v207, 0
    v_mfma_f32_16x16x32_bf16 v[156:159], a[204:207], v[224:227], v[156:159]
    v_exp_f32 v17, v133
    v_exp_f32 v18, v134
    v_cvt_pk_bf16_f32 v170, v16, v17
    v_exp_f32 v19, v135
    v_exp_f32 v16, v136
    v_cvt_pk_bf16_f32 v171, v18, v19
    v_mfma_f32_16x16x32_bf16 v[156:159], a[200:203], v[212:215], v[156:159]
    v_exp_f32 v17, v137
    v_exp_f32 v18, v138
    v_cvt_pk_bf16_f32 v174, v16, v17
    v_exp_f32 v19, v139
    s_nop 0
    v_cvt_pk_bf16_f32 v175, v18, v19
    v_mfma_f32_16x16x32_bf16 v[200:203], a[232:235], v[164:167], v[204:207]
    v_accvgpr_read_b32 v14, a60
    v_accvgpr_read_b32 v15, a61
    v_mfma_f32_16x16x32_bf16 v[200:203], a[236:239], v[168:171], v[200:203]
    ds_read_b64_tr_b16 a[216:217], v4 offset:0
    ds_read_b64_tr_b16 a[218:219], v4 offset:512
    v_mfma_f32_16x16x32_bf16 v[200:203], a[240:243], v[172:175], v[200:203]
    v_mul_f32 v14, s85, v14
    v_mul_f32 v15, s85, v15
    v_mfma_f32_16x16x32_bf16 v[160:163], a[200:203], v[216:219], v[196:199]
    v_cvt_pk_bf16_f32 v14, v14, v15
    s_nop 1
    v_permlane16_swap_b32 v13, v14
    v_mfma_f32_16x16x32_bf16 v[160:163], a[204:207], v[228:231], v[160:163]
    ds_read_b64_tr_b16 a[220:221], v4 offset:32
    ds_read_b64_tr_b16 a[222:223], v4 offset:544
    v_mfma_f32_16x16x32_bf16 v[160:163], a[208:211], v[240:243], v[160:163]
    v_cmp_nge_f32 vcc, s84, v203
    s_waitcnt vmcnt(20) lgkmcnt(4)
    s_barrier
    v_mfma_f32_16x16x32_bf16 v[160:163], a[212:215], v[252:255], v[160:163]
    s_cbranch_vccnz K_R0_12
K_R0_12_ret:
    s_waitcnt lgkmcnt(2)
    v_mfma_f32_16x16x32_bf16 v[28:31], a[216:219], v[172:175], v[28:31]
    ds_read_b64_tr_b16 a[224:225], v4 offset:64
    ds_read_b64_tr_b16 a[226:227], v4 offset:576
    v_mfma_f32_16x16x32_bf16 v[24:27], a[216:219], v[168:171], v[24:27]
    s_add_u32 m0, s56, 25344
    s_mov_b32 s57, 163840
    v_mfma_f32_16x16x32_bf16 v[20:23], a[216:219], v[164:167], v[20:23]
    v_accvgpr_write_b32 a24, v13
    s_waitcnt lgkmcnt(2)
    v_mfma_f32_16x16x32_bf16 v[32:35], a[220:223], v[164:167], v[32:35]
    ds_read_b64_tr_b16 a[228:229], v4 offset:96
    ds_read_b64_tr_b16 a[230:231], v4 offset:608
    v_mfma_f32_16x16x32_bf16 v[36:39], a[220:223], v[168:171], v[36:39]
    buffer_load_dwordx4 v8, s[24:27], s57 offen offset:0 nt lds
    v_mfma_f32_16x16x32_bf16 v[40:43], a[220:223], v[172:175], v[40:43]
    v_accvgpr_write_b32 a26, v14
    s_waitcnt lgkmcnt(2)
    v_mfma_f32_16x16x32_bf16 v[52:55], a[224:227], v[172:175], v[52:55]
    ds_read_b64_tr_b16 a[192:193], v3 offset:192
    ds_read_b64_tr_b16 a[194:195], v3 offset:704
    v_mfma_f32_16x16x32_bf16 v[48:51], a[224:227], v[168:171], v[48:51]
    ds_read_b64_tr_b16 a[196:197], v3 offset:8640
    ds_read_b64_tr_b16 a[198:199], v3 offset:9152
    v_mfma_f32_16x16x32_bf16 v[44:47], a[224:227], v[164:167], v[44:47]
    ds_read_b64_tr_b16 a[200:201], v2 offset:33984
    ds_read_b64_tr_b16 a[202:203], v2 offset:34496
    s_waitcnt lgkmcnt(6)
    v_mfma_f32_16x16x32_bf16 v[56:59], a[228:231], v[164:167], v[56:59]
    ds_read_b64_tr_b16 a[204:205], v3 offset:33984
    ds_read_b64_tr_b16 a[206:207], v3 offset:34496
    v_mfma_f32_16x16x32_bf16 v[60:63], a[228:231], v[168:171], v[60:63]
    buffer_load_dwordx4 v9, s[24:27], s57 offen offset:1056 nt lds
    v_mfma_f32_16x16x32_bf16 v[64:67], a[228:231], v[172:175], v[64:67]
    s_add_u32 m0, s56, 109824
    s_mov_b32 s57, 155648
    s_waitcnt lgkmcnt(6)
    v_mfma_f32_16x16x32_bf16 a[72:75], a[192:195], a[96:99], a[72:75]
    v_accvgpr_read_b32 v13, a50
    s_waitcnt lgkmcnt(4)
    v_mfma_f32_16x16x32_bf16 a[72:75], a[196:199], a[108:111], a[72:75]
    v_accvgpr_read_b32 v14, a51
    s_waitcnt lgkmcnt(2)
    v_mfma_f32_16x16x32_bf16 a[72:75], a[200:203], a[120:123], a[72:75]
    v_mul_f32 v13, s85, v13
    s_waitcnt lgkmcnt(0)
    v_mfma_f32_16x16x32_bf16 a[72:75], a[204:207], a[132:135], a[72:75]
    buffer_load_dwordx4 v8, s[28:31], s57 offen offset:0 nt lds
    v_mfma_f32_16x16x32_bf16 a[76:79], a[204:207], a[136:139], a[76:79]
    v_mul_f32 v14, s85, v14
    v_cvt_pk_bf16_f32 v13, v13, v14
    v_mfma_f32_16x16x32_bf16 a[76:79], a[200:203], a[124:127], a[76:79]
    v_accvgpr_read_b32 v14, a62
    v_accvgpr_read_b32 v15, a63
    v_mfma_f32_16x16x32_bf16 a[76:79], a[196:199], a[112:115], a[76:79]
    ds_read_b64_tr_b16 a[208:209], v3 offset:224
    ds_read_b64_tr_b16 a[210:211], v3 offset:736
    v_mfma_f32_16x16x32_bf16 a[76:79], a[192:195], a[100:103], a[76:79]
    ds_read_b64_tr_b16 a[212:213], v3 offset:8672
    ds_read_b64_tr_b16 a[214:215], v3 offset:9184
    v_mfma_f32_16x16x32_bf16 a[80:83], a[192:195], a[104:107], a[80:83]
    ds_read_b64_tr_b16 a[216:217], v2 offset:34016
    ds_read_b64_tr_b16 a[218:219], v2 offset:34528
    v_mfma_f32_16x16x32_bf16 a[80:83], a[196:199], a[116:119], a[80:83]
    ds_read_b64_tr_b16 a[220:221], v3 offset:34016
    ds_read_b64_tr_b16 a[222:223], v3 offset:34528
    v_mfma_f32_16x16x32_bf16 a[80:83], a[200:203], a[128:131], a[80:83]
    buffer_load_dwordx4 v9, s[28:31], s57 offen offset:1056 nt lds
    v_mfma_f32_16x16x32_bf16 a[80:83], a[204:207], a[140:143], a[80:83]
    v_mul_f32 v14, s85, v14
    s_waitcnt lgkmcnt(6)
    v_mfma_f32_16x16x32_bf16 a[84:87], a[208:211], a[96:99], a[84:87]
    v_mul_f32 v15, s85, v15
    s_waitcnt lgkmcnt(4)
    v_mfma_f32_16x16x32_bf16 a[84:87], a[212:215], a[108:111], a[84:87]
    v_cvt_pk_bf16_f32 v14, v14, v15
    s_waitcnt lgkmcnt(2)
    v_mfma_f32_16x16x32_bf16 a[84:87], a[216:219], a[120:123], a[84:87]
    v_permlane16_swap_b32 v13, v14
    s_waitcnt lgkmcnt(0)
    v_mfma_f32_16x16x32_bf16 a[84:87], a[220:223], a[132:135], a[84:87]
    v_accvgpr_write_b32 a25, v13
    v_accvgpr_write_b32 a27, v14
    v_mfma_f32_16x16x32_bf16 a[88:91], a[220:223], a[136:139], a[88:91]
    v_accvgpr_read_b32 v13, a52
    v_accvgpr_read_b32 v14, a53
    v_mfma_f32_16x16x32_bf16 a[88:91], a[216:219], a[124:127], a[88:91]
    v_mul_f32 v13, s85, v13
    v_mul_f32 v14, s85, v14
    v_mfma_f32_16x16x32_bf16 a[88:91], a[212:215], a[112:115], a[88:91]
    ds_read_b64_tr_b16 a[224:225], v4 offset:128
    ds_read_b64_tr_b16 a[226:227], v4 offset:640
    v_mfma_f32_16x16x32_bf16 a[88:91], a[208:211], a[100:103], a[88:91]
    v_cvt_pk_bf16_f32 v13, v13, v14
    v_accvgpr_read_b32 v14, a64
    v_mfma_f32_16x16x32_bf16 a[92:95], a[208:211], a[104:107], a[92:95]
    v_exp_f32 v16, v140
    v_mfma_f32_16x16x32_bf16 a[92:95], a[212:215], a[116:119], a[92:95]
    ds_read_b64_tr_b16 a[228:229], v4 offset:160
    ds_read_b64_tr_b16 a[230:231], v4 offset:672
    v_mfma_f32_16x16x32_bf16 a[92:95], a[216:219], a[128:131], a[92:95]
    v_accvgpr_read_b32 v15, a65
    v_mul_f32 v14, s85, v14
    v_mfma_f32_16x16x32_bf16 a[92:95], a[220:223], a[140:143], a[92:95]
    v_mul_f32 v15, s85, v15
    s_waitcnt lgkmcnt(2)
    v_mfma_f32_16x16x32_bf16 v[76:79], a[224:227], v[172:175], v[76:79]
    ds_read_b64_tr_b16 a[192:193], v4 offset:192
    ds_read_b64_tr_b16 a[194:195], v4 offset:704
    v_mfma_f32_16x16x32_bf16 v[72:75], a[224:227], v[168:171], v[72:75]
    v_exp_f32 v17, v141
    v_mfma_f32_16x16x32_bf16 v[68:71], a[224:227], v[164:167], v[68:71]
    v_cvt_pk_bf16_f32 v14, v14, v15
    s_waitcnt lgkmcnt(2)
    v_mfma_f32_16x16x32_bf16 v[80:83], a[228:231], v[164:167], v[80:83]
    ds_read_b64_tr_b16 a[196:197], v4 offset:224
    ds_read_b64_tr_b16 a[198:199], v4 offset:736
    v_mfma_f32_16x16x32_bf16 v[84:87], a[228:231], v[168:171], v[84:87]
    v_exp_f32 v18, v142
    v_mfma_f32_16x16x32_bf16 v[88:91], a[228:231], v[172:175], v[88:91]
    v_permlane16_swap_b32 v13, v14
    s_waitcnt lgkmcnt(2)
    v_mfma_f32_16x16x32_bf16 v[100:103], a[192:195], v[172:175], v[100:103]
    ds_read_b128 a[200:203], v5 offset:42240
    v_cvt_pk_bf16_f32 v176, v16, v17
    v_mfma_f32_16x16x32_bf16 v[96:99], a[192:195], v[168:171], v[96:99]
    ds_read_b128 a[204:207], v5 offset:42304
    v_accvgpr_write_b32 a28, v13
    v_mfma_f32_16x16x32_bf16 v[92:95], a[192:195], v[164:167], v[92:95]
    ds_read_b128 a[208:211], v5 offset:42368
    s_waitcnt lgkmcnt(3)
    v_mfma_f32_16x16x32_bf16 v[104:107], a[196:199], v[164:167], v[104:107]
    ds_read_b128 a[212:215], v5 offset:42432
    v_accvgpr_write_b32 a30, v14
    v_mfma_f32_16x16x32_bf16 v[108:111], a[196:199], v[168:171], v[108:111]
    v_exp_f32 v19, v143
    v_mfma_f32_16x16x32_bf16 v[112:115], a[196:199], v[172:175], v[112:115]
    v_accvgpr_read_b32 v13, a54
    s_waitcnt lgkmcnt(3)
    v_mfma_f32_16x16x32_bf16 v[116:119], a[200:203], v[208:211], v[188:191]
    v_accvgpr_read_b32 v14, a55
    s_waitcnt lgkmcnt(2)
    v_mfma_f32_16x16x32_bf16 v[116:119], a[204:207], v[220:223], v[116:119]
    v_mul_f32 v13, s85, v13
    s_waitcnt lgkmcnt(1)
    v_mfma_f32_16x16x32_bf16 v[116:119], a[208:211], v[232:235], v[116:119]
    v_mul_f32 v14, s85, v14
    s_waitcnt lgkmcnt(0)
    v_mfma_f32_16x16x32_bf16 v[116:119], a[212:215], v[244:247], v[116:119]
    v_exp_f32 v16, v144
    v_mfma_f32_16x16x32_bf16 v[120:123], a[212:215], v[248:251], v[192:195]
    v_cvt_pk_bf16_f32 v177, v18, v19
    v_cvt_pk_bf16_f32 v13, v13, v14
    v_mfma_f32_16x16x32_bf16 v[120:123], a[208:211], v[236:239], v[120:123]
    v_exp_f32 v17, v145
    v_mfma_f32_16x16x32_bf16 v[120:123], a[204:207], v[224:227], v[120:123]
    ds_read_b128 a[216:219], v5 offset:42752
    v_accvgpr_read_b32 v14, a66
    v_mfma_f32_16x16x32_bf16 v[120:123], a[200:203], v[212:215], v[120:123]
    ds_read_b128 a[220:223], v5 offset:42816
    v_accvgpr_read_b32 v15, a67
    v_mfma_f32_16x16x32_bf16 v[124:127], a[200:203], v[216:219], v[196:199]
    ds_read_b128 a[224:227], v5 offset:42880
    v_mul_f32 v14, s85, v14
    v_mfma_f32_16x16x32_bf16 v[124:127], a[204:207], v[228:231], v[124:127]
    ds_read_b128 a[228:231], v5 offset:42944
    v_mul_f32 v15, s85, v15
    v_mfma_f32_16x16x32_bf16 v[124:127], a[208:211], v[240:243], v[124:127]
    v_exp_f32 v18, v146
    v_mfma_f32_16x16x32_bf16 v[124:127], a[212:215], v[252:255], v[124:127]
    v_cvt_pk_bf16_f32 v180, v16, v17
    s_waitcnt lgkmcnt(3)
    v_mfma_f32_16x16x32_bf16 v[128:131], a[216:219], v[208:211], v[188:191]
    v_cvt_pk_bf16_f32 v14, v14, v15
    s_waitcnt lgkmcnt(2)
    v_mfma_f32_16x16x32_bf16 v[128:131], a[220:223], v[220:223], v[128:131]
    v_permlane16_swap_b32 v13, v14
    s_waitcnt lgkmcnt(1)
    v_mfma_f32_16x16x32_bf16 v[128:131], a[224:227], v[232:235], v[128:131]
    v_accvgpr_write_b32 a29, v13
    s_waitcnt lgkmcnt(0)
    v_mfma_f32_16x16x32_bf16 v[128:131], a[228:231], v[244:247], v[128:131]
    v_exp_f32 v19, v147
    v_mfma_f32_16x16x32_bf16 v[132:135], a[228:231], v[248:251], v[192:195]
    v_exp_f32 v16, v148
    v_mfma_f32_16x16x32_bf16 v[132:135], a[224:227], v[236:239], v[132:135]
    v_cvt_pk_bf16_f32 v181, v18, v19
    v_exp_f32 v17, v149
    v_exp_f32 v18, v150
    v_cvt_pk_bf16_f32 v184, v16, v17
    v_exp_f32 v19, v151
    v_exp_f32 v16, v152
    v_cvt_pk_bf16_f32 v185, v18, v19
    v_exp_f32 v17, v153
    v_exp_f32 v18, v154
    v_cvt_pk_bf16_f32 v178, v16, v17
    v_exp_f32 v19, v155
    v_exp_f32 v16, v156
    v_cvt_pk_bf16_f32 v179, v18, v19
    v_mov_b32 v203, 0
    v_mfma_f32_16x16x32_bf16 v[132:135], a[220:223], v[224:227], v[132:135]
    v_exp_f32 v17, v157
    v_exp_f32 v18, v158
    v_cvt_pk_bf16_f32 v182, v16, v17
    v_exp_f32 v19, v159
    v_exp_f32 v16, v160
    v_cvt_pk_bf16_f32 v183, v18, v19
    v_mfma_f32_16x16x32_bf16 v[132:135], a[216:219], v[212:215], v[132:135]
    v_exp_f32 v17, v161
    v_exp_f32 v18, v162
    v_cvt_pk_bf16_f32 v186, v16, v17
    v_exp_f32 v19, v163
    s_nop 0
    v_cvt_pk_bf16_f32 v187, v18, v19
    v_mfma_f32_16x16x32_bf16 v[204:207], a[232:235], v[176:179], v[200:203]
    v_accvgpr_write_b32 a31, v14
    v_accvgpr_read_b32 v13, a56
    v_mfma_f32_16x16x32_bf16 v[204:207], a[236:239], v[180:183], v[204:207]
    ds_read_b64_tr_b16 a[192:193], v2 offset:59136
    ds_read_b64_tr_b16 a[194:195], v2 offset:59648
    v_mfma_f32_16x16x32_bf16 v[204:207], a[240:243], v[184:187], v[204:207]
    v_accvgpr_read_b32 v14, a57
    v_mul_f32 v13, s85, v13
    v_mfma_f32_16x16x32_bf16 v[136:139], a[216:219], v[216:219], v[196:199]
    v_mul_f32 v14, s85, v14
    v_cvt_pk_bf16_f32 v13, v13, v14
    v_mfma_f32_16x16x32_bf16 v[136:139], a[220:223], v[228:231], v[136:139]
    ds_read_b64_tr_b16 a[196:197], v2 offset:59168
    ds_read_b64_tr_b16 a[198:199], v2 offset:59680
    v_mfma_f32_16x16x32_bf16 v[136:139], a[224:227], v[240:243], v[136:139]
    v_cmp_nge_f32 vcc, s84, v207
    s_waitcnt vmcnt(20) lgkmcnt(4)
    s_barrier
    v_mfma_f32_16x16x32_bf16 v[136:139], a[228:231], v[252:255], v[136:139]
    s_cbranch_vccnz K_R0_13
K_R0_13_ret:
    s_waitcnt lgkmcnt(2)
    v_mfma_f32_16x16x32_bf16 v[28:31], a[192:195], v[184:187], v[28:31]
    ds_read_b64_tr_b16 a[200:201], v2 offset:59200
    ds_read_b64_tr_b16 a[202:203], v2 offset:59712
    v_mfma_f32_16x16x32_bf16 v[24:27], a[192:195], v[180:183], v[24:27]
    s_add_u32 m0, s56, 33792
    s_mov_b32 s57, 172032
    v_mfma_f32_16x16x32_bf16 v[20:23], a[192:195], v[176:179], v[20:23]
    v_accvgpr_read_b32 v14, a68
    s_waitcnt lgkmcnt(2)
    v_mfma_f32_16x16x32_bf16 v[32:35], a[196:199], v[176:179], v[32:35]
    ds_read_b64_tr_b16 a[204:205], v2 offset:59232
    ds_read_b64_tr_b16 a[206:207], v2 offset:59744
    v_mfma_f32_16x16x32_bf16 v[36:39], a[196:199], v[180:183], v[36:39]
    buffer_load_dwordx4 v8, s[24:27], s57 offen offset:0 nt lds
    v_mfma_f32_16x16x32_bf16 v[40:43], a[196:199], v[184:187], v[40:43]
    v_accvgpr_read_b32 v15, a69
    s_waitcnt lgkmcnt(2)
    v_mfma_f32_16x16x32_bf16 v[52:55], a[200:203], v[184:187], v[52:55]
    ds_read_b64_tr_b16 a[208:209], v2 offset:59264
    ds_read_b64_tr_b16 a[210:211], v2 offset:59776
    v_mfma_f32_16x16x32_bf16 v[48:51], a[200:203], v[180:183], v[48:51]
    v_mul_f32 v14, s85, v14
    v_mul_f32 v15, s85, v15
    v_mfma_f32_16x16x32_bf16 v[44:47], a[200:203], v[176:179], v[44:47]
    v_cvt_pk_bf16_f32 v14, v14, v15
    s_waitcnt lgkmcnt(2)
    v_mfma_f32_16x16x32_bf16 v[56:59], a[204:207], v[176:179], v[56:59]
    ds_read_b64_tr_b16 a[212:213], v2 offset:59296
    ds_read_b64_tr_b16 a[214:215], v2 offset:59808
    v_mfma_f32_16x16x32_bf16 v[60:63], a[204:207], v[180:183], v[60:63]
    buffer_load_dwordx4 v9, s[24:27], s57 offen offset:1056 nt lds
    v_mfma_f32_16x16x32_bf16 v[64:67], a[204:207], v[184:187], v[64:67]
    s_add_u32 m0, s56, 42240
    s_mov_b32 s57, 163840
    s_waitcnt lgkmcnt(2)
    v_mfma_f32_16x16x32_bf16 v[76:79], a[208:211], v[184:187], v[76:79]
    ds_read_b64_tr_b16 a[216:217], v2 offset:59328
    ds_read_b64_tr_b16 a[218:219], v2 offset:59840
    v_mfma_f32_16x16x32_bf16 v[72:75], a[208:211], v[180:183], v[72:75]
    v_permlane16_swap_b32 v13, v14
    v_accvgpr_write_b32 a32, v13
    v_mfma_f32_16x16x32_bf16 v[68:71], a[208:211], v[176:179], v[68:71]
    v_accvgpr_write_b32 a34, v14
    s_waitcnt lgkmcnt(2)
    v_mfma_f32_16x16x32_bf16 v[80:83], a[212:215], v[176:179], v[80:83]
    ds_read_b64_tr_b16 a[220:221], v2 offset:59360
    ds_read_b64_tr_b16 a[222:223], v2 offset:59872
    v_mfma_f32_16x16x32_bf16 v[84:87], a[212:215], v[180:183], v[84:87]
    buffer_load_dwordx4 v8, s[28:31], s57 offen offset:0 nt lds
    v_mfma_f32_16x16x32_bf16 v[88:91], a[212:215], v[184:187], v[88:91]
    v_accvgpr_read_b32 v13, a58
    s_waitcnt lgkmcnt(2)
    v_mfma_f32_16x16x32_bf16 v[100:103], a[216:219], v[184:187], v[100:103]
    ds_read_b128 a[224:227], v6 offset:25344
    v_accvgpr_read_b32 v14, a59
    v_mfma_f32_16x16x32_bf16 v[96:99], a[216:219], v[180:183], v[96:99]
    ds_read_b128 a[228:231], v6 offset:25408
    v_mul_f32 v13, s85, v13
    v_mfma_f32_16x16x32_bf16 v[92:95], a[216:219], v[176:179], v[92:95]
    ds_read_b128 a[192:195], v6 offset:25472
    s_waitcnt lgkmcnt(3)
    v_mfma_f32_16x16x32_bf16 v[104:107], a[220:223], v[176:179], v[104:107]
    ds_read_b128 a[196:199], v6 offset:25536
    v_mul_f32 v14, s85, v14
    v_mfma_f32_16x16x32_bf16 v[108:111], a[220:223], v[180:183], v[108:111]
    buffer_load_dwordx4 v9, s[28:31], s57 offen offset:1056 nt lds
    v_mfma_f32_16x16x32_bf16 v[112:115], a[220:223], v[184:187], v[112:115]
    s_add_u32 m0, s56, 67584
    s_mov_b32 s57, 180224
    s_waitcnt lgkmcnt(3)
    v_mfma_f32_16x16x32_bf16 v[140:143], a[224:227], v[208:211], v[188:191]
    v_cvt_pk_bf16_f32 v13, v13, v14
    s_waitcnt lgkmcnt(2)
    v_mfma_f32_16x16x32_bf16 v[140:143], a[228:231], v[220:223], v[140:143]
    v_accvgpr_read_b32 v14, a70
    s_waitcnt lgkmcnt(1)
    v_mfma_f32_16x16x32_bf16 v[140:143], a[192:195], v[232:235], v[140:143]
    v_accvgpr_read_b32 v15, a71
    s_waitcnt lgkmcnt(0)
    v_mfma_f32_16x16x32_bf16 v[140:143], a[196:199], v[244:247], v[140:143]
    buffer_load_dwordx4 v8, s[24:27], s57 offen offset:0 nt lds
    v_mfma_f32_16x16x32_bf16 v[144:147], a[196:199], v[248:251], v[192:195]
    v_mul_f32 v14, s85, v14
    v_mul_f32 v15, s85, v15
    v_mfma_f32_16x16x32_bf16 v[144:147], a[192:195], v[236:239], v[144:147]
    v_cvt_pk_bf16_f32 v14, v14, v15
    s_nop 1
    v_permlane16_swap_b32 v13, v14
    v_mfma_f32_16x16x32_bf16 v[144:147], a[228:231], v[224:227], v[144:147]
    ds_read_b128 a[200:203], v6 offset:25856
    v_accvgpr_write_b32 a33, v13
    v_mfma_f32_16x16x32_bf16 v[144:147], a[224:227], v[212:215], v[144:147]
    ds_read_b128 a[204:207], v6 offset:25920
    v_accvgpr_write_b32 a35, v14
    v_mfma_f32_16x16x32_bf16 v[148:151], a[224:227], v[216:219], v[196:199]
    ds_read_b128 a[208:211], v6 offset:25984
    v_accvgpr_read_b32 v13, a72
    v_mfma_f32_16x16x32_bf16 v[148:151], a[228:231], v[228:231], v[148:151]
    ds_read_b128 a[212:215], v6 offset:26048
    buffer_load_dwordx4 v9, s[24:27], s57 offen offset:1056 nt lds
    v_mfma_f32_16x16x32_bf16 v[148:151], a[192:195], v[240:243], v[148:151]
    v_accvgpr_read_b32 v14, a73
    v_mul_f32 v13, s85, v13
    v_mfma_f32_16x16x32_bf16 v[148:151], a[196:199], v[252:255], v[148:151]
    v_mul_f32 v14, s85, v14
    s_waitcnt lgkmcnt(3)
    v_mfma_f32_16x16x32_bf16 v[152:155], a[200:203], v[208:211], v[188:191]
    v_cvt_pk_bf16_f32 v13, v13, v14
    s_waitcnt lgkmcnt(2)
    v_mfma_f32_16x16x32_bf16 v[152:155], a[204:207], v[220:223], v[152:155]
    v_accvgpr_read_b32 v14, a84
    s_waitcnt lgkmcnt(1)
    v_mfma_f32_16x16x32_bf16 v[152:155], a[208:211], v[232:235], v[152:155]
    v_accvgpr_read_b32 v15, a85
    s_waitcnt lgkmcnt(0)
    v_mfma_f32_16x16x32_bf16 v[152:155], a[212:215], v[244:247], v[152:155]
    v_mul_f32 v14, s85, v14
    v_mul_f32 v15, s85, v15
    v_mfma_f32_16x16x32_bf16 v[156:159], a[212:215], v[248:251], v[192:195]
    v_cvt_pk_bf16_f32 v14, v14, v15
    s_nop 1
    v_permlane16_swap_b32 v13, v14
    v_mfma_f32_16x16x32_bf16 v[156:159], a[208:211], v[236:239], v[156:159]
    v_exp_f32 v16, v116
    v_exp_f32 v17, v117
    v_exp_f32 v18, v118
    v_cvt_pk_bf16_f32 v164, v16, v17
    v_exp_f32 v19, v119
    v_exp_f32 v16, v120
    v_cvt_pk_bf16_f32 v165, v18, v19
    v_exp_f32 v17, v121
    v_exp_f32 v18, v122
    v_cvt_pk_bf16_f32 v168, v16, v17
    v_exp_f32 v19, v123
    v_exp_f32 v16, v124
    v_cvt_pk_bf16_f32 v169, v18, v19
    v_exp_f32 v17, v125
    v_exp_f32 v18, v126
    v_cvt_pk_bf16_f32 v172, v16, v17
    v_exp_f32 v19, v127
    v_exp_f32 v16, v128
    v_cvt_pk_bf16_f32 v173, v18, v19
    v_exp_f32 v17, v129
    v_exp_f32 v18, v130
    v_cvt_pk_bf16_f32 v166, v16, v17
    v_exp_f32 v19, v131
    v_exp_f32 v16, v132
    v_cvt_pk_bf16_f32 v167, v18, v19
    v_mov_b32 v207, 0
    v_mfma_f32_16x16x32_bf16 v[156:159], a[204:207], v[224:227], v[156:159]
    v_exp_f32 v17, v133
    v_exp_f32 v18, v134
    v_cvt_pk_bf16_f32 v170, v16, v17
    v_exp_f32 v19, v135
    v_exp_f32 v16, v136
    v_cvt_pk_bf16_f32 v171, v18, v19
    v_mfma_f32_16x16x32_bf16 v[156:159], a[200:203], v[212:215], v[156:159]
    v_exp_f32 v17, v137
    v_exp_f32 v18, v138
    v_cvt_pk_bf16_f32 v174, v16, v17
    v_exp_f32 v19, v139
    s_nop 0
    v_cvt_pk_bf16_f32 v175, v18, v19
    v_mfma_f32_16x16x32_bf16 v[200:203], a[232:235], v[164:167], v[204:207]
    v_accvgpr_write_b32 a36, v13
    v_accvgpr_write_b32 a38, v14
    v_mfma_f32_16x16x32_bf16 v[200:203], a[236:239], v[168:171], v[200:203]
    ds_read_b64_tr_b16 a[216:217], v4 offset:8448
    ds_read_b64_tr_b16 a[218:219], v4 offset:8960
    v_mfma_f32_16x16x32_bf16 v[200:203], a[240:243], v[172:175], v[200:203]
    v_accvgpr_read_b32 v13, a74
    v_accvgpr_read_b32 v14, a75
    v_mfma_f32_16x16x32_bf16 v[160:163], a[200:203], v[216:219], v[196:199]
    v_mul_f32 v13, s85, v13
    v_mul_f32 v14, s85, v14
    v_mfma_f32_16x16x32_bf16 v[160:163], a[204:207], v[228:231], v[160:163]
    ds_read_b64_tr_b16 a[220:221], v4 offset:8480
    ds_read_b64_tr_b16 a[222:223], v4 offset:8992
    v_mfma_f32_16x16x32_bf16 v[160:163], a[208:211], v[240:243], v[160:163]
    v_cmp_nge_f32 vcc, s84, v203
    s_waitcnt vmcnt(22) lgkmcnt(4)
    s_barrier
    v_mfma_f32_16x16x32_bf16 v[160:163], a[212:215], v[252:255], v[160:163]
    s_cbranch_vccnz K_R0_14
K_R0_14_ret:
    s_waitcnt lgkmcnt(2)
    v_mfma_f32_16x16x32_bf16 v[28:31], a[216:219], v[172:175], v[28:31]
    ds_read_b64_tr_b16 a[224:225], v4 offset:8512
    ds_read_b64_tr_b16 a[226:227], v4 offset:9024
    v_mfma_f32_16x16x32_bf16 v[24:27], a[216:219], v[168:171], v[24:27]
    v_cvt_pk_bf16_f32 v13, v13, v14
    v_accvgpr_read_b32 v14, a86
    v_mfma_f32_16x16x32_bf16 v[20:23], a[216:219], v[164:167], v[20:23]
    v_accvgpr_read_b32 v15, a87
    s_waitcnt lgkmcnt(2)
    v_mfma_f32_16x16x32_bf16 v[32:35], a[220:223], v[164:167], v[32:35]
    ds_read_b64_tr_b16 a[228:229], v4 offset:8544
    ds_read_b64_tr_b16 a[230:231], v4 offset:9056
    v_mfma_f32_16x16x32_bf16 v[36:39], a[220:223], v[168:171], v[36:39]
    s_add_u32 m0, s56, 59136
    s_mov_b32 s57, 172032
    v_mfma_f32_16x16x32_bf16 v[40:43], a[220:223], v[172:175], v[40:43]
    v_mul_f32 v14, s85, v14
    s_waitcnt lgkmcnt(2)
    v_mfma_f32_16x16x32_bf16 v[52:55], a[224:227], v[172:175], v[52:55]
    ds_read_b64_tr_b16 a[192:193], v4 offset:8576
    ds_read_b64_tr_b16 a[194:195], v4 offset:9088
    v_mfma_f32_16x16x32_bf16 v[48:51], a[224:227], v[168:171], v[48:51]
    v_mul_f32 v15, s85, v15
    v_cvt_pk_bf16_f32 v14, v14, v15
    v_mfma_f32_16x16x32_bf16 v[44:47], a[224:227], v[164:167], v[44:47]
    buffer_load_dwordx4 v8, s[28:31], s57 offen offset:0 nt lds
    s_waitcnt lgkmcnt(2)
    v_mfma_f32_16x16x32_bf16 v[56:59], a[228:231], v[164:167], v[56:59]
    ds_read_b64_tr_b16 a[196:197], v4 offset:8608
    ds_read_b64_tr_b16 a[198:199], v4 offset:9120
    v_mfma_f32_16x16x32_bf16 v[60:63], a[228:231], v[168:171], v[60:63]
    v_permlane16_swap_b32 v13, v14
    v_accvgpr_write_b32 a37, v13
    v_mfma_f32_16x16x32_bf16 v[64:67], a[228:231], v[172:175], v[64:67]
    v_accvgpr_write_b32 a39, v14
    s_waitcnt lgkmcnt(2)
    v_mfma_f32_16x16x32_bf16 v[76:79], a[192:195], v[172:175], v[76:79]
    ds_read_b64_tr_b16 a[200:201], v4 offset:8640
    ds_read_b64_tr_b16 a[202:203], v4 offset:9152
    v_mfma_f32_16x16x32_bf16 v[72:75], a[192:195], v[168:171], v[72:75]
    buffer_load_dwordx4 v9, s[28:31], s57 offen offset:1056 nt lds
    v_mfma_f32_16x16x32_bf16 v[68:71], a[192:195], v[164:167], v[68:71]
    v_accvgpr_read_b32 v13, a76
    s_waitcnt lgkmcnt(2)
    v_mfma_f32_16x16x32_bf16 v[80:83], a[196:199], v[164:167], v[80:83]
    ds_read_b64_tr_b16 a[204:205], v4 offset:8672
    ds_read_b64_tr_b16 a[206:207], v4 offset:9184
    v_mfma_f32_16x16x32_bf16 v[84:87], a[196:199], v[168:171], v[84:87]
    v_accvgpr_read_b32 v14, a77
    v_mul_f32 v13, s85, v13
    v_mfma_f32_16x16x32_bf16 v[88:91], a[196:199], v[172:175], v[88:91]
    v_mul_f32 v14, s85, v14
    s_waitcnt lgkmcnt(2)
    v_mfma_f32_16x16x32_bf16 v[100:103], a[200:203], v[172:175], v[100:103]
    ds_read_b128 a[208:211], v6 offset:50688
    v_cvt_pk_bf16_f32 v13, v13, v14
    v_mfma_f32_16x16x32_bf16 v[96:99], a[200:203], v[168:171], v[96:99]
    ds_read_b128 a[212:215], v6 offset:50752
    v_accvgpr_read_b32 v14, a88
    v_mfma_f32_16x16x32_bf16 v[92:95], a[200:203], v[164:167], v[92:95]
    ds_read_b128 a[216:219], v6 offset:50816
    s_waitcnt lgkmcnt(3)
    v_mfma_f32_16x16x32_bf16 v[104:107], a[204:207], v[164:167], v[104:107]
    ds_read_b128 a[220:223], v6 offset:50880
    v_accvgpr_read_b32 v15, a89
    v_mfma_f32_16x16x32_bf16 v[108:111], a[204:207], v[168:171], v[108:111]
    v_mul_f32 v14, s85, v14
    v_mul_f32 v15, s85, v15
    v_mfma_f32_16x16x32_bf16 v[112:115], a[204:207], v[172:175], v[112:115]
    v_cvt_pk_bf16_f32 v14, v14, v15
    s_waitcnt lgkmcnt(3)
    v_mfma_f32_16x16x32_bf16 v[116:119], a[208:211], a[0:3], 0
    v_permlane16_swap_b32 v13, v14
    s_waitcnt lgkmcnt(2)
    v_mfma_f32_16x16x32_bf16 v[116:119], a[212:215], a[12:15], v[116:119]
    v_accvgpr_write_b32 a40, v13
    v_accvgpr_write_b32 a42, v14
    v_accvgpr_read_b32 v13, a78
    v_accvgpr_read_b32 v14, a79
    v_mul_f32 v13, s85, v13
    v_mul_f32 v14, s85, v14
    v_cvt_pk_bf16_f32 v13, v13, v14
    v_accvgpr_read_b32 v14, a90
    v_accvgpr_read_b32 v15, a91
    v_mul_f32 v14, s85, v14
    v_mul_f32 v15, s85, v15
    v_cvt_pk_bf16_f32 v14, v14, v15
    s_nop 1
    v_permlane16_swap_b32 v13, v14
    v_accvgpr_write_b32 a41, v13
    v_accvgpr_write_b32 a43, v14
    s_waitcnt lgkmcnt(1)
    v_mfma_f32_16x16x32_bf16 v[116:119], a[216:219], a[24:27], v[116:119]
    s_add_u32 m0, s56, 76032
    s_mov_b32 s57, 188416
    s_waitcnt lgkmcnt(0)
    v_mfma_f32_16x16x32_bf16 v[116:119], a[220:223], a[36:39], v[116:119]
    buffer_load_dwordx4 v8, s[24:27], s57 offen offset:0 nt lds
    v_mfma_f32_16x16x32_bf16 v[120:123], a[220:223], a[40:43], 0
    v_accvgpr_read_b32 v13, a80
    v_accvgpr_read_b32 v14, a81
    v_mfma_f32_16x16x32_bf16 v[120:123], a[216:219], a[28:31], v[120:123]
    v_mul_f32 v13, s85, v13
    v_mul_f32 v14, s85, v14
    v_mfma_f32_16x16x32_bf16 v[120:123], a[212:215], a[16:19], v[120:123]
    ds_read_b128 a[224:227], v6 offset:51200
    v_cvt_pk_bf16_f32 v13, v13, v14
    v_mfma_f32_16x16x32_bf16 v[120:123], a[208:211], a[4:7], v[120:123]
    ds_read_b128 a[228:231], v6 offset:51264
    v_accvgpr_read_b32 v14, a92
    v_mfma_f32_16x16x32_bf16 v[124:127], a[208:211], a[8:11], 0
    ds_read_b128 a[192:195], v6 offset:51328
    v_accvgpr_read_b32 v15, a93
    v_mul_f32 v14, s85, v14
    v_mul_f32 v15, s85, v15
    v_cvt_pk_bf16_f32 v14, v14, v15
    s_nop 1
    v_permlane16_swap_b32 v13, v14
    v_accvgpr_write_b32 a44, v13
    v_accvgpr_write_b32 a46, v14
    v_accvgpr_read_b32 v13, a82
    v_accvgpr_read_b32 v14, a83
    v_mul_f32 v13, s85, v13
    v_mul_f32 v14, s85, v14
    v_cvt_pk_bf16_f32 v13, v13, v14
    v_accvgpr_read_b32 v14, a94
    v_accvgpr_read_b32 v15, a95
    v_mul_f32 v14, s85, v14
    v_mul_f32 v15, s85, v15
    v_cvt_pk_bf16_f32 v14, v14, v15
    s_nop 1
    v_permlane16_swap_b32 v13, v14
    v_accvgpr_write_b32 a45, v13
    v_accvgpr_write_b32 a47, v14
    v_mfma_f32_16x16x32_bf16 v[124:127], a[212:215], a[20:23], v[124:127]
    ds_read_b128 a[196:199], v6 offset:51392
    buffer_load_dwordx4 v9, s[24:27], s57 offen offset:1056 nt lds
    v_mfma_f32_16x16x32_bf16 v[124:127], a[216:219], a[32:35], v[124:127]
    s_add_u32 m0, s56, 92928
    s_mov_b32 s57, 180224
    v_mfma_f32_16x16x32_bf16 v[124:127], a[220:223], a[44:47], v[124:127]
    ds_read_b64_tr_b16 a[200:201], v4 offset:16896
    s_waitcnt lgkmcnt(4)
    v_mfma_f32_16x16x32_bf16 v[128:131], a[224:227], a[0:3], 0
    ds_read_b64_tr_b16 a[202:203], v4 offset:17408
    s_waitcnt lgkmcnt(4)
    v_mfma_f32_16x16x32_bf16 v[128:131], a[228:231], a[12:15], v[128:131]
    ds_read_b64_tr_b16 a[204:205], v4 offset:16928
    s_waitcnt lgkmcnt(4)
    v_mfma_f32_16x16x32_bf16 v[128:131], a[192:195], a[24:27], v[128:131]
    buffer_load_dwordx4 v8, s[28:31], s57 offen offset:0 nt lds
    s_waitcnt lgkmcnt(3)
    v_mfma_f32_16x16x32_bf16 v[128:131], a[196:199], a[36:39], v[128:131]
    v_exp_f32 v16, v140
    v_mfma_f32_16x16x32_bf16 v[132:135], a[196:199], a[40:43], 0
    v_exp_f32 v17, v141
    v_mfma_f32_16x16x32_bf16 v[132:135], a[192:195], a[28:31], v[132:135]
    v_exp_f32 v18, v142
    v_cvt_pk_bf16_f32 v176, v16, v17
    v_exp_f32 v19, v143
    v_exp_f32 v16, v144
    v_cvt_pk_bf16_f32 v177, v18, v19
    v_exp_f32 v17, v145
    v_exp_f32 v18, v146
    v_cvt_pk_bf16_f32 v180, v16, v17
    v_exp_f32 v19, v147
    v_exp_f32 v16, v148
    v_cvt_pk_bf16_f32 v181, v18, v19
    v_exp_f32 v17, v149
    v_exp_f32 v18, v150
    v_cvt_pk_bf16_f32 v184, v16, v17
    v_exp_f32 v19, v151
    v_exp_f32 v16, v152
    v_cvt_pk_bf16_f32 v185, v18, v19
    v_exp_f32 v17, v153
    v_exp_f32 v18, v154
    v_cvt_pk_bf16_f32 v178, v16, v17
    v_exp_f32 v19, v155
    v_exp_f32 v16, v156
    v_cvt_pk_bf16_f32 v179, v18, v19
    v_mov_b32 v203, 0
    v_mfma_f32_16x16x32_bf16 v[132:135], a[228:231], a[16:19], v[132:135]
    v_exp_f32 v17, v157
    v_exp_f32 v18, v158
    v_cvt_pk_bf16_f32 v182, v16, v17
    v_exp_f32 v19, v159
    v_exp_f32 v16, v160
    v_cvt_pk_bf16_f32 v183, v18, v19
    v_mfma_f32_16x16x32_bf16 v[132:135], a[224:227], a[4:7], v[132:135]
    v_exp_f32 v17, v161
    v_exp_f32 v18, v162
    v_cvt_pk_bf16_f32 v186, v16, v17
    v_exp_f32 v19, v163
    s_nop 0
    v_cvt_pk_bf16_f32 v187, v18, v19
    v_mfma_f32_16x16x32_bf16 v[204:207], a[232:235], v[176:179], v[200:203]
    buffer_load_dwordx4 v9, s[28:31], s57 offen offset:1056 nt lds
    v_mfma_f32_16x16x32_bf16 v[204:207], a[236:239], v[180:183], v[204:207]
    ds_read_b64_tr_b16 a[206:207], v4 offset:17440
    s_add_u32 m0, s56, 101376
    s_mov_b32 s57, 196608
    v_mfma_f32_16x16x32_bf16 v[204:207], a[240:243], v[184:187], v[204:207]
    ds_read_b64_tr_b16 a[208:209], v4 offset:16960
    ds_read_b64_tr_b16 a[210:211], v4 offset:17472
    v_mfma_f32_16x16x32_bf16 v[136:139], a[224:227], a[8:11], 0
    ds_read_b64_tr_b16 a[212:213], v4 offset:16992
    ds_read_b64_tr_b16 a[214:215], v4 offset:17504
    v_mfma_f32_16x16x32_bf16 v[136:139], a[228:231], a[20:23], v[136:139]
    buffer_load_dwordx4 v8, s[24:27], s57 offen offset:0 nt lds
    v_mfma_f32_16x16x32_bf16 v[136:139], a[192:195], a[32:35], v[136:139]
    v_cmp_nge_f32 vcc, s84, v207
    s_waitcnt vmcnt(25) lgkmcnt(5)
    s_barrier
    v_mfma_f32_16x16x32_bf16 v[136:139], a[196:199], a[44:47], v[136:139]
    s_cbranch_vccnz K_R0_15
K_R0_15_ret:
    v_max3_f32 v166, v116, v117, v118
    v_mfma_f32_16x16x32_bf16 v[28:31], a[200:203], v[184:187], v[28:31]
    v_max3_f32 v170, v120, v121, v122
    v_max3_f32 v174, v124, v125, v126
    v_mfma_f32_16x16x32_bf16 v[24:27], a[200:203], v[180:183], v[24:27]
    buffer_load_dwordx4 v9, s[24:27], s57 offen offset:1056 nt lds
    v_mfma_f32_16x16x32_bf16 v[20:23], a[200:203], v[176:179], v[20:23]
    ds_read_b64_tr_b16 a[216:217], v4 offset:17024
    s_waitcnt lgkmcnt(5)
    v_mfma_f32_16x16x32_bf16 v[32:35], a[204:207], v[176:179], v[32:35]
    ds_read_b64_tr_b16 a[218:219], v4 offset:17536
    v_max_f32 v166, v166, v119
    v_mfma_f32_16x16x32_bf16 v[36:39], a[204:207], v[180:183], v[36:39]
    ds_read_b64_tr_b16 a[220:221], v4 offset:17056
    v_max_f32 v170, v170, v123
    v_mfma_f32_16x16x32_bf16 v[40:43], a[204:207], v[184:187], v[40:43]
    ds_read_b64_tr_b16 a[222:223], v4 offset:17568
    s_waitcnt lgkmcnt(4)
    v_mfma_f32_16x16x32_bf16 v[52:55], a[208:211], v[184:187], v[52:55]
    v_max_f32 v174, v174, v127
    v_mov_b32 v167, v166
    v_mfma_f32_16x16x32_bf16 v[48:51], a[208:211], v[180:183], v[48:51]
    v_mov_b32 v171, v170
    v_mov_b32 v175, v174
    v_mfma_f32_16x16x32_bf16 v[44:47], a[208:211], v[176:179], v[44:47]
    v_permlane16_swap_b32 v166, v167
    v_permlane16_swap_b32 v170, v171
    v_mfma_f32_16x16x32_bf16 v[56:59], a[212:215], v[176:179], v[56:59]
    v_permlane16_swap_b32 v174, v175
    v_max_f32 v166, v166, v167
    v_mfma_f32_16x16x32_bf16 v[60:63], a[212:215], v[180:183], v[60:63]
    v_max_f32 v170, v170, v171
    v_max_f32 v174, v174, v175
    v_mfma_f32_16x16x32_bf16 v[64:67], a[212:215], v[184:187], v[64:67]
    v_mov_b32 v167, v166
    s_waitcnt lgkmcnt(2)
    v_mfma_f32_16x16x32_bf16 v[76:79], a[216:219], v[184:187], v[76:79]
    ds_read_b64_tr_b16 a[224:225], v4 offset:17088
    ds_read_b64_tr_b16 a[226:227], v4 offset:17600
    v_mfma_f32_16x16x32_bf16 v[72:75], a[216:219], v[180:183], v[72:75]
    v_mov_b32 v171, v170
    v_mov_b32 v175, v174
    v_mfma_f32_16x16x32_bf16 v[68:71], a[216:219], v[176:179], v[68:71]
    v_permlane32_swap_b32 v166, v167
    s_waitcnt lgkmcnt(2)
    v_mfma_f32_16x16x32_bf16 v[80:83], a[220:223], v[176:179], v[80:83]
    ds_read_b64_tr_b16 a[228:229], v4 offset:17120
    ds_read_b64_tr_b16 a[230:231], v4 offset:17632
    v_mfma_f32_16x16x32_bf16 v[84:87], a[220:223], v[180:183], v[84:87]
    v_permlane32_swap_b32 v170, v171
    v_permlane32_swap_b32 v174, v175
    v_mfma_f32_16x16x32_bf16 v[88:91], a[220:223], v[184:187], v[88:91]
    v_min_f32 v188, -v166, -v167
    s_waitcnt lgkmcnt(2)
    v_mfma_f32_16x16x32_bf16 v[100:103], a[224:227], v[184:187], v[100:103]
    ds_read_b128 a[192:195], v5 offset:0
    v_min_f32 v189, -v166, -v167
    v_mfma_f32_16x16x32_bf16 v[96:99], a[224:227], v[180:183], v[96:99]
    ds_read_b128 a[196:199], v5 offset:64
    v_min_f32 v190, -v166, -v167
    v_mfma_f32_16x16x32_bf16 v[92:95], a[224:227], v[176:179], v[92:95]
    ds_read_b128 a[200:203], v5 offset:128
    s_waitcnt lgkmcnt(3)
    v_mfma_f32_16x16x32_bf16 v[104:107], a[228:231], v[176:179], v[104:107]
    ds_read_b128 a[204:207], v5 offset:192
    v_min_f32 v191, -v166, -v167
    v_mfma_f32_16x16x32_bf16 v[108:111], a[228:231], v[180:183], v[108:111]
    v_rcp_f32 v13, v204
    v_mfma_f32_16x16x32_bf16 v[112:115], a[228:231], v[184:187], v[112:115]
    v_mov_b32 v204, 0
    s_waitcnt lgkmcnt(3)
    v_mfma_f32_16x16x32_bf16 v[140:143], a[192:195], a[0:3], v[188:191]
    v_min_f32 v192, -v170, -v171
    s_waitcnt lgkmcnt(2)
    v_mfma_f32_16x16x32_bf16 v[140:143], a[196:199], a[12:15], v[140:143]
    v_min_f32 v193, -v170, -v171
    v_min_f32 v194, -v170, -v171
    v_min_f32 v195, -v170, -v171
    s_waitcnt lgkmcnt(1)
    v_mfma_f32_16x16x32_bf16 v[140:143], a[200:203], a[24:27], v[140:143]
    v_min_f32 v196, -v174, -v175
    s_waitcnt lgkmcnt(0)
    v_mfma_f32_16x16x32_bf16 v[140:143], a[204:207], a[36:39], v[140:143]
    v_rcp_f32 v14, v205
    v_mfma_f32_16x16x32_bf16 v[144:147], a[204:207], a[40:43], v[192:195]
    v_add_f32 v116, v116, v188
    v_min_f32 v197, -v174, -v175
    v_mfma_f32_16x16x32_bf16 v[144:147], a[200:203], a[28:31], v[144:147]
    v_min_f32 v198, -v174, -v175
    v_min_f32 v199, -v174, -v175
    v_mfma_f32_16x16x32_bf16 v[144:147], a[196:199], a[16:19], v[144:147]
    ds_read_b128 a[208:211], v5 offset:512
    v_add_f32 v117, v117, v188
    v_mfma_f32_16x16x32_bf16 v[144:147], a[192:195], a[4:7], v[144:147]
    ds_read_b128 a[212:215], v5 offset:576
    v_mov_b32 v205, 0
    v_mfma_f32_16x16x32_bf16 v[148:151], a[192:195], a[8:11], v[196:199]
    ds_read_b128 a[216:219], v5 offset:640
    s_add_u32 m0, s56, 118272
    s_mov_b32 s57, 188416
    v_mfma_f32_16x16x32_bf16 v[148:151], a[196:199], a[20:23], v[148:151]
    ds_read_b128 a[220:223], v5 offset:704
    ds_read_b64_tr_b16 a[224:225], v3 offset:59136
    v_mfma_f32_16x16x32_bf16 v[148:151], a[200:203], a[32:35], v[148:151]
    v_rcp_f32 v15, v206
    v_mfma_f32_16x16x32_bf16 v[148:151], a[204:207], a[44:47], v[148:151]
    v_mov_b32 v206, 0
    s_waitcnt lgkmcnt(4)
    v_mfma_f32_16x16x32_bf16 v[152:155], a[208:211], a[0:3], v[188:191]
    v_mul_f32 v20, v13, v20
    s_waitcnt lgkmcnt(3)
    v_mfma_f32_16x16x32_bf16 v[152:155], a[212:215], a[12:15], v[152:155]
    v_mul_f32 v21, v13, v21
    s_waitcnt lgkmcnt(2)
    v_mfma_f32_16x16x32_bf16 v[152:155], a[216:219], a[24:27], v[152:155]
    v_mul_f32 v22, v13, v22
    s_waitcnt lgkmcnt(1)
    v_mfma_f32_16x16x32_bf16 v[152:155], a[220:223], a[36:39], v[152:155]
    buffer_load_dwordx4 v8, s[28:31], s57 offen offset:0 nt lds
    v_exp_f32 v16, v116
    v_mfma_f32_16x16x32_bf16 v[156:159], a[220:223], a[40:43], v[192:195]
    v_add_f32 v118, v118, v188
    v_mul_f32 v23, v13, v23
    v_mfma_f32_16x16x32_bf16 v[156:159], a[216:219], a[28:31], v[156:159]
    v_mov_b32 v207, 0
    v_exp_f32 v17, v117
    v_add_f32 v119, v119, v188
    v_exp_f32 v18, v118
    v_cvt_pk_bf16_f32 v164, v16, v17
    v_add_f32 v120, v120, v192
    v_exp_f32 v19, v119
    v_add_f32 v121, v121, v192
    v_exp_f32 v16, v120
    v_cvt_pk_bf16_f32 v165, v18, v19
    v_add_f32 v122, v122, v192
    v_exp_f32 v17, v121
    v_add_f32 v123, v123, v192
    v_exp_f32 v18, v122
    v_cvt_pk_bf16_f32 v168, v16, v17
    v_add_f32 v124, v124, v196
    v_exp_f32 v19, v123
    v_add_f32 v125, v125, v196
    v_exp_f32 v16, v124
    v_cvt_pk_bf16_f32 v169, v18, v19
    v_add_f32 v126, v126, v196
    v_exp_f32 v17, v125
    v_add_f32 v127, v127, v196
    v_exp_f32 v18, v126
    v_cvt_pk_bf16_f32 v172, v16, v17
    v_add_f32 v128, v128, v188
    v_exp_f32 v19, v127
    v_add_f32 v129, v129, v188
    v_exp_f32 v16, v128
    v_cvt_pk_bf16_f32 v173, v18, v19
    v_add_f32 v130, v130, v188
    v_exp_f32 v17, v129
    v_add_f32 v131, v131, v188
    v_exp_f32 v18, v130
    v_cvt_pk_bf16_f32 v166, v16, v17
    v_add_f32 v132, v132, v192
    v_exp_f32 v19, v131
    v_add_f32 v133, v133, v192
    v_exp_f32 v16, v132
    v_cvt_pk_bf16_f32 v167, v18, v19
    v_mfma_f32_16x16x32_bf16 v[156:159], a[212:215], a[16:19], v[156:159]
    v_add_f32 v134, v134, v192
    v_exp_f32 v17, v133
    v_add_f32 v135, v135, v192
    v_exp_f32 v18, v134
    v_cvt_pk_bf16_f32 v170, v16, v17
    v_add_f32 v136, v136, v196
    v_exp_f32 v19, v135
    v_add_f32 v137, v137, v196
    v_exp_f32 v16, v136
    v_cvt_pk_bf16_f32 v171, v18, v19
    v_mfma_f32_16x16x32_bf16 v[156:159], a[208:211], a[4:7], v[156:159]
    v_add_f32 v138, v138, v196
    v_exp_f32 v17, v137
    v_add_f32 v139, v139, v196
    v_exp_f32 v18, v138
    v_cvt_pk_bf16_f32 v174, v16, v17
    v_exp_f32 v19, v139
    s_nop 0
    v_cvt_pk_bf16_f32 v175, v18, v19
    v_mfma_f32_16x16x32_bf16 v[200:203], a[232:235], v[164:167], v[204:207]
    v_mul_f32 v32, v13, v32
    v_mul_f32 v33, v13, v33
    v_mfma_f32_16x16x32_bf16 v[200:203], a[236:239], v[168:171], v[200:203]
    ds_read_b64_tr_b16 a[226:227], v3 offset:59648
    v_mul_f32 v34, v13, v34
    v_mfma_f32_16x16x32_bf16 v[200:203], a[240:243], v[172:175], v[200:203]
    v_mul_f32 v35, v13, v35
    v_cvt_pk_bf16_f32 v208, v20, v21
    v_mfma_f32_16x16x32_bf16 v[160:163], a[208:211], a[8:11], v[196:199]
    v_cvt_pk_bf16_f32 v209, v22, v23
    v_cvt_pk_bf16_f32 v210, v32, v33
    v_mfma_f32_16x16x32_bf16 v[160:163], a[212:215], a[20:23], v[160:163]
    ds_read_b64_tr_b16 a[228:229], v3 offset:59168
    ds_read_b64_tr_b16 a[230:231], v3 offset:59680
    buffer_load_dwordx4 v9, s[28:31], s57 offen offset:1056 nt lds
    v_cvt_pk_bf16_f32 v211, v34, v35
    v_mul_f32 v24, v14, v24
    v_mul_f32 v25, v14, v25
    v_mul_f32 v26, v14, v26
    v_mul_f32 v27, v14, v27
    v_mul_f32 v36, v14, v36
    v_mul_f32 v37, v14, v37
    v_mul_f32 v38, v14, v38
    v_mul_f32 v39, v14, v39
    v_cvt_pk_bf16_f32 v212, v24, v25
    v_cvt_pk_bf16_f32 v213, v26, v27
    v_cvt_pk_bf16_f32 v214, v36, v37
    v_cvt_pk_bf16_f32 v215, v38, v39
    v_mul_f32 v28, v15, v28
    v_mul_f32 v29, v15, v29
    v_mul_f32 v30, v15, v30
    v_mul_f32 v31, v15, v31
    v_mfma_f32_16x16x32_bf16 v[160:163], a[216:219], a[32:35], v[160:163]
    v_cmp_nge_f32 vcc, s84, v203
    s_waitcnt vmcnt(20) lgkmcnt(3)
    s_barrier
    v_mfma_f32_16x16x32_bf16 v[160:163], a[220:223], a[44:47], v[160:163]
    s_cbranch_vccnz K_R1_0
K_R1_0_ret:
    v_mul_f32 v40, v15, v40
    v_mul_f32 v41, v15, v41
    v_mul_f32 v42, v15, v42
    v_mul_f32 v43, v15, v43
    v_cvt_pk_bf16_f32 v216, v28, v29
    v_cvt_pk_bf16_f32 v217, v30, v31
    s_waitcnt lgkmcnt(2)
    v_mfma_f32_16x16x32_bf16 v[28:31], a[224:227], v[172:175], 0
    ds_read_b64_tr_b16 a[192:193], v3 offset:59200
    ds_read_b64_tr_b16 a[194:195], v3 offset:59712
    v_mfma_f32_16x16x32_bf16 v[24:27], a[224:227], v[168:171], 0
    v_cvt_pk_bf16_f32 v218, v40, v41
    v_cvt_pk_bf16_f32 v219, v42, v43
    v_mfma_f32_16x16x32_bf16 v[20:23], a[224:227], v[164:167], 0
    v_mul_f32 v44, v13, v44
    s_waitcnt lgkmcnt(2)
    v_mfma_f32_16x16x32_bf16 v[32:35], a[228:231], v[164:167], 0
    ds_read_b64_tr_b16 a[196:197], v3 offset:59232
    ds_read_b64_tr_b16 a[198:199], v3 offset:59744
    v_mul_f32 v45, v13, v45
    v_mul_f32 v46, v13, v46
    v_mul_f32 v47, v13, v47
    v_mul_f32 v56, v13, v56
    v_mul_f32 v57, v13, v57
    v_mul_f32 v58, v13, v58
    v_mul_f32 v59, v13, v59
    v_cvt_pk_bf16_f32 v220, v44, v45
    v_cvt_pk_bf16_f32 v221, v46, v47
    v_cvt_pk_bf16_f32 v222, v56, v57
    v_cvt_pk_bf16_f32 v223, v58, v59
    v_mul_f32 v48, v14, v48
    v_mul_f32 v49, v14, v49
    v_mul_f32 v50, v14, v50
    v_mul_f32 v51, v14, v51
    v_mul_f32 v60, v14, v60
    v_mul_f32 v61, v14, v61
    v_mul_f32 v62, v14, v62
    v_mul_f32 v63, v14, v63
    v_cvt_pk_bf16_f32 v224, v48, v49
    v_cvt_pk_bf16_f32 v225, v50, v51
    v_cvt_pk_bf16_f32 v226, v60, v61
    v_cvt_pk_bf16_f32 v227, v62, v63
    v_mul_f32 v52, v15, v52
    v_mul_f32 v53, v15, v53
    v_mul_f32 v54, v15, v54
    v_mul_f32 v55, v15, v55
    v_mfma_f32_16x16x32_bf16 v[36:39], a[228:231], v[168:171], 0
    v_and_b32 v208, -2, v208
    v_mul_f32 v64, v15, v64
    v_mfma_f32_16x16x32_bf16 v[40:43], a[228:231], v[172:175], 0
    v_mul_f32 v65, v15, v65
    v_mul_f32 v66, v15, v66
    v_mul_f32 v67, v15, v67
    v_cvt_pk_bf16_f32 v228, v52, v53
    v_cvt_pk_bf16_f32 v229, v54, v55
    s_waitcnt lgkmcnt(2)
    v_mfma_f32_16x16x32_bf16 v[52:55], a[192:195], v[172:175], 0
    ds_read_b64_tr_b16 a[200:201], v3 offset:59264
    ds_read_b64_tr_b16 a[202:203], v3 offset:59776
    v_mfma_f32_16x16x32_bf16 v[48:51], a[192:195], v[168:171], 0
    s_add_u32 s11, s65, 0
    buffer_store_dwordx4 v[208:211], v12, s[44:47], s11 offen offset:0 sc1
    v_mfma_f32_16x16x32_bf16 v[44:47], a[192:195], v[164:167], 0
    ds_read_b64_tr_b16 a[204:205], v3 offset:59296
    s_waitcnt lgkmcnt(3)
    v_mfma_f32_16x16x32_bf16 v[56:59], a[196:199], v[164:167], 0
    ds_read_b64_tr_b16 a[206:207], v3 offset:59808
    v_cvt_pk_bf16_f32 v230, v64, v65
    v_cvt_pk_bf16_f32 v231, v66, v67
    v_mul_f32 v68, v13, v68
    v_mul_f32 v69, v13, v69
    v_mul_f32 v70, v13, v70
    v_mul_f32 v71, v13, v71
    v_mul_f32 v80, v13, v80
    v_mul_f32 v81, v13, v81
    v_mul_f32 v82, v13, v82
    v_mul_f32 v83, v13, v83
    v_cvt_pk_bf16_f32 v232, v68, v69
    v_cvt_pk_bf16_f32 v233, v70, v71
    v_cvt_pk_bf16_f32 v234, v80, v81
    v_cvt_pk_bf16_f32 v235, v82, v83
    v_mul_f32 v72, v14, v72
    v_mul_f32 v73, v14, v73
    v_mul_f32 v74, v14, v74
    v_mul_f32 v75, v14, v75
    v_mul_f32 v84, v14, v84
    v_mul_f32 v85, v14, v85
    v_mul_f32 v86, v14, v86
    v_mul_f32 v87, v14, v87
    v_cvt_pk_bf16_f32 v236, v72, v73
    v_cvt_pk_bf16_f32 v237, v74, v75
    v_cvt_pk_bf16_f32 v238, v84, v85
    v_cvt_pk_bf16_f32 v239, v86, v87
    v_mul_f32 v76, v15, v76
    v_mul_f32 v77, v15, v77
    v_mul_f32 v78, v15, v78
    v_mul_f32 v79, v15, v79
    v_mfma_f32_16x16x32_bf16 v[60:63], a[196:199], v[168:171], 0
    s_add_u32 m0, s56, 0
    s_mov_b32 s57, 204800
    v_and_b32 v212, -2, v212
    v_mfma_f32_16x16x32_bf16 v[64:67], a[196:199], v[172:175], 0
    v_mul_f32 v88, v15, v88
    v_mul_f32 v89, v15, v89
    v_mul_f32 v90, v15, v90
    v_mul_f32 v91, v15, v91
    v_cvt_pk_bf16_f32 v240, v76, v77
    v_cvt_pk_bf16_f32 v241, v78, v79
    s_waitcnt lgkmcnt(2)
    v_mfma_f32_16x16x32_bf16 v[76:79], a[200:203], v[172:175], 0
    ds_read_b64_tr_b16 a[208:209], v3 offset:59328
    ds_read_b64_tr_b16 a[210:211], v3 offset:59840
    v_mfma_f32_16x16x32_bf16 v[72:75], a[200:203], v[168:171], 0
    buffer_store_dwordx4 v[212:215], v12, s[44:47], s11 offen offset:1024 sc1
    v_mfma_f32_16x16x32_bf16 v[68:71], a[200:203], v[164:167], 0
    v_and_b32 v216, -2, v216
    s_waitcnt lgkmcnt(2)
    v_mfma_f32_16x16x32_bf16 v[80:83], a[204:207], v[164:167], 0
    ds_read_b64_tr_b16 a[212:213], v3 offset:59360
    ds_read_b64_tr_b16 a[214:215], v3 offset:59872
    v_cvt_pk_bf16_f32 v242, v88, v89
    v_cvt_pk_bf16_f32 v243, v90, v91
    v_mul_f32 v92, v13, v92
    v_mul_f32 v93, v13, v93
    v_mul_f32 v94, v13, v94
    v_mul_f32 v95, v13, v95
    v_mul_f32 v104, v13, v104
    v_mul_f32 v105, v13, v105
    v_mul_f32 v106, v13, v106
    v_mul_f32 v107, v13, v107
    v_cvt_pk_bf16_f32 v244, v92, v93
    v_cvt_pk_bf16_f32 v245, v94, v95
    v_cvt_pk_bf16_f32 v246, v104, v105
    v_cvt_pk_bf16_f32 v247, v106, v107
    v_mul_f32 v96, v14, v96
    v_mul_f32 v97, v14, v97
    v_mul_f32 v98, v14, v98
    v_mul_f32 v99, v14, v99
    v_mul_f32 v108, v14, v108
    v_mul_f32 v109, v14, v109
    v_mul_f32 v110, v14, v110
    v_mul_f32 v111, v14, v111
    v_cvt_pk_bf16_f32 v248, v96, v97
    v_cvt_pk_bf16_f32 v249, v98, v99
    v_cvt_pk_bf16_f32 v250, v108, v109
    v_cvt_pk_bf16_f32 v251, v110, v111
    v_mul_f32 v100, v15, v100
    v_mul_f32 v101, v15, v101
    v_mul_f32 v102, v15, v102
    v_mul_f32 v103, v15, v103
    v_mfma_f32_16x16x32_bf16 v[84:87], a[204:207], v[168:171], 0
    v_exp_f32 v16, v140
    v_mfma_f32_16x16x32_bf16 v[88:91], a[204:207], v[172:175], 0
    buffer_load_dwordx4 v8, s[24:27], s57 offen offset:0 nt lds
    v_mul_f32 v112, v15, v112
    v_mul_f32 v113, v15, v113
    v_mul_f32 v114, v15, v114
    v_mul_f32 v115, v15, v115
    v_cvt_pk_bf16_f32 v252, v100, v101
    v_cvt_pk_bf16_f32 v253, v102, v103
    s_waitcnt lgkmcnt(2)
    v_mfma_f32_16x16x32_bf16 v[100:103], a[208:211], v[172:175], 0
    ds_read_b128 a[216:219], v5 offset:8448
    ds_read_b128 a[220:223], v5 offset:8512
    v_mfma_f32_16x16x32_bf16 v[96:99], a[208:211], v[168:171], 0
    v_exp_f32 v17, v141
    v_mfma_f32_16x16x32_bf16 v[92:95], a[208:211], v[164:167], 0
    ds_read_b128 a[224:227], v5 offset:8576
    s_waitcnt lgkmcnt(3)
    v_mfma_f32_16x16x32_bf16 v[104:107], a[212:215], v[164:167], 0
    ds_read_b128 a[228:231], v5 offset:8640
    buffer_store_dwordx4 v[216:219], v12, s[44:47], s11 offen offset:2048 sc1
    v_mfma_f32_16x16x32_bf16 v[108:111], a[212:215], v[168:171], 0
    v_cvt_pk_bf16_f32 v254, v112, v113
    v_cvt_pk_bf16_f32 v255, v114, v115
    v_mfma_f32_16x16x32_bf16 v[112:115], a[212:215], v[172:175], 0
    ds_read_b128 a[192:195], v5 offset:8960
    s_waitcnt lgkmcnt(4)
    v_mfma_f32_16x16x32_bf16 v[116:119], a[216:219], a[0:3], v[188:191]
    ds_read_b128 a[196:199], v5 offset:9024
    s_waitcnt lgkmcnt(4)
    v_mfma_f32_16x16x32_bf16 v[116:119], a[220:223], a[12:15], v[116:119]
    buffer_load_dwordx4 v9, s[24:27], s57 offen offset:1056 nt lds
    s_waitcnt lgkmcnt(3)
    v_mfma_f32_16x16x32_bf16 v[116:119], a[224:227], a[24:27], v[116:119]
    ds_read_b128 a[200:203], v5 offset:9088
    s_waitcnt lgkmcnt(3)
    v_mfma_f32_16x16x32_bf16 v[116:119], a[228:231], a[36:39], v[116:119]
    v_exp_f32 v18, v142
    v_mfma_f32_16x16x32_bf16 v[120:123], a[228:231], a[40:43], v[192:195]
    ds_read_b128 a[204:207], v5 offset:9152
    v_cvt_pk_bf16_f32 v176, v16, v17
    v_mfma_f32_16x16x32_bf16 v[120:123], a[224:227], a[28:31], v[120:123]
    v_exp_f32 v19, v143
    v_mfma_f32_16x16x32_bf16 v[120:123], a[220:223], a[16:19], v[120:123]
    v_exp_f32 v16, v144
    v_mfma_f32_16x16x32_bf16 v[120:123], a[216:219], a[4:7], v[120:123]
    buffer_store_dwordx4 v[220:223], v12, s[44:47], s11 offen offset:3072 sc1
    v_cvt_pk_bf16_f32 v177, v18, v19
    v_mfma_f32_16x16x32_bf16 v[124:127], a[216:219], a[8:11], v[196:199]
    v_exp_f32 v17, v145
    v_mfma_f32_16x16x32_bf16 v[124:127], a[220:223], a[20:23], v[124:127]
    v_exp_f32 v18, v146
    v_mfma_f32_16x16x32_bf16 v[124:127], a[224:227], a[32:35], v[124:127]
    v_cvt_pk_bf16_f32 v180, v16, v17
    v_and_b32 v224, -2, v224
    v_mfma_f32_16x16x32_bf16 v[124:127], a[228:231], a[44:47], v[124:127]
    s_add_u32 s11, s65, 4096
    buffer_store_dwordx4 v[224:227], v12, s[44:47], s11 offen offset:0 sc1
    s_waitcnt lgkmcnt(1)
    v_mfma_f32_16x16x32_bf16 v[128:131], a[192:195], a[0:3], v[188:191]
    v_exp_f32 v19, v147
    v_mfma_f32_16x16x32_bf16 v[128:131], a[196:199], a[12:15], v[128:131]
    v_exp_f32 v16, v148
    v_mfma_f32_16x16x32_bf16 v[128:131], a[200:203], a[24:27], v[128:131]
    v_cvt_pk_bf16_f32 v181, v18, v19
    s_waitcnt lgkmcnt(0)
    v_mfma_f32_16x16x32_bf16 v[128:131], a[204:207], a[36:39], v[128:131]
    v_exp_f32 v17, v149
    v_mfma_f32_16x16x32_bf16 v[132:135], a[204:207], a[40:43], v[192:195]
    v_exp_f32 v18, v150
    v_mfma_f32_16x16x32_bf16 v[132:135], a[200:203], a[28:31], v[132:135]
    v_cvt_pk_bf16_f32 v184, v16, v17
    v_exp_f32 v19, v151
    v_exp_f32 v16, v152
    v_cvt_pk_bf16_f32 v185, v18, v19
    v_exp_f32 v17, v153
    v_exp_f32 v18, v154
    v_cvt_pk_bf16_f32 v178, v16, v17
    v_exp_f32 v19, v155
    v_exp_f32 v16, v156
    v_cvt_pk_bf16_f32 v179, v18, v19
    v_mov_b32 v203, 0
    v_mfma_f32_16x16x32_bf16 v[132:135], a[196:199], a[16:19], v[132:135]
    v_exp_f32 v17, v157
    v_exp_f32 v18, v158
    v_cvt_pk_bf16_f32 v182, v16, v17
    v_exp_f32 v19, v159
    v_exp_f32 v16, v160
    v_cvt_pk_bf16_f32 v183, v18, v19
    v_mfma_f32_16x16x32_bf16 v[132:135], a[192:195], a[4:7], v[132:135]
    v_exp_f32 v17, v161
    v_exp_f32 v18, v162
    v_cvt_pk_bf16_f32 v186, v16, v17
    v_exp_f32 v19, v163
    s_nop 0
    v_cvt_pk_bf16_f32 v187, v18, v19
    v_mfma_f32_16x16x32_bf16 v[204:207], a[232:235], v[176:179], v[200:203]
    s_add_u32 m0, s56, 135168
    s_mov_b32 s57, 196608
    v_mfma_f32_16x16x32_bf16 v[204:207], a[236:239], v[180:183], v[204:207]
    ds_read_b64_tr_b16 a[208:209], v2 offset:16896
    ds_read_b64_tr_b16 a[210:211], v2 offset:17408
    v_mfma_f32_16x16x32_bf16 v[204:207], a[240:243], v[184:187], v[204:207]
    v_and_b32 v13, 3, v1
    v_and_b32 v10, 0x70, v10
    v_mfma_f32_16x16x32_bf16 v[136:139], a[192:195], a[8:11], v[196:199]
    ds_read_b64_tr_b16 a[212:213], v2 offset:16928
    ds_read_b64_tr_b16 a[214:215], v2 offset:17440
    v_mfma_f32_16x16x32_bf16 v[136:139], a[196:199], a[20:23], v[136:139]
    buffer_load_dwordx4 v8, s[28:31], s57 offen offset:0 nt lds
    v_mfma_f32_16x16x32_bf16 v[136:139], a[200:203], a[32:35], v[136:139]
    v_lshlrev_b32 v13, 9, v13
    v_cmp_nge_f32 vcc, s84, v207
    v_mfma_f32_16x16x32_bf16 v[136:139], a[204:207], a[44:47], v[136:139]
    s_cbranch_vccnz K_R1_1
K_R1_1_ret:
    s_waitcnt lgkmcnt(2)
    v_mfma_f32_16x16x32_bf16 v[28:31], a[208:211], v[184:187], v[28:31]
    ds_read_b64_tr_b16 a[216:217], v2 offset:16960
    ds_read_b64_tr_b16 a[218:219], v2 offset:17472
    v_mfma_f32_16x16x32_bf16 v[24:27], a[208:211], v[180:183], v[24:27]
    buffer_load_dwordx4 v9, s[28:31], s57 offen offset:1056 nt lds
    v_mfma_f32_16x16x32_bf16 v[20:23], a[208:211], v[176:179], v[20:23]
    v_and_b32 v228, -2, v228
    s_waitcnt lgkmcnt(2)
    v_mfma_f32_16x16x32_bf16 v[32:35], a[212:215], v[176:179], v[32:35]
    ds_read_b64_tr_b16 a[220:221], v2 offset:16992
    ds_read_b64_tr_b16 a[222:223], v2 offset:17504
    v_mfma_f32_16x16x32_bf16 v[36:39], a[212:215], v[180:183], v[36:39]
    s_and_b32 s86, s22, 1
    s_xor_b32 s86, s86, 1
    s_lshl_b32 s86, s86, 6
    v_xor_b32 v10, s86, v10
    v_mfma_f32_16x16x32_bf16 v[40:43], a[212:215], v[184:187], v[40:43]
    buffer_store_dwordx4 v[228:231], v12, s[44:47], s11 offen offset:1024 sc1
    s_waitcnt lgkmcnt(2)
    v_mfma_f32_16x16x32_bf16 v[52:55], a[216:219], v[184:187], v[52:55]
    ds_read_b64_tr_b16 a[224:225], v2 offset:17024
    ds_read_b64_tr_b16 a[226:227], v2 offset:17536
    v_mfma_f32_16x16x32_bf16 v[48:51], a[216:219], v[180:183], v[48:51]
    ds_read_b64_tr_b16 a[228:229], v2 offset:17056
    v_accvgpr_write_b32 a144, v208
    v_mfma_f32_16x16x32_bf16 v[44:47], a[216:219], v[176:179], v[44:47]
    ds_read_b64_tr_b16 a[230:231], v2 offset:17568
    s_waitcnt lgkmcnt(4)
    v_mfma_f32_16x16x32_bf16 v[56:59], a[220:223], v[176:179], v[56:59]
    v_and_b32 v232, -2, v232
    v_accvgpr_write_b32 a145, v209
    v_mfma_f32_16x16x32_bf16 v[60:63], a[220:223], v[180:183], v[60:63]
    buffer_store_dwordx4 v[232:235], v12, s[44:47], s11 offen offset:2048 sc1
    v_mfma_f32_16x16x32_bf16 v[64:67], a[220:223], v[184:187], v[64:67]
    v_accvgpr_write_b32 a146, v210
    s_waitcnt lgkmcnt(2)
    v_mfma_f32_16x16x32_bf16 v[76:79], a[224:227], v[184:187], v[76:79]
    ds_read_b64_tr_b16 a[192:193], v2 offset:17088
    ds_read_b64_tr_b16 a[194:195], v2 offset:17600
    v_mfma_f32_16x16x32_bf16 v[72:75], a[224:227], v[180:183], v[72:75]
    v_exp_f32 v16, v116
    v_mfma_f32_16x16x32_bf16 v[68:71], a[224:227], v[176:179], v[68:71]
    ds_read_b64_tr_b16 a[196:197], v2 offset:17120
    s_waitcnt lgkmcnt(3)
    v_mfma_f32_16x16x32_bf16 v[80:83], a[228:231], v[176:179], v[80:83]
    ds_read_b64_tr_b16 a[198:199], v2 offset:17632
    buffer_store_dwordx4 v[236:239], v12, s[44:47], s11 offen offset:3072 sc1
    v_mfma_f32_16x16x32_bf16 v[84:87], a[228:231], v[180:183], v[84:87]
    v_exp_f32 v17, v117
    v_mfma_f32_16x16x32_bf16 v[88:91], a[228:231], v[184:187], v[88:91]
    ds_read_b128 a[200:203], v5 offset:50688
    s_waitcnt lgkmcnt(3)
    v_mfma_f32_16x16x32_bf16 v[100:103], a[192:195], v[184:187], v[100:103]
    v_exp_f32 v18, v118
    v_mfma_f32_16x16x32_bf16 v[96:99], a[192:195], v[180:183], v[96:99]
    ds_read_b128 a[204:207], v5 offset:50752
    s_add_u32 m0, s56, 143616
    s_mov_b32 s57, 212992
    v_mfma_f32_16x16x32_bf16 v[92:95], a[192:195], v[176:179], v[92:95]
    ds_read_b128 a[208:211], v5 offset:50816
    s_waitcnt lgkmcnt(3)
    v_mfma_f32_16x16x32_bf16 v[104:107], a[196:199], v[176:179], v[104:107]
    ds_read_b128 a[212:215], v5 offset:50880
    v_cvt_pk_bf16_f32 v164, v16, v17
    v_mfma_f32_16x16x32_bf16 v[108:111], a[196:199], v[180:183], v[108:111]
    v_exp_f32 v19, v119
    v_mfma_f32_16x16x32_bf16 v[112:115], a[196:199], v[184:187], v[112:115]
    v_accvgpr_write_b32 a147, v211
    s_waitcnt lgkmcnt(3)
    v_mfma_f32_16x16x32_bf16 v[140:143], a[200:203], a[0:3], v[188:191]
    buffer_load_dwordx4 v8, s[24:27], s57 offen offset:0 nt lds
    s_waitcnt lgkmcnt(2)
    v_mfma_f32_16x16x32_bf16 v[140:143], a[204:207], a[12:15], v[140:143]
    v_and_b32 v240, -2, v240
    s_waitcnt lgkmcnt(1)
    v_mfma_f32_16x16x32_bf16 v[140:143], a[208:211], a[24:27], v[140:143]
    ds_read_b128 a[216:219], v5 offset:51200
    s_waitcnt lgkmcnt(1)
    v_mfma_f32_16x16x32_bf16 v[140:143], a[212:215], a[36:39], v[140:143]
    v_exp_f32 v16, v120
    v_mfma_f32_16x16x32_bf16 v[144:147], a[212:215], a[40:43], v[192:195]
    s_add_u32 s11, s65, 8192
    buffer_store_dwordx4 v[240:243], v12, s[44:47], s11 offen offset:0 sc1
    v_cvt_pk_bf16_f32 v165, v18, v19
    v_mfma_f32_16x16x32_bf16 v[144:147], a[208:211], a[28:31], v[144:147]
    v_exp_f32 v17, v121
    v_mfma_f32_16x16x32_bf16 v[144:147], a[204:207], a[16:19], v[144:147]
    v_exp_f32 v18, v122
    v_mfma_f32_16x16x32_bf16 v[144:147], a[200:203], a[4:7], v[144:147]
    ds_read_b128 a[220:223], v5 offset:51264
    v_cvt_pk_bf16_f32 v168, v16, v17
    v_mfma_f32_16x16x32_bf16 v[148:151], a[200:203], a[8:11], v[196:199]
    ds_read_b128 a[224:227], v5 offset:51328
    buffer_load_dwordx4 v9, s[24:27], s57 offen offset:1056 nt lds
    v_mfma_f32_16x16x32_bf16 v[148:151], a[204:207], a[20:23], v[148:151]
    ds_read_b128 a[228:231], v5 offset:51392
    v_accvgpr_write_b32 a148, v212
    v_mfma_f32_16x16x32_bf16 v[148:151], a[208:211], a[32:35], v[148:151]
    v_exp_f32 v19, v123
    v_mfma_f32_16x16x32_bf16 v[148:151], a[212:215], a[44:47], v[148:151]
    v_accvgpr_write_b32 a149, v213
    s_waitcnt lgkmcnt(3)
    v_mfma_f32_16x16x32_bf16 v[152:155], a[216:219], a[0:3], v[188:191]
    v_and_b32 v244, -2, v244
    s_waitcnt lgkmcnt(2)
    v_mfma_f32_16x16x32_bf16 v[152:155], a[220:223], a[12:15], v[152:155]
    ds_read_b64_tr_b16 a[192:193], v3 offset:16896
    s_waitcnt lgkmcnt(2)
    v_mfma_f32_16x16x32_bf16 v[152:155], a[224:227], a[24:27], v[152:155]
    ds_read_b64_tr_b16 a[194:195], v3 offset:17408
    s_waitcnt lgkmcnt(2)
    v_mfma_f32_16x16x32_bf16 v[152:155], a[228:231], a[36:39], v[152:155]
    v_exp_f32 v16, v124
    v_mfma_f32_16x16x32_bf16 v[156:159], a[228:231], a[40:43], v[192:195]
    v_cvt_pk_bf16_f32 v169, v18, v19
    v_lshrrev_b32 v15, 4, v1
    v_mfma_f32_16x16x32_bf16 v[156:159], a[224:227], a[28:31], v[156:159]
    v_exp_f32 v17, v125
    v_exp_f32 v18, v126
    v_cvt_pk_bf16_f32 v172, v16, v17
    v_exp_f32 v19, v127
    v_exp_f32 v16, v128
    v_cvt_pk_bf16_f32 v173, v18, v19
    v_exp_f32 v17, v129
    v_exp_f32 v18, v130
    v_cvt_pk_bf16_f32 v166, v16, v17
    v_exp_f32 v19, v131
    v_exp_f32 v16, v132
    v_cvt_pk_bf16_f32 v167, v18, v19
    v_mov_b32 v207, 0
    v_mfma_f32_16x16x32_bf16 v[156:159], a[220:223], a[16:19], v[156:159]
    v_exp_f32 v17, v133
    v_exp_f32 v18, v134
    v_cvt_pk_bf16_f32 v170, v16, v17
    v_exp_f32 v19, v135
    v_exp_f32 v16, v136
    v_cvt_pk_bf16_f32 v171, v18, v19
    v_mfma_f32_16x16x32_bf16 v[156:159], a[216:219], a[4:7], v[156:159]
    v_exp_f32 v17, v137
    v_exp_f32 v18, v138
    v_cvt_pk_bf16_f32 v174, v16, v17
    v_exp_f32 v19, v139
    s_nop 0
    v_cvt_pk_bf16_f32 v175, v18, v19
    v_mfma_f32_16x16x32_bf16 v[200:203], a[232:235], v[164:167], v[204:207]
    buffer_store_dwordx4 v[244:247], v12, s[44:47], s11 offen offset:1024 sc1
    v_mfma_f32_16x16x32_bf16 v[200:203], a[236:239], v[168:171], v[200:203]
    ds_read_b64_tr_b16 a[196:197], v3 offset:16928
    ds_read_b64_tr_b16 a[198:199], v3 offset:17440
    v_mfma_f32_16x16x32_bf16 v[200:203], a[240:243], v[172:175], v[200:203]
    v_accvgpr_write_b32 a150, v214
    v_and_b32 v248, -2, v248
    v_mfma_f32_16x16x32_bf16 v[160:163], a[216:219], a[8:11], v[196:199]
    v_accvgpr_write_b32 a151, v215
    v_lshl_add_u32 v10, v15, 13, v10
    v_mfma_f32_16x16x32_bf16 v[160:163], a[220:223], a[20:23], v[160:163]
    ds_read_b64_tr_b16 a[200:201], v3 offset:16960
    ds_read_b64_tr_b16 a[202:203], v3 offset:17472
    v_mfma_f32_16x16x32_bf16 v[160:163], a[224:227], a[32:35], v[160:163]
    v_cmp_nge_f32 vcc, s84, v203
    s_waitcnt vmcnt(28) lgkmcnt(4)
    s_barrier
    v_mfma_f32_16x16x32_bf16 v[160:163], a[228:231], a[44:47], v[160:163]
    s_cbranch_vccnz K_R1_2
K_R1_2_ret:
    buffer_store_dwordx4 v[248:251], v12, s[44:47], s11 offen offset:2048 sc1
    v_mfma_f32_16x16x32_bf16 v[28:31], a[192:195], v[172:175], v[28:31]
    ds_read_b64_tr_b16 a[204:205], v3 offset:16992
    ds_read_b64_tr_b16 a[206:207], v3 offset:17504
    v_mfma_f32_16x16x32_bf16 v[24:27], a[192:195], v[168:171], v[24:27]
    s_add_u32 m0, s56, 8448
    s_mov_b32 s57, 204800
    v_mfma_f32_16x16x32_bf16 v[20:23], a[192:195], v[164:167], v[20:23]
    ds_read_b64_tr_b16 a[208:209], v3 offset:17024
    s_waitcnt lgkmcnt(5)
    v_mfma_f32_16x16x32_bf16 v[32:35], a[196:199], v[164:167], v[32:35]
    ds_read_b64_tr_b16 a[210:211], v3 offset:17536
    ds_read_b64_tr_b16 a[212:213], v3 offset:17056
    v_mfma_f32_16x16x32_bf16 v[36:39], a[196:199], v[168:171], v[36:39]
    ds_read_b64_tr_b16 a[214:215], v3 offset:17568
    v_accvgpr_write_b32 a152, v216
    v_mfma_f32_16x16x32_bf16 v[40:43], a[196:199], v[172:175], v[40:43]
    buffer_load_dwordx4 v8, s[28:31], s57 offen offset:0 nt lds
    s_waitcnt lgkmcnt(6)
    v_mfma_f32_16x16x32_bf16 v[52:55], a[200:203], v[172:175], v[52:55]
    v_bfe_u32 v15, v1, 3, 1
    v_accvgpr_write_b32 a153, v217
    v_mfma_f32_16x16x32_bf16 v[48:51], a[200:203], v[168:171], v[48:51]
    ds_read_b64_tr_b16 a[216:217], v3 offset:17088
    ds_read_b64_tr_b16 a[218:219], v3 offset:17600
    v_mfma_f32_16x16x32_bf16 v[44:47], a[200:203], v[164:167], v[44:47]
    ds_read_b64_tr_b16 a[220:221], v3 offset:17120
    s_waitcnt lgkmcnt(7)
    v_mfma_f32_16x16x32_bf16 v[56:59], a[204:207], v[164:167], v[56:59]
    buffer_load_dwordx4 v9, s[28:31], s57 offen offset:1056 nt lds
    v_mfma_f32_16x16x32_bf16 v[60:63], a[204:207], v[168:171], v[60:63]
    v_exp_f32 v16, v140
    v_mfma_f32_16x16x32_bf16 v[64:67], a[204:207], v[172:175], v[64:67]
    ds_read_b64_tr_b16 a[222:223], v3 offset:17632
    s_waitcnt lgkmcnt(6)
    v_mfma_f32_16x16x32_bf16 v[76:79], a[208:211], v[172:175], v[76:79]
    v_exp_f32 v17, v141
    v_mfma_f32_16x16x32_bf16 v[72:75], a[208:211], v[168:171], v[72:75]
    buffer_store_dwordx4 v[252:255], v12, s[44:47], s11 offen offset:3072 sc1
K_NOSLOW0:
    v_mfma_f32_16x16x32_bf16 v[68:71], a[208:211], v[164:167], v[68:71]
    ds_read_b128 a[224:227], v5 offset:25344
    s_waitcnt lgkmcnt(5)
    v_mfma_f32_16x16x32_bf16 v[80:83], a[212:215], v[164:167], v[80:83]
    v_exp_f32 v18, v142
    v_mfma_f32_16x16x32_bf16 v[84:87], a[212:215], v[168:171], v[84:87]
    ds_read_b128 a[228:231], v5 offset:25408
    v_cvt_pk_bf16_f32 v176, v16, v17
    v_mfma_f32_16x16x32_bf16 v[88:91], a[212:215], v[172:175], v[88:91]
    v_accvgpr_write_b32 a154, v218
    s_waitcnt lgkmcnt(3)
    v_mfma_f32_16x16x32_bf16 v[100:103], a[216:219], v[172:175], v[100:103]
    ds_read_b128 a[192:195], v5 offset:25472
    v_lshl_add_u32 v10, v15, 15, v10
    v_mfma_f32_16x16x32_bf16 v[96:99], a[216:219], v[168:171], v[96:99]
    v_exp_f32 v19, v143
    v_mfma_f32_16x16x32_bf16 v[92:95], a[216:219], v[164:167], v[92:95]
    ds_read_b128 a[196:199], v5 offset:25536
    s_waitcnt lgkmcnt(4)
    v_mfma_f32_16x16x32_bf16 v[104:107], a[220:223], v[164:167], v[104:107]
    v_exp_f32 v16, v144
    v_mfma_f32_16x16x32_bf16 v[108:111], a[220:223], v[168:171], v[108:111]
    v_cvt_pk_bf16_f32 v177, v18, v19
    v_accvgpr_write_b32 a155, v219
    v_mfma_f32_16x16x32_bf16 v[112:115], a[220:223], v[172:175], v[112:115]
    ds_read_b128 a[200:203], v5 offset:25856
    s_waitcnt lgkmcnt(4)
    v_mfma_f32_16x16x32_bf16 v[116:119], a[224:227], a[0:3], v[188:191]
    ds_read_b128 a[204:207], v5 offset:25920
    s_waitcnt lgkmcnt(4)
    v_mfma_f32_16x16x32_bf16 v[116:119], a[228:231], a[12:15], v[116:119]
    ds_read_b128 a[208:211], v5 offset:25984
    s_waitcnt lgkmcnt(4)
    v_mfma_f32_16x16x32_bf16 v[116:119], a[192:195], a[24:27], v[116:119]
    v_accvgpr_write_b32 a156, v220
    s_waitcnt lgkmcnt(3)
    v_mfma_f32_16x16x32_bf16 v[116:119], a[196:199], a[36:39], v[116:119]
    v_exp_f32 v17, v145
    v_mfma_f32_16x16x32_bf16 v[120:123], a[196:199], a[40:43], v[192:195]
    v_exp_f32 v18, v146
    v_mfma_f32_16x16x32_bf16 v[120:123], a[192:195], a[28:31], v[120:123]
    s_add_u32 m0, s56, 16896
    s_mov_b32 s57, 221184
    v_cvt_pk_bf16_f32 v180, v16, v17
    v_mfma_f32_16x16x32_bf16 v[120:123], a[228:231], a[16:19], v[120:123]
    v_exp_f32 v19, v147
    v_mfma_f32_16x16x32_bf16 v[120:123], a[224:227], a[4:7], v[120:123]
    v_exp_f32 v16, v148
    v_mfma_f32_16x16x32_bf16 v[124:127], a[224:227], a[8:11], v[196:199]
    ds_read_b128 a[212:215], v5 offset:26048
    v_cvt_pk_bf16_f32 v181, v18, v19
    v_mfma_f32_16x16x32_bf16 v[124:127], a[228:231], a[20:23], v[124:127]
    s_lshl_b32 s86, s3, 11
    s_add_u32 s86, s86, 1024
    v_add_u32 v10, s86, v10
    v_mfma_f32_16x16x32_bf16 v[124:127], a[192:195], a[32:35], v[124:127]
    v_exp_f32 v17, v149
    v_mfma_f32_16x16x32_bf16 v[124:127], a[196:199], a[44:47], v[124:127]
    buffer_load_dwordx4 v8, s[24:27], s57 offen offset:0 nt lds
    s_waitcnt lgkmcnt(1)
    v_mfma_f32_16x16x32_bf16 v[128:131], a[200:203], a[0:3], v[188:191]
    v_exp_f32 v18, v150
    v_mfma_f32_16x16x32_bf16 v[128:131], a[204:207], a[12:15], v[128:131]
    ds_read_b64_tr_b16 a[216:217], v3 offset:42240
    v_cvt_pk_bf16_f32 v184, v16, v17
    v_mfma_f32_16x16x32_bf16 v[128:131], a[208:211], a[24:27], v[128:131]
    ds_read_b64_tr_b16 a[218:219], v3 offset:42752
    s_waitcnt lgkmcnt(2)
    v_mfma_f32_16x16x32_bf16 v[128:131], a[212:215], a[36:39], v[128:131]
    v_exp_f32 v19, v151
    v_mfma_f32_16x16x32_bf16 v[132:135], a[212:215], a[40:43], v[192:195]
    v_exp_f32 v16, v152
    v_mfma_f32_16x16x32_bf16 v[132:135], a[208:211], a[28:31], v[132:135]
    v_cvt_pk_bf16_f32 v185, v18, v19
    v_exp_f32 v17, v153
    v_exp_f32 v18, v154
    v_cvt_pk_bf16_f32 v178, v16, v17
    v_exp_f32 v19, v155
    v_exp_f32 v16, v156
    v_cvt_pk_bf16_f32 v179, v18, v19
    v_mov_b32 v203, 0
    v_mfma_f32_16x16x32_bf16 v[132:135], a[204:207], a[16:19], v[132:135]
    v_exp_f32 v17, v157
    v_exp_f32 v18, v158
    v_cvt_pk_bf16_f32 v182, v16, v17
    v_exp_f32 v19, v159
    v_exp_f32 v16, v160
    v_cvt_pk_bf16_f32 v183, v18, v19
    v_mfma_f32_16x16x32_bf16 v[132:135], a[200:203], a[4:7], v[132:135]
    v_exp_f32 v17, v161
    v_exp_f32 v18, v162
    v_cvt_pk_bf16_f32 v186, v16, v17
    v_exp_f32 v19, v163
    s_nop 0
    v_cvt_pk_bf16_f32 v187, v18, v19
    v_mfma_f32_16x16x32_bf16 v[204:207], a[232:235], v[176:179], v[200:203]
    buffer_load_dwordx4 v9, s[24:27], s57 offen offset:1056 nt lds
    v_mfma_f32_16x16x32_bf16 v[204:207], a[236:239], v[180:183], v[204:207]
    ds_read_b64_tr_b16 a[220:221], v3 offset:42272
    v_accvgpr_write_b32 a157, v221
    v_mfma_f32_16x16x32_bf16 v[204:207], a[240:243], v[184:187], v[204:207]
    ds_read_b64_tr_b16 a[222:223], v3 offset:42784
    v_accvgpr_write_b32 a158, v222
    v_mfma_f32_16x16x32_bf16 v[136:139], a[200:203], a[8:11], v[196:199]
    ds_read_b64_tr_b16 a[224:225], v3 offset:42304
    ds_read_b64_tr_b16 a[226:227], v3 offset:42816
    v_mfma_f32_16x16x32_bf16 v[136:139], a[204:207], a[20:23], v[136:139]
    ds_read_b64_tr_b16 a[228:229], v3 offset:42336
    ds_read_b64_tr_b16 a[230:231], v3 offset:42848
    v_mfma_f32_16x16x32_bf16 v[136:139], a[208:211], a[32:35], v[136:139]
    ds_read_b64_tr_b16 a[192:193], v3 offset:42368
    v_cmp_nge_f32 vcc, s84, v207
    v_mfma_f32_16x16x32_bf16 v[136:139], a[212:215], a[44:47], v[136:139]
    s_cbranch_vccnz K_R1_3
K_R1_3_ret:
    s_waitcnt lgkmcnt(7)
    v_mfma_f32_16x16x32_bf16 v[28:31], a[216:219], v[184:187], v[28:31]
    ds_read_b64_tr_b16 a[194:195], v3 offset:42880
    ds_read_b64_tr_b16 a[196:197], v3 offset:42400
    v_mfma_f32_16x16x32_bf16 v[24:27], a[216:219], v[180:183], v[24:27]
    ds_read_b64_tr_b16 a[198:199], v3 offset:42912
    v_accvgpr_write_b32 a159, v223
    v_mfma_f32_16x16x32_bf16 v[20:23], a[216:219], v[176:179], v[20:23]
    v_subrev_u32 v11, 32, v10
    s_waitcnt lgkmcnt(8)
    v_mfma_f32_16x16x32_bf16 v[32:35], a[220:223], v[176:179], v[32:35]
    ds_read_b64_tr_b16 a[200:201], v3 offset:42432
    v_accvgpr_write_b32 a160, v224
    v_mfma_f32_16x16x32_bf16 v[36:39], a[220:223], v[180:183], v[36:39]
    s_add_u32 m0, s56, 50688
    s_mov_b32 s57, 212992
    v_mfma_f32_16x16x32_bf16 v[40:43], a[220:223], v[184:187], v[40:43]
    ds_read_b64_tr_b16 a[202:203], v3 offset:42944
    s_waitcnt lgkmcnt(8)
    v_mfma_f32_16x16x32_bf16 v[52:55], a[224:227], v[184:187], v[52:55]
    v_exp_f32 v16, v116
    v_mfma_f32_16x16x32_bf16 v[48:51], a[224:227], v[180:183], v[48:51]
    ds_read_b64_tr_b16 a[204:205], v3 offset:42464
    ds_read_b64_tr_b16 a[206:207], v3 offset:42976
    v_mfma_f32_16x16x32_bf16 v[44:47], a[224:227], v[176:179], v[44:47]
    ds_read_b128 a[208:211], v5 offset:33792
    s_waitcnt lgkmcnt(8)
    v_mfma_f32_16x16x32_bf16 v[56:59], a[228:231], v[176:179], v[56:59]
    v_exp_f32 v17, v117
    v_mfma_f32_16x16x32_bf16 v[60:63], a[228:231], v[180:183], v[60:63]
    v_exp_f32 v18, v118
    v_mfma_f32_16x16x32_bf16 v[64:67], a[228:231], v[184:187], v[64:67]
    ds_read_b128 a[212:215], v5 offset:33856
    buffer_load_dwordx4 v8, s[28:31], s57 offen offset:0 nt lds
    s_waitcnt lgkmcnt(6)
    v_mfma_f32_16x16x32_bf16 v[76:79], a[192:195], v[184:187], v[76:79]
    v_accvgpr_write_b32 a161, v225
    v_cvt_pk_bf16_f32 v164, v16, v17
    v_mfma_f32_16x16x32_bf16 v[72:75], a[192:195], v[180:183], v[72:75]
    v_exp_f32 v19, v119
    v_mfma_f32_16x16x32_bf16 v[68:71], a[192:195], v[176:179], v[68:71]
    ds_read_b128 a[216:219], v5 offset:33920
    ds_read_b128 a[220:223], v5 offset:33984
    v_mfma_f32_16x16x32_bf16 v[80:83], a[196:199], v[176:179], v[80:83]
    buffer_load_dwordx4 v9, s[28:31], s57 offen offset:1056 nt lds
    v_mfma_f32_16x16x32_bf16 v[84:87], a[196:199], v[180:183], v[84:87]
    v_exp_f32 v16, v120
    v_mfma_f32_16x16x32_bf16 v[88:91], a[196:199], v[184:187], v[88:91]
    v_cvt_pk_bf16_f32 v165, v18, v19
    s_waitcnt lgkmcnt(3)
    v_mfma_f32_16x16x32_bf16 v[100:103], a[200:203], v[184:187], v[100:103]
    v_exp_f32 v17, v121
    v_mfma_f32_16x16x32_bf16 v[96:99], a[200:203], v[180:183], v[96:99]
    v_exp_f32 v18, v122
    v_mfma_f32_16x16x32_bf16 v[92:95], a[200:203], v[176:179], v[92:95]
    v_accvgpr_write_b32 a162, v226
    v_cvt_pk_bf16_f32 v168, v16, v17
    v_mfma_f32_16x16x32_bf16 v[104:107], a[204:207], v[176:179], v[104:107]
    v_exp_f32 v19, v123
    v_mfma_f32_16x16x32_bf16 v[108:111], a[204:207], v[180:183], v[108:111]
    ds_read_b128 a[224:227], v5 offset:34304
    ds_read_b128 a[228:231], v5 offset:34368
    v_mfma_f32_16x16x32_bf16 v[112:115], a[204:207], v[184:187], v[112:115]
    v_exp_f32 v16, v124
    v_mfma_f32_16x16x32_bf16 v[140:143], a[208:211], a[0:3], v[188:191]
    v_cvt_pk_bf16_f32 v169, v18, v19
    s_waitcnt lgkmcnt(2)
    v_mfma_f32_16x16x32_bf16 v[140:143], a[212:215], a[12:15], v[140:143]
    v_exp_f32 v17, v125
    v_mfma_f32_16x16x32_bf16 v[140:143], a[216:219], a[24:27], v[140:143]
    v_exp_f32 v18, v126
    v_mfma_f32_16x16x32_bf16 v[140:143], a[220:223], a[36:39], v[140:143]
    ds_read_b128 a[192:195], v5 offset:34432
    v_accvgpr_write_b32 a163, v227
    v_mfma_f32_16x16x32_bf16 v[144:147], a[220:223], a[40:43], v[192:195]
    ds_read_b128 a[196:199], v5 offset:34496
    v_cvt_pk_bf16_f32 v172, v16, v17
    v_mfma_f32_16x16x32_bf16 v[144:147], a[216:219], a[28:31], v[144:147]
    v_exp_f32 v19, v127
    v_mfma_f32_16x16x32_bf16 v[144:147], a[212:215], a[16:19], v[144:147]
    v_exp_f32 v16, v128
    v_mfma_f32_16x16x32_bf16 v[144:147], a[208:211], a[4:7], v[144:147]
    ds_read_b64_tr_b16 a[200:201], v2 offset:42240
    v_cvt_pk_bf16_f32 v173, v18, v19
    v_mfma_f32_16x16x32_bf16 v[148:151], a[208:211], a[8:11], v[196:199]
    v_exp_f32 v17, v129
    v_mfma_f32_16x16x32_bf16 v[148:151], a[212:215], a[20:23], v[148:151]
    v_exp_f32 v18, v130
    v_mfma_f32_16x16x32_bf16 v[148:151], a[216:219], a[32:35], v[148:151]
    ds_read_b64_tr_b16 a[202:203], v2 offset:42752
    v_accvgpr_write_b32 a164, v228
    v_mfma_f32_16x16x32_bf16 v[148:151], a[220:223], a[44:47], v[148:151]
    v_cvt_pk_bf16_f32 v166, v16, v17
    s_waitcnt lgkmcnt(4)
    v_mfma_f32_16x16x32_bf16 v[152:155], a[224:227], a[0:3], v[188:191]
    v_exp_f32 v19, v131
    v_mfma_f32_16x16x32_bf16 v[152:155], a[228:231], a[12:15], v[152:155]
    ds_read_b64_tr_b16 a[204:205], v2 offset:42272
    s_waitcnt lgkmcnt(3)
    v_mfma_f32_16x16x32_bf16 v[152:155], a[192:195], a[24:27], v[152:155]
    ds_read_b64_tr_b16 a[206:207], v2 offset:42784
    v_mov_b32 v207, 0
    v_mfma_f32_16x16x32_bf16 v[152:155], a[196:199], a[36:39], v[152:155]
    v_exp_f32 v16, v132
    v_mfma_f32_16x16x32_bf16 v[156:159], a[196:199], a[40:43], v[192:195]
    v_cvt_pk_bf16_f32 v167, v18, v19
    v_accvgpr_write_b32 a165, v229
    v_mfma_f32_16x16x32_bf16 v[156:159], a[192:195], a[28:31], v[156:159]
    v_exp_f32 v17, v133
    v_mfma_f32_16x16x32_bf16 v[156:159], a[228:231], a[16:19], v[156:159]
    v_exp_f32 v18, v134
    v_cvt_pk_bf16_f32 v170, v16, v17
    v_exp_f32 v19, v135
    v_exp_f32 v16, v136
    v_cvt_pk_bf16_f32 v171, v18, v19
    v_mfma_f32_16x16x32_bf16 v[156:159], a[224:227], a[4:7], v[156:159]
    v_exp_f32 v17, v137
    v_exp_f32 v18, v138
    v_cvt_pk_bf16_f32 v174, v16, v17
    v_exp_f32 v19, v139
    s_nop 0
    v_cvt_pk_bf16_f32 v175, v18, v19
    v_mfma_f32_16x16x32_bf16 v[200:203], a[232:235], v[164:167], v[204:207]
    s_add_u32 m0, s56, 126720
    s_mov_b32 s57, 229376
    v_mfma_f32_16x16x32_bf16 v[200:203], a[236:239], v[168:171], v[200:203]
    buffer_load_dwordx4 v8, s[24:27], s57 offen offset:0 nt lds
    v_mfma_f32_16x16x32_bf16 v[200:203], a[240:243], v[172:175], v[200:203]
    ds_read_b64_tr_b16 a[208:209], v2 offset:42304
    ds_read_b64_tr_b16 a[210:211], v2 offset:42816
    v_mfma_f32_16x16x32_bf16 v[160:163], a[224:227], a[8:11], v[196:199]
    ds_read_b64_tr_b16 a[212:213], v2 offset:42336
    ds_read_b64_tr_b16 a[214:215], v2 offset:42848
    v_mfma_f32_16x16x32_bf16 v[160:163], a[228:231], a[20:23], v[160:163]
    ds_read_b64_tr_b16 a[216:217], v2 offset:42368
    ds_read_b64_tr_b16 a[218:219], v2 offset:42880
    v_mfma_f32_16x16x32_bf16 v[160:163], a[192:195], a[32:35], v[160:163]
    v_cmp_nge_f32 vcc, s84, v203
    s_waitcnt vmcnt(29) lgkmcnt(6)
    s_barrier
    v_mfma_f32_16x16x32_bf16 v[160:163], a[196:199], a[44:47], v[160:163]
    s_cbranch_vccnz K_R1_4
K_R1_4_ret:
    v_accvgpr_write_b32 a166, v230
    v_mfma_f32_16x16x32_bf16 v[28:31], a[200:203], v[172:175], v[28:31]
    buffer_load_dwordx4 v9, s[24:27], s57 offen offset:1056 nt lds
    v_mfma_f32_16x16x32_bf16 v[24:27], a[200:203], v[168:171], v[24:27]
    ds_read_b64_tr_b16 a[220:221], v2 offset:42400
    ds_read_b64_tr_b16 a[222:223], v2 offset:42912
    v_mfma_f32_16x16x32_bf16 v[20:23], a[200:203], v[164:167], v[20:23]
    ds_read_b64_tr_b16 a[224:225], v2 offset:42432
    v_accvgpr_write_b32 a167, v231
    v_mfma_f32_16x16x32_bf16 v[32:35], a[204:207], v[164:167], v[32:35]
    ds_read_b64_tr_b16 a[226:227], v2 offset:42944
    ds_read_b64_tr_b16 a[228:229], v2 offset:42464
    v_mfma_f32_16x16x32_bf16 v[36:39], a[204:207], v[168:171], v[36:39]
    v_exp_f32 v16, v140
    v_mfma_f32_16x16x32_bf16 v[40:43], a[204:207], v[172:175], v[40:43]
    ds_read_b64_tr_b16 a[230:231], v2 offset:42976
    s_waitcnt lgkmcnt(8)
    v_mfma_f32_16x16x32_bf16 v[52:55], a[208:211], v[172:175], v[52:55]
    v_exp_f32 v17, v141
    v_mfma_f32_16x16x32_bf16 v[48:51], a[208:211], v[168:171], v[48:51]
    ds_read_b128 a[192:195], v6 offset:0
    v_accvgpr_write_b32 a168, v232
    v_mfma_f32_16x16x32_bf16 v[44:47], a[208:211], v[164:167], v[44:47]
    v_exp_f32 v18, v142
    v_mfma_f32_16x16x32_bf16 v[56:59], a[212:215], v[164:167], v[56:59]
    ds_read_b128 a[196:199], v6 offset:64
    v_cvt_pk_bf16_f32 v176, v16, v17
    v_mfma_f32_16x16x32_bf16 v[60:63], a[212:215], v[168:171], v[60:63]
    v_exp_f32 v19, v143
    v_mfma_f32_16x16x32_bf16 v[64:67], a[212:215], v[172:175], v[64:67]
    ds_read_b128 a[200:203], v6 offset:128
    s_waitcnt lgkmcnt(6)
    v_mfma_f32_16x16x32_bf16 v[76:79], a[216:219], v[172:175], v[76:79]
    v_exp_f32 v16, v144
    v_mfma_f32_16x16x32_bf16 v[72:75], a[216:219], v[168:171], v[72:75]
    ds_read_b128 a[204:207], v6 offset:192
    v_cvt_pk_bf16_f32 v177, v18, v19
    v_mfma_f32_16x16x32_bf16 v[68:71], a[216:219], v[164:167], v[68:71]
    v_exp_f32 v17, v145
    v_mfma_f32_16x16x32_bf16 v[80:83], a[220:223], v[164:167], v[80:83]
    ds_read_b128 a[208:211], v6 offset:512
    v_accvgpr_write_b32 a169, v233
    v_mfma_f32_16x16x32_bf16 v[84:87], a[220:223], v[168:171], v[84:87]
    v_exp_f32 v18, v146
    v_mfma_f32_16x16x32_bf16 v[88:91], a[220:223], v[172:175], v[88:91]
    v_cvt_pk_bf16_f32 v180, v16, v17
    s_waitcnt lgkmcnt(4)
    v_mfma_f32_16x16x32_bf16 v[100:103], a[224:227], v[172:175], v[100:103]
    v_exp_f32 v19, v147
    v_mfma_f32_16x16x32_bf16 v[96:99], a[224:227], v[168:171], v[96:99]
    s_add_u32 m0, s56, 25344
    s_mov_b32 s57, 221184
    v_mfma_f32_16x16x32_bf16 v[92:95], a[224:227], v[164:167], v[92:95]
    v_exp_f32 v16, v148
    v_mfma_f32_16x16x32_bf16 v[104:107], a[228:231], v[164:167], v[104:107]
    ds_read_b128 a[212:215], v6 offset:576
    v_cvt_pk_bf16_f32 v181, v18, v19
    v_mfma_f32_16x16x32_bf16 v[108:111], a[228:231], v[168:171], v[108:111]
    v_exp_f32 v17, v149
    v_mfma_f32_16x16x32_bf16 v[112:115], a[228:231], v[172:175], v[112:115]
    buffer_load_dwordx4 v8, s[28:31], s57 offen offset:0 nt lds
    v_accvgpr_write_b32 a170, v234
    v_mfma_f32_16x16x32_bf16 v[116:119], a[192:195], a[0:3], v[188:191]
    ds_read_b128 a[216:219], v6 offset:640
    s_waitcnt lgkmcnt(2)
    v_mfma_f32_16x16x32_bf16 v[116:119], a[196:199], a[12:15], v[116:119]
    v_exp_f32 v18, v150
    v_mfma_f32_16x16x32_bf16 v[116:119], a[200:203], a[24:27], v[116:119]
    ds_read_b128 a[220:223], v6 offset:704
    v_cvt_pk_bf16_f32 v184, v16, v17
    v_mfma_f32_16x16x32_bf16 v[116:119], a[204:207], a[36:39], v[116:119]
    buffer_load_dwordx4 v9, s[28:31], s57 offen offset:1056 nt lds
    v_mfma_f32_16x16x32_bf16 v[120:123], a[204:207], a[40:43], v[192:195]
    v_exp_f32 v19, v151
    v_mfma_f32_16x16x32_bf16 v[120:123], a[200:203], a[28:31], v[120:123]
    v_exp_f32 v16, v152
    v_mfma_f32_16x16x32_bf16 v[120:123], a[196:199], a[16:19], v[120:123]
    v_cvt_pk_bf16_f32 v185, v18, v19
    v_accvgpr_write_b32 a171, v235
    v_mfma_f32_16x16x32_bf16 v[120:123], a[192:195], a[4:7], v[120:123]
    v_exp_f32 v17, v153
    v_mfma_f32_16x16x32_bf16 v[124:127], a[192:195], a[8:11], v[196:199]
    v_exp_f32 v18, v154
    v_mfma_f32_16x16x32_bf16 v[124:127], a[196:199], a[20:23], v[124:127]
    ds_read_b64_tr_b16 a[224:225], v2 offset:59136
    ds_read_b64_tr_b16 a[226:227], v2 offset:59648
    v_mfma_f32_16x16x32_bf16 v[124:127], a[200:203], a[32:35], v[124:127]
    ds_read_b64_tr_b16 a[228:229], v2 offset:59168
    v_cvt_pk_bf16_f32 v178, v16, v17
    v_mfma_f32_16x16x32_bf16 v[124:127], a[204:207], a[44:47], v[124:127]
    v_exp_f32 v19, v155
    v_mfma_f32_16x16x32_bf16 v[128:131], a[208:211], a[0:3], v[188:191]
    ds_read_b64_tr_b16 a[230:231], v2 offset:59680
    s_waitcnt lgkmcnt(4)
    v_mfma_f32_16x16x32_bf16 v[128:131], a[212:215], a[12:15], v[128:131]
    v_exp_f32 v16, v156
    v_mfma_f32_16x16x32_bf16 v[128:131], a[216:219], a[24:27], v[128:131]
    v_cvt_pk_bf16_f32 v179, v18, v19
    v_accvgpr_write_b32 a172, v236
    v_mfma_f32_16x16x32_bf16 v[128:131], a[220:223], a[36:39], v[128:131]
    v_exp_f32 v17, v157
    v_mfma_f32_16x16x32_bf16 v[132:135], a[220:223], a[40:43], v[192:195]
    v_exp_f32 v18, v158
    v_mfma_f32_16x16x32_bf16 v[132:135], a[216:219], a[28:31], v[132:135]
    v_mov_b32 v203, 0
    v_cvt_pk_bf16_f32 v182, v16, v17
    v_mfma_f32_16x16x32_bf16 v[132:135], a[212:215], a[16:19], v[132:135]
    v_exp_f32 v19, v159
    v_exp_f32 v16, v160
    v_cvt_pk_bf16_f32 v183, v18, v19
    v_mfma_f32_16x16x32_bf16 v[132:135], a[208:211], a[4:7], v[132:135]
    v_exp_f32 v17, v161
    v_exp_f32 v18, v162
    v_cvt_pk_bf16_f32 v186, v16, v17
    v_exp_f32 v19, v163
    s_nop 0
    v_cvt_pk_bf16_f32 v187, v18, v19
    v_mfma_f32_16x16x32_bf16 v[204:207], a[232:235], v[176:179], v[200:203]
    ds_read_b64_tr_b16 a[192:193], v2 offset:59200
    ds_read_b64_tr_b16 a[194:195], v2 offset:59712
    v_mfma_f32_16x16x32_bf16 v[204:207], a[236:239], v[180:183], v[204:207]
    ds_read_b64_tr_b16 a[196:197], v2 offset:59232
    ds_read_b64_tr_b16 a[198:199], v2 offset:59744
    v_mfma_f32_16x16x32_bf16 v[204:207], a[240:243], v[184:187], v[204:207]
    ds_read_b64_tr_b16 a[200:201], v2 offset:59264
    v_accvgpr_write_b32 a173, v237
    v_mfma_f32_16x16x32_bf16 v[136:139], a[208:211], a[8:11], v[196:199]
    ds_read_b64_tr_b16 a[202:203], v2 offset:59776
    ds_read_b64_tr_b16 a[204:205], v2 offset:59296
    v_mfma_f32_16x16x32_bf16 v[136:139], a[212:215], a[20:23], v[136:139]
    ds_read_b64_tr_b16 a[206:207], v2 offset:59808
    v_accvgpr_write_b32 a174, v238
    v_mfma_f32_16x16x32_bf16 v[136:139], a[216:219], a[32:35], v[136:139]
    ds_read_b64_tr_b16 a[208:209], v2 offset:59328
    v_cmp_nge_f32 vcc, s84, v207
    v_mfma_f32_16x16x32_bf16 v[136:139], a[220:223], a[44:47], v[136:139]
    s_cbranch_vccnz K_R1_5
K_R1_5_ret:
    s_waitcnt lgkmcnt(9)
    v_mfma_f32_16x16x32_bf16 v[28:31], a[224:227], v[184:187], v[28:31]
    s_add_u32 m0, s56, 33792
    s_mov_b32 s57, 237568
    v_mfma_f32_16x16x32_bf16 v[24:27], a[224:227], v[180:183], v[24:27]
    buffer_load_dwordx4 v8, s[24:27], s57 offen offset:0 nt lds
    v_mfma_f32_16x16x32_bf16 v[20:23], a[224:227], v[176:179], v[20:23]
    ds_read_b64_tr_b16 a[210:211], v2 offset:59840
    v_accvgpr_write_b32 a175, v239
    v_mfma_f32_16x16x32_bf16 v[32:35], a[228:231], v[176:179], v[32:35]
    s_waitcnt vmcnt(9)
    s_mov_b64 exec, 1
    buffer_store_byte a232, v13, s[44:47], s76 offen offset:0 sc1
    s_mov_b64 exec, -1
    v_mfma_f32_16x16x32_bf16 v[36:39], a[228:231], v[180:183], v[36:39]
    v_exp_f32 v16, v116
    v_mfma_f32_16x16x32_bf16 v[40:43], a[228:231], v[184:187], v[40:43]
    ds_read_b64_tr_b16 a[212:213], v2 offset:59360
    s_waitcnt lgkmcnt(4)
    v_mfma_f32_16x16x32_bf16 v[52:55], a[192:195], v[184:187], v[52:55]
    buffer_load_dwordx4 v9, s[24:27], s57 offen offset:1056 nt lds
    v_mfma_f32_16x16x32_bf16 v[48:51], a[192:195], v[180:183], v[48:51]
    ds_read_b64_tr_b16 a[214:215], v2 offset:59872
    ds_read_b128 a[216:219], v6 offset:8448
    v_mfma_f32_16x16x32_bf16 v[44:47], a[192:195], v[176:179], v[44:47]
    v_exp_f32 v17, v117
    v_mfma_f32_16x16x32_bf16 v[56:59], a[196:199], v[176:179], v[56:59]
    v_exp_f32 v18, v118
    v_mfma_f32_16x16x32_bf16 v[60:63], a[196:199], v[180:183], v[60:63]
    ds_read_b128 a[220:223], v6 offset:8512
    v_cvt_pk_bf16_f32 v164, v16, v17
    v_mfma_f32_16x16x32_bf16 v[64:67], a[196:199], v[184:187], v[64:67]
    v_exp_f32 v19, v119
    v_mfma_f32_16x16x32_bf16 v[76:79], a[200:203], v[184:187], v[76:79]
    ds_read_b128 a[224:227], v6 offset:8576
    v_accvgpr_write_b32 a176, v240
    v_mfma_f32_16x16x32_bf16 v[72:75], a[200:203], v[180:183], v[72:75]
    v_exp_f32 v16, v120
    v_mfma_f32_16x16x32_bf16 v[68:71], a[200:203], v[176:179], v[68:71]
    v_cvt_pk_bf16_f32 v165, v18, v19
    s_waitcnt lgkmcnt(4)
    v_mfma_f32_16x16x32_bf16 v[80:83], a[204:207], v[176:179], v[80:83]
    v_exp_f32 v17, v121
    v_mfma_f32_16x16x32_bf16 v[84:87], a[204:207], v[180:183], v[84:87]
    ds_read_b128 a[228:231], v6 offset:8640
    ds_read_b128 a[192:195], v6 offset:8960
    v_mfma_f32_16x16x32_bf16 v[88:91], a[204:207], v[184:187], v[88:91]
    v_exp_f32 v18, v122
    v_mfma_f32_16x16x32_bf16 v[100:103], a[208:211], v[184:187], v[100:103]
    v_cvt_pk_bf16_f32 v168, v16, v17
    v_accvgpr_write_b32 a177, v241
    v_mfma_f32_16x16x32_bf16 v[96:99], a[208:211], v[180:183], v[96:99]
    v_exp_f32 v19, v123
    v_mfma_f32_16x16x32_bf16 v[92:95], a[208:211], v[176:179], v[92:95]
    ds_read_b128 a[196:199], v6 offset:9024
    s_waitcnt lgkmcnt(4)
    v_mfma_f32_16x16x32_bf16 v[104:107], a[212:215], v[176:179], v[104:107]
    v_exp_f32 v16, v124
    v_mfma_f32_16x16x32_bf16 v[108:111], a[212:215], v[180:183], v[108:111]
    ds_read_b128 a[200:203], v6 offset:9088
    v_cvt_pk_bf16_f32 v169, v18, v19
    v_mfma_f32_16x16x32_bf16 v[112:115], a[212:215], v[184:187], v[112:115]
    v_exp_f32 v17, v125
    v_mfma_f32_16x16x32_bf16 v[140:143], a[216:219], a[0:3], v[188:191]
    v_exp_f32 v18, v126
    v_mfma_f32_16x16x32_bf16 v[140:143], a[220:223], a[12:15], v[140:143]
    v_cvt_pk_bf16_f32 v172, v16, v17
    s_waitcnt lgkmcnt(2)
    v_mfma_f32_16x16x32_bf16 v[140:143], a[224:227], a[24:27], v[140:143]
    v_exp_f32 v19, v127
    v_mfma_f32_16x16x32_bf16 v[140:143], a[228:231], a[36:39], v[140:143]
    v_exp_f32 v16, v128
    v_mfma_f32_16x16x32_bf16 v[144:147], a[228:231], a[40:43], v[192:195]
    ds_read_b128 a[204:207], v6 offset:9152
    v_cvt_pk_bf16_f32 v173, v18, v19
    v_mfma_f32_16x16x32_bf16 v[144:147], a[224:227], a[28:31], v[144:147]
    ds_read_b64_tr_b16 a[208:209], v3 offset:25344
    v_accvgpr_write_b32 a178, v242
    v_mfma_f32_16x16x32_bf16 v[144:147], a[220:223], a[16:19], v[144:147]
    v_exp_f32 v17, v129
    v_mfma_f32_16x16x32_bf16 v[144:147], a[216:219], a[4:7], v[144:147]
    v_exp_f32 v18, v130
    v_mfma_f32_16x16x32_bf16 v[148:151], a[216:219], a[8:11], v[196:199]
    ds_read_b64_tr_b16 a[210:211], v3 offset:25856
    v_cvt_pk_bf16_f32 v166, v16, v17
    v_mfma_f32_16x16x32_bf16 v[148:151], a[220:223], a[20:23], v[148:151]
    v_exp_f32 v19, v131
    v_mfma_f32_16x16x32_bf16 v[148:151], a[224:227], a[32:35], v[148:151]
    s_add_u32 m0, s56, 84480
    s_mov_b32 s57, 229376
    v_mfma_f32_16x16x32_bf16 v[148:151], a[228:231], a[44:47], v[148:151]
    ds_read_b64_tr_b16 a[212:213], v3 offset:25376
    ds_read_b64_tr_b16 a[214:215], v3 offset:25888
    v_mfma_f32_16x16x32_bf16 v[152:155], a[192:195], a[0:3], v[188:191]
    v_accvgpr_write_b32 a179, v243
    s_waitcnt lgkmcnt(5)
    v_mfma_f32_16x16x32_bf16 v[152:155], a[196:199], a[12:15], v[152:155]
    v_exp_f32 v16, v132
    v_mfma_f32_16x16x32_bf16 v[152:155], a[200:203], a[24:27], v[152:155]
    v_cvt_pk_bf16_f32 v167, v18, v19
    s_waitcnt lgkmcnt(3)
    v_mfma_f32_16x16x32_bf16 v[152:155], a[204:207], a[36:39], v[152:155]
    v_exp_f32 v17, v133
    v_mfma_f32_16x16x32_bf16 v[156:159], a[204:207], a[40:43], v[192:195]
    buffer_load_dwordx4 v8, s[28:31], s57 offen offset:0 nt lds
    v_mfma_f32_16x16x32_bf16 v[156:159], a[200:203], a[28:31], v[156:159]
    v_mov_b32 v207, 0
    v_lshlrev_b32 v15, 7, v1
    v_mfma_f32_16x16x32_bf16 v[156:159], a[196:199], a[16:19], v[156:159]
    v_exp_f32 v18, v134
    v_cvt_pk_bf16_f32 v170, v16, v17
    v_exp_f32 v19, v135
    v_exp_f32 v16, v136
    v_cvt_pk_bf16_f32 v171, v18, v19
    v_mfma_f32_16x16x32_bf16 v[156:159], a[192:195], a[4:7], v[156:159]
    v_exp_f32 v17, v137
    v_exp_f32 v18, v138
    v_cvt_pk_bf16_f32 v174, v16, v17
    v_exp_f32 v19, v139
    s_nop 0
    v_cvt_pk_bf16_f32 v175, v18, v19
    v_mfma_f32_16x16x32_bf16 v[200:203], a[232:235], v[164:167], v[204:207]
    buffer_load_dwordx4 v9, s[28:31], s57 offen offset:1056 nt lds
    v_mfma_f32_16x16x32_bf16 v[200:203], a[236:239], v[168:171], v[200:203]
    s_lshr_b32 s86, s2, 3
    s_lshl_b32 s86, s86, 2
    s_add_u32 s86, s86, s3
    s_lshl_b32 s86, s86, 13
    s_lshl_b32 s87, s22, 20
    s_add_u32 s86, s86, s87
    s_lshl_b32 s87, s23, 8
    s_sub_u32 s86, s86, s87
    s_mov_b32 s96, s86
    v_mfma_f32_16x16x32_bf16 v[200:203], a[240:243], v[172:175], v[200:203]
    ds_read_b64_tr_b16 a[216:217], v3 offset:25408
    ds_read_b64_tr_b16 a[218:219], v3 offset:25920
    v_mfma_f32_16x16x32_bf16 v[160:163], a[192:195], a[8:11], v[196:199]
    ds_read_b64_tr_b16 a[220:221], v3 offset:25440
    v_accvgpr_write_b32 a180, v244
    v_mfma_f32_16x16x32_bf16 v[160:163], a[196:199], a[20:23], v[160:163]
    ds_read_b64_tr_b16 a[222:223], v3 offset:25952
    ds_read_b64_tr_b16 a[224:225], v3 offset:25472
    v_mfma_f32_16x16x32_bf16 v[160:163], a[200:203], a[32:35], v[160:163]
    v_cmp_nge_f32 vcc, s84, v203
    s_waitcnt lgkmcnt(5)
    s_barrier
    v_mfma_f32_16x16x32_bf16 v[160:163], a[204:207], a[44:47], v[160:163]
    s_cbranch_vccnz K_R1_6
K_R1_6_ret:
    ds_read_b64_tr_b16 a[226:227], v3 offset:25984
    v_mfma_f32_16x16x32_bf16 v[28:31], a[208:211], v[172:175], v[28:31]
    ds_read_b64_tr_b16 a[228:229], v3 offset:25504
    ds_read_b64_tr_b16 a[230:231], v3 offset:26016
    v_mfma_f32_16x16x32_bf16 v[24:27], a[208:211], v[168:171], v[24:27]
    v_accvgpr_write_b32 a181, v245
    v_accvgpr_write_b32 a182, v246
    v_mfma_f32_16x16x32_bf16 v[20:23], a[208:211], v[164:167], v[20:23]
    ds_read_b64_tr_b16 a[192:193], v3 offset:25536
    ds_read_b64_tr_b16 a[194:195], v3 offset:26048
    v_mfma_f32_16x16x32_bf16 v[32:35], a[212:215], v[164:167], v[32:35]
    v_exp_f32 v16, v140
    v_mfma_f32_16x16x32_bf16 v[36:39], a[212:215], v[168:171], v[36:39]
    s_mov_b32 exec_hi, 0x0
    buffer_load_dword a244, v15, s[40:43], s96 offen offset:1024
    s_mov_b64 exec, -1
    v_mfma_f32_16x16x32_bf16 v[40:43], a[212:215], v[172:175], v[40:43]
    ds_read_b64_tr_b16 a[196:197], v3 offset:25568
    s_waitcnt lgkmcnt(8)
    v_mfma_f32_16x16x32_bf16 v[52:55], a[216:219], v[172:175], v[52:55]
    ds_read_b64_tr_b16 a[198:199], v3 offset:26080
    ds_read_b128 a[200:203], v6 offset:33792
    v_mfma_f32_16x16x32_bf16 v[48:51], a[216:219], v[168:171], v[48:51]
    v_exp_f32 v17, v141
    v_mfma_f32_16x16x32_bf16 v[44:47], a[216:219], v[164:167], v[44:47]
    ds_read_b128 a[204:207], v6 offset:33856
    s_waitcnt lgkmcnt(8)
    v_mfma_f32_16x16x32_bf16 v[56:59], a[220:223], v[164:167], v[56:59]
    v_exp_f32 v18, v142
    v_mfma_f32_16x16x32_bf16 v[60:63], a[220:223], v[168:171], v[60:63]
    ds_read_b128 a[208:211], v6 offset:33920
    v_cvt_pk_bf16_f32 v176, v16, v17
    v_mfma_f32_16x16x32_bf16 v[64:67], a[220:223], v[172:175], v[64:67]
    v_exp_f32 v19, v143
    v_mfma_f32_16x16x32_bf16 v[76:79], a[224:227], v[172:175], v[76:79]
    ds_read_b128 a[212:215], v6 offset:33984
    v_accvgpr_write_b32 a183, v247
    v_mfma_f32_16x16x32_bf16 v[72:75], a[224:227], v[168:171], v[72:75]
    v_exp_f32 v16, v144
    v_mfma_f32_16x16x32_bf16 v[68:71], a[224:227], v[164:167], v[68:71]
    v_cvt_pk_bf16_f32 v177, v18, v19
    s_waitcnt lgkmcnt(5)
    v_mfma_f32_16x16x32_bf16 v[80:83], a[228:231], v[164:167], v[80:83]
    s_add_u32 m0, s56, 42240
    s_mov_b32 s57, 245760
    v_mfma_f32_16x16x32_bf16 v[84:87], a[228:231], v[168:171], v[84:87]
    v_exp_f32 v17, v145
    v_mfma_f32_16x16x32_bf16 v[88:91], a[228:231], v[172:175], v[88:91]
    v_exp_f32 v18, v146
    v_mfma_f32_16x16x32_bf16 v[100:103], a[192:195], v[172:175], v[100:103]
    buffer_load_dwordx4 v8, s[24:27], s57 offen offset:0 nt lds
    v_mfma_f32_16x16x32_bf16 v[96:99], a[192:195], v[168:171], v[96:99]
    ds_read_b128 a[216:219], v6 offset:34304
    v_cvt_pk_bf16_f32 v180, v16, v17
    v_mfma_f32_16x16x32_bf16 v[92:95], a[192:195], v[164:167], v[92:95]
    v_accvgpr_write_b32 a184, v248
    s_waitcnt lgkmcnt(2)
    v_mfma_f32_16x16x32_bf16 v[104:107], a[196:199], v[164:167], v[104:107]
    v_exp_f32 v19, v147
    v_mfma_f32_16x16x32_bf16 v[108:111], a[196:199], v[168:171], v[108:111]
    buffer_load_dwordx4 v9, s[24:27], s57 offen offset:1056 nt lds
    v_mfma_f32_16x16x32_bf16 v[112:115], a[196:199], v[172:175], v[112:115]
    v_exp_f32 v16, v148
    v_mfma_f32_16x16x32_bf16 v[116:119], a[200:203], a[0:3], v[188:191]
    ds_read_b128 a[220:223], v6 offset:34368
    v_cvt_pk_bf16_f32 v181, v18, v19
    v_mfma_f32_16x16x32_bf16 v[116:119], a[204:207], a[12:15], v[116:119]
    v_exp_f32 v17, v149
    v_mfma_f32_16x16x32_bf16 v[116:119], a[208:211], a[24:27], v[116:119]
    ds_read_b128 a[224:227], v6 offset:34432
    s_waitcnt lgkmcnt(3)
    v_mfma_f32_16x16x32_bf16 v[116:119], a[212:215], a[36:39], v[116:119]
    v_exp_f32 v18, v150
    v_mfma_f32_16x16x32_bf16 v[120:123], a[212:215], a[40:43], v[192:195]
    v_cvt_pk_bf16_f32 v184, v16, v17
    v_accvgpr_write_b32 a185, v249
    v_mfma_f32_16x16x32_bf16 v[120:123], a[208:211], a[28:31], v[120:123]
    v_exp_f32 v19, v151
    v_mfma_f32_16x16x32_bf16 v[120:123], a[204:207], a[16:19], v[120:123]
    v_exp_f32 v16, v152
    v_mfma_f32_16x16x32_bf16 v[120:123], a[200:203], a[4:7], v[120:123]
    ds_read_b128 a[228:231], v6 offset:34496
    v_cvt_pk_bf16_f32 v185, v18, v19
    v_mfma_f32_16x16x32_bf16 v[124:127], a[200:203], a[8:11], v[196:199]
    v_exp_f32 v17, v153
    v_mfma_f32_16x16x32_bf16 v[124:127], a[204:207], a[20:23], v[124:127]
    v_exp_f32 v18, v154
    v_mfma_f32_16x16x32_bf16 v[124:127], a[208:211], a[32:35], v[124:127]
    ds_read_b64_tr_b16 a[192:193], v3 offset:50688
    ds_read_b64_tr_b16 a[194:195], v3 offset:51200
    v_mfma_f32_16x16x32_bf16 v[124:127], a[212:215], a[44:47], v[124:127]
    v_cvt_pk_bf16_f32 v178, v16, v17
    s_waitcnt lgkmcnt(3)
    v_mfma_f32_16x16x32_bf16 v[128:131], a[216:219], a[0:3], v[188:191]
    v_exp_f32 v19, v155
    v_mfma_f32_16x16x32_bf16 v[128:131], a[220:223], a[12:15], v[128:131]
    ds_read_b64_tr_b16 a[196:197], v3 offset:50720
    ds_read_b64_tr_b16 a[198:199], v3 offset:51232
    v_mfma_f32_16x16x32_bf16 v[128:131], a[224:227], a[24:27], v[128:131]
    v_accvgpr_write_b32 a186, v250
    s_waitcnt lgkmcnt(4)
    v_mfma_f32_16x16x32_bf16 v[128:131], a[228:231], a[36:39], v[128:131]
    v_exp_f32 v16, v156
    v_mfma_f32_16x16x32_bf16 v[132:135], a[228:231], a[40:43], v[192:195]
    v_cvt_pk_bf16_f32 v179, v18, v19
    v_mov_b32 v203, 0
    v_mfma_f32_16x16x32_bf16 v[132:135], a[224:227], a[28:31], v[132:135]
    v_exp_f32 v17, v157
    v_mfma_f32_16x16x32_bf16 v[132:135], a[220:223], a[16:19], v[132:135]
    v_exp_f32 v18, v158
    v_cvt_pk_bf16_f32 v182, v16, v17
    v_exp_f32 v19, v159
    v_exp_f32 v16, v160
    v_cvt_pk_bf16_f32 v183, v18, v19
    v_mfma_f32_16x16x32_bf16 v[132:135], a[216:219], a[4:7], v[132:135]
    v_exp_f32 v17, v161
    v_exp_f32 v18, v162
    v_cvt_pk_bf16_f32 v186, v16, v17
    v_exp_f32 v19, v163
    s_nop 0
    v_cvt_pk_bf16_f32 v187, v18, v19
    v_mfma_f32_16x16x32_bf16 v[204:207], a[232:235], v[176:179], v[200:203]
    ds_read_b64_tr_b16 a[200:201], v3 offset:50752
    v_accvgpr_write_b32 a187, v251
    v_mfma_f32_16x16x32_bf16 v[204:207], a[236:239], v[180:183], v[204:207]
    ds_read_b64_tr_b16 a[202:203], v3 offset:51264
    ds_read_b64_tr_b16 a[204:205], v3 offset:50784
    v_mfma_f32_16x16x32_bf16 v[204:207], a[240:243], v[184:187], v[204:207]
    ds_read_b64_tr_b16 a[206:207], v3 offset:51296
    ds_read_b64_tr_b16 a[208:209], v3 offset:50816
    v_mfma_f32_16x16x32_bf16 v[136:139], a[216:219], a[8:11], v[196:199]
    ds_read_b64_tr_b16 a[210:211], v3 offset:51328
    ds_read_b64_tr_b16 a[212:213], v3 offset:50848
    v_mfma_f32_16x16x32_bf16 v[136:139], a[220:223], a[20:23], v[136:139]
    ds_read_b64_tr_b16 a[214:215], v3 offset:51360
    v_accvgpr_write_b32 a188, v252
    v_mfma_f32_16x16x32_bf16 v[136:139], a[224:227], a[32:35], v[136:139]
    v_accvgpr_write_b32 a189, v253
    v_cmp_nge_f32 vcc, s84, v207
    v_mfma_f32_16x16x32_bf16 v[136:139], a[228:231], a[44:47], v[136:139]
    s_cbranch_vccnz K_R1_7
K_R1_7_ret:
    s_waitcnt lgkmcnt(8)
    v_mfma_f32_16x16x32_bf16 v[28:31], a[192:195], v[184:187], v[28:31]
    s_add_u32 m0, s56, 59136
    s_mov_b32 s57, 237568
    v_mfma_f32_16x16x32_bf16 v[24:27], a[192:195], v[180:183], v[24:27]
    buffer_load_dwordx4 v8, s[28:31], s57 offen offset:0 nt lds
    v_mfma_f32_16x16x32_bf16 v[20:23], a[192:195], v[176:179], v[20:23]
    s_mov_b32 exec_lo, 0x0
    buffer_load_dword a245, v15, s[40:43], s96 offen offset:1024
    s_mov_b64 exec, -1
    v_mfma_f32_16x16x32_bf16 v[32:35], a[196:199], v[176:179], v[32:35]
    ds_read_b64_tr_b16 a[216:217], v3 offset:50880
    ds_read_b64_tr_b16 a[218:219], v3 offset:51392
    v_mfma_f32_16x16x32_bf16 v[36:39], a[196:199], v[180:183], v[36:39]
    v_exp_f32 v16, v116
    v_mfma_f32_16x16x32_bf16 v[40:43], a[196:199], v[184:187], v[40:43]
    ds_read_b64_tr_b16 a[220:221], v3 offset:50912
    s_waitcnt lgkmcnt(4)
    v_mfma_f32_16x16x32_bf16 v[52:55], a[200:203], v[184:187], v[52:55]
    buffer_load_dwordx4 v9, s[28:31], s57 offen offset:1056 nt lds
    v_mfma_f32_16x16x32_bf16 v[48:51], a[200:203], v[180:183], v[48:51]
    ds_read_b64_tr_b16 a[222:223], v3 offset:51424
    ds_read_b128 a[224:227], v5 offset:0
    v_mfma_f32_16x16x32_bf16 v[44:47], a[200:203], v[176:179], v[44:47]
    v_exp_f32 v17, v117
    v_mfma_f32_16x16x32_bf16 v[56:59], a[204:207], v[176:179], v[56:59]
    v_exp_f32 v18, v118
    v_mfma_f32_16x16x32_bf16 v[60:63], a[204:207], v[180:183], v[60:63]
    ds_read_b128 a[228:231], v5 offset:64
    v_cvt_pk_bf16_f32 v164, v16, v17
    v_mfma_f32_16x16x32_bf16 v[64:67], a[204:207], v[184:187], v[64:67]
    ds_read_b128 a[192:195], v5 offset:128
    v_accvgpr_write_b32 a190, v254
    v_mfma_f32_16x16x32_bf16 v[76:79], a[208:211], v[184:187], v[76:79]
    v_exp_f32 v19, v119
    v_mfma_f32_16x16x32_bf16 v[72:75], a[208:211], v[180:183], v[72:75]
    v_exp_f32 v16, v120
    v_mfma_f32_16x16x32_bf16 v[68:71], a[208:211], v[176:179], v[68:71]
    v_cvt_pk_bf16_f32 v165, v18, v19
    s_waitcnt lgkmcnt(4)
    v_mfma_f32_16x16x32_bf16 v[80:83], a[212:215], v[176:179], v[80:83]
    v_exp_f32 v17, v121
    v_mfma_f32_16x16x32_bf16 v[84:87], a[212:215], v[180:183], v[84:87]
    ds_read_b128 a[196:199], v5 offset:192
    v_accvgpr_write_b32 a191, v255
    v_mfma_f32_16x16x32_bf16 v[88:91], a[212:215], v[184:187], v[88:91]
    v_exp_f32 v18, v122
    v_mfma_f32_16x16x32_bf16 v[100:103], a[216:219], v[184:187], v[100:103]
    ds_read_b128 a[200:203], v5 offset:512
    v_cvt_pk_bf16_f32 v168, v16, v17
    v_mfma_f32_16x16x32_bf16 v[96:99], a[216:219], v[180:183], v[96:99]
    v_exp_f32 v19, v123
    v_mfma_f32_16x16x32_bf16 v[92:95], a[216:219], v[176:179], v[92:95]
    ds_read_b128 a[204:207], v5 offset:576
    s_waitcnt lgkmcnt(3)
    v_mfma_f32_16x16x32_bf16 v[104:107], a[220:223], v[176:179], v[104:107]
    v_exp_f32 v16, v124
    v_mfma_f32_16x16x32_bf16 v[108:111], a[220:223], v[180:183], v[108:111]
    ds_read_b128 a[208:211], v5 offset:640
    v_cvt_pk_bf16_f32 v169, v18, v19
    v_mfma_f32_16x16x32_bf16 v[112:115], a[220:223], v[184:187], v[112:115]
    v_exp_f32 v17, v125
    v_mfma_f32_16x16x32_bf16 v[140:143], a[224:227], a[0:3], v[188:191]
    v_exp_f32 v18, v126
    v_mfma_f32_16x16x32_bf16 v[140:143], a[228:231], a[12:15], v[140:143]
    ds_read_b128 a[212:215], v5 offset:704
    v_cvt_pk_bf16_f32 v172, v16, v17
    v_mfma_f32_16x16x32_bf16 v[140:143], a[192:195], a[24:27], v[140:143]
    ds_read_b64_tr_b16 a[216:217], v4 offset:0
    s_waitcnt lgkmcnt(5)
    v_mfma_f32_16x16x32_bf16 v[140:143], a[196:199], a[36:39], v[140:143]
    v_exp_f32 v19, v127
    v_mfma_f32_16x16x32_bf16 v[144:147], a[196:199], a[40:43], v[192:195]
    v_exp_f32 v16, v128
    v_mfma_f32_16x16x32_bf16 v[144:147], a[192:195], a[28:31], v[144:147]
    s_add_u32 m0, s56, 67584
    s_mov_b32 s57, 253952
    v_mfma_f32_16x16x32_bf16 v[144:147], a[228:231], a[16:19], v[144:147]
    ds_read_b64_tr_b16 a[218:219], v4 offset:512
    v_cvt_pk_bf16_f32 v173, v18, v19
    v_mfma_f32_16x16x32_bf16 v[144:147], a[224:227], a[4:7], v[144:147]
    v_exp_f32 v17, v129
    v_mfma_f32_16x16x32_bf16 v[148:151], a[224:227], a[8:11], v[196:199]
    v_exp_f32 v18, v130
    v_mfma_f32_16x16x32_bf16 v[148:151], a[228:231], a[20:23], v[148:151]
    buffer_load_ubyte v14, v13, s[44:47], s75 offen offset:0 sc1
    v_mfma_f32_16x16x32_bf16 v[148:151], a[192:195], a[32:35], v[148:151]
    buffer_load_dwordx4 v8, s[24:27], s57 offen offset:0 nt lds
    v_mfma_f32_16x16x32_bf16 v[148:151], a[196:199], a[44:47], v[148:151]
    v_cvt_pk_bf16_f32 v166, v16, v17
    s_waitcnt lgkmcnt(1)
    v_mfma_f32_16x16x32_bf16 v[152:155], a[200:203], a[0:3], v[188:191]
    v_exp_f32 v19, v131
    v_mfma_f32_16x16x32_bf16 v[152:155], a[204:207], a[12:15], v[152:155]
    ds_read_b64_tr_b16 a[220:221], v4 offset:32
    ds_read_b64_tr_b16 a[222:223], v4 offset:544
    v_mfma_f32_16x16x32_bf16 v[152:155], a[208:211], a[24:27], v[152:155]
    buffer_load_dwordx4 v9, s[24:27], s57 offen offset:1056 nt lds
    v_mfma_f32_16x16x32_bf16 v[152:155], a[212:215], a[36:39], v[152:155]
    v_exp_f32 v16, v132
    v_mfma_f32_16x16x32_bf16 v[156:159], a[212:215], a[40:43], v[192:195]
    v_cvt_pk_bf16_f32 v167, v18, v19
    v_mov_b32 v207, 0
    v_mfma_f32_16x16x32_bf16 v[156:159], a[208:211], a[28:31], v[156:159]
    v_exp_f32 v17, v133
    v_mfma_f32_16x16x32_bf16 v[156:159], a[204:207], a[16:19], v[156:159]
    v_exp_f32 v18, v134
    v_cvt_pk_bf16_f32 v170, v16, v17
    v_exp_f32 v19, v135
    v_exp_f32 v16, v136
    v_cvt_pk_bf16_f32 v171, v18, v19
    v_mfma_f32_16x16x32_bf16 v[156:159], a[200:203], a[4:7], v[156:159]
    v_exp_f32 v17, v137
    v_exp_f32 v18, v138
    v_cvt_pk_bf16_f32 v174, v16, v17
    v_exp_f32 v19, v139
    s_nop 0
    v_cvt_pk_bf16_f32 v175, v18, v19
    v_mfma_f32_16x16x32_bf16 v[200:203], a[232:235], v[164:167], v[204:207]
    ds_read_b64_tr_b16 a[224:225], v4 offset:64
    ds_read_b64_tr_b16 a[226:227], v4 offset:576
    v_mfma_f32_16x16x32_bf16 v[200:203], a[236:239], v[168:171], v[200:203]
    ds_read_b64_tr_b16 a[228:229], v4 offset:96
    ds_read_b64_tr_b16 a[230:231], v4 offset:608
    v_mfma_f32_16x16x32_bf16 v[200:203], a[240:243], v[172:175], v[200:203]
    ds_read_b64_tr_b16 a[192:193], v4 offset:128
    ds_read_b64_tr_b16 a[194:195], v4 offset:640
    v_mfma_f32_16x16x32_bf16 v[160:163], a[200:203], a[8:11], v[196:199]
    ds_read_b64_tr_b16 a[196:197], v4 offset:160
    ds_read_b64_tr_b16 a[198:199], v4 offset:672
    v_mfma_f32_16x16x32_bf16 v[160:163], a[204:207], a[20:23], v[160:163]
    ds_read_b64_tr_b16 a[200:201], v4 offset:192
    ds_read_b64_tr_b16 a[202:203], v4 offset:704
    v_mfma_f32_16x16x32_bf16 v[160:163], a[208:211], a[32:35], v[160:163]
    v_cmp_nge_f32 vcc, s84, v203
    s_waitcnt vmcnt(18) lgkmcnt(10)
    s_barrier
    v_mfma_f32_16x16x32_bf16 v[160:163], a[212:215], a[44:47], v[160:163]
    s_cbranch_vccnz K_R1_8
K_R1_8_ret:
    ds_read_b64_tr_b16 a[204:205], v4 offset:224
    v_mfma_f32_16x16x32_bf16 v[28:31], a[216:219], v[172:175], v[28:31]
    v_exp_f32 v16, v140
    v_mfma_f32_16x16x32_bf16 v[24:27], a[216:219], v[168:171], v[24:27]
    ds_read_b64_tr_b16 a[206:207], v4 offset:736
    ds_read_b128 a[208:211], v7 offset:8448
    v_mfma_f32_16x16x32_bf16 v[20:23], a[216:219], v[164:167], v[20:23]
    v_exp_f32 v17, v141
    v_mfma_f32_16x16x32_bf16 v[32:35], a[220:223], v[164:167], v[32:35]
    s_add_u32 m0, s56, 0
    s_mov_b32 s57, 245760
    v_mfma_f32_16x16x32_bf16 v[36:39], a[220:223], v[168:171], v[36:39]
    v_exp_f32 v18, v142
    v_mfma_f32_16x16x32_bf16 v[40:43], a[220:223], v[172:175], v[40:43]
    ds_read_b128 a[212:215], v7 offset:8512
    s_waitcnt lgkmcnt(6)
    v_mfma_f32_16x16x32_bf16 v[52:55], a[224:227], v[172:175], v[52:55]
    ds_read_b128 a[216:219], v7 offset:8576
    v_cvt_pk_bf16_f32 v176, v16, v17
    v_mfma_f32_16x16x32_bf16 v[48:51], a[224:227], v[168:171], v[48:51]
    v_exp_f32 v19, v143
    v_mfma_f32_16x16x32_bf16 v[44:47], a[224:227], v[164:167], v[44:47]
    buffer_load_dwordx4 v8, s[28:31], s57 offen offset:0 nt lds
    v_mfma_f32_16x16x32_bf16 v[56:59], a[228:231], v[164:167], v[56:59]
    v_exp_f32 v16, v144
    v_mfma_f32_16x16x32_bf16 v[60:63], a[228:231], v[168:171], v[60:63]
    ds_read_b128 a[220:223], v7 offset:8640
    v_cvt_pk_bf16_f32 v177, v18, v19
    v_mfma_f32_16x16x32_bf16 v[64:67], a[228:231], v[172:175], v[64:67]
    v_exp_f32 v17, v145
    v_mfma_f32_16x16x32_bf16 v[76:79], a[192:195], v[172:175], v[76:79]
    buffer_load_dwordx4 v9, s[28:31], s57 offen offset:1056 nt lds
    v_mfma_f32_16x16x32_bf16 v[72:75], a[192:195], v[168:171], v[72:75]
    v_exp_f32 v18, v146
    v_mfma_f32_16x16x32_bf16 v[68:71], a[192:195], v[164:167], v[68:71]
    ds_read_b128 a[224:227], v7 offset:8960
    v_cvt_pk_bf16_f32 v180, v16, v17
    v_mfma_f32_16x16x32_bf16 v[80:83], a[196:199], v[164:167], v[80:83]
    v_exp_f32 v19, v147
    v_mfma_f32_16x16x32_bf16 v[84:87], a[196:199], v[168:171], v[84:87]
    v_exp_f32 v16, v148
    v_mfma_f32_16x16x32_bf16 v[88:91], a[196:199], v[172:175], v[88:91]
    v_cvt_pk_bf16_f32 v181, v18, v19
    s_waitcnt lgkmcnt(2)
    v_mfma_f32_16x16x32_bf16 v[100:103], a[200:203], v[172:175], v[100:103]
    ds_read_b128 a[228:231], v7 offset:9024
    ds_read_b128 a[192:195], v7 offset:9088
    v_mfma_f32_16x16x32_bf16 v[96:99], a[200:203], v[168:171], v[96:99]
    v_exp_f32 v17, v149
    v_mfma_f32_16x16x32_bf16 v[92:95], a[200:203], v[164:167], v[92:95]
    v_exp_f32 v18, v150
    v_mfma_f32_16x16x32_bf16 v[104:107], a[204:207], v[164:167], v[104:107]
    ds_read_b128 a[196:199], v7 offset:9152
    v_cvt_pk_bf16_f32 v184, v16, v17
    v_mfma_f32_16x16x32_bf16 v[108:111], a[204:207], v[168:171], v[108:111]
    v_exp_f32 v19, v151
    v_mfma_f32_16x16x32_bf16 v[112:115], a[204:207], v[172:175], v[112:115]
    v_exp_f32 v16, v152
    v_mfma_f32_16x16x32_bf16 v[116:119], a[208:211], a[0:3], v[188:191]
    ds_read_b64_tr_b16 a[200:201], v2 offset:8448
    v_cvt_pk_bf16_f32 v185, v18, v19
    v_mfma_f32_16x16x32_bf16 v[116:119], a[212:215], a[12:15], v[116:119]
    v_exp_f32 v17, v153
    v_mfma_f32_16x16x32_bf16 v[116:119], a[216:219], a[24:27], v[116:119]
    ds_read_b64_tr_b16 a[202:203], v2 offset:8960
    s_waitcnt lgkmcnt(5)
    v_mfma_f32_16x16x32_bf16 v[116:119], a[220:223], a[36:39], v[116:119]
    v_exp_f32 v18, v154
    v_mfma_f32_16x16x32_bf16 v[120:123], a[220:223], a[40:43], v[192:195]
    ds_read_b64_tr_b16 a[204:205], v2 offset:8480
    v_cvt_pk_bf16_f32 v178, v16, v17
    v_mfma_f32_16x16x32_bf16 v[120:123], a[216:219], a[28:31], v[120:123]
    v_exp_f32 v19, v155
    v_mfma_f32_16x16x32_bf16 v[120:123], a[212:215], a[16:19], v[120:123]
    ds_read_b64_tr_b16 a[206:207], v2 offset:8992
    v_mov_b32 v203, 0
    v_mfma_f32_16x16x32_bf16 v[120:123], a[208:211], a[4:7], v[120:123]
    v_exp_f32 v16, v156
    v_mfma_f32_16x16x32_bf16 v[124:127], a[208:211], a[8:11], v[196:199]
    ds_read_b64_tr_b16 a[208:209], v2 offset:8512
    v_cvt_pk_bf16_f32 v179, v18, v19
    v_mfma_f32_16x16x32_bf16 v[124:127], a[212:215], a[20:23], v[124:127]
    v_exp_f32 v17, v157
    v_mfma_f32_16x16x32_bf16 v[124:127], a[216:219], a[32:35], v[124:127]
    v_exp_f32 v18, v158
    v_mfma_f32_16x16x32_bf16 v[124:127], a[220:223], a[44:47], v[124:127]
    ds_read_b64_tr_b16 a[210:211], v2 offset:9024
    v_cvt_pk_bf16_f32 v182, v16, v17
    v_mfma_f32_16x16x32_bf16 v[128:131], a[224:227], a[0:3], v[188:191]
    ds_read_b64_tr_b16 a[212:213], v2 offset:8544
    s_waitcnt lgkmcnt(5)
    v_mfma_f32_16x16x32_bf16 v[128:131], a[228:231], a[12:15], v[128:131]
    v_exp_f32 v19, v159
    v_mfma_f32_16x16x32_bf16 v[128:131], a[192:195], a[24:27], v[128:131]
    s_add_u32 m0, s56, 76032
    s_mov_b32 s57, 253952
    v_mfma_f32_16x16x32_bf16 v[128:131], a[196:199], a[36:39], v[128:131]
    v_exp_f32 v16, v160
    v_mfma_f32_16x16x32_bf16 v[132:135], a[196:199], a[40:43], v[192:195]
    ds_read_b64_tr_b16 a[214:215], v2 offset:9056
    v_cvt_pk_bf16_f32 v183, v18, v19
    v_mfma_f32_16x16x32_bf16 v[132:135], a[192:195], a[28:31], v[132:135]
    v_exp_f32 v17, v161
    v_mfma_f32_16x16x32_bf16 v[132:135], a[228:231], a[16:19], v[132:135]
    v_exp_f32 v18, v162
    v_mfma_f32_16x16x32_bf16 v[132:135], a[224:227], a[4:7], v[132:135]
    v_cvt_pk_bf16_f32 v186, v16, v17
    v_exp_f32 v19, v163
    s_nop 0
    v_cvt_pk_bf16_f32 v187, v18, v19
    v_mfma_f32_16x16x32_bf16 v[204:207], a[232:235], v[176:179], v[200:203]
    ds_read_b64_tr_b16 a[216:217], v2 offset:8576
    ds_read_b64_tr_b16 a[218:219], v2 offset:9088
    v_mfma_f32_16x16x32_bf16 v[204:207], a[236:239], v[180:183], v[204:207]
    buffer_load_dwordx4 v8, s[28:31], s57 offen offset:0 nt lds
    v_mfma_f32_16x16x32_bf16 v[204:207], a[240:243], v[184:187], v[204:207]
    ds_read_b64_tr_b16 a[220:221], v2 offset:8608
    ds_read_b64_tr_b16 a[222:223], v2 offset:9120
    v_mfma_f32_16x16x32_bf16 v[136:139], a[224:227], a[8:11], v[196:199]
    ds_read_b64_tr_b16 a[224:225], v2 offset:8640
    ds_read_b64_tr_b16 a[226:227], v2 offset:9152
    v_mfma_f32_16x16x32_bf16 v[136:139], a[228:231], a[20:23], v[136:139]
    ds_read_b64_tr_b16 a[228:229], v2 offset:8672
    ds_read_b64_tr_b16 a[230:231], v2 offset:9184
    v_mfma_f32_16x16x32_bf16 v[136:139], a[192:195], a[32:35], v[136:139]
    ds_read_b128 a[192:195], v5 offset:16896
    v_cmp_nge_f32 vcc, s84, v207
    v_mfma_f32_16x16x32_bf16 v[136:139], a[196:199], a[44:47], v[136:139]
    s_cbranch_vccnz K_R1_9
K_R1_9_ret:
    ds_read_b128 a[196:199], v5 offset:16960
    v_mfma_f32_16x16x32_bf16 v[28:31], a[200:203], v[184:187], v[28:31]
    buffer_load_dwordx4 v9, s[28:31], s57 offen offset:1056 nt lds
    v_mfma_f32_16x16x32_bf16 v[24:27], a[200:203], v[180:183], v[24:27]
    v_exp_f32 v16, v116
    v_mfma_f32_16x16x32_bf16 v[20:23], a[200:203], v[176:179], v[20:23]
    ds_read_b128 a[200:203], v5 offset:17024
    s_waitcnt lgkmcnt(9)
    v_mfma_f32_16x16x32_bf16 v[32:35], a[204:207], v[176:179], v[32:35]
    v_exp_f32 v17, v117
    v_mfma_f32_16x16x32_bf16 v[36:39], a[204:207], v[180:183], v[36:39]
    v_exp_f32 v18, v118
    v_mfma_f32_16x16x32_bf16 v[40:43], a[204:207], v[184:187], v[40:43]
    ds_read_b128 a[204:207], v5 offset:17088
    v_cvt_pk_bf16_f32 v164, v16, v17
    v_mfma_f32_16x16x32_bf16 v[52:55], a[208:211], v[184:187], v[52:55]
    v_exp_f32 v19, v119
    v_mfma_f32_16x16x32_bf16 v[48:51], a[208:211], v[180:183], v[48:51]
    v_exp_f32 v16, v120
    v_mfma_f32_16x16x32_bf16 v[44:47], a[208:211], v[176:179], v[44:47]
    ds_read_b128 a[208:211], v5 offset:17408
    v_cvt_pk_bf16_f32 v165, v18, v19
    v_mfma_f32_16x16x32_bf16 v[56:59], a[212:215], v[176:179], v[56:59]
    v_exp_f32 v17, v121
    v_mfma_f32_16x16x32_bf16 v[60:63], a[212:215], v[180:183], v[60:63]
    v_exp_f32 v18, v122
    v_mfma_f32_16x16x32_bf16 v[64:67], a[212:215], v[184:187], v[64:67]
    ds_read_b128 a[212:215], v5 offset:17472
    v_cvt_pk_bf16_f32 v168, v16, v17
    v_mfma_f32_16x16x32_bf16 v[76:79], a[216:219], v[184:187], v[76:79]
    v_exp_f32 v19, v123
    v_mfma_f32_16x16x32_bf16 v[72:75], a[216:219], v[180:183], v[72:75]
    v_exp_f32 v16, v124
    v_mfma_f32_16x16x32_bf16 v[68:71], a[216:219], v[176:179], v[68:71]
    v_cvt_pk_bf16_f32 v169, v18, v19
    s_waitcnt lgkmcnt(2)
    v_mfma_f32_16x16x32_bf16 v[80:83], a[220:223], v[176:179], v[80:83]
    v_exp_f32 v17, v125
    v_mfma_f32_16x16x32_bf16 v[84:87], a[220:223], v[180:183], v[84:87]
    v_exp_f32 v18, v126
    v_mfma_f32_16x16x32_bf16 v[88:91], a[220:223], v[184:187], v[88:91]
    ds_read_b128 a[216:219], v5 offset:17536
    v_cvt_pk_bf16_f32 v172, v16, v17
    v_mfma_f32_16x16x32_bf16 v[100:103], a[224:227], v[184:187], v[100:103]
    v_exp_f32 v19, v127
    v_mfma_f32_16x16x32_bf16 v[96:99], a[224:227], v[180:183], v[96:99]
    v_exp_f32 v16, v128
    v_mfma_f32_16x16x32_bf16 v[92:95], a[224:227], v[176:179], v[92:95]
    ds_read_b128 a[220:223], v5 offset:17600
    v_cvt_pk_bf16_f32 v173, v18, v19
    v_mfma_f32_16x16x32_bf16 v[104:107], a[228:231], v[176:179], v[104:107]
    v_exp_f32 v17, v129
    v_mfma_f32_16x16x32_bf16 v[108:111], a[228:231], v[180:183], v[108:111]
    v_exp_f32 v18, v130
    v_mfma_f32_16x16x32_bf16 v[112:115], a[228:231], v[184:187], v[112:115]
    ds_read_b64_tr_b16 a[224:225], v2 offset:50688
    ds_read_b64_tr_b16 a[226:227], v2 offset:51200
    v_mfma_f32_16x16x32_bf16 v[140:143], a[192:195], a[0:3], v[188:191]
    ds_read_b64_tr_b16 a[228:229], v2 offset:50720
    v_cvt_pk_bf16_f32 v166, v16, v17
    v_mfma_f32_16x16x32_bf16 v[140:143], a[196:199], a[12:15], v[140:143]
    v_exp_f32 v19, v131
    v_mfma_f32_16x16x32_bf16 v[140:143], a[200:203], a[24:27], v[140:143]
    ds_read_b64_tr_b16 a[230:231], v2 offset:51232
    v_mov_b32 v207, 0
    v_mfma_f32_16x16x32_bf16 v[140:143], a[204:207], a[36:39], v[140:143]
    v_exp_f32 v16, v132
    v_mfma_f32_16x16x32_bf16 v[144:147], a[204:207], a[40:43], v[192:195]
    v_cvt_pk_bf16_f32 v167, v18, v19
    v_mfma_f32_16x16x32_bf16 v[144:147], a[200:203], a[28:31], v[144:147]
    v_exp_f32 v17, v133
    v_mfma_f32_16x16x32_bf16 v[144:147], a[196:199], a[16:19], v[144:147]
    v_exp_f32 v18, v134
    v_mfma_f32_16x16x32_bf16 v[144:147], a[192:195], a[4:7], v[144:147]
    v_cvt_pk_bf16_f32 v170, v16, v17
    v_mfma_f32_16x16x32_bf16 v[148:151], a[192:195], a[8:11], v[196:199]
    v_exp_f32 v19, v135
    v_mfma_f32_16x16x32_bf16 v[148:151], a[196:199], a[20:23], v[148:151]
    v_exp_f32 v16, v136
    v_mfma_f32_16x16x32_bf16 v[148:151], a[200:203], a[32:35], v[148:151]
    ds_read_b64_tr_b16 a[192:193], v2 offset:50752
    v_cvt_pk_bf16_f32 v171, v18, v19
    v_mfma_f32_16x16x32_bf16 v[148:151], a[204:207], a[44:47], v[148:151]
    ds_read_b64_tr_b16 a[194:195], v2 offset:51264
    s_waitcnt lgkmcnt(2)
    v_mfma_f32_16x16x32_bf16 v[152:155], a[208:211], a[0:3], v[188:191]
    v_exp_f32 v17, v137
    v_mfma_f32_16x16x32_bf16 v[152:155], a[212:215], a[12:15], v[152:155]
    ds_read_b64_tr_b16 a[196:197], v2 offset:50784
    ds_read_b64_tr_b16 a[198:199], v2 offset:51296
    v_mfma_f32_16x16x32_bf16 v[152:155], a[216:219], a[24:27], v[152:155]
    v_exp_f32 v18, v138
    v_mfma_f32_16x16x32_bf16 v[152:155], a[220:223], a[36:39], v[152:155]
    ds_read_b64_tr_b16 a[200:201], v2 offset:50816
    ds_read_b64_tr_b16 a[202:203], v2 offset:51328
    v_mfma_f32_16x16x32_bf16 v[156:159], a[220:223], a[40:43], v[192:195]
    ds_read_b64_tr_b16 a[204:205], v2 offset:50848
    ds_read_b64_tr_b16 a[206:207], v2 offset:51360
    v_mfma_f32_16x16x32_bf16 v[156:159], a[216:219], a[28:31], v[156:159]
    v_cvt_pk_bf16_f32 v174, v16, v17
    v_mfma_f32_16x16x32_bf16 v[156:159], a[212:215], a[16:19], v[156:159]
    v_exp_f32 v19, v139
    v_mfma_f32_16x16x32_bf16 v[156:159], a[208:211], a[4:7], v[156:159]
    v_cvt_pk_bf16_f32 v175, v18, v19
    v_mfma_f32_16x16x32_bf16 v[200:203], a[232:235], v[164:167], v[204:207]
    v_mfma_f32_16x16x32_bf16 v[200:203], a[236:239], v[168:171], v[200:203]
    v_mfma_f32_16x16x32_bf16 v[200:203], a[240:243], v[172:175], v[200:203]
    s_nop 1
    v_mfma_f32_16x16x32_bf16 v[160:163], a[208:211], a[8:11], v[196:199]
    ds_read_b64_tr_b16 a[208:209], v2 offset:50880
    ds_read_b64_tr_b16 a[210:211], v2 offset:51392
    v_mfma_f32_16x16x32_bf16 v[160:163], a[212:215], a[20:23], v[160:163]
    ds_read_b64_tr_b16 a[212:213], v2 offset:50912
    ds_read_b64_tr_b16 a[214:215], v2 offset:51424
    v_mfma_f32_16x16x32_bf16 v[160:163], a[216:219], a[32:35], v[160:163]
    v_cmp_nge_f32 vcc, s84, v203
    s_waitcnt vmcnt(13) lgkmcnt(4)
    s_barrier
    v_mfma_f32_16x16x32_bf16 v[160:163], a[220:223], a[44:47], v[160:163]
    s_cbranch_vccnz K_R1_10
K_R1_10_ret:
    ds_read_b128 a[216:219], v6 offset:59136
    v_mfma_f32_16x16x32_bf16 v[28:31], a[224:227], v[172:175], v[28:31]
    v_exp_f32 v16, v140
    v_mfma_f32_16x16x32_bf16 v[24:27], a[224:227], v[168:171], v[24:27]
    v_exp_f32 v17, v141
    v_mfma_f32_16x16x32_bf16 v[20:23], a[224:227], v[164:167], v[20:23]
    v_exp_f32 v18, v142
    v_mfma_f32_16x16x32_bf16 v[32:35], a[228:231], v[164:167], v[32:35]
    ds_read_b128 a[220:223], v6 offset:59200
    v_cvt_pk_bf16_f32 v176, v16, v17
    v_mfma_f32_16x16x32_bf16 v[36:39], a[228:231], v[168:171], v[36:39]
    v_exp_f32 v19, v143
    v_mfma_f32_16x16x32_bf16 v[40:43], a[228:231], v[172:175], v[40:43]
    ds_read_b128 a[224:227], v6 offset:59264
    ds_read_b128 a[228:231], v6 offset:59328
    v_mfma_f32_16x16x32_bf16 v[52:55], a[192:195], v[172:175], v[52:55]
    v_exp_f32 v16, v144
    v_mfma_f32_16x16x32_bf16 v[48:51], a[192:195], v[168:171], v[48:51]
    v_cvt_pk_bf16_f32 v177, v18, v19
    v_mov_b32 v203, 0
    v_mfma_f32_16x16x32_bf16 v[44:47], a[192:195], v[164:167], v[44:47]
    v_exp_f32 v17, v145
    v_mfma_f32_16x16x32_bf16 v[56:59], a[196:199], v[164:167], v[56:59]
    v_exp_f32 v18, v146
    v_mfma_f32_16x16x32_bf16 v[60:63], a[196:199], v[168:171], v[60:63]
    ds_read_b128 a[192:195], v6 offset:59648
    v_cvt_pk_bf16_f32 v180, v16, v17
    v_mfma_f32_16x16x32_bf16 v[64:67], a[196:199], v[172:175], v[64:67]
    v_exp_f32 v19, v147
    v_mfma_f32_16x16x32_bf16 v[76:79], a[200:203], v[172:175], v[76:79]
    v_exp_f32 v16, v148
    v_mfma_f32_16x16x32_bf16 v[72:75], a[200:203], v[168:171], v[72:75]
    ds_read_b128 a[196:199], v6 offset:59712
    v_cvt_pk_bf16_f32 v181, v18, v19
    v_mfma_f32_16x16x32_bf16 v[68:71], a[200:203], v[164:167], v[68:71]
    v_exp_f32 v17, v149
    v_mfma_f32_16x16x32_bf16 v[80:83], a[204:207], v[164:167], v[80:83]
    v_exp_f32 v18, v150
    v_mfma_f32_16x16x32_bf16 v[84:87], a[204:207], v[168:171], v[84:87]
    ds_read_b128 a[200:203], v6 offset:59776
    v_cvt_pk_bf16_f32 v184, v16, v17
    v_mfma_f32_16x16x32_bf16 v[88:91], a[204:207], v[172:175], v[88:91]
    ds_read_b128 a[204:207], v6 offset:59840
    s_waitcnt lgkmcnt(4)
    v_mfma_f32_16x16x32_bf16 v[100:103], a[208:211], v[172:175], v[100:103]
    v_exp_f32 v19, v151
    v_mfma_f32_16x16x32_bf16 v[96:99], a[208:211], v[168:171], v[96:99]
    v_exp_f32 v16, v152
    v_mfma_f32_16x16x32_bf16 v[92:95], a[208:211], v[164:167], v[92:95]
    ds_read_b64_tr_b16 a[208:209], v2 offset:25344
    v_cvt_pk_bf16_f32 v185, v18, v19
    v_mfma_f32_16x16x32_bf16 v[104:107], a[212:215], v[164:167], v[104:107]
    v_exp_f32 v17, v153
    v_mfma_f32_16x16x32_bf16 v[108:111], a[212:215], v[168:171], v[108:111]
    v_exp_f32 v18, v154
    v_mfma_f32_16x16x32_bf16 v[112:115], a[212:215], v[172:175], v[112:115]
    ds_read_b64_tr_b16 a[210:211], v2 offset:25856
    v_cvt_pk_bf16_f32 v178, v16, v17
    v_mfma_f32_16x16x32_bf16 v[116:119], a[216:219], a[0:3], v[188:191]
    s_waitcnt vmcnt(6)
    v_cmp_gt_u32 vcc, 64, v14
    s_and_b32 s87, vcc_lo, s79
    s_cbranch_scc1 K_PA
K_PA_ret:
    v_mfma_f32_16x16x32_bf16 v[116:119], a[220:223], a[12:15], v[116:119]
    v_exp_f32 v19, v155
    v_mfma_f32_16x16x32_bf16 v[116:119], a[224:227], a[24:27], v[116:119]
    ds_read_b64_tr_b16 a[212:213], v2 offset:25376
    ds_read_b64_tr_b16 a[214:215], v2 offset:25888
    v_mfma_f32_16x16x32_bf16 v[116:119], a[228:231], a[36:39], v[116:119]
    v_exp_f32 v16, v156
    v_mfma_f32_16x16x32_bf16 v[120:123], a[228:231], a[40:43], v[192:195]
    v_cvt_pk_bf16_f32 v179, v18, v19
    v_mfma_f32_16x16x32_bf16 v[120:123], a[224:227], a[28:31], v[120:123]
    v_exp_f32 v17, v157
    v_mfma_f32_16x16x32_bf16 v[120:123], a[220:223], a[16:19], v[120:123]
    s_add_u32 s10, s66, 0
    buffer_load_dwordx4 a[48:51], v12, s[44:47], s10 offen offset:0 sc1
    v_mfma_f32_16x16x32_bf16 v[120:123], a[216:219], a[4:7], v[120:123]
    v_exp_f32 v18, v158
    v_mfma_f32_16x16x32_bf16 v[124:127], a[216:219], a[8:11], v[196:199]
    ds_read_b64_tr_b16 a[216:217], v2 offset:25408
    v_cvt_pk_bf16_f32 v182, v16, v17
    v_mfma_f32_16x16x32_bf16 v[124:127], a[220:223], a[20:23], v[124:127]
    v_exp_f32 v19, v159
    v_mfma_f32_16x16x32_bf16 v[124:127], a[224:227], a[32:35], v[124:127]
    v_exp_f32 v16, v160
    v_mfma_f32_16x16x32_bf16 v[124:127], a[228:231], a[44:47], v[124:127]
    v_cvt_pk_bf16_f32 v183, v18, v19
    s_waitcnt lgkmcnt(1)
    v_mfma_f32_16x16x32_bf16 v[128:131], a[192:195], a[0:3], v[188:191]
    ds_read_b64_tr_b16 a[218:219], v2 offset:25920
    ds_read_b64_tr_b16 a[220:221], v2 offset:25440
    v_mfma_f32_16x16x32_bf16 v[128:131], a[196:199], a[12:15], v[128:131]
    v_exp_f32 v17, v161
    v_mfma_f32_16x16x32_bf16 v[128:131], a[200:203], a[24:27], v[128:131]
    ds_read_b64_tr_b16 a[222:223], v2 offset:25952
    ds_read_b64_tr_b16 a[224:225], v2 offset:25472
    v_mfma_f32_16x16x32_bf16 v[128:131], a[204:207], a[36:39], v[128:131]
    v_exp_f32 v18, v162
    v_mfma_f32_16x16x32_bf16 v[132:135], a[204:207], a[40:43], v[192:195]
    ds_read_b64_tr_b16 a[226:227], v2 offset:25984
    ds_read_b64_tr_b16 a[228:229], v2 offset:25504
    v_mfma_f32_16x16x32_bf16 v[132:135], a[200:203], a[28:31], v[132:135]
    ds_read_b64_tr_b16 a[230:231], v2 offset:26016
    v_cvt_pk_bf16_f32 v186, v16, v17
    v_mfma_f32_16x16x32_bf16 v[132:135], a[196:199], a[16:19], v[132:135]
    buffer_load_dwordx4 a[52:55], v12, s[44:47], s10 offen offset:1024 sc1
    v_mfma_f32_16x16x32_bf16 v[132:135], a[192:195], a[4:7], v[132:135]
    v_exp_f32 v19, v163
    s_nop 0
    v_cvt_pk_bf16_f32 v187, v18, v19
    v_mfma_f32_16x16x32_bf16 v[204:207], a[232:235], v[176:179], v[200:203]
    v_mfma_f32_16x16x32_bf16 v[204:207], a[236:239], v[180:183], v[204:207]
    v_mfma_f32_16x16x32_bf16 v[204:207], a[240:243], v[184:187], v[204:207]
    buffer_load_dwordx4 a[56:59], v12, s[44:47], s10 offen offset:2048 sc1
    v_mfma_f32_16x16x32_bf16 v[136:139], a[192:195], a[8:11], v[196:199]
    ds_read_b64_tr_b16 a[192:193], v2 offset:25536
    ds_read_b64_tr_b16 a[194:195], v2 offset:26048
    v_mfma_f32_16x16x32_bf16 v[136:139], a[196:199], a[20:23], v[136:139]
    ds_read_b64_tr_b16 a[196:197], v2 offset:25568
    ds_read_b64_tr_b16 a[198:199], v2 offset:26080
    v_mfma_f32_16x16x32_bf16 v[136:139], a[200:203], a[32:35], v[136:139]
    ds_read_b128 a[200:203], v5 offset:33792
    v_cmp_nge_f32 vcc, s84, v207
    v_mfma_f32_16x16x32_bf16 v[136:139], a[204:207], a[44:47], v[136:139]
    s_cbranch_vccnz K_R1_11
K_R1_11_ret:
    ds_read_b128 a[204:207], v5 offset:33856
    v_mfma_f32_16x16x32_bf16 v[28:31], a[208:211], v[184:187], v[28:31]
    v_exp_f32 v16, v116
    v_mfma_f32_16x16x32_bf16 v[24:27], a[208:211], v[180:183], v[24:27]
    buffer_load_dwordx4 a[60:63], v12, s[44:47], s10 offen offset:3072 sc1
    v_mfma_f32_16x16x32_bf16 v[20:23], a[208:211], v[176:179], v[20:23]
    v_exp_f32 v17, v117
    v_mfma_f32_16x16x32_bf16 v[32:35], a[212:215], v[176:179], v[32:35]
    v_exp_f32 v18, v118
    v_mfma_f32_16x16x32_bf16 v[36:39], a[212:215], v[180:183], v[36:39]
    ds_read_b128 a[208:211], v5 offset:33920
    v_cvt_pk_bf16_f32 v164, v16, v17
    v_mfma_f32_16x16x32_bf16 v[40:43], a[212:215], v[184:187], v[40:43]
    ds_read_b128 a[212:215], v5 offset:33984
    s_waitcnt lgkmcnt(6)
    v_mfma_f32_16x16x32_bf16 v[52:55], a[216:219], v[184:187], v[52:55]
    v_exp_f32 v19, v119
    v_mfma_f32_16x16x32_bf16 v[48:51], a[216:219], v[180:183], v[48:51]
    v_exp_f32 v16, v120
    v_mfma_f32_16x16x32_bf16 v[44:47], a[216:219], v[176:179], v[44:47]
    s_add_u32 s10, s66, 4096
    buffer_load_dwordx4 a[64:67], v12, s[44:47], s10 offen offset:0 sc1
    v_mfma_f32_16x16x32_bf16 v[56:59], a[220:223], v[176:179], v[56:59]
    ds_read_b128 a[216:219], v5 offset:34304
    v_cvt_pk_bf16_f32 v165, v18, v19
    v_mfma_f32_16x16x32_bf16 v[60:63], a[220:223], v[180:183], v[60:63]
    v_exp_f32 v17, v121
    v_mfma_f32_16x16x32_bf16 v[64:67], a[220:223], v[184:187], v[64:67]
    v_exp_f32 v18, v122
    v_mfma_f32_16x16x32_bf16 v[76:79], a[224:227], v[184:187], v[76:79]
    ds_read_b128 a[220:223], v5 offset:34368
    v_cvt_pk_bf16_f32 v168, v16, v17
    v_mfma_f32_16x16x32_bf16 v[72:75], a[224:227], v[180:183], v[72:75]
    v_exp_f32 v19, v123
    v_mfma_f32_16x16x32_bf16 v[68:71], a[224:227], v[176:179], v[68:71]
    v_exp_f32 v16, v124
    v_mfma_f32_16x16x32_bf16 v[80:83], a[228:231], v[176:179], v[80:83]
    ds_read_b128 a[224:227], v5 offset:34432
    v_cvt_pk_bf16_f32 v169, v18, v19
    v_mfma_f32_16x16x32_bf16 v[84:87], a[228:231], v[180:183], v[84:87]
    v_exp_f32 v17, v125
    v_mfma_f32_16x16x32_bf16 v[88:91], a[228:231], v[184:187], v[88:91]
    v_exp_f32 v18, v126
    v_mfma_f32_16x16x32_bf16 v[100:103], a[192:195], v[184:187], v[100:103]
    buffer_load_dwordx4 a[68:71], v12, s[44:47], s10 offen offset:1024 sc1
    v_mfma_f32_16x16x32_bf16 v[96:99], a[192:195], v[180:183], v[96:99]
    ds_read_b128 a[228:231], v5 offset:34496
    v_cvt_pk_bf16_f32 v172, v16, v17
    v_mfma_f32_16x16x32_bf16 v[92:95], a[192:195], v[176:179], v[92:95]
    ds_read_b64_tr_b16 a[192:193], v3 offset:16896
    s_waitcnt lgkmcnt(4)
    v_mfma_f32_16x16x32_bf16 v[104:107], a[196:199], v[176:179], v[104:107]
    v_exp_f32 v19, v127
    v_mfma_f32_16x16x32_bf16 v[108:111], a[196:199], v[180:183], v[108:111]
    v_exp_f32 v16, v128
    v_mfma_f32_16x16x32_bf16 v[112:115], a[196:199], v[184:187], v[112:115]
    ds_read_b64_tr_b16 a[194:195], v3 offset:17408
    v_cvt_pk_bf16_f32 v173, v18, v19
    v_mfma_f32_16x16x32_bf16 v[140:143], a[200:203], a[0:3], v[188:191]
    v_exp_f32 v17, v129
    v_mfma_f32_16x16x32_bf16 v[140:143], a[204:207], a[12:15], v[140:143]
    buffer_load_dwordx4 a[72:75], v12, s[44:47], s10 offen offset:2048 sc1
    v_mfma_f32_16x16x32_bf16 v[140:143], a[208:211], a[24:27], v[140:143]
    v_exp_f32 v18, v130
    v_mfma_f32_16x16x32_bf16 v[140:143], a[212:215], a[36:39], v[140:143]
    ds_read_b64_tr_b16 a[196:197], v3 offset:16928
    v_cvt_pk_bf16_f32 v166, v16, v17
    v_mfma_f32_16x16x32_bf16 v[144:147], a[212:215], a[40:43], v[192:195]
    v_exp_f32 v19, v131
    v_mfma_f32_16x16x32_bf16 v[144:147], a[208:211], a[28:31], v[144:147]
    ds_read_b64_tr_b16 a[198:199], v3 offset:17440
    v_mov_b32 v207, 0
    v_mfma_f32_16x16x32_bf16 v[144:147], a[204:207], a[16:19], v[144:147]
    v_exp_f32 v16, v132
    v_mfma_f32_16x16x32_bf16 v[144:147], a[200:203], a[4:7], v[144:147]
    v_cvt_pk_bf16_f32 v167, v18, v19
    v_mfma_f32_16x16x32_bf16 v[148:151], a[200:203], a[8:11], v[196:199]
    v_exp_f32 v17, v133
    v_mfma_f32_16x16x32_bf16 v[148:151], a[204:207], a[20:23], v[148:151]
    buffer_load_dwordx4 a[76:79], v12, s[44:47], s10 offen offset:3072 sc1
    v_mfma_f32_16x16x32_bf16 v[148:151], a[208:211], a[32:35], v[148:151]
    v_exp_f32 v18, v134
    v_mfma_f32_16x16x32_bf16 v[148:151], a[212:215], a[44:47], v[148:151]
    ds_read_b64_tr_b16 a[200:201], v3 offset:16960
    v_cvt_pk_bf16_f32 v170, v16, v17
    v_mfma_f32_16x16x32_bf16 v[152:155], a[216:219], a[0:3], v[188:191]
    ds_read_b64_tr_b16 a[202:203], v3 offset:17472
    s_waitcnt lgkmcnt(3)
    v_mfma_f32_16x16x32_bf16 v[152:155], a[220:223], a[12:15], v[152:155]
    v_exp_f32 v19, v135
    v_mfma_f32_16x16x32_bf16 v[152:155], a[224:227], a[24:27], v[152:155]
    v_exp_f32 v16, v136
    v_mfma_f32_16x16x32_bf16 v[152:155], a[228:231], a[36:39], v[152:155]
    s_add_u32 s10, s66, 8192
    buffer_load_dwordx4 a[80:83], v12, s[44:47], s10 offen offset:0 sc1
    v_cvt_pk_bf16_f32 v171, v18, v19
    v_mfma_f32_16x16x32_bf16 v[156:159], a[228:231], a[40:43], v[192:195]
    v_exp_f32 v17, v137
    v_mfma_f32_16x16x32_bf16 v[156:159], a[224:227], a[28:31], v[156:159]
    ds_read_b64_tr_b16 a[204:205], v3 offset:16992
    ds_read_b64_tr_b16 a[206:207], v3 offset:17504
    v_mfma_f32_16x16x32_bf16 v[156:159], a[220:223], a[16:19], v[156:159]
    v_exp_f32 v18, v138
    v_mfma_f32_16x16x32_bf16 v[156:159], a[216:219], a[4:7], v[156:159]
    v_cvt_pk_bf16_f32 v174, v16, v17
    v_exp_f32 v19, v139
    s_nop 0
    v_cvt_pk_bf16_f32 v175, v18, v19
    v_mfma_f32_16x16x32_bf16 v[200:203], a[232:235], v[164:167], v[204:207]
    ds_read_b64_tr_b16 a[208:209], v3 offset:17024
    ds_read_b64_tr_b16 a[210:211], v3 offset:17536
    v_mfma_f32_16x16x32_bf16 v[200:203], a[236:239], v[168:171], v[200:203]
    ds_read_b64_tr_b16 a[212:213], v3 offset:17056
    ds_read_b64_tr_b16 a[214:215], v3 offset:17568
    v_mfma_f32_16x16x32_bf16 v[200:203], a[240:243], v[172:175], v[200:203]
    buffer_load_dwordx4 a[84:87], v12, s[44:47], s10 offen offset:1024 sc1
    v_mfma_f32_16x16x32_bf16 v[160:163], a[216:219], a[8:11], v[196:199]
    ds_read_b64_tr_b16 a[216:217], v3 offset:17088
    ds_read_b64_tr_b16 a[218:219], v3 offset:17600
    v_mfma_f32_16x16x32_bf16 v[160:163], a[220:223], a[20:23], v[160:163]
    ds_read_b64_tr_b16 a[220:221], v3 offset:17120
    ds_read_b64_tr_b16 a[222:223], v3 offset:17632
    v_mfma_f32_16x16x32_bf16 v[160:163], a[224:227], a[32:35], v[160:163]
    v_cmp_nge_f32 vcc, s84, v203
    s_waitcnt vmcnt(12) lgkmcnt(10)
    s_barrier
    v_mfma_f32_16x16x32_bf16 v[160:163], a[228:231], a[44:47], v[160:163]
    s_cbranch_vccnz K_R1_12
K_R1_12_ret:
    ds_read_b128 a[224:227], v5 offset:42240
    v_mfma_f32_16x16x32_bf16 v[28:31], a[192:195], v[172:175], v[28:31]
    v_exp_f32 v16, v140
    v_mfma_f32_16x16x32_bf16 v[24:27], a[192:195], v[168:171], v[24:27]
    buffer_load_dwordx4 a[88:91], v12, s[44:47], s10 offen offset:2048 sc1
    v_mfma_f32_16x16x32_bf16 v[20:23], a[192:195], v[164:167], v[20:23]
    v_exp_f32 v17, v141
    v_mfma_f32_16x16x32_bf16 v[32:35], a[196:199], v[164:167], v[32:35]
    v_exp_f32 v18, v142
    v_mfma_f32_16x16x32_bf16 v[36:39], a[196:199], v[168:171], v[36:39]
    ds_read_b128 a[228:231], v5 offset:42304
    v_cvt_pk_bf16_f32 v176, v16, v17
    v_mfma_f32_16x16x32_bf16 v[40:43], a[196:199], v[172:175], v[40:43]
    s_add_u32 m0, s56, 8448
    s_add_u32 s57, s61, 0
    v_mfma_f32_16x16x32_bf16 v[52:55], a[200:203], v[172:175], v[52:55]
    v_exp_f32 v19, v143
    v_mfma_f32_16x16x32_bf16 v[48:51], a[200:203], v[168:171], v[48:51]
    ds_read_b128 a[192:195], v5 offset:42368
    ds_read_b128 a[196:199], v5 offset:42432
    v_mfma_f32_16x16x32_bf16 v[44:47], a[200:203], v[164:167], v[44:47]
    ds_read_b128 a[200:203], v5 offset:42752
    s_waitcnt lgkmcnt(4)
    v_mfma_f32_16x16x32_bf16 v[56:59], a[204:207], v[164:167], v[56:59]
    v_exp_f32 v16, v144
    v_mfma_f32_16x16x32_bf16 v[60:63], a[204:207], v[168:171], v[60:63]
    buffer_load_dwordx4 v10, s[40:43], s57 offen offset:0 lds
    v_mfma_f32_16x16x32_bf16 v[64:67], a[204:207], v[172:175], v[64:67]
    ds_read_b128 a[204:207], v5 offset:42816
    v_cvt_pk_bf16_f32 v177, v18, v19
    v_mfma_f32_16x16x32_bf16 v[76:79], a[208:211], v[172:175], v[76:79]
    v_exp_f32 v17, v145
    v_mfma_f32_16x16x32_bf16 v[72:75], a[208:211], v[168:171], v[72:75]
    v_exp_f32 v18, v146
    v_mfma_f32_16x16x32_bf16 v[68:71], a[208:211], v[164:167], v[68:71]
    buffer_load_dwordx4 a[92:95], v12, s[44:47], s10 offen offset:3072 sc1
    v_mfma_f32_16x16x32_bf16 v[80:83], a[212:215], v[164:167], v[80:83]
    ds_read_b128 a[208:211], v5 offset:42880
    v_cvt_pk_bf16_f32 v180, v16, v17
    v_mfma_f32_16x16x32_bf16 v[84:87], a[212:215], v[168:171], v[84:87]
    v_exp_f32 v19, v147
    v_mfma_f32_16x16x32_bf16 v[88:91], a[212:215], v[172:175], v[88:91]
    v_exp_f32 v16, v148
    v_mfma_f32_16x16x32_bf16 v[100:103], a[216:219], v[172:175], v[100:103]
    buffer_load_dwordx4 v11, s[40:43], s57 offen offset:1056 lds
    v_mfma_f32_16x16x32_bf16 v[96:99], a[216:219], v[168:171], v[96:99]
    ds_read_b128 a[212:215], v5 offset:42944
    v_cvt_pk_bf16_f32 v181, v18, v19
    v_mfma_f32_16x16x32_bf16 v[92:95], a[216:219], v[164:167], v[92:95]
    v_exp_f32 v17, v149
    v_mfma_f32_16x16x32_bf16 v[104:107], a[220:223], v[164:167], v[104:107]
    v_exp_f32 v18, v150
    v_mfma_f32_16x16x32_bf16 v[108:111], a[220:223], v[168:171], v[108:111]
    s_add_u32 s10, s67, 0
    buffer_load_dwordx4 a[96:99], v12, s[44:47], s10 offen offset:0 sc1
    v_mfma_f32_16x16x32_bf16 v[112:115], a[220:223], v[172:175], v[112:115]
    ds_read_b64_tr_b16 a[216:217], v2 offset:59136
    v_cvt_pk_bf16_f32 v184, v16, v17
    v_mfma_f32_16x16x32_bf16 v[116:119], a[224:227], a[0:3], v[188:191]
    ds_read_b64_tr_b16 a[218:219], v2 offset:59648
    s_waitcnt lgkmcnt(3)
    v_mfma_f32_16x16x32_bf16 v[116:119], a[228:231], a[12:15], v[116:119]
    v_exp_f32 v19, v151
    v_mfma_f32_16x16x32_bf16 v[116:119], a[192:195], a[24:27], v[116:119]
    s_add_u32 m0, s56, 16896
    s_add_u32 s57, s61, 65536
    v_mfma_f32_16x16x32_bf16 v[116:119], a[196:199], a[36:39], v[116:119]
    v_exp_f32 v16, v152
    v_mfma_f32_16x16x32_bf16 v[120:123], a[196:199], a[40:43], v[192:195]
    buffer_load_dwordx4 a[100:103], v12, s[44:47], s10 offen offset:1024 sc1
    v_cvt_pk_bf16_f32 v185, v18, v19
    v_mfma_f32_16x16x32_bf16 v[120:123], a[192:195], a[28:31], v[120:123]
    v_exp_f32 v17, v153
    v_mfma_f32_16x16x32_bf16 v[120:123], a[228:231], a[16:19], v[120:123]
    v_exp_f32 v18, v154
    v_mfma_f32_16x16x32_bf16 v[120:123], a[224:227], a[4:7], v[120:123]
    ds_read_b64_tr_b16 a[220:221], v2 offset:59168
    v_cvt_pk_bf16_f32 v178, v16, v17
    v_mfma_f32_16x16x32_bf16 v[124:127], a[224:227], a[8:11], v[196:199]
    buffer_load_dwordx4 v10, s[40:43], s57 offen offset:0 lds
    v_mfma_f32_16x16x32_bf16 v[124:127], a[228:231], a[20:23], v[124:127]
    v_exp_f32 v19, v155
    v_mfma_f32_16x16x32_bf16 v[124:127], a[192:195], a[32:35], v[124:127]
    ds_read_b64_tr_b16 a[222:223], v2 offset:59680
    v_mov_b32 v203, 0
    v_mfma_f32_16x16x32_bf16 v[124:127], a[196:199], a[44:47], v[124:127]
    v_exp_f32 v16, v156
    v_mfma_f32_16x16x32_bf16 v[128:131], a[200:203], a[0:3], v[188:191]
    buffer_load_dwordx4 v11, s[40:43], s57 offen offset:1056 lds
    v_mfma_f32_16x16x32_bf16 v[128:131], a[204:207], a[12:15], v[128:131]
    ds_read_b64_tr_b16 a[224:225], v2 offset:59200
    v_cvt_pk_bf16_f32 v179, v18, v19
    v_mfma_f32_16x16x32_bf16 v[128:131], a[208:211], a[24:27], v[128:131]
    buffer_load_dwordx4 a[104:107], v12, s[44:47], s10 offen offset:2048 sc1
    s_waitcnt lgkmcnt(3)
    v_mfma_f32_16x16x32_bf16 v[128:131], a[212:215], a[36:39], v[128:131]
    v_exp_f32 v17, v157
    v_mfma_f32_16x16x32_bf16 v[132:135], a[212:215], a[40:43], v[192:195]
    v_exp_f32 v18, v158
    v_mfma_f32_16x16x32_bf16 v[132:135], a[208:211], a[28:31], v[132:135]
    ds_read_b64_tr_b16 a[226:227], v2 offset:59712
    v_cvt_pk_bf16_f32 v182, v16, v17
    v_mfma_f32_16x16x32_bf16 v[132:135], a[204:207], a[16:19], v[132:135]
    v_exp_f32 v19, v159
    v_exp_f32 v16, v160
    v_cvt_pk_bf16_f32 v183, v18, v19
    v_mfma_f32_16x16x32_bf16 v[132:135], a[200:203], a[4:7], v[132:135]
    v_exp_f32 v17, v161
    v_exp_f32 v18, v162
    v_cvt_pk_bf16_f32 v186, v16, v17
    v_exp_f32 v19, v163
    s_nop 0
    v_cvt_pk_bf16_f32 v187, v18, v19
    v_mfma_f32_16x16x32_bf16 v[204:207], a[232:235], v[176:179], v[200:203]
    buffer_load_dwordx4 a[108:111], v12, s[44:47], s10 offen offset:3072 sc1
    v_mfma_f32_16x16x32_bf16 v[204:207], a[236:239], v[180:183], v[204:207]
    s_add_u32 m0, s56, 25344
    s_add_u32 s57, s4, 0
    v_mfma_f32_16x16x32_bf16 v[204:207], a[240:243], v[184:187], v[204:207]
    ds_read_b64_tr_b16 a[228:229], v2 offset:59232
    ds_read_b64_tr_b16 a[230:231], v2 offset:59744
    v_mfma_f32_16x16x32_bf16 v[136:139], a[200:203], a[8:11], v[196:199]
    ds_read_b64_tr_b16 a[192:193], v2 offset:59264
    ds_read_b64_tr_b16 a[194:195], v2 offset:59776
    v_mfma_f32_16x16x32_bf16 v[136:139], a[204:207], a[20:23], v[136:139]
    buffer_load_dwordx4 v10, s[40:43], s57 offen offset:0 lds
    v_mfma_f32_16x16x32_bf16 v[136:139], a[208:211], a[32:35], v[136:139]
    ds_read_b64_tr_b16 a[196:197], v2 offset:59296
    v_cmp_nge_f32 vcc, s84, v207
    v_mfma_f32_16x16x32_bf16 v[136:139], a[212:215], a[44:47], v[136:139]
    s_cbranch_vccnz K_R1_13
K_R1_13_ret:
    ds_read_b64_tr_b16 a[198:199], v2 offset:59808
    v_mfma_f32_16x16x32_bf16 v[28:31], a[216:219], v[184:187], v[28:31]
    s_add_u32 s10, s67, 4096
    buffer_load_dwordx4 a[112:115], v12, s[44:47], s10 offen offset:0 sc1
    v_mfma_f32_16x16x32_bf16 v[24:27], a[216:219], v[180:183], v[24:27]
    ds_read_b64_tr_b16 a[200:201], v2 offset:59328
    ds_read_b64_tr_b16 a[202:203], v2 offset:59840
    v_mfma_f32_16x16x32_bf16 v[20:23], a[216:219], v[176:179], v[20:23]
    ds_read_b64_tr_b16 a[204:205], v2 offset:59360
    s_waitcnt lgkmcnt(9)
    v_mfma_f32_16x16x32_bf16 v[32:35], a[220:223], v[176:179], v[32:35]
    v_exp_f32 v16, v116
    v_mfma_f32_16x16x32_bf16 v[36:39], a[220:223], v[180:183], v[36:39]
    ds_read_b64_tr_b16 a[206:207], v2 offset:59872
    ds_read_b128 a[208:211], v6 offset:0
    v_mfma_f32_16x16x32_bf16 v[40:43], a[220:223], v[184:187], v[40:43]
    buffer_load_dwordx4 v11, s[40:43], s57 offen offset:1056 lds
    v_mfma_f32_16x16x32_bf16 v[52:55], a[224:227], v[184:187], v[52:55]
    s_add_u32 m0, s56, 33792
    s_add_u32 s57, s4, 65536
    v_mfma_f32_16x16x32_bf16 v[48:51], a[224:227], v[180:183], v[48:51]
    v_exp_f32 v17, v117
    v_mfma_f32_16x16x32_bf16 v[44:47], a[224:227], v[176:179], v[44:47]
    ds_read_b128 a[212:215], v6 offset:64
    s_waitcnt lgkmcnt(6)
    v_mfma_f32_16x16x32_bf16 v[56:59], a[228:231], v[176:179], v[56:59]
    buffer_load_dwordx4 a[116:119], v12, s[44:47], s10 offen offset:1024 sc1
    v_mfma_f32_16x16x32_bf16 v[60:63], a[228:231], v[180:183], v[60:63]
    v_exp_f32 v18, v118
    v_mfma_f32_16x16x32_bf16 v[64:67], a[228:231], v[184:187], v[64:67]
    ds_read_b128 a[216:219], v6 offset:128
    v_cvt_pk_bf16_f32 v164, v16, v17
    v_mfma_f32_16x16x32_bf16 v[76:79], a[192:195], v[184:187], v[76:79]
    v_exp_f32 v19, v119
    v_mfma_f32_16x16x32_bf16 v[72:75], a[192:195], v[180:183], v[72:75]
    buffer_load_dwordx4 v10, s[40:43], s57 offen offset:0 lds
    v_mfma_f32_16x16x32_bf16 v[68:71], a[192:195], v[176:179], v[68:71]
    v_exp_f32 v16, v120
    v_mfma_f32_16x16x32_bf16 v[80:83], a[196:199], v[176:179], v[80:83]
    buffer_load_dwordx4 a[120:123], v12, s[44:47], s10 offen offset:2048 sc1
    v_mfma_f32_16x16x32_bf16 v[84:87], a[196:199], v[180:183], v[84:87]
    ds_read_b128 a[220:223], v6 offset:192
    v_cvt_pk_bf16_f32 v165, v18, v19
    v_mfma_f32_16x16x32_bf16 v[88:91], a[196:199], v[184:187], v[88:91]
    ds_read_b128 a[224:227], v6 offset:512
    s_waitcnt lgkmcnt(3)
    v_mfma_f32_16x16x32_bf16 v[100:103], a[200:203], v[184:187], v[100:103]
    v_exp_f32 v17, v121
    v_mfma_f32_16x16x32_bf16 v[96:99], a[200:203], v[180:183], v[96:99]
    v_exp_f32 v18, v122
    v_mfma_f32_16x16x32_bf16 v[92:95], a[200:203], v[176:179], v[92:95]
    ds_read_b128 a[228:231], v6 offset:576
    v_cvt_pk_bf16_f32 v168, v16, v17
    v_mfma_f32_16x16x32_bf16 v[104:107], a[204:207], v[176:179], v[104:107]
    buffer_load_dwordx4 v11, s[40:43], s57 offen offset:1056 lds
    v_mfma_f32_16x16x32_bf16 v[108:111], a[204:207], v[180:183], v[108:111]
    buffer_load_dwordx4 a[124:127], v12, s[44:47], s10 offen offset:3072 sc1
    v_mfma_f32_16x16x32_bf16 v[112:115], a[204:207], v[184:187], v[112:115]
    v_exp_f32 v19, v123
    v_mfma_f32_16x16x32_bf16 v[140:143], a[208:211], a[0:3], v[188:191]
    s_add_u32 m0, s56, 50688
    s_add_u32 s57, s62, 0
    v_mfma_f32_16x16x32_bf16 v[140:143], a[212:215], a[12:15], v[140:143]
    ds_read_b128 a[192:195], v6 offset:640
    s_waitcnt lgkmcnt(3)
    v_mfma_f32_16x16x32_bf16 v[140:143], a[216:219], a[24:27], v[140:143]
    v_exp_f32 v16, v124
    v_mfma_f32_16x16x32_bf16 v[140:143], a[220:223], a[36:39], v[140:143]
    ds_read_b128 a[196:199], v6 offset:704
    v_cvt_pk_bf16_f32 v169, v18, v19
    v_mfma_f32_16x16x32_bf16 v[144:147], a[220:223], a[40:43], v[192:195]
    s_add_u32 s10, s67, 8192
    buffer_load_dwordx4 a[128:131], v12, s[44:47], s10 offen offset:0 sc1
    v_mfma_f32_16x16x32_bf16 v[144:147], a[216:219], a[28:31], v[144:147]
    v_exp_f32 v17, v125
    v_mfma_f32_16x16x32_bf16 v[144:147], a[212:215], a[16:19], v[144:147]
    v_exp_f32 v18, v126
    v_mfma_f32_16x16x32_bf16 v[144:147], a[208:211], a[4:7], v[144:147]
    ds_read_b64_tr_b16 a[200:201], v2 offset:0
    v_cvt_pk_bf16_f32 v172, v16, v17
    v_mfma_f32_16x16x32_bf16 v[148:151], a[208:211], a[8:11], v[196:199]
    v_exp_f32 v19, v127
    v_mfma_f32_16x16x32_bf16 v[148:151], a[212:215], a[20:23], v[148:151]
    buffer_load_dwordx4 v10, s[40:43], s57 offen offset:0 lds
    v_mfma_f32_16x16x32_bf16 v[148:151], a[216:219], a[32:35], v[148:151]
    v_exp_f32 v16, v128
    v_mfma_f32_16x16x32_bf16 v[148:151], a[220:223], a[44:47], v[148:151]
    v_cvt_pk_bf16_f32 v173, v18, v19
    s_waitcnt lgkmcnt(2)
    v_mfma_f32_16x16x32_bf16 v[152:155], a[224:227], a[0:3], v[188:191]
    v_exp_f32 v17, v129
    v_mfma_f32_16x16x32_bf16 v[152:155], a[228:231], a[12:15], v[152:155]
    buffer_load_dwordx4 v11, s[40:43], s57 offen offset:1056 lds
    v_mfma_f32_16x16x32_bf16 v[152:155], a[192:195], a[24:27], v[152:155]
    buffer_load_dwordx4 a[132:135], v12, s[44:47], s10 offen offset:1024 sc1
    s_waitcnt lgkmcnt(1)
    v_mfma_f32_16x16x32_bf16 v[152:155], a[196:199], a[36:39], v[152:155]
    v_exp_f32 v18, v130
    v_mfma_f32_16x16x32_bf16 v[156:159], a[196:199], a[40:43], v[192:195]
    ds_read_b64_tr_b16 a[202:203], v2 offset:512
    v_cvt_pk_bf16_f32 v166, v16, v17
    v_mfma_f32_16x16x32_bf16 v[156:159], a[192:195], a[28:31], v[156:159]
    v_exp_f32 v19, v131
    v_exp_f32 v16, v132
    v_cvt_pk_bf16_f32 v167, v18, v19
    v_mov_b32 v207, 0
    v_mfma_f32_16x16x32_bf16 v[156:159], a[228:231], a[16:19], v[156:159]
    v_exp_f32 v17, v133
    v_exp_f32 v18, v134
    v_cvt_pk_bf16_f32 v170, v16, v17
    v_exp_f32 v19, v135
    v_exp_f32 v16, v136
    v_cvt_pk_bf16_f32 v171, v18, v19
    v_mfma_f32_16x16x32_bf16 v[156:159], a[224:227], a[4:7], v[156:159]
    v_exp_f32 v17, v137
    v_exp_f32 v18, v138
    v_cvt_pk_bf16_f32 v174, v16, v17
    v_exp_f32 v19, v139
    s_nop 0
    v_cvt_pk_bf16_f32 v175, v18, v19
    v_mfma_f32_16x16x32_bf16 v[200:203], a[232:235], v[164:167], v[204:207]
    buffer_load_dwordx4 a[136:139], v12, s[44:47], s10 offen offset:2048 sc1
    v_mfma_f32_16x16x32_bf16 v[200:203], a[236:239], v[168:171], v[200:203]
    ds_read_b64_tr_b16 a[204:205], v2 offset:32
    ds_read_b64_tr_b16 a[206:207], v2 offset:544
    v_mfma_f32_16x16x32_bf16 v[200:203], a[240:243], v[172:175], v[200:203]
    s_add_u32 m0, s56, 92928
    s_add_u32 s57, s62, 65536
    v_mfma_f32_16x16x32_bf16 v[160:163], a[224:227], a[8:11], v[196:199]
    ds_read_b64_tr_b16 a[208:209], v2 offset:64
    ds_read_b64_tr_b16 a[210:211], v2 offset:576
    v_mfma_f32_16x16x32_bf16 v[160:163], a[228:231], a[20:23], v[160:163]
    ds_read_b64_tr_b16 a[212:213], v2 offset:96
    ds_read_b64_tr_b16 a[214:215], v2 offset:608
    v_mfma_f32_16x16x32_bf16 v[160:163], a[192:195], a[32:35], v[160:163]
    v_cmp_nge_f32 vcc, s84, v203
    s_waitcnt vmcnt(15) lgkmcnt(6)
    s_barrier
    v_mfma_f32_16x16x32_bf16 v[160:163], a[196:199], a[44:47], v[160:163]
    s_cbranch_vccnz K_R1_14
K_R1_14_ret:
    buffer_load_dwordx4 a[140:143], v12, s[44:47], s10 offen offset:3072 sc1
    v_mfma_f32_16x16x32_bf16 v[28:31], a[200:203], v[172:175], v[28:31]
    ds_read_b64_tr_b16 a[216:217], v2 offset:128
    ds_read_b64_tr_b16 a[218:219], v2 offset:640
    v_mfma_f32_16x16x32_bf16 v[24:27], a[200:203], v[168:171], v[24:27]
    ds_read_b64_tr_b16 a[220:221], v2 offset:160
    ds_read_b64_tr_b16 a[222:223], v2 offset:672
    v_mfma_f32_16x16x32_bf16 v[20:23], a[200:203], v[164:167], v[20:23]
    ds_read_b64_tr_b16 a[224:225], v2 offset:192
    s_waitcnt lgkmcnt(9)
    v_mfma_f32_16x16x32_bf16 v[32:35], a[204:207], v[164:167], v[32:35]
    buffer_load_dwordx4 v10, s[40:43], s57 offen offset:0 lds
    v_mfma_f32_16x16x32_bf16 v[36:39], a[204:207], v[168:171], v[36:39]
    ds_read_b64_tr_b16 a[226:227], v2 offset:704
    ds_read_b64_tr_b16 a[228:229], v2 offset:224
    v_mfma_f32_16x16x32_bf16 v[40:43], a[204:207], v[172:175], v[40:43]
    ds_read_b64_tr_b16 a[230:231], v2 offset:736
    s_waitcnt lgkmcnt(10)
    v_mfma_f32_16x16x32_bf16 v[52:55], a[208:211], v[172:175], v[52:55]
    v_exp_f32 v16, v140
    v_mfma_f32_16x16x32_bf16 v[48:51], a[208:211], v[168:171], v[48:51]
    buffer_load_dwordx4 v11, s[40:43], s57 offen offset:1056 lds
    v_mfma_f32_16x16x32_bf16 v[44:47], a[208:211], v[164:167], v[44:47]
    s_add_u32 m0, s56, 42240
    s_add_u32 s57, s5, 0
    s_waitcnt lgkmcnt(8)
    v_mfma_f32_16x16x32_bf16 v[56:59], a[212:215], v[164:167], v[56:59]
    v_exp_f32 v17, v141
    v_mfma_f32_16x16x32_bf16 v[60:63], a[212:215], v[168:171], v[60:63]
    v_exp_f32 v18, v142
    v_mfma_f32_16x16x32_bf16 v[64:67], a[212:215], v[172:175], v[64:67]
    ds_read_b64_tr_b16 a[192:193], v2 offset:8448
    s_waitcnt lgkmcnt(4)
    v_mfma_f32_16x16x32_bf16 v[76:79], a[216:219], v[172:175], v[76:79]
    buffer_load_dwordx4 v10, s[40:43], s57 offen offset:0 lds
    v_mfma_f32_16x16x32_bf16 v[72:75], a[216:219], v[168:171], v[72:75]
    s_add_u32 s10, s68, 0
    buffer_load_dwordx4 a[0:3], v12, s[44:47], s10 offen offset:0 sc1
    v_mfma_f32_16x16x32_bf16 v[68:71], a[216:219], v[164:167], v[68:71]
    ds_read_b64_tr_b16 a[194:195], v2 offset:8960
    ds_read_b64_tr_b16 a[196:197], v2 offset:8576
    v_mfma_f32_16x16x32_bf16 v[80:83], a[220:223], v[164:167], v[80:83]
    ds_read_b64_tr_b16 a[198:199], v2 offset:9088
    v_cvt_pk_bf16_f32 v176, v16, v17
    v_mfma_f32_16x16x32_bf16 v[84:87], a[220:223], v[168:171], v[84:87]
    v_exp_f32 v19, v143
    v_mfma_f32_16x16x32_bf16 v[88:91], a[220:223], v[172:175], v[88:91]
    ds_read_b64_tr_b16 a[200:201], v2 offset:16896
    s_waitcnt lgkmcnt(5)
    v_mfma_f32_16x16x32_bf16 v[100:103], a[224:227], v[172:175], v[100:103]
    ds_read_b64_tr_b16 a[202:203], v2 offset:17408
    ds_read_b64_tr_b16 a[204:205], v2 offset:17024
    v_mfma_f32_16x16x32_bf16 v[96:99], a[224:227], v[168:171], v[96:99]
    v_exp_f32 v16, v144
    v_mfma_f32_16x16x32_bf16 v[92:95], a[224:227], v[164:167], v[92:95]
    buffer_load_dwordx4 a[4:7], v12, s[44:47], s10 offen offset:1024 sc1
    v_mfma_f32_16x16x32_bf16 v[104:107], a[228:231], v[164:167], v[104:107]
    ds_read_b64_tr_b16 a[206:207], v2 offset:17536
    v_cvt_pk_bf16_f32 v177, v18, v19
    v_mfma_f32_16x16x32_bf16 v[108:111], a[228:231], v[168:171], v[108:111]
    v_exp_f32 v17, v145
    v_mfma_f32_16x16x32_bf16 v[112:115], a[228:231], v[172:175], v[112:115]
    ds_read_b64_tr_b16 a[208:209], v2 offset:8480
    s_waitcnt lgkmcnt(6)
    v_mfma_f32_16x16x32_bf16 v[208:211], a[192:195], a[144:147], 0
    buffer_load_dwordx4 v11, s[40:43], s57 offen offset:1056 lds
    s_waitcnt lgkmcnt(5)
    v_mfma_f32_16x16x32_bf16 v[208:211], a[196:199], a[156:159], v[208:211]
    buffer_load_dwordx4 a[8:11], v12, s[44:47], s10 offen offset:2048 sc1
    s_waitcnt lgkmcnt(3)
    v_mfma_f32_16x16x32_bf16 v[208:211], a[200:203], a[168:171], v[208:211]
    s_add_u32 m0, s56, 59136
    s_add_u32 s57, s5, 65536
    s_waitcnt lgkmcnt(1)
    v_mfma_f32_16x16x32_bf16 v[208:211], a[204:207], a[180:183], v[208:211]
    v_exp_f32 v18, v146
    v_mfma_f32_16x16x32_bf16 v[212:215], a[204:207], a[184:187], 0
    ds_read_b64_tr_b16 a[210:211], v2 offset:8992
    v_cvt_pk_bf16_f32 v180, v16, v17
    v_mfma_f32_16x16x32_bf16 v[212:215], a[200:203], a[172:175], v[212:215]
    v_exp_f32 v19, v147
    v_mfma_f32_16x16x32_bf16 v[212:215], a[196:199], a[160:163], v[212:215]
    buffer_load_dwordx4 a[12:15], v12, s[44:47], s10 offen offset:3072 sc1
    v_mfma_f32_16x16x32_bf16 v[212:215], a[192:195], a[148:151], v[212:215]
    ds_read_b64_tr_b16 a[212:213], v2 offset:8608
    ds_read_b64_tr_b16 a[214:215], v2 offset:9120
    v_mfma_f32_16x16x32_bf16 v[216:219], a[192:195], a[152:155], 0
    ds_read_b64_tr_b16 a[216:217], v2 offset:16928
    ds_read_b64_tr_b16 a[218:219], v2 offset:17440
    v_mfma_f32_16x16x32_bf16 v[216:219], a[196:199], a[164:167], v[216:219]
    ds_read_b64_tr_b16 a[220:221], v2 offset:17056
    ds_read_b64_tr_b16 a[222:223], v2 offset:17568
    v_mfma_f32_16x16x32_bf16 v[216:219], a[200:203], a[176:179], v[216:219]
    v_exp_f32 v16, v148
    v_mfma_f32_16x16x32_bf16 v[216:219], a[204:207], a[188:191], v[216:219]
    s_add_u32 s10, s68, 4096
    buffer_load_dwordx4 a[16:19], v12, s[44:47], s10 offen offset:0 sc1
    s_waitcnt lgkmcnt(6)
    v_mfma_f32_16x16x32_bf16 v[220:223], a[208:211], a[144:147], 0
    v_cvt_pk_bf16_f32 v181, v18, v19
    s_waitcnt lgkmcnt(4)
    v_mfma_f32_16x16x32_bf16 v[220:223], a[212:215], a[156:159], v[220:223]
    ds_read_b64_tr_b16 a[224:225], v3 offset:8448
    s_waitcnt lgkmcnt(3)
    v_mfma_f32_16x16x32_bf16 v[220:223], a[216:219], a[168:171], v[220:223]
    ds_read_b64_tr_b16 a[226:227], v3 offset:8960
    s_waitcnt lgkmcnt(2)
    v_mfma_f32_16x16x32_bf16 v[220:223], a[220:223], a[180:183], v[220:223]
    v_exp_f32 v17, v149
    v_mfma_f32_16x16x32_bf16 v[224:227], a[220:223], a[184:187], 0
    buffer_load_dwordx4 v10, s[40:43], s57 offen offset:0 lds
    v_mfma_f32_16x16x32_bf16 v[224:227], a[216:219], a[172:175], v[224:227]
    v_exp_f32 v18, v150
    v_cvt_pk_bf16_f32 v184, v16, v17
    v_exp_f32 v19, v151
    v_exp_f32 v16, v152
    v_cvt_pk_bf16_f32 v185, v18, v19
    v_exp_f32 v17, v153
    v_exp_f32 v18, v154
    v_cvt_pk_bf16_f32 v178, v16, v17
    v_exp_f32 v19, v155
    v_exp_f32 v16, v156
    v_cvt_pk_bf16_f32 v179, v18, v19
    v_mov_b32 v203, 0
    v_mfma_f32_16x16x32_bf16 v[224:227], a[212:215], a[160:163], v[224:227]
    v_exp_f32 v17, v157
    v_exp_f32 v18, v158
    v_cvt_pk_bf16_f32 v182, v16, v17
    v_exp_f32 v19, v159
    v_exp_f32 v16, v160
    v_cvt_pk_bf16_f32 v183, v18, v19
    v_mfma_f32_16x16x32_bf16 v[224:227], a[208:211], a[148:151], v[224:227]
    buffer_load_dwordx4 a[20:23], v12, s[44:47], s10 offen offset:1024 sc1
    v_exp_f32 v17, v161
    v_exp_f32 v18, v162
    v_cvt_pk_bf16_f32 v186, v16, v17
    v_exp_f32 v19, v163
    s_nop 0
    v_cvt_pk_bf16_f32 v187, v18, v19
    v_mfma_f32_16x16x32_bf16 v[204:207], a[232:235], v[176:179], v[200:203]
    ds_read_b64_tr_b16 a[228:229], v3 offset:8480
    ds_read_b64_tr_b16 a[230:231], v3 offset:8992
    v_mfma_f32_16x16x32_bf16 v[204:207], a[236:239], v[180:183], v[204:207]
    ds_read_b64_tr_b16 a[192:193], v3 offset:8512
    ds_read_b64_tr_b16 a[194:195], v3 offset:9024
    v_mfma_f32_16x16x32_bf16 v[204:207], a[240:243], v[184:187], v[204:207]
    ds_read_b64_tr_b16 a[196:197], v3 offset:8544
    ds_read_b64_tr_b16 a[198:199], v3 offset:9056
    v_mfma_f32_16x16x32_bf16 v[228:231], a[208:211], a[152:155], 0
    ds_read_b64_tr_b16 a[200:201], v3 offset:8576
    ds_read_b64_tr_b16 a[202:203], v3 offset:9088
    v_mfma_f32_16x16x32_bf16 v[228:231], a[212:215], a[164:167], v[228:231]
    buffer_load_dwordx4 a[24:27], v12, s[44:47], s10 offen offset:2048 sc1
    v_mfma_f32_16x16x32_bf16 v[228:231], a[216:219], a[176:179], v[228:231]
    v_cmp_nge_f32 vcc, s84, v207
    s_waitcnt lgkmcnt(8)
    s_barrier
    v_mfma_f32_16x16x32_bf16 v[228:231], a[220:223], a[188:191], v[228:231]
    s_cbranch_vccnz K_R1_15
K_R1_15_ret:
    ds_read_b64_tr_b16 a[204:205], v3 offset:8608
    v_mfma_f32_16x16x32_bf16 v[28:31], a[224:227], v[184:187], v[28:31]
    ds_read_b64_tr_b16 a[206:207], v3 offset:9120
    v_mfma_f32_16x16x32_bf16 v[24:27], a[224:227], v[180:183], v[24:27]
    buffer_load_dwordx4 v11, s[40:43], s57 offen offset:1056 lds
    v_mfma_f32_16x16x32_bf16 v[20:23], a[224:227], v[176:179], v[20:23]
    buffer_load_dwordx4 a[28:31], v12, s[44:47], s10 offen offset:3072 sc1
    s_waitcnt lgkmcnt(8)
    v_mfma_f32_16x16x32_bf16 v[32:35], a[228:231], v[176:179], v[32:35]
    s_add_u32 m0, s56, 0
    s_add_u32 s57, s63, 0
    v_mfma_f32_16x16x32_bf16 v[36:39], a[228:231], v[180:183], v[36:39]
    ds_read_b64_tr_b16 a[208:209], v3 offset:8640
    v_mfma_f32_16x16x32_bf16 v[40:43], a[228:231], v[184:187], v[40:43]
    ds_read_b64_tr_b16 a[210:211], v3 offset:9152
    s_waitcnt lgkmcnt(4)
    v_mfma_f32_16x16x32_bf16 v[52:55], a[192:195], v[184:187], v[52:55]
    ds_read_b64_tr_b16 a[212:213], v3 offset:8672
    v_mfma_f32_16x16x32_bf16 v[48:51], a[192:195], v[180:183], v[48:51]
    s_add_u32 s10, s68, 8192
    buffer_load_dwordx4 a[32:35], v12, s[44:47], s10 offen offset:0 sc1
    v_mfma_f32_16x16x32_bf16 v[44:47], a[192:195], v[176:179], v[44:47]
    ds_read_b64_tr_b16 a[214:215], v3 offset:9184
    v_mfma_f32_16x16x32_bf16 v[56:59], a[196:199], v[176:179], v[56:59]
    v_rcp_f32 v16, v204
    v_mfma_f32_16x16x32_bf16 v[60:63], a[196:199], v[180:183], v[60:63]
    ds_read_b64_tr_b16 a[216:217], v2 offset:8512
    v_mfma_f32_16x16x32_bf16 v[64:67], a[196:199], v[184:187], v[64:67]
    ds_read_b64_tr_b16 a[218:219], v2 offset:9024
    v_mfma_f32_16x16x32_bf16 v[76:79], a[200:203], v[184:187], v[76:79]
    v_rcp_f32 v17, v205
    v_mfma_f32_16x16x32_bf16 v[72:75], a[200:203], v[180:183], v[72:75]
    buffer_load_dwordx4 v10, s[40:43], s57 offen offset:0 lds
    v_mfma_f32_16x16x32_bf16 v[68:71], a[200:203], v[176:179], v[68:71]
    buffer_load_dwordx4 a[36:39], v12, s[44:47], s10 offen offset:1024 sc1
    s_waitcnt lgkmcnt(4)
    v_mfma_f32_16x16x32_bf16 v[80:83], a[204:207], v[176:179], v[80:83]
    ds_read_b64_tr_b16 a[220:221], v2 offset:8640
    v_mfma_f32_16x16x32_bf16 v[84:87], a[204:207], v[180:183], v[84:87]
    ds_read_b64_tr_b16 a[222:223], v2 offset:9152
    v_mfma_f32_16x16x32_bf16 v[88:91], a[204:207], v[184:187], v[88:91]
    v_rcp_f32 v18, v206
    v_mfma_f32_16x16x32_bf16 v[100:103], a[208:211], v[184:187], v[100:103]
    v_mul_f32 v20, v16, v20
    v_mul_f32 v21, v16, v21
    v_mfma_f32_16x16x32_bf16 v[96:99], a[208:211], v[180:183], v[96:99]
    buffer_load_dwordx4 a[40:43], v12, s[44:47], s10 offen offset:2048 sc1
    v_mul_f32 v22, v16, v22
    v_mfma_f32_16x16x32_bf16 v[92:95], a[208:211], v[176:179], v[92:95]
    ds_read_b64_tr_b16 a[224:225], v2 offset:16960
    ds_read_b64_tr_b16 a[226:227], v2 offset:17472
    v_mul_f32 v23, v16, v23
    v_mul_f32 v32, v16, v32
    s_waitcnt lgkmcnt(4)
    v_mfma_f32_16x16x32_bf16 v[104:107], a[212:215], v[176:179], v[104:107]
    ds_read_b64_tr_b16 a[228:229], v2 offset:17088
    ds_read_b64_tr_b16 a[230:231], v2 offset:17600
    v_mul_f32 v33, v16, v33
    v_mfma_f32_16x16x32_bf16 v[108:111], a[212:215], v[180:183], v[108:111]
    v_mul_f32 v34, v16, v34
    v_mul_f32 v35, v16, v35
    v_mfma_f32_16x16x32_bf16 v[112:115], a[212:215], v[184:187], v[112:115]
    ds_read_b64_tr_b16 a[192:193], v2 offset:8544
    v_cvt_pk_bf16_f32 v20, v20, v21
    v_mfma_f32_16x16x32_bf16 v[232:235], a[216:219], a[144:147], 0
    buffer_load_dwordx4 a[44:47], v12, s[44:47], s10 offen offset:3072 sc1
    v_cvt_pk_bf16_f32 v21, v22, v23
    v_cvt_pk_bf16_f32 v22, v32, v33
    s_waitcnt lgkmcnt(5)
    v_mfma_f32_16x16x32_bf16 v[232:235], a[220:223], a[156:159], v[232:235]
    v_cvt_pk_bf16_f32 v23, v34, v35
    s_waitcnt lgkmcnt(3)
    v_mfma_f32_16x16x32_bf16 v[232:235], a[224:227], a[168:171], v[232:235]
    v_mul_f32 v24, v17, v24
    v_mul_f32 v25, v17, v25
    s_waitcnt lgkmcnt(1)
    v_mfma_f32_16x16x32_bf16 v[232:235], a[228:231], a[180:183], v[232:235]
    ds_read_b64_tr_b16 a[194:195], v2 offset:9056
    v_mul_f32 v26, v17, v26
    v_mfma_f32_16x16x32_bf16 v[236:239], a[228:231], a[184:187], 0
    v_mul_f32 v27, v17, v27
    v_mul_f32 v36, v17, v36
    v_mfma_f32_16x16x32_bf16 v[236:239], a[224:227], a[172:175], v[236:239]
    buffer_load_dwordx4 v11, s[40:43], s57 offen offset:1056 lds
    v_mul_f32 v37, v17, v37
    v_mfma_f32_16x16x32_bf16 v[236:239], a[220:223], a[160:163], v[236:239]
    s_add_u32 s11, s65, 49152
    buffer_store_dwordx4 v[20:23], v12, s[44:47], s11 offen offset:0 sc1
    v_mul_f32 v38, v17, v38
    v_mul_f32 v39, v17, v39
    v_mfma_f32_16x16x32_bf16 v[236:239], a[216:219], a[148:151], v[236:239]
    ds_read_b64_tr_b16 a[196:197], v2 offset:8672
    ds_read_b64_tr_b16 a[198:199], v2 offset:9184
    v_cvt_pk_bf16_f32 v24, v24, v25
    v_mfma_f32_16x16x32_bf16 v[240:243], a[216:219], a[152:155], 0
    ds_read_b64_tr_b16 a[200:201], v2 offset:16992
    ds_read_b64_tr_b16 a[202:203], v2 offset:17504
    v_cvt_pk_bf16_f32 v25, v26, v27
    v_cvt_pk_bf16_f32 v26, v36, v37
    v_mfma_f32_16x16x32_bf16 v[240:243], a[220:223], a[164:167], v[240:243]
    ds_read_b64_tr_b16 a[204:205], v2 offset:17120
    ds_read_b64_tr_b16 a[206:207], v2 offset:17632
    v_cvt_pk_bf16_f32 v27, v38, v39
    v_mfma_f32_16x16x32_bf16 v[240:243], a[224:227], a[176:179], v[240:243]
    s_add_u32 m0, s56, 67584
    s_add_u32 s57, s63, 65536
    v_mul_f32 v28, v18, v28
    v_mfma_f32_16x16x32_bf16 v[240:243], a[228:231], a[188:191], v[240:243]
    v_mul_f32 v29, v18, v29
    v_mul_f32 v30, v18, v30
    s_waitcnt lgkmcnt(6)
    v_mfma_f32_16x16x32_bf16 v[244:247], a[192:195], a[144:147], 0
    v_mul_f32 v31, v18, v31
    s_waitcnt vmcnt(28) lgkmcnt(4)
    s_barrier
    v_mfma_f32_16x16x32_bf16 v[244:247], a[196:199], a[156:159], v[244:247]
    v_mul_f32 v40, v18, v40
    v_mul_f32 v41, v18, v41
    s_waitcnt lgkmcnt(2)
    v_mfma_f32_16x16x32_bf16 v[244:247], a[200:203], a[168:171], v[244:247]
    v_mul_f32 v42, v18, v42
    s_waitcnt lgkmcnt(0)
    v_mfma_f32_16x16x32_bf16 v[244:247], a[204:207], a[180:183], v[244:247]
    v_mul_f32 v43, v18, v43
    v_cvt_pk_bf16_f32 v28, v28, v29
    v_mfma_f32_16x16x32_bf16 v[248:251], a[204:207], a[184:187], 0
    buffer_store_dwordx4 v[24:27], v12, s[44:47], s11 offen offset:1024 sc1
    v_cvt_pk_bf16_f32 v29, v30, v31
    v_mfma_f32_16x16x32_bf16 v[248:251], a[200:203], a[172:175], v[248:251]
    v_cvt_pk_bf16_f32 v30, v40, v41
    v_cvt_pk_bf16_f32 v31, v42, v43
    v_mfma_f32_16x16x32_bf16 v[248:251], a[196:199], a[160:163], v[248:251]
    ds_read_b64_tr_b16 a[208:209], v2 offset:25344
    ds_read_b64_tr_b16 a[210:211], v2 offset:25856
    v_mul_f32 v44, v16, v44
    v_mfma_f32_16x16x32_bf16 v[248:251], a[192:195], a[148:151], v[248:251]
    ds_read_b64_tr_b16 a[212:213], v2 offset:25472
    ds_read_b64_tr_b16 a[214:215], v2 offset:25984
    v_mul_f32 v45, v16, v45
    v_mul_f32 v46, v16, v46
    v_mfma_f32_16x16x32_bf16 v[252:255], a[192:195], a[152:155], 0
    ds_read_b64_tr_b16 a[216:217], v2 offset:33792
    ds_read_b64_tr_b16 a[218:219], v2 offset:34304
    buffer_load_dwordx4 v10, s[40:43], s57 offen offset:0 lds
    v_mul_f32 v47, v16, v47
    v_mfma_f32_16x16x32_bf16 v[252:255], a[196:199], a[164:167], v[252:255]
    ds_read_b64_tr_b16 a[220:221], v2 offset:33920
    ds_read_b64_tr_b16 a[222:223], v2 offset:34432
    v_mul_f32 v56, v16, v56
    v_mul_f32 v57, v16, v57
    v_mfma_f32_16x16x32_bf16 v[252:255], a[200:203], a[176:179], v[252:255]
    ds_read_b64_tr_b16 a[224:225], v2 offset:25376
    v_mul_f32 v58, v16, v58
    v_mfma_f32_16x16x32_bf16 v[252:255], a[204:207], a[188:191], v[252:255]
    buffer_store_dwordx4 v[28:31], v12, s[44:47], s11 offen offset:2048 sc1
    v_mul_f32 v59, v16, v59
    v_cvt_pk_bf16_f32 v32, v44, v45
    s_waitcnt lgkmcnt(7)
    v_mfma_f32_16x16x32_bf16 v[116:119], a[208:211], a[144:147], 0
    v_cvt_pk_bf16_f32 v33, v46, v47
    s_waitcnt lgkmcnt(5)
    v_mfma_f32_16x16x32_bf16 v[116:119], a[212:215], a[156:159], v[116:119]
    v_cvt_pk_bf16_f32 v34, v56, v57
    v_cvt_pk_bf16_f32 v35, v58, v59
    s_waitcnt lgkmcnt(3)
    v_mfma_f32_16x16x32_bf16 v[116:119], a[216:219], a[168:171], v[116:119]
    v_mul_f32 v48, v17, v48
    s_waitcnt lgkmcnt(1)
    v_mfma_f32_16x16x32_bf16 v[116:119], a[220:223], a[180:183], v[116:119]
    ds_read_b64_tr_b16 a[226:227], v2 offset:25888
    v_mul_f32 v49, v17, v49
    v_mfma_f32_16x16x32_bf16 v[120:123], a[220:223], a[184:187], 0
    v_mul_f32 v50, v17, v50
    v_mul_f32 v51, v17, v51
    v_mfma_f32_16x16x32_bf16 v[120:123], a[216:219], a[172:175], v[120:123]
    buffer_load_dwordx4 v11, s[40:43], s57 offen offset:1056 lds
    v_mul_f32 v60, v17, v60
    v_mfma_f32_16x16x32_bf16 v[120:123], a[212:215], a[160:163], v[120:123]
    buffer_store_dwordx4 v[32:35], v12, s[44:47], s11 offen offset:3072 sc1
    v_mul_f32 v61, v17, v61
    v_mul_f32 v62, v17, v62
    v_mfma_f32_16x16x32_bf16 v[120:123], a[208:211], a[148:151], v[120:123]
    ds_read_b64_tr_b16 a[228:229], v2 offset:25504
    ds_read_b64_tr_b16 a[230:231], v2 offset:26016
    v_mul_f32 v63, v17, v63
    v_mfma_f32_16x16x32_bf16 v[124:127], a[208:211], a[152:155], 0
    ds_read_b64_tr_b16 a[192:193], v2 offset:33824
    ds_read_b64_tr_b16 a[194:195], v2 offset:34336
    v_cvt_pk_bf16_f32 v36, v48, v49
    v_cvt_pk_bf16_f32 v37, v50, v51
    v_mfma_f32_16x16x32_bf16 v[124:127], a[212:215], a[164:167], v[124:127]
    ds_read_b64_tr_b16 a[196:197], v2 offset:33952
    ds_read_b64_tr_b16 a[198:199], v2 offset:34464
    v_cvt_pk_bf16_f32 v38, v60, v61
    v_mfma_f32_16x16x32_bf16 v[124:127], a[216:219], a[176:179], v[124:127]
    v_cvt_pk_bf16_f32 v39, v62, v63
    v_mul_f32 v52, v18, v52
    v_mfma_f32_16x16x32_bf16 v[124:127], a[220:223], a[188:191], v[124:127]
    v_mul_f32 v53, v18, v53
    s_waitcnt lgkmcnt(6)
    v_mfma_f32_16x16x32_bf16 v[128:131], a[224:227], a[144:147], 0
    v_mul_f32 v54, v18, v54
    v_mul_f32 v55, v18, v55
    s_waitcnt lgkmcnt(4)
    v_mfma_f32_16x16x32_bf16 v[128:131], a[228:231], a[156:159], v[128:131]
    v_mul_f32 v64, v18, v64
    s_waitcnt lgkmcnt(2)
    v_mfma_f32_16x16x32_bf16 v[128:131], a[192:195], a[168:171], v[128:131]
    s_add_u32 s11, s65, 53248
    buffer_store_dwordx4 v[36:39], v12, s[44:47], s11 offen offset:0 sc1
    v_mul_f32 v65, v18, v65
    v_mul_f32 v66, v18, v66
    s_waitcnt lgkmcnt(0)
    v_mfma_f32_16x16x32_bf16 v[128:131], a[196:199], a[180:183], v[128:131]
    s_add_u32 m0, s56, 8448
    s_add_u32 s57, s6, 0
    v_mul_f32 v67, v18, v67
    v_mfma_f32_16x16x32_bf16 v[132:135], a[196:199], a[184:187], 0
    v_cvt_pk_bf16_f32 v40, v52, v53
    v_cvt_pk_bf16_f32 v41, v54, v55
    v_mfma_f32_16x16x32_bf16 v[132:135], a[192:195], a[172:175], v[132:135]
    ds_read_b64_tr_b16 a[200:201], v2 offset:25408
    v_cvt_pk_bf16_f32 v42, v64, v65
    v_mfma_f32_16x16x32_bf16 v[132:135], a[228:231], a[160:163], v[132:135]
    ds_read_b64_tr_b16 a[202:203], v2 offset:25920
    v_cvt_pk_bf16_f32 v43, v66, v67
    v_mfma_f32_16x16x32_bf16 v[132:135], a[224:227], a[148:151], v[132:135]
    ds_read_b64_tr_b16 a[204:205], v2 offset:25536
    ds_read_b64_tr_b16 a[206:207], v2 offset:26048
    v_mul_f32 v68, v16, v68
    v_mul_f32 v69, v16, v69
    v_mfma_f32_16x16x32_bf16 v[136:139], a[224:227], a[152:155], 0
    ds_read_b64_tr_b16 a[208:209], v2 offset:33856
    ds_read_b64_tr_b16 a[210:211], v2 offset:34368
    v_mul_f32 v70, v16, v70
    v_mfma_f32_16x16x32_bf16 v[136:139], a[228:231], a[164:167], v[136:139]
    ds_read_b64_tr_b16 a[212:213], v2 offset:33984
    ds_read_b64_tr_b16 a[214:215], v2 offset:34496
    v_mul_f32 v71, v16, v71
    v_mul_f32 v80, v16, v80
    v_mfma_f32_16x16x32_bf16 v[136:139], a[192:195], a[176:179], v[136:139]
    buffer_load_dwordx4 v10, s[40:43], s57 offen offset:0 lds
    v_mul_f32 v81, v16, v81
    v_mfma_f32_16x16x32_bf16 v[136:139], a[196:199], a[188:191], v[136:139]
    v_mul_f32 v82, v16, v82
    v_mul_f32 v83, v16, v83
    s_waitcnt lgkmcnt(6)
    v_mfma_f32_16x16x32_bf16 v[140:143], a[200:203], a[144:147], 0
    buffer_store_dwordx4 v[40:43], v12, s[44:47], s11 offen offset:1024 sc1
    v_cvt_pk_bf16_f32 v44, v68, v69
    s_waitcnt lgkmcnt(4)
    v_mfma_f32_16x16x32_bf16 v[140:143], a[204:207], a[156:159], v[140:143]
    v_cvt_pk_bf16_f32 v45, v70, v71
    v_cvt_pk_bf16_f32 v46, v80, v81
    s_waitcnt lgkmcnt(2)
    v_mfma_f32_16x16x32_bf16 v[140:143], a[208:211], a[168:171], v[140:143]
    v_cvt_pk_bf16_f32 v47, v82, v83
    s_waitcnt lgkmcnt(0)
    v_mfma_f32_16x16x32_bf16 v[140:143], a[212:215], a[180:183], v[140:143]
    v_mul_f32 v72, v17, v72
    v_mul_f32 v73, v17, v73
    v_mfma_f32_16x16x32_bf16 v[144:147], a[212:215], a[184:187], 0
    ds_read_b64_tr_b16 a[216:217], v2 offset:25440
    v_mul_f32 v74, v17, v74
    v_mfma_f32_16x16x32_bf16 v[144:147], a[208:211], a[172:175], v[144:147]
    v_mul_f32 v75, v17, v75
    v_mul_f32 v84, v17, v84
    v_mfma_f32_16x16x32_bf16 v[144:147], a[204:207], a[160:163], v[144:147]
    ds_read_b64_tr_b16 a[218:219], v2 offset:25952
    v_mul_f32 v85, v17, v85
    v_mfma_f32_16x16x32_bf16 v[144:147], a[200:203], a[148:151], v[144:147]
    ds_read_b64_tr_b16 a[220:221], v2 offset:25568
    ds_read_b64_tr_b16 a[222:223], v2 offset:26080
    buffer_store_dwordx4 v[44:47], v12, s[44:47], s11 offen offset:2048 sc1
    v_mul_f32 v86, v17, v86
    v_mul_f32 v87, v17, v87
    v_mfma_f32_16x16x32_bf16 v[148:151], a[200:203], a[152:155], 0
    ds_read_b64_tr_b16 a[224:225], v2 offset:33888
    ds_read_b64_tr_b16 a[226:227], v2 offset:34400
    v_cvt_pk_bf16_f32 v48, v72, v73
    v_mfma_f32_16x16x32_bf16 v[148:151], a[204:207], a[164:167], v[148:151]
    ds_read_b64_tr_b16 a[228:229], v2 offset:34016
    ds_read_b64_tr_b16 a[230:231], v2 offset:34528
    v_cvt_pk_bf16_f32 v49, v74, v75
    v_cvt_pk_bf16_f32 v50, v84, v85
    v_mfma_f32_16x16x32_bf16 v[148:151], a[208:211], a[176:179], v[148:151]
    v_cvt_pk_bf16_f32 v51, v86, v87
    v_mul_f32 v76, v18, v76
    v_mfma_f32_16x16x32_bf16 v[148:151], a[212:215], a[188:191], v[148:151]
    buffer_load_dwordx4 v11, s[40:43], s57 offen offset:1056 lds
    s_waitcnt lgkmcnt(6)
    v_mfma_f32_16x16x32_bf16 v[152:155], a[216:219], a[144:147], 0
    v_mul_f32 v77, v18, v77
    v_mul_f32 v78, v18, v78
    s_waitcnt vmcnt(29) lgkmcnt(4)
    s_barrier
    v_mfma_f32_16x16x32_bf16 v[152:155], a[220:223], a[156:159], v[152:155]
    v_mul_f32 v79, v18, v79
    s_waitcnt lgkmcnt(2)
    v_mfma_f32_16x16x32_bf16 v[152:155], a[224:227], a[168:171], v[152:155]
    buffer_store_dwordx4 v[48:51], v12, s[44:47], s11 offen offset:3072 sc1
    v_mul_f32 v88, v18, v88
    v_mul_f32 v89, v18, v89
    s_waitcnt lgkmcnt(0)
    v_mfma_f32_16x16x32_bf16 v[152:155], a[228:231], a[180:183], v[152:155]
    s_add_u32 m0, s56, 16896
    s_add_u32 s57, s6, 65536
    v_mul_f32 v90, v18, v90
    v_mfma_f32_16x16x32_bf16 v[156:159], a[228:231], a[184:187], 0
    v_mul_f32 v91, v18, v91
    v_cvt_pk_bf16_f32 v52, v76, v77
    v_mfma_f32_16x16x32_bf16 v[156:159], a[224:227], a[172:175], v[156:159]
    v_cvt_pk_bf16_f32 v53, v78, v79
    v_cvt_pk_bf16_f32 v54, v88, v89
    v_mfma_f32_16x16x32_bf16 v[156:159], a[220:223], a[160:163], v[156:159]
    ds_read_b64_tr_b16 a[192:193], v2 offset:50688
    ds_read_b64_tr_b16 a[194:195], v2 offset:51200
    v_cvt_pk_bf16_f32 v55, v90, v91
    v_mfma_f32_16x16x32_bf16 v[156:159], a[216:219], a[148:151], v[156:159]
    ds_read_b64_tr_b16 a[196:197], v2 offset:50816
    ds_read_b64_tr_b16 a[198:199], v2 offset:51328
    v_mul_f32 v92, v16, v92
    v_mfma_f32_16x16x32_bf16 v[160:163], a[216:219], a[152:155], 0
    ds_read_b64_tr_b16 a[200:201], v3 offset:25344
    ds_read_b64_tr_b16 a[202:203], v3 offset:25856
    v_mul_f32 v93, v16, v93
    v_mul_f32 v94, v16, v94
    v_mfma_f32_16x16x32_bf16 v[160:163], a[220:223], a[164:167], v[160:163]
    ds_read_b64_tr_b16 a[204:205], v3 offset:25472
    ds_read_b64_tr_b16 a[206:207], v3 offset:25984
    v_mul_f32 v95, v16, v95
    v_mfma_f32_16x16x32_bf16 v[160:163], a[224:227], a[176:179], v[160:163]
    s_add_u32 s11, s65, 57344
    buffer_store_dwordx4 v[52:55], v12, s[44:47], s11 offen offset:0 sc1
    v_mul_f32 v104, v16, v104
    v_mul_f32 v105, v16, v105
    v_mfma_f32_16x16x32_bf16 v[160:163], a[228:231], a[188:191], v[160:163]
    v_mul_f32 v106, v16, v106
    s_waitcnt lgkmcnt(6)
    v_mfma_f32_16x16x32_bf16 v[208:211], a[192:195], a[48:51], v[208:211]
    v_mul_f32 v107, v16, v107
    v_cvt_pk_bf16_f32 v56, v92, v93
    s_waitcnt lgkmcnt(4)
    v_mfma_f32_16x16x32_bf16 v[208:211], a[196:199], a[60:63], v[208:211]
    v_cvt_pk_bf16_f32 v57, v94, v95
    s_waitcnt lgkmcnt(2)
    v_mfma_f32_16x16x32_bf16 v[208:211], a[200:203], a[72:75], v[208:211]
    buffer_load_dwordx4 v10, s[40:43], s57 offen offset:0 lds
    v_cvt_pk_bf16_f32 v58, v104, v105
    v_cvt_pk_bf16_f32 v59, v106, v107
    s_waitcnt lgkmcnt(0)
    v_mfma_f32_16x16x32_bf16 v[208:211], a[204:207], a[84:87], v[208:211]
    ds_read_b64_tr_b16 a[208:209], v2 offset:50720
    v_mul_f32 v96, v17, v96
    v_mfma_f32_16x16x32_bf16 v[212:215], a[204:207], a[88:91], v[212:215]
    ds_read_b64_tr_b16 a[210:211], v2 offset:51232
    v_mul_f32 v97, v17, v97
    v_mfma_f32_16x16x32_bf16 v[212:215], a[200:203], a[76:79], v[212:215]
    v_mul_f32 v98, v17, v98
    v_mul_f32 v99, v17, v99
    v_mfma_f32_16x16x32_bf16 v[212:215], a[196:199], a[64:67], v[212:215]
    ds_read_b64_tr_b16 a[212:213], v2 offset:50848
    v_mul_f32 v108, v17, v108
    v_mfma_f32_16x16x32_bf16 v[212:215], a[192:195], a[52:55], v[212:215]
    ds_read_b64_tr_b16 a[214:215], v2 offset:51360
    v_mul_f32 v109, v17, v109
    v_mul_f32 v110, v17, v110
    v_mfma_f32_16x16x32_bf16 v[216:219], a[192:195], a[56:59], v[216:219]
    ds_read_b64_tr_b16 a[216:217], v3 offset:25376
    ds_read_b64_tr_b16 a[218:219], v3 offset:25888
    buffer_store_dwordx4 v[56:59], v12, s[44:47], s11 offen offset:1024 sc1
    v_mul_f32 v111, v17, v111
    v_mfma_f32_16x16x32_bf16 v[216:219], a[196:199], a[68:71], v[216:219]
    ds_read_b64_tr_b16 a[220:221], v3 offset:25504
    ds_read_b64_tr_b16 a[222:223], v3 offset:26016
    v_cvt_pk_bf16_f32 v60, v96, v97
    v_cvt_pk_bf16_f32 v61, v98, v99
    v_mfma_f32_16x16x32_bf16 v[216:219], a[200:203], a[80:83], v[216:219]
    ds_read_b64_tr_b16 a[224:225], v2 offset:50752
    v_cvt_pk_bf16_f32 v62, v108, v109
    v_mfma_f32_16x16x32_bf16 v[216:219], a[204:207], a[92:95], v[216:219]
    v_cvt_pk_bf16_f32 v63, v110, v111
    v_mul_f32 v100, v18, v100
    s_waitcnt lgkmcnt(7)
    v_mfma_f32_16x16x32_bf16 v[220:223], a[208:211], a[48:51], v[220:223]
    buffer_load_dwordx4 v11, s[40:43], s57 offen offset:1056 lds
    v_mul_f32 v101, v18, v101
    s_waitcnt lgkmcnt(5)
    v_mfma_f32_16x16x32_bf16 v[220:223], a[212:215], a[60:63], v[220:223]
    v_mul_f32 v102, v18, v102
    v_mul_f32 v103, v18, v103
    s_waitcnt lgkmcnt(3)
    v_mfma_f32_16x16x32_bf16 v[220:223], a[216:219], a[72:75], v[220:223]
    v_mul_f32 v112, v18, v112
    s_waitcnt lgkmcnt(1)
    v_mfma_f32_16x16x32_bf16 v[220:223], a[220:223], a[84:87], v[220:223]
    buffer_store_dwordx4 v[60:63], v12, s[44:47], s11 offen offset:2048 sc1
    v_mul_f32 v113, v18, v113
    v_mul_f32 v114, v18, v114
    v_mfma_f32_16x16x32_bf16 v[224:227], a[220:223], a[88:91], v[224:227]
    ds_read_b64_tr_b16 a[226:227], v2 offset:51264
    v_mul_f32 v115, v18, v115
    v_mfma_f32_16x16x32_bf16 v[224:227], a[216:219], a[76:79], v[224:227]
    v_cvt_pk_bf16_f32 v64, v100, v101
    v_cvt_pk_bf16_f32 v65, v102, v103
    v_mfma_f32_16x16x32_bf16 v[224:227], a[212:215], a[64:67], v[224:227]
    ds_read_b64_tr_b16 a[228:229], v2 offset:50880
    v_cvt_pk_bf16_f32 v66, v112, v113
    v_mfma_f32_16x16x32_bf16 v[224:227], a[208:211], a[52:55], v[224:227]
    ds_read_b64_tr_b16 a[230:231], v2 offset:51392
    v_cvt_pk_bf16_f32 v67, v114, v115
    v_mfma_f32_16x16x32_bf16 v[228:231], a[208:211], a[56:59], v[228:231]
    ds_read_b64_tr_b16 a[192:193], v3 offset:25408
    ds_read_b64_tr_b16 a[194:195], v3 offset:25920
    v_mfma_f32_16x16x32_bf16 v[228:231], a[212:215], a[68:71], v[228:231]
    ds_read_b64_tr_b16 a[196:197], v3 offset:25536
    ds_read_b64_tr_b16 a[198:199], v3 offset:26048
    v_mfma_f32_16x16x32_bf16 v[228:231], a[216:219], a[80:83], v[228:231]
    buffer_store_dwordx4 v[64:67], v12, s[44:47], s11 offen offset:3072 sc1
    v_mfma_f32_16x16x32_bf16 v[228:231], a[220:223], a[92:95], v[228:231]
    ds_read_b64_tr_b16 a[200:201], v2 offset:50784
    s_waitcnt lgkmcnt(7)
    v_mfma_f32_16x16x32_bf16 v[232:235], a[224:227], a[48:51], v[232:235]
    ds_read_b64_tr_b16 a[202:203], v2 offset:51296
K_NOSLOW1:
    s_waitcnt lgkmcnt(6)
    v_mfma_f32_16x16x32_bf16 v[232:235], a[228:231], a[60:63], v[232:235]
    ds_read_b64_tr_b16 a[204:205], v2 offset:50912
    s_waitcnt lgkmcnt(5)
    v_mfma_f32_16x16x32_bf16 v[232:235], a[192:195], a[72:75], v[232:235]
    ds_read_b64_tr_b16 a[206:207], v2 offset:51424
    s_waitcnt lgkmcnt(4)
    v_mfma_f32_16x16x32_bf16 v[232:235], a[196:199], a[84:87], v[232:235]
    ds_read_b64_tr_b16 a[208:209], v3 offset:25440
    v_mfma_f32_16x16x32_bf16 v[236:239], a[196:199], a[88:91], v[236:239]
    ds_read_b64_tr_b16 a[210:211], v3 offset:25952
    v_mfma_f32_16x16x32_bf16 v[236:239], a[192:195], a[76:79], v[236:239]
    ds_read_b64_tr_b16 a[212:213], v3 offset:25568
    v_mfma_f32_16x16x32_bf16 v[236:239], a[228:231], a[64:67], v[236:239]
    ds_read_b64_tr_b16 a[214:215], v3 offset:26080
    v_mfma_f32_16x16x32_bf16 v[236:239], a[224:227], a[52:55], v[236:239]
    s_add_u32 m0, s56, 25344
    s_add_u32 s57, s64, 0
    v_mfma_f32_16x16x32_bf16 v[240:243], a[224:227], a[56:59], v[240:243]
    buffer_load_dwordx4 v10, s[40:43], s57 offen offset:0 lds
    v_mfma_f32_16x16x32_bf16 v[240:243], a[228:231], a[68:71], v[240:243]
    v_mfma_f32_16x16x32_bf16 v[240:243], a[192:195], a[80:83], v[240:243]
    v_mfma_f32_16x16x32_bf16 v[240:243], a[196:199], a[92:95], v[240:243]
    s_waitcnt lgkmcnt(4)
    v_mfma_f32_16x16x32_bf16 v[244:247], a[200:203], a[48:51], v[244:247]
    s_waitcnt vmcnt(26) lgkmcnt(3)
    s_barrier
    v_mfma_f32_16x16x32_bf16 v[244:247], a[204:207], a[60:63], v[244:247]
    ds_read_b64_tr_b16 a[216:217], v2 offset:42240
    s_waitcnt lgkmcnt(3)
    v_mfma_f32_16x16x32_bf16 v[244:247], a[208:211], a[72:75], v[244:247]
    buffer_load_dwordx4 v11, s[40:43], s57 offen offset:1056 lds
    s_waitcnt lgkmcnt(1)
    v_mfma_f32_16x16x32_bf16 v[244:247], a[212:215], a[84:87], v[244:247]
    ds_read_b64_tr_b16 a[218:219], v2 offset:42752
    v_mfma_f32_16x16x32_bf16 v[248:251], a[212:215], a[88:91], v[248:251]
    ds_read_b64_tr_b16 a[220:221], v2 offset:42368
    v_mfma_f32_16x16x32_bf16 v[248:251], a[208:211], a[76:79], v[248:251]
    ds_read_b64_tr_b16 a[222:223], v2 offset:42880
    v_mfma_f32_16x16x32_bf16 v[248:251], a[204:207], a[64:67], v[248:251]
    ds_read_b64_tr_b16 a[224:225], v2 offset:59136
    v_mfma_f32_16x16x32_bf16 v[248:251], a[200:203], a[52:55], v[248:251]
    ds_read_b64_tr_b16 a[226:227], v2 offset:59648
    v_mfma_f32_16x16x32_bf16 v[252:255], a[200:203], a[56:59], v[252:255]
    ds_read_b64_tr_b16 a[228:229], v2 offset:59264
    v_mfma_f32_16x16x32_bf16 v[252:255], a[204:207], a[68:71], v[252:255]
    ds_read_b64_tr_b16 a[230:231], v2 offset:59776
    v_mfma_f32_16x16x32_bf16 v[252:255], a[208:211], a[80:83], v[252:255]
    ds_read_b64_tr_b16 a[192:193], v2 offset:42272
    v_mfma_f32_16x16x32_bf16 v[252:255], a[212:215], a[92:95], v[252:255]
    ds_read_b64_tr_b16 a[194:195], v2 offset:42784
    s_waitcnt lgkmcnt(8)
    v_mfma_f32_16x16x32_bf16 v[116:119], a[216:219], a[48:51], v[116:119]
    ds_read_b64_tr_b16 a[196:197], v2 offset:42400
    s_waitcnt lgkmcnt(7)
    v_mfma_f32_16x16x32_bf16 v[116:119], a[220:223], a[60:63], v[116:119]
    ds_read_b64_tr_b16 a[198:199], v2 offset:42912
    s_waitcnt lgkmcnt(6)
    v_mfma_f32_16x16x32_bf16 v[116:119], a[224:227], a[72:75], v[116:119]
    ds_read_b64_tr_b16 a[200:201], v2 offset:59168
    s_waitcnt lgkmcnt(5)
    v_mfma_f32_16x16x32_bf16 v[116:119], a[228:231], a[84:87], v[116:119]
    s_add_u32 m0, s56, 33792
    s_add_u32 s57, s64, 65536
    v_mfma_f32_16x16x32_bf16 v[120:123], a[228:231], a[88:91], v[120:123]
    buffer_load_dwordx4 v10, s[40:43], s57 offen offset:0 lds
    v_mfma_f32_16x16x32_bf16 v[120:123], a[224:227], a[76:79], v[120:123]
    ds_read_b64_tr_b16 a[202:203], v2 offset:59680
    v_mfma_f32_16x16x32_bf16 v[120:123], a[220:223], a[64:67], v[120:123]
    ds_read_b64_tr_b16 a[204:205], v2 offset:59296
    v_mfma_f32_16x16x32_bf16 v[120:123], a[216:219], a[52:55], v[120:123]
    ds_read_b64_tr_b16 a[206:207], v2 offset:59808
    v_mfma_f32_16x16x32_bf16 v[124:127], a[216:219], a[56:59], v[124:127]
    buffer_load_dwordx4 v11, s[40:43], s57 offen offset:1056 lds
    v_mfma_f32_16x16x32_bf16 v[124:127], a[220:223], a[68:71], v[124:127]
    ds_read_b64_tr_b16 a[208:209], v2 offset:42304
    v_mfma_f32_16x16x32_bf16 v[124:127], a[224:227], a[80:83], v[124:127]
    ds_read_b64_tr_b16 a[210:211], v2 offset:42816
    v_mfma_f32_16x16x32_bf16 v[124:127], a[228:231], a[92:95], v[124:127]
    ds_read_b64_tr_b16 a[212:213], v2 offset:42432
    s_waitcnt lgkmcnt(6)
    v_mfma_f32_16x16x32_bf16 v[128:131], a[192:195], a[48:51], v[128:131]
    ds_read_b64_tr_b16 a[214:215], v2 offset:42944
    v_mfma_f32_16x16x32_bf16 v[128:131], a[196:199], a[60:63], v[128:131]
    ds_read_b64_tr_b16 a[216:217], v2 offset:59200
    s_waitcnt lgkmcnt(7)
    v_mfma_f32_16x16x32_bf16 v[128:131], a[200:203], a[72:75], v[128:131]
    ds_read_b64_tr_b16 a[218:219], v2 offset:59712
    s_waitcnt lgkmcnt(6)
    v_mfma_f32_16x16x32_bf16 v[128:131], a[204:207], a[84:87], v[128:131]
    s_add_u32 m0, s56, 50688
    s_add_u32 s57, s7, 0
    v_mfma_f32_16x16x32_bf16 v[132:135], a[204:207], a[88:91], v[132:135]
    ds_read_b64_tr_b16 a[220:221], v2 offset:59328
    v_mfma_f32_16x16x32_bf16 v[132:135], a[200:203], a[76:79], v[132:135]
    ds_read_b64_tr_b16 a[222:223], v2 offset:59840
    v_mfma_f32_16x16x32_bf16 v[132:135], a[196:199], a[64:67], v[132:135]
    s_waitcnt vmcnt(4)
    s_mov_b64 exec, 1
    buffer_store_byte a252, v13, s[44:47], s76 offen offset:0 sc1
    s_mov_b64 exec, -1
    v_mfma_f32_16x16x32_bf16 v[132:135], a[192:195], a[52:55], v[132:135]
    buffer_load_dwordx4 v10, s[40:43], s57 offen offset:0 lds
    v_mfma_f32_16x16x32_bf16 v[136:139], a[192:195], a[56:59], v[136:139]
    ds_read_b64_tr_b16 a[224:225], v2 offset:42336
    v_mfma_f32_16x16x32_bf16 v[136:139], a[196:199], a[68:71], v[136:139]
    ds_read_b64_tr_b16 a[226:227], v2 offset:42848
    v_mfma_f32_16x16x32_bf16 v[136:139], a[200:203], a[80:83], v[136:139]
    ds_read_b64_tr_b16 a[228:229], v2 offset:42464
    v_mfma_f32_16x16x32_bf16 v[136:139], a[204:207], a[92:95], v[136:139]
    ds_read_b64_tr_b16 a[230:231], v2 offset:42976
    s_waitcnt lgkmcnt(6)
    v_mfma_f32_16x16x32_bf16 v[140:143], a[208:211], a[48:51], v[140:143]
    buffer_load_dwordx4 v11, s[40:43], s57 offen offset:1056 lds
    v_mfma_f32_16x16x32_bf16 v[140:143], a[212:215], a[60:63], v[140:143]
    s_add_u32 m0, s56, 76032
    s_add_u32 s57, s7, 65536
    v_mfma_f32_16x16x32_bf16 v[140:143], a[216:219], a[72:75], v[140:143]
    ds_read_b64_tr_b16 a[192:193], v2 offset:59232
    s_waitcnt lgkmcnt(5)
    v_mfma_f32_16x16x32_bf16 v[140:143], a[220:223], a[84:87], v[140:143]
    ds_read_b64_tr_b16 a[194:195], v2 offset:59744
    v_mfma_f32_16x16x32_bf16 v[144:147], a[220:223], a[88:91], v[144:147]
    ds_read_b64_tr_b16 a[196:197], v2 offset:59360
    v_mfma_f32_16x16x32_bf16 v[144:147], a[216:219], a[76:79], v[144:147]
    ds_read_b64_tr_b16 a[198:199], v2 offset:59872
    buffer_load_dwordx4 v10, s[40:43], s57 offen offset:0 lds
    v_mfma_f32_16x16x32_bf16 v[144:147], a[212:215], a[64:67], v[144:147]
    v_mfma_f32_16x16x32_bf16 v[144:147], a[208:211], a[52:55], v[144:147]
    v_mfma_f32_16x16x32_bf16 v[148:151], a[208:211], a[56:59], v[148:151]
    v_mfma_f32_16x16x32_bf16 v[148:151], a[212:215], a[68:71], v[148:151]
    buffer_load_dwordx4 v11, s[40:43], s57 offen offset:1056 lds
    v_mfma_f32_16x16x32_bf16 v[148:151], a[216:219], a[80:83], v[148:151]
    v_mfma_f32_16x16x32_bf16 v[148:151], a[220:223], a[92:95], v[148:151]
    s_waitcnt lgkmcnt(3)
    v_mfma_f32_16x16x32_bf16 v[152:155], a[224:227], a[48:51], v[152:155]
    s_waitcnt lgkmcnt(2)
    s_barrier
    v_mfma_f32_16x16x32_bf16 v[152:155], a[228:231], a[60:63], v[152:155]
    s_add_u32 m0, s56, 42240
    s_add_u32 s57, s61, 131072
    v_mfma_f32_16x16x32_bf16 v[152:155], a[192:195], a[72:75], v[152:155]
    ds_read_b64_tr_b16 a[200:201], v2 offset:0
    s_waitcnt lgkmcnt(1)
    v_mfma_f32_16x16x32_bf16 v[152:155], a[196:199], a[84:87], v[152:155]
    buffer_load_dwordx4 v10, s[40:43], s57 offen offset:0 lds
    v_mfma_f32_16x16x32_bf16 v[156:159], a[196:199], a[88:91], v[156:159]
    ds_read_b64_tr_b16 a[202:203], v2 offset:512
    v_mfma_f32_16x16x32_bf16 v[156:159], a[192:195], a[76:79], v[156:159]
    ds_read_b64_tr_b16 a[204:205], v2 offset:128
    v_mfma_f32_16x16x32_bf16 v[156:159], a[228:231], a[64:67], v[156:159]
    ds_read_b64_tr_b16 a[206:207], v2 offset:640
    v_mfma_f32_16x16x32_bf16 v[156:159], a[224:227], a[52:55], v[156:159]
    ds_read_b64_tr_b16 a[208:209], v3 offset:0
    v_mfma_f32_16x16x32_bf16 v[160:163], a[224:227], a[56:59], v[160:163]
    ds_read_b64_tr_b16 a[210:211], v3 offset:512
    v_mfma_f32_16x16x32_bf16 v[160:163], a[228:231], a[68:71], v[160:163]
    ds_read_b64_tr_b16 a[212:213], v3 offset:128
    ds_read_b64_tr_b16 a[214:215], v3 offset:640
    v_mfma_f32_16x16x32_bf16 v[160:163], a[192:195], a[80:83], v[160:163]
    ds_read_b64_tr_b16 a[216:217], v2 offset:32
    buffer_load_dwordx4 v11, s[40:43], s57 offen offset:1056 lds
    v_mfma_f32_16x16x32_bf16 v[160:163], a[196:199], a[92:95], v[160:163]
    s_waitcnt lgkmcnt(7)
    v_mfma_f32_16x16x32_bf16 v[208:211], a[200:203], a[96:99], v[208:211]
    s_waitcnt lgkmcnt(5)
    v_mfma_f32_16x16x32_bf16 v[208:211], a[204:207], a[108:111], v[208:211]
    s_waitcnt lgkmcnt(3)
    v_mfma_f32_16x16x32_bf16 v[208:211], a[208:211], a[120:123], v[208:211]
    s_waitcnt lgkmcnt(1)
    v_mfma_f32_16x16x32_bf16 v[208:211], a[212:215], a[132:135], v[208:211]
    ds_read_b64_tr_b16 a[218:219], v2 offset:544
    v_mfma_f32_16x16x32_bf16 v[212:215], a[212:215], a[136:139], v[212:215]
    ds_read_b64_tr_b16 a[220:221], v2 offset:160
    v_mfma_f32_16x16x32_bf16 v[212:215], a[208:211], a[124:127], v[212:215]
    ds_read_b64_tr_b16 a[222:223], v2 offset:672
    v_mfma_f32_16x16x32_bf16 v[212:215], a[204:207], a[112:115], v[212:215]
    ds_read_b64_tr_b16 a[224:225], v3 offset:32
    v_mfma_f32_16x16x32_bf16 v[212:215], a[200:203], a[100:103], v[212:215]
    ds_read_b64_tr_b16 a[226:227], v3 offset:544
    v_mfma_f32_16x16x32_bf16 v[216:219], a[200:203], a[104:107], v[216:219]
    ds_read_b64_tr_b16 a[228:229], v3 offset:160
    v_mfma_f32_16x16x32_bf16 v[216:219], a[204:207], a[116:119], v[216:219]
    ds_read_b64_tr_b16 a[230:231], v3 offset:672
    v_mfma_f32_16x16x32_bf16 v[216:219], a[208:211], a[128:131], v[216:219]
    ds_read_b64_tr_b16 a[192:193], v2 offset:64
    v_mfma_f32_16x16x32_bf16 v[216:219], a[212:215], a[140:143], v[216:219]
    ds_read_b64_tr_b16 a[194:195], v2 offset:576
    s_waitcnt lgkmcnt(8)
    v_mfma_f32_16x16x32_bf16 v[220:223], a[216:219], a[96:99], v[220:223]
    ds_read_b64_tr_b16 a[196:197], v2 offset:192
    s_waitcnt lgkmcnt(7)
    v_mfma_f32_16x16x32_bf16 v[220:223], a[220:223], a[108:111], v[220:223]
    s_add_u32 m0, s56, 84480
    s_add_u32 s57, s61, 196608
    s_waitcnt lgkmcnt(5)
    v_mfma_f32_16x16x32_bf16 v[220:223], a[224:227], a[120:123], v[220:223]
    ds_read_b64_tr_b16 a[198:199], v2 offset:704
    s_waitcnt lgkmcnt(4)
    v_mfma_f32_16x16x32_bf16 v[220:223], a[228:231], a[132:135], v[220:223]
    buffer_load_dwordx4 v10, s[40:43], s57 offen offset:0 lds
    v_mfma_f32_16x16x32_bf16 v[224:227], a[228:231], a[136:139], v[224:227]
    ds_read_b64_tr_b16 a[200:201], v3 offset:64
    v_mfma_f32_16x16x32_bf16 v[224:227], a[224:227], a[124:127], v[224:227]
    ds_read_b64_tr_b16 a[202:203], v3 offset:576
    v_mfma_f32_16x16x32_bf16 v[224:227], a[220:223], a[112:115], v[224:227]
    ds_read_b64_tr_b16 a[204:205], v3 offset:192
    v_mfma_f32_16x16x32_bf16 v[224:227], a[216:219], a[100:103], v[224:227]
    buffer_load_dwordx4 v11, s[40:43], s57 offen offset:1056 lds
    v_mfma_f32_16x16x32_bf16 v[228:231], a[216:219], a[104:107], v[228:231]
    ds_read_b64_tr_b16 a[206:207], v3 offset:704
    v_mfma_f32_16x16x32_bf16 v[228:231], a[220:223], a[116:119], v[228:231]
    buffer_load_ubyte v14, v13, s[44:47], s75 offen offset:0 sc1
    v_mfma_f32_16x16x32_bf16 v[228:231], a[224:227], a[128:131], v[228:231]
    ds_read_b64_tr_b16 a[208:209], v2 offset:96
    v_mfma_f32_16x16x32_bf16 v[228:231], a[228:231], a[140:143], v[228:231]
    ds_read_b64_tr_b16 a[210:211], v2 offset:608
    s_waitcnt lgkmcnt(6)
    v_mfma_f32_16x16x32_bf16 v[232:235], a[192:195], a[96:99], v[232:235]
    ds_read_b64_tr_b16 a[212:213], v2 offset:224
    v_mfma_f32_16x16x32_bf16 v[232:235], a[196:199], a[108:111], v[232:235]
    ds_read_b64_tr_b16 a[214:215], v2 offset:736
    s_waitcnt lgkmcnt(6)
    v_mfma_f32_16x16x32_bf16 v[232:235], a[200:203], a[120:123], v[232:235]
    ds_read_b64_tr_b16 a[216:217], v3 offset:96
    s_waitcnt lgkmcnt(5)
    v_mfma_f32_16x16x32_bf16 v[232:235], a[204:207], a[132:135], v[232:235]
    s_add_u32 m0, s56, 92928
    s_add_u32 s57, s4, 131072
    v_mfma_f32_16x16x32_bf16 v[236:239], a[204:207], a[136:139], v[236:239]
    buffer_load_dwordx4 v10, s[40:43], s57 offen offset:0 lds
    v_mfma_f32_16x16x32_bf16 v[236:239], a[200:203], a[124:127], v[236:239]
    ds_read_b64_tr_b16 a[218:219], v3 offset:608
    v_mfma_f32_16x16x32_bf16 v[236:239], a[196:199], a[112:115], v[236:239]
    ds_read_b64_tr_b16 a[220:221], v3 offset:224
    v_mfma_f32_16x16x32_bf16 v[236:239], a[192:195], a[100:103], v[236:239]
    ds_read_b64_tr_b16 a[222:223], v3 offset:736
    v_mfma_f32_16x16x32_bf16 v[240:243], a[192:195], a[104:107], v[240:243]
    buffer_load_dwordx4 v11, s[40:43], s57 offen offset:1056 lds
    v_mfma_f32_16x16x32_bf16 v[240:243], a[196:199], a[116:119], v[240:243]
    s_add_u32 m0, s56, 101376
    s_add_u32 s57, s4, 196608
    v_mfma_f32_16x16x32_bf16 v[240:243], a[200:203], a[128:131], v[240:243]
    v_mfma_f32_16x16x32_bf16 v[240:243], a[204:207], a[140:143], v[240:243]
    s_waitcnt lgkmcnt(3)
    v_mfma_f32_16x16x32_bf16 v[244:247], a[208:211], a[96:99], v[244:247]
    s_waitcnt vmcnt(12) lgkmcnt(3)
    s_barrier
    v_mfma_f32_16x16x32_bf16 v[244:247], a[212:215], a[108:111], v[244:247]
    buffer_load_dwordx4 v10, s[40:43], s57 offen offset:0 lds
    s_waitcnt lgkmcnt(2)
    v_mfma_f32_16x16x32_bf16 v[244:247], a[216:219], a[120:123], v[244:247]
    ds_read_b64_tr_b16 a[224:225], v2 offset:8448
    s_waitcnt lgkmcnt(1)
    v_mfma_f32_16x16x32_bf16 v[244:247], a[220:223], a[132:135], v[244:247]
    ds_read_b64_tr_b16 a[226:227], v2 offset:8960
    v_mfma_f32_16x16x32_bf16 v[248:251], a[220:223], a[136:139], v[248:251]
    ds_read_b64_tr_b16 a[228:229], v2 offset:8576
    v_mfma_f32_16x16x32_bf16 v[248:251], a[216:219], a[124:127], v[248:251]
    buffer_load_dwordx4 v11, s[40:43], s57 offen offset:1056 lds
    v_mfma_f32_16x16x32_bf16 v[248:251], a[212:215], a[112:115], v[248:251]
    ds_read_b64_tr_b16 a[230:231], v2 offset:9088
    v_mfma_f32_16x16x32_bf16 v[248:251], a[208:211], a[100:103], v[248:251]
    ds_read_b64_tr_b16 a[192:193], v2 offset:16896
    v_mfma_f32_16x16x32_bf16 v[252:255], a[208:211], a[104:107], v[252:255]
    ds_read_b64_tr_b16 a[194:195], v2 offset:17408
    v_mfma_f32_16x16x32_bf16 v[252:255], a[212:215], a[116:119], v[252:255]
    ds_read_b64_tr_b16 a[196:197], v2 offset:17024
    ds_read_b64_tr_b16 a[198:199], v2 offset:17536
    v_mfma_f32_16x16x32_bf16 v[252:255], a[216:219], a[128:131], v[252:255]
    ds_read_b64_tr_b16 a[200:201], v2 offset:8480
    v_mfma_f32_16x16x32_bf16 v[252:255], a[220:223], a[140:143], v[252:255]
    ds_read_b64_tr_b16 a[202:203], v2 offset:8992
    s_waitcnt lgkmcnt(8)
    v_mfma_f32_16x16x32_bf16 v[116:119], a[224:227], a[96:99], v[116:119]
    ds_read_b64_tr_b16 a[204:205], v2 offset:8608
    s_waitcnt lgkmcnt(7)
    v_mfma_f32_16x16x32_bf16 v[116:119], a[228:231], a[108:111], v[116:119]
    ds_read_b64_tr_b16 a[206:207], v2 offset:9120
    s_waitcnt lgkmcnt(6)
    v_mfma_f32_16x16x32_bf16 v[116:119], a[192:195], a[120:123], v[116:119]
    ds_read_b64_tr_b16 a[208:209], v2 offset:16928
    s_waitcnt lgkmcnt(5)
    v_mfma_f32_16x16x32_bf16 v[116:119], a[196:199], a[132:135], v[116:119]
    s_add_u32 m0, s56, 0
    s_add_u32 s57, s62, 131072
    v_mfma_f32_16x16x32_bf16 v[120:123], a[196:199], a[136:139], v[120:123]
    ds_read_b64_tr_b16 a[210:211], v2 offset:17440
    v_mfma_f32_16x16x32_bf16 v[120:123], a[192:195], a[124:127], v[120:123]
    buffer_load_dwordx4 v10, s[40:43], s57 offen offset:0 lds
    v_mfma_f32_16x16x32_bf16 v[120:123], a[228:231], a[112:115], v[120:123]
    ds_read_b64_tr_b16 a[212:213], v2 offset:17056
    v_mfma_f32_16x16x32_bf16 v[120:123], a[224:227], a[100:103], v[120:123]
    ds_read_b64_tr_b16 a[214:215], v2 offset:17568
    v_mfma_f32_16x16x32_bf16 v[124:127], a[224:227], a[104:107], v[124:127]
    s_waitcnt vmcnt(5)
    v_cmp_gt_u32 vcc, 0xff, v14
    s_and_b32 s87, vcc_lo, s79
    s_cbranch_scc1 K_PB
K_PB_ret:
    v_mfma_f32_16x16x32_bf16 v[124:127], a[228:231], a[116:119], v[124:127]
    buffer_load_dwordx4 v11, s[40:43], s57 offen offset:1056 lds
    v_mfma_f32_16x16x32_bf16 v[124:127], a[192:195], a[128:131], v[124:127]
    ds_read_b64_tr_b16 a[216:217], v2 offset:25344
    v_mfma_f32_16x16x32_bf16 v[124:127], a[196:199], a[140:143], v[124:127]
    ds_read_b64_tr_b16 a[218:219], v2 offset:25856
    s_waitcnt lgkmcnt(5)
    v_mfma_f32_16x16x32_bf16 v[128:131], a[200:203], a[96:99], v[128:131]
    ds_read_b64_tr_b16 a[220:221], v2 offset:25472
    v_mfma_f32_16x16x32_bf16 v[128:131], a[204:207], a[108:111], v[128:131]
    ds_read_b64_tr_b16 a[222:223], v2 offset:25984
    s_waitcnt lgkmcnt(6)
    v_mfma_f32_16x16x32_bf16 v[128:131], a[208:211], a[120:123], v[128:131]
    s_add_u32 s10, s66, 49152
    buffer_load_dwordx4 v[68:71], v12, s[44:47], s10 offen offset:0 sc1
    s_waitcnt lgkmcnt(4)
    v_mfma_f32_16x16x32_bf16 v[128:131], a[212:215], a[132:135], v[128:131]
    s_mov_b64 exec, 1
    buffer_store_byte a252, v13, s[44:47], s17 offen offset:0 sc1
    s_mov_b64 exec, -1
    v_mfma_f32_16x16x32_bf16 v[132:135], a[212:215], a[136:139], v[132:135]
    s_add_u32 m0, s56, 59136
    s_add_u32 s57, s62, 196608
    v_mfma_f32_16x16x32_bf16 v[132:135], a[208:211], a[124:127], v[132:135]
    ds_read_b64_tr_b16 a[224:225], v2 offset:33792
    v_mfma_f32_16x16x32_bf16 v[132:135], a[204:207], a[112:115], v[132:135]
    ds_read_b64_tr_b16 a[226:227], v2 offset:34304
    buffer_load_dwordx4 v[72:75], v12, s[44:47], s10 offen offset:1024 sc1
    v_mfma_f32_16x16x32_bf16 v[132:135], a[200:203], a[100:103], v[132:135]
    ds_read_b64_tr_b16 a[228:229], v2 offset:33920
    v_mfma_f32_16x16x32_bf16 v[136:139], a[200:203], a[104:107], v[136:139]
    ds_read_b64_tr_b16 a[230:231], v2 offset:34432
    v_mfma_f32_16x16x32_bf16 v[136:139], a[204:207], a[116:119], v[136:139]
    ds_read_b64_tr_b16 a[192:193], v2 offset:25376
    v_mfma_f32_16x16x32_bf16 v[136:139], a[208:211], a[128:131], v[136:139]
    buffer_load_dwordx4 v10, s[40:43], s57 offen offset:0 lds
    v_mfma_f32_16x16x32_bf16 v[136:139], a[212:215], a[140:143], v[136:139]
    s_waitcnt lgkmcnt(5)
    v_mfma_f32_16x16x32_bf16 v[208:211], a[216:219], a[0:3], v[208:211]
    ds_read_b64_tr_b16 a[194:195], v2 offset:25888
    v_mfma_f32_16x16x32_bf16 v[208:211], a[220:223], a[12:15], v[208:211]
    s_waitcnt lgkmcnt(4)
    v_mfma_f32_16x16x32_bf16 v[208:211], a[224:227], a[24:27], v[208:211]
    s_waitcnt lgkmcnt(2)
    v_mfma_f32_16x16x32_bf16 v[208:211], a[228:231], a[36:39], v[208:211]
    buffer_load_dwordx4 v11, s[40:43], s57 offen offset:1056 lds
    v_mfma_f32_16x16x32_bf16 v[212:215], a[228:231], a[40:43], v[212:215]
    ds_read_b64_tr_b16 a[196:197], v2 offset:25504
    v_mfma_f32_16x16x32_bf16 v[212:215], a[224:227], a[28:31], v[212:215]
    ds_read_b64_tr_b16 a[198:199], v2 offset:26016
    v_mfma_f32_16x16x32_bf16 v[212:215], a[220:223], a[16:19], v[212:215]
    s_add_u32 m0, s56, 109824
    s_add_u32 s57, s5, 131072
    v_mfma_f32_16x16x32_bf16 v[212:215], a[216:219], a[4:7], v[212:215]
    buffer_load_dwordx4 v[76:79], v12, s[44:47], s10 offen offset:2048 sc1
    v_mfma_f32_16x16x32_bf16 v[216:219], a[216:219], a[8:11], v[216:219]
    ds_read_b64_tr_b16 a[200:201], v2 offset:33824
    ds_read_b64_tr_b16 a[202:203], v2 offset:34336
    v_mfma_f32_16x16x32_bf16 v[216:219], a[220:223], a[20:23], v[216:219]
    ds_read_b64_tr_b16 a[204:205], v2 offset:33952
    ds_read_b64_tr_b16 a[206:207], v2 offset:34464
    v_mfma_f32_16x16x32_bf16 v[216:219], a[224:227], a[32:35], v[216:219]
    ds_read_b64_tr_b16 a[208:209], v2 offset:25408
    v_mfma_f32_16x16x32_bf16 v[216:219], a[228:231], a[44:47], v[216:219]
    buffer_load_dwordx4 v[80:83], v12, s[44:47], s10 offen offset:3072 sc1
    s_waitcnt lgkmcnt(7)
    v_mfma_f32_16x16x32_bf16 v[220:223], a[192:195], a[0:3], v[220:223]
    s_waitcnt lgkmcnt(5)
    s_barrier
    v_mfma_f32_16x16x32_bf16 v[220:223], a[196:199], a[12:15], v[220:223]
    ds_read_b64_tr_b16 a[210:211], v2 offset:25920
    s_waitcnt lgkmcnt(4)
    v_mfma_f32_16x16x32_bf16 v[220:223], a[200:203], a[24:27], v[220:223]
    ds_read_b64_tr_b16 a[212:213], v2 offset:25536
    s_waitcnt lgkmcnt(3)
    v_mfma_f32_16x16x32_bf16 v[220:223], a[204:207], a[36:39], v[220:223]
    ds_read_b64_tr_b16 a[214:215], v2 offset:26048
    buffer_load_dwordx4 v10, s[40:43], s57 offen offset:0 lds
    v_mfma_f32_16x16x32_bf16 v[224:227], a[204:207], a[40:43], v[224:227]
    ds_read_b64_tr_b16 a[216:217], v2 offset:33856
    v_mfma_f32_16x16x32_bf16 v[224:227], a[200:203], a[28:31], v[224:227]
    ds_read_b64_tr_b16 a[218:219], v2 offset:34368
    v_mfma_f32_16x16x32_bf16 v[224:227], a[196:199], a[16:19], v[224:227]
    ds_read_b64_tr_b16 a[220:221], v2 offset:33984
    v_mfma_f32_16x16x32_bf16 v[224:227], a[192:195], a[4:7], v[224:227]
    buffer_load_dwordx4 v11, s[40:43], s57 offen offset:1056 lds
    v_mfma_f32_16x16x32_bf16 v[228:231], a[192:195], a[8:11], v[228:231]
    ds_read_b64_tr_b16 a[222:223], v2 offset:34496
    v_mfma_f32_16x16x32_bf16 v[228:231], a[196:199], a[20:23], v[228:231]
    s_add_u32 m0, s56, 67584
    s_add_u32 s57, s5, 196608
    v_mfma_f32_16x16x32_bf16 v[228:231], a[200:203], a[32:35], v[228:231]
    ds_read_b64_tr_b16 a[224:225], v2 offset:25440
    v_mfma_f32_16x16x32_bf16 v[228:231], a[204:207], a[44:47], v[228:231]
    s_add_u32 s10, s66, 53248
    buffer_load_dwordx4 v[84:87], v12, s[44:47], s10 offen offset:0 sc1
    s_waitcnt lgkmcnt(6)
    v_mfma_f32_16x16x32_bf16 v[232:235], a[208:211], a[0:3], v[232:235]
    ds_read_b64_tr_b16 a[226:227], v2 offset:25952
    s_waitcnt lgkmcnt(6)
    v_mfma_f32_16x16x32_bf16 v[232:235], a[212:215], a[12:15], v[232:235]
    ds_read_b64_tr_b16 a[228:229], v2 offset:25568
    s_waitcnt lgkmcnt(5)
    v_mfma_f32_16x16x32_bf16 v[232:235], a[216:219], a[24:27], v[232:235]
    ds_read_b64_tr_b16 a[230:231], v2 offset:26080
    s_waitcnt lgkmcnt(4)
    v_mfma_f32_16x16x32_bf16 v[232:235], a[220:223], a[36:39], v[232:235]
    buffer_load_dwordx4 v[88:91], v12, s[44:47], s10 offen offset:1024 sc1
    v_mfma_f32_16x16x32_bf16 v[236:239], a[220:223], a[40:43], v[236:239]
    ds_read_b64_tr_b16 a[192:193], v2 offset:33888
    v_mfma_f32_16x16x32_bf16 v[236:239], a[216:219], a[28:31], v[236:239]
    ds_read_b64_tr_b16 a[194:195], v2 offset:34400
    v_mfma_f32_16x16x32_bf16 v[236:239], a[212:215], a[16:19], v[236:239]
    ds_read_b64_tr_b16 a[196:197], v2 offset:34016
    v_mfma_f32_16x16x32_bf16 v[236:239], a[208:211], a[4:7], v[236:239]
    buffer_load_dwordx4 v10, s[40:43], s57 offen offset:0 lds
    v_mfma_f32_16x16x32_bf16 v[240:243], a[208:211], a[8:11], v[240:243]
    ds_read_b64_tr_b16 a[198:199], v2 offset:34528
    v_mfma_f32_16x16x32_bf16 v[240:243], a[212:215], a[20:23], v[240:243]
    ds_read_b64_tr_b16 a[200:201], v2 offset:50688
    v_mfma_f32_16x16x32_bf16 v[240:243], a[216:219], a[32:35], v[240:243]
    ds_read_b64_tr_b16 a[202:203], v2 offset:51200
    v_mfma_f32_16x16x32_bf16 v[240:243], a[220:223], a[44:47], v[240:243]
    buffer_load_dwordx4 v[92:95], v12, s[44:47], s10 offen offset:2048 sc1
    s_waitcnt lgkmcnt(6)
    v_mfma_f32_16x16x32_bf16 v[244:247], a[224:227], a[0:3], v[244:247]
    ds_read_b64_tr_b16 a[204:205], v2 offset:50816
    v_mfma_f32_16x16x32_bf16 v[244:247], a[228:231], a[12:15], v[244:247]
    ds_read_b64_tr_b16 a[206:207], v2 offset:51328
    s_waitcnt lgkmcnt(6)
    v_mfma_f32_16x16x32_bf16 v[244:247], a[192:195], a[24:27], v[244:247]
    ds_read_b64_tr_b16 a[208:209], v3 offset:8448
    s_waitcnt lgkmcnt(5)
    v_mfma_f32_16x16x32_bf16 v[244:247], a[196:199], a[36:39], v[244:247]
    buffer_load_dwordx4 v11, s[40:43], s57 offen offset:1056 lds
    v_mfma_f32_16x16x32_bf16 v[248:251], a[196:199], a[40:43], v[248:251]
    s_add_u32 m0, s56, 118272
    s_add_u32 s57, s63, 131072
    v_mfma_f32_16x16x32_bf16 v[248:251], a[192:195], a[28:31], v[248:251]
    ds_read_b64_tr_b16 a[210:211], v3 offset:8960
    v_mfma_f32_16x16x32_bf16 v[248:251], a[228:231], a[16:19], v[248:251]
    ds_read_b64_tr_b16 a[212:213], v3 offset:8576
    v_mfma_f32_16x16x32_bf16 v[248:251], a[224:227], a[4:7], v[248:251]
    buffer_load_dwordx4 v[96:99], v12, s[44:47], s10 offen offset:3072 sc1
    v_mfma_f32_16x16x32_bf16 v[252:255], a[224:227], a[8:11], v[252:255]
    ds_read_b64_tr_b16 a[214:215], v3 offset:9088
    v_mfma_f32_16x16x32_bf16 v[252:255], a[228:231], a[20:23], v[252:255]
    ds_read_b64_tr_b16 a[216:217], v2 offset:50720
    v_mfma_f32_16x16x32_bf16 v[252:255], a[192:195], a[32:35], v[252:255]
    ds_read_b64_tr_b16 a[218:219], v2 offset:51232
    v_mfma_f32_16x16x32_bf16 v[252:255], a[196:199], a[44:47], v[252:255]
    s_add_u32 s10, s66, 57344
    buffer_load_dwordx4 v[100:103], v12, s[44:47], s10 offen offset:0 sc1
    s_waitcnt lgkmcnt(5)
    v_mfma_f32_16x16x32_bf16 v[116:119], a[200:203], a[0:3], v[116:119]
    ds_read_b64_tr_b16 a[220:221], v2 offset:50848
    v_mfma_f32_16x16x32_bf16 v[116:119], a[204:207], a[12:15], v[116:119]
    ds_read_b64_tr_b16 a[222:223], v2 offset:51360
    s_waitcnt lgkmcnt(6)
    v_mfma_f32_16x16x32_bf16 v[116:119], a[208:211], a[24:27], v[116:119]
    ds_read_b64_tr_b16 a[224:225], v3 offset:8480
    s_waitcnt lgkmcnt(5)
    v_mfma_f32_16x16x32_bf16 v[116:119], a[212:215], a[36:39], v[116:119]
    buffer_load_dwordx4 v10, s[40:43], s57 offen offset:0 lds
    v_mfma_f32_16x16x32_bf16 v[120:123], a[212:215], a[40:43], v[120:123]
    ds_read_b64_tr_b16 a[226:227], v3 offset:8992
    v_mfma_f32_16x16x32_bf16 v[120:123], a[208:211], a[28:31], v[120:123]
    ds_read_b64_tr_b16 a[228:229], v3 offset:8608
    v_mfma_f32_16x16x32_bf16 v[120:123], a[204:207], a[16:19], v[120:123]
    ds_read_b64_tr_b16 a[230:231], v3 offset:9120
    v_mfma_f32_16x16x32_bf16 v[120:123], a[200:203], a[4:7], v[120:123]
    buffer_load_dwordx4 v11, s[40:43], s57 offen offset:1056 lds
    v_mfma_f32_16x16x32_bf16 v[124:127], a[200:203], a[8:11], v[124:127]
    s_add_u32 m0, s56, 126720
    s_add_u32 s57, s63, 196608
    v_mfma_f32_16x16x32_bf16 v[124:127], a[204:207], a[20:23], v[124:127]
    v_mfma_f32_16x16x32_bf16 v[124:127], a[208:211], a[32:35], v[124:127]
    v_mfma_f32_16x16x32_bf16 v[124:127], a[212:215], a[44:47], v[124:127]
    buffer_load_dwordx4 v[104:107], v12, s[44:47], s10 offen offset:1024 sc1
    s_waitcnt lgkmcnt(3)
    v_mfma_f32_16x16x32_bf16 v[128:131], a[216:219], a[0:3], v[128:131]
    s_waitcnt lgkmcnt(3)
    s_barrier
    v_mfma_f32_16x16x32_bf16 v[128:131], a[220:223], a[12:15], v[128:131]
    ds_read_b64_tr_b16 a[192:193], v2 offset:42240
    s_waitcnt lgkmcnt(3)
    v_mfma_f32_16x16x32_bf16 v[128:131], a[224:227], a[24:27], v[128:131]
    ds_read_b64_tr_b16 a[194:195], v2 offset:42752
    s_waitcnt lgkmcnt(2)
    v_mfma_f32_16x16x32_bf16 v[128:131], a[228:231], a[36:39], v[128:131]
    buffer_load_dwordx4 v[108:111], v12, s[44:47], s10 offen offset:2048 sc1
    v_mfma_f32_16x16x32_bf16 v[132:135], a[228:231], a[40:43], v[132:135]
    ds_read_b64_tr_b16 a[196:197], v2 offset:42368
    v_mfma_f32_16x16x32_bf16 v[132:135], a[224:227], a[28:31], v[132:135]
    ds_read_b64_tr_b16 a[198:199], v2 offset:42880
    v_mfma_f32_16x16x32_bf16 v[132:135], a[220:223], a[16:19], v[132:135]
    ds_read_b64_tr_b16 a[200:201], v3 offset:16896
    v_mfma_f32_16x16x32_bf16 v[132:135], a[216:219], a[4:7], v[132:135]
    buffer_load_dwordx4 v10, s[40:43], s57 offen offset:0 lds
    v_mfma_f32_16x16x32_bf16 v[136:139], a[216:219], a[8:11], v[136:139]
    ds_read_b64_tr_b16 a[202:203], v3 offset:17408
    v_mfma_f32_16x16x32_bf16 v[136:139], a[220:223], a[20:23], v[136:139]
    ds_read_b64_tr_b16 a[204:205], v3 offset:17024
    ds_read_b64_tr_b16 a[206:207], v3 offset:17536
    v_mfma_f32_16x16x32_bf16 v[136:139], a[224:227], a[32:35], v[136:139]
    ds_read_b64_tr_b16 a[208:209], v2 offset:42272
    v_mfma_f32_16x16x32_bf16 v[136:139], a[228:231], a[44:47], v[136:139]
    buffer_load_dwordx4 v[112:115], v12, s[44:47], s10 offen offset:3072 sc1
    s_waitcnt lgkmcnt(7)
    v_mfma_f32_16x16x32_bf16 v[208:211], a[192:195], v[20:23], v[208:211]
    ds_read_b64_tr_b16 a[210:211], v2 offset:42784
    s_waitcnt lgkmcnt(6)
    v_mfma_f32_16x16x32_bf16 v[208:211], a[196:199], v[32:35], v[208:211]
    ds_read_b64_tr_b16 a[212:213], v2 offset:42400
    s_waitcnt lgkmcnt(5)
    v_mfma_f32_16x16x32_bf16 v[208:211], a[200:203], v[44:47], v[208:211]
    ds_read_b64_tr_b16 a[214:215], v2 offset:42912
    s_waitcnt lgkmcnt(4)
    v_mfma_f32_16x16x32_bf16 v[208:211], a[204:207], v[56:59], v[208:211]
    buffer_load_dwordx4 v11, s[40:43], s57 offen offset:1056 lds
    v_mfma_f32_16x16x32_bf16 v[212:215], a[204:207], v[60:63], v[212:215]
    s_add_u32 m0, s56, 25344
    s_add_u32 s57, s64, 131072
    v_mfma_f32_16x16x32_bf16 v[212:215], a[200:203], v[48:51], v[212:215]
    ds_read_b64_tr_b16 a[216:217], v3 offset:16928
    v_mfma_f32_16x16x32_bf16 v[212:215], a[196:199], v[36:39], v[212:215]
    ds_read_b64_tr_b16 a[218:219], v3 offset:17440
    v_mfma_f32_16x16x32_bf16 v[212:215], a[192:195], v[24:27], v[212:215]
    s_add_u32 s10, s67, 49152
    buffer_load_dwordx4 a[144:147], v12, s[44:47], s10 offen offset:0 sc1
    v_mfma_f32_16x16x32_bf16 v[216:219], a[192:195], v[28:31], v[216:219]
    ds_read_b64_tr_b16 a[220:221], v3 offset:17056
    v_mfma_f32_16x16x32_bf16 v[216:219], a[196:199], v[40:43], v[216:219]
    ds_read_b64_tr_b16 a[222:223], v3 offset:17568
    v_mfma_f32_16x16x32_bf16 v[216:219], a[200:203], v[52:55], v[216:219]
    ds_read_b64_tr_b16 a[224:225], v2 offset:42304
    v_mfma_f32_16x16x32_bf16 v[216:219], a[204:207], v[64:67], v[216:219]
    buffer_load_dwordx4 v10, s[40:43], s57 offen offset:0 lds
    s_waitcnt lgkmcnt(5)
    v_mfma_f32_16x16x32_bf16 v[220:223], a[208:211], v[20:23], v[220:223]
    ds_read_b64_tr_b16 a[226:227], v2 offset:42816
    v_mfma_f32_16x16x32_bf16 v[220:223], a[212:215], v[32:35], v[220:223]
    ds_read_b64_tr_b16 a[228:229], v2 offset:42432
    s_waitcnt lgkmcnt(5)
    v_mfma_f32_16x16x32_bf16 v[220:223], a[216:219], v[44:47], v[220:223]
    ds_read_b64_tr_b16 a[230:231], v2 offset:42944
    s_waitcnt lgkmcnt(4)
    v_mfma_f32_16x16x32_bf16 v[220:223], a[220:223], v[56:59], v[220:223]
    buffer_load_dwordx4 v11, s[40:43], s57 offen offset:1056 lds
    v_mfma_f32_16x16x32_bf16 v[224:227], a[220:223], v[60:63], v[224:227]
    s_add_u32 m0, s56, 33792
    s_add_u32 s57, s64, 196608
    v_mfma_f32_16x16x32_bf16 v[224:227], a[216:219], v[48:51], v[224:227]
    ds_read_b64_tr_b16 a[192:193], v3 offset:16960
    v_mfma_f32_16x16x32_bf16 v[224:227], a[212:215], v[36:39], v[224:227]
    ds_read_b64_tr_b16 a[194:195], v3 offset:17472
    v_mfma_f32_16x16x32_bf16 v[224:227], a[208:211], v[24:27], v[224:227]
    buffer_load_dwordx4 a[148:151], v12, s[44:47], s10 offen offset:1024 sc1
    v_mfma_f32_16x16x32_bf16 v[228:231], a[208:211], v[28:31], v[228:231]
    ds_read_b64_tr_b16 a[196:197], v3 offset:17088
    v_mfma_f32_16x16x32_bf16 v[228:231], a[212:215], v[40:43], v[228:231]
    ds_read_b64_tr_b16 a[198:199], v3 offset:17600
    v_mfma_f32_16x16x32_bf16 v[228:231], a[216:219], v[52:55], v[228:231]
    ds_read_b64_tr_b16 a[200:201], v2 offset:42336
    v_mfma_f32_16x16x32_bf16 v[228:231], a[220:223], v[64:67], v[228:231]
    buffer_load_dwordx4 a[152:155], v12, s[44:47], s10 offen offset:2048 sc1
    s_waitcnt lgkmcnt(5)
    v_mfma_f32_16x16x32_bf16 v[232:235], a[224:227], v[20:23], v[232:235]
    ds_read_b64_tr_b16 a[202:203], v2 offset:42848
    v_mfma_f32_16x16x32_bf16 v[232:235], a[228:231], v[32:35], v[232:235]
    ds_read_b64_tr_b16 a[204:205], v2 offset:42464
    s_waitcnt lgkmcnt(5)
    v_mfma_f32_16x16x32_bf16 v[232:235], a[192:195], v[44:47], v[232:235]
    ds_read_b64_tr_b16 a[206:207], v2 offset:42976
    s_waitcnt lgkmcnt(4)
    v_mfma_f32_16x16x32_bf16 v[232:235], a[196:199], v[56:59], v[232:235]
    buffer_load_dwordx4 a[156:159], v12, s[44:47], s10 offen offset:3072 sc1
    v_mfma_f32_16x16x32_bf16 v[236:239], a[196:199], v[60:63], v[236:239]
    ds_read_b64_tr_b16 a[208:209], v3 offset:16992
    v_mfma_f32_16x16x32_bf16 v[236:239], a[192:195], v[48:51], v[236:239]
    ds_read_b64_tr_b16 a[210:211], v3 offset:17504
    v_mfma_f32_16x16x32_bf16 v[236:239], a[228:231], v[36:39], v[236:239]
    ds_read_b64_tr_b16 a[212:213], v3 offset:17120
    v_mfma_f32_16x16x32_bf16 v[236:239], a[224:227], v[24:27], v[236:239]
    buffer_load_dwordx4 v10, s[40:43], s57 offen offset:0 lds
    v_mfma_f32_16x16x32_bf16 v[240:243], a[224:227], v[28:31], v[240:243]
    ds_read_b64_tr_b16 a[214:215], v3 offset:17632
    v_mfma_f32_16x16x32_bf16 v[240:243], a[228:231], v[40:43], v[240:243]
    v_mfma_f32_16x16x32_bf16 v[240:243], a[192:195], v[52:55], v[240:243]
    v_mfma_f32_16x16x32_bf16 v[240:243], a[196:199], v[64:67], v[240:243]
    s_add_u32 s10, s67, 53248
    buffer_load_dwordx4 a[160:163], v12, s[44:47], s10 offen offset:0 sc1
    s_waitcnt lgkmcnt(4)
    v_mfma_f32_16x16x32_bf16 v[244:247], a[200:203], v[20:23], v[244:247]
    s_waitcnt vmcnt(26) lgkmcnt(4)
    s_barrier
    v_mfma_f32_16x16x32_bf16 v[244:247], a[204:207], v[32:35], v[244:247]
    ds_read_b64_tr_b16 a[216:217], v3 offset:25344
    s_waitcnt lgkmcnt(3)
    v_mfma_f32_16x16x32_bf16 v[244:247], a[208:211], v[44:47], v[244:247]
    ds_read_b64_tr_b16 a[218:219], v3 offset:25856
    s_waitcnt lgkmcnt(2)
    v_mfma_f32_16x16x32_bf16 v[244:247], a[212:215], v[56:59], v[244:247]
    buffer_load_dwordx4 v11, s[40:43], s57 offen offset:1056 lds
    v_mfma_f32_16x16x32_bf16 v[248:251], a[212:215], v[60:63], v[248:251]
    s_add_u32 m0, s56, 42240
    s_add_u32 s57, s6, 131072
    v_mfma_f32_16x16x32_bf16 v[248:251], a[208:211], v[48:51], v[248:251]
    ds_read_b64_tr_b16 a[220:221], v3 offset:25472
    v_mfma_f32_16x16x32_bf16 v[248:251], a[204:207], v[36:39], v[248:251]
    ds_read_b64_tr_b16 a[222:223], v3 offset:25984
    v_mfma_f32_16x16x32_bf16 v[248:251], a[200:203], v[24:27], v[248:251]
    buffer_load_dwordx4 a[164:167], v12, s[44:47], s10 offen offset:1024 sc1
    v_mfma_f32_16x16x32_bf16 v[252:255], a[200:203], v[28:31], v[252:255]
    ds_read_b64_tr_b16 a[224:225], v3 offset:33792
    ds_read_b64_tr_b16 a[226:227], v3 offset:34304
    v_mfma_f32_16x16x32_bf16 v[252:255], a[204:207], v[40:43], v[252:255]
    ds_read_b64_tr_b16 a[228:229], v3 offset:33920
    ds_read_b64_tr_b16 a[230:231], v3 offset:34432
    v_mfma_f32_16x16x32_bf16 v[252:255], a[208:211], v[52:55], v[252:255]
    ds_read_b64_tr_b16 a[192:193], v3 offset:25376
    v_mfma_f32_16x16x32_bf16 v[252:255], a[212:215], v[64:67], v[252:255]
    buffer_load_dwordx4 v10, s[40:43], s57 offen offset:0 lds
    s_waitcnt lgkmcnt(7)
    v_mfma_f32_16x16x32_bf16 v[116:119], a[216:219], v[20:23], v[116:119]
    ds_read_b64_tr_b16 a[194:195], v3 offset:25888
    s_waitcnt lgkmcnt(6)
    v_mfma_f32_16x16x32_bf16 v[116:119], a[220:223], v[32:35], v[116:119]
    ds_read_b64_tr_b16 a[196:197], v3 offset:25504
    s_waitcnt lgkmcnt(5)
    v_mfma_f32_16x16x32_bf16 v[116:119], a[224:227], v[44:47], v[116:119]
    ds_read_b64_tr_b16 a[198:199], v3 offset:26016
    s_waitcnt lgkmcnt(4)
    v_mfma_f32_16x16x32_bf16 v[116:119], a[228:231], v[56:59], v[116:119]
    buffer_load_dwordx4 v11, s[40:43], s57 offen offset:1056 lds
    v_mfma_f32_16x16x32_bf16 v[120:123], a[228:231], v[60:63], v[120:123]
    s_add_u32 m0, s56, 135168
    s_add_u32 s57, s6, 196608
    v_mfma_f32_16x16x32_bf16 v[120:123], a[224:227], v[48:51], v[120:123]
    ds_read_b64_tr_b16 a[200:201], v3 offset:33824
    v_mfma_f32_16x16x32_bf16 v[120:123], a[220:223], v[36:39], v[120:123]
    ds_read_b64_tr_b16 a[202:203], v3 offset:34336
    v_mfma_f32_16x16x32_bf16 v[120:123], a[216:219], v[24:27], v[120:123]
    buffer_load_dwordx4 a[168:171], v12, s[44:47], s10 offen offset:2048 sc1
    v_mfma_f32_16x16x32_bf16 v[124:127], a[216:219], v[28:31], v[124:127]
    ds_read_b64_tr_b16 a[204:205], v3 offset:33952
    v_mfma_f32_16x16x32_bf16 v[124:127], a[220:223], v[40:43], v[124:127]
    ds_read_b64_tr_b16 a[206:207], v3 offset:34464
    v_mfma_f32_16x16x32_bf16 v[124:127], a[224:227], v[52:55], v[124:127]
    ds_read_b64_tr_b16 a[208:209], v2 offset:0
    v_mfma_f32_16x16x32_bf16 v[124:127], a[228:231], v[64:67], v[124:127]
    buffer_load_dwordx4 a[172:175], v12, s[44:47], s10 offen offset:3072 sc1
    s_waitcnt lgkmcnt(5)
    v_mfma_f32_16x16x32_bf16 v[128:131], a[192:195], v[20:23], v[128:131]
    ds_read_b64_tr_b16 a[210:211], v2 offset:512
    v_mfma_f32_16x16x32_bf16 v[128:131], a[196:199], v[32:35], v[128:131]
    ds_read_b64_tr_b16 a[212:213], v2 offset:128
    s_waitcnt lgkmcnt(5)
    v_mfma_f32_16x16x32_bf16 v[128:131], a[200:203], v[44:47], v[128:131]
    ds_read_b64_tr_b16 a[214:215], v2 offset:640
    s_waitcnt lgkmcnt(4)
    v_mfma_f32_16x16x32_bf16 v[128:131], a[204:207], v[56:59], v[128:131]
    buffer_load_dwordx4 v10, s[40:43], s57 offen offset:0 lds
    v_mfma_f32_16x16x32_bf16 v[132:135], a[204:207], v[60:63], v[132:135]
    ds_read_b64_tr_b16 a[216:217], v2 offset:59136
    v_mfma_f32_16x16x32_bf16 v[132:135], a[200:203], v[48:51], v[132:135]
    ds_read_b64_tr_b16 a[218:219], v2 offset:59648
    v_mfma_f32_16x16x32_bf16 v[132:135], a[196:199], v[36:39], v[132:135]
    ds_read_b64_tr_b16 a[220:221], v2 offset:59264
    v_mfma_f32_16x16x32_bf16 v[132:135], a[192:195], v[24:27], v[132:135]
    buffer_load_dwordx4 v11, s[40:43], s57 offen offset:1056 lds
    v_mfma_f32_16x16x32_bf16 v[136:139], a[192:195], v[28:31], v[136:139]
    s_add_u32 m0, s56, 143616
    s_add_u32 s57, s7, 131072
    v_mfma_f32_16x16x32_bf16 v[136:139], a[196:199], v[40:43], v[136:139]
    ds_read_b64_tr_b16 a[222:223], v2 offset:59776
    v_mfma_f32_16x16x32_bf16 v[136:139], a[200:203], v[52:55], v[136:139]
    ds_read_b64_tr_b16 a[224:225], v2 offset:32
    v_mfma_f32_16x16x32_bf16 v[136:139], a[204:207], v[64:67], v[136:139]
    s_waitcnt vmcnt(33)
    s_waitcnt lgkmcnt(5)
    v_mfma_f32_16x16x32_bf16 v[208:211], a[208:211], v[68:71], v[208:211]
    s_waitcnt vmcnt(28)
    s_add_u32 s10, s67, 57344
    buffer_load_dwordx4 a[176:179], v12, s[44:47], s10 offen offset:0 sc1
    v_mfma_f32_16x16x32_bf16 v[208:211], a[212:215], v[80:83], v[208:211]
    s_waitcnt vmcnt(24)
    s_waitcnt lgkmcnt(3)
    v_mfma_f32_16x16x32_bf16 v[208:211], a[216:219], v[92:95], v[208:211]
    s_waitcnt vmcnt(18)
    s_waitcnt lgkmcnt(1)
    v_mfma_f32_16x16x32_bf16 v[208:211], a[220:223], v[104:107], v[208:211]
    ds_read_b64_tr_b16 a[226:227], v2 offset:544
    v_mfma_f32_16x16x32_bf16 v[212:215], a[220:223], v[108:111], v[212:215]
    buffer_load_dwordx4 a[180:183], v12, s[44:47], s10 offen offset:1024 sc1
    v_mfma_f32_16x16x32_bf16 v[212:215], a[216:219], v[96:99], v[212:215]
    ds_read_b64_tr_b16 a[228:229], v2 offset:160
    v_mfma_f32_16x16x32_bf16 v[212:215], a[212:215], v[84:87], v[212:215]
    ds_read_b64_tr_b16 a[230:231], v2 offset:672
    v_mfma_f32_16x16x32_bf16 v[212:215], a[208:211], v[72:75], v[212:215]
    ds_read_b64_tr_b16 a[192:193], v2 offset:59168
    v_mfma_f32_16x16x32_bf16 v[216:219], a[208:211], v[76:79], v[216:219]
    ds_read_b64_tr_b16 a[194:195], v2 offset:59680
    buffer_load_dwordx4 v10, s[40:43], s57 offen offset:0 lds
    v_mfma_f32_16x16x32_bf16 v[216:219], a[212:215], v[88:91], v[216:219]
    ds_read_b64_tr_b16 a[196:197], v2 offset:59296
    ds_read_b64_tr_b16 a[198:199], v2 offset:59808
    v_mfma_f32_16x16x32_bf16 v[216:219], a[216:219], v[100:103], v[216:219]
    ds_read_b64_tr_b16 a[200:201], v2 offset:64
    v_mfma_f32_16x16x32_bf16 v[216:219], a[220:223], v[112:115], v[216:219]
    ds_read_b64_tr_b16 a[202:203], v2 offset:576
    s_waitcnt lgkmcnt(8)
    v_mfma_f32_16x16x32_bf16 v[220:223], a[224:227], v[68:71], v[220:223]
    s_waitcnt lgkmcnt(6)
    s_barrier
    v_mfma_f32_16x16x32_bf16 v[220:223], a[228:231], v[80:83], v[220:223]
    buffer_load_dwordx4 a[184:187], v12, s[44:47], s10 offen offset:2048 sc1
    s_waitcnt lgkmcnt(4)
    v_mfma_f32_16x16x32_bf16 v[220:223], a[192:195], v[92:95], v[220:223]
    ds_read_b64_tr_b16 a[204:205], v2 offset:192
    s_waitcnt lgkmcnt(3)
    v_mfma_f32_16x16x32_bf16 v[220:223], a[196:199], v[104:107], v[220:223]
    ds_read_b64_tr_b16 a[206:207], v2 offset:704
    v_mfma_f32_16x16x32_bf16 v[224:227], a[196:199], v[108:111], v[224:227]
    ds_read_b64_tr_b16 a[208:209], v2 offset:59200
    v_mfma_f32_16x16x32_bf16 v[224:227], a[192:195], v[96:99], v[224:227]
    buffer_load_dwordx4 v11, s[40:43], s57 offen offset:1056 lds
    v_mfma_f32_16x16x32_bf16 v[224:227], a[228:231], v[84:87], v[224:227]
    s_add_u32 m0, s56, 84480
    s_add_u32 s57, s7, 196608
    v_mfma_f32_16x16x32_bf16 v[224:227], a[224:227], v[72:75], v[224:227]
    ds_read_b64_tr_b16 a[210:211], v2 offset:59712
    v_mfma_f32_16x16x32_bf16 v[228:231], a[224:227], v[76:79], v[228:231]
    ds_read_b64_tr_b16 a[212:213], v2 offset:59328
    v_mfma_f32_16x16x32_bf16 v[228:231], a[228:231], v[88:91], v[228:231]
    ds_read_b64_tr_b16 a[214:215], v2 offset:59840
    buffer_load_dwordx4 a[188:191], v12, s[44:47], s10 offen offset:3072 sc1
    v_mfma_f32_16x16x32_bf16 v[228:231], a[192:195], v[100:103], v[228:231]
    ds_read_b64_tr_b16 a[216:217], v2 offset:96
    v_mfma_f32_16x16x32_bf16 v[228:231], a[196:199], v[112:115], v[228:231]
    ds_read_b64_tr_b16 a[218:219], v2 offset:608
    s_waitcnt lgkmcnt(7)
    v_mfma_f32_16x16x32_bf16 v[232:235], a[200:203], v[68:71], v[232:235]
    ds_read_b64_tr_b16 a[220:221], v2 offset:224
    s_waitcnt lgkmcnt(7)
    v_mfma_f32_16x16x32_bf16 v[232:235], a[204:207], v[80:83], v[232:235]
    s_add_u32 s10, s68, 49152
    buffer_load_dwordx4 a[48:51], v12, s[44:47], s10 offen offset:0 sc1
    s_waitcnt lgkmcnt(5)
    v_mfma_f32_16x16x32_bf16 v[232:235], a[208:211], v[92:95], v[232:235]
    ds_read_b64_tr_b16 a[222:223], v2 offset:736
    s_waitcnt lgkmcnt(4)
    v_mfma_f32_16x16x32_bf16 v[232:235], a[212:215], v[104:107], v[232:235]
    ds_read_b64_tr_b16 a[224:225], v2 offset:59232
    v_and_b32 v15, 48, v1
    v_mfma_f32_16x16x32_bf16 v[236:239], a[212:215], v[108:111], v[236:239]
    ds_read_b64_tr_b16 a[226:227], v2 offset:59744
    v_and_b32 v165, 15, v1
    v_mfma_f32_16x16x32_bf16 v[236:239], a[208:211], v[96:99], v[236:239]
    buffer_load_dwordx4 v10, s[40:43], s57 offen offset:0 lds
    v_mfma_f32_16x16x32_bf16 v[236:239], a[204:207], v[84:87], v[236:239]
    ds_read_b64_tr_b16 a[228:229], v2 offset:59360
    v_lshl_add_u32 v15, v165, 10, v15
    v_mfma_f32_16x16x32_bf16 v[236:239], a[200:203], v[72:75], v[236:239]
    ds_read_b64_tr_b16 a[230:231], v2 offset:59872
    v_mfma_f32_16x16x32_bf16 v[240:243], a[200:203], v[76:79], v[240:243]
    ds_read_b64_tr_b16 a[192:193], v3 offset:42240
    v_mfma_f32_16x16x32_bf16 v[240:243], a[204:207], v[88:91], v[240:243]
    buffer_load_dwordx4 v11, s[40:43], s57 offen offset:1056 lds
    v_mfma_f32_16x16x32_bf16 v[240:243], a[208:211], v[100:103], v[240:243]
    ds_read_b64_tr_b16 a[194:195], v3 offset:42752
    v_mfma_f32_16x16x32_bf16 v[240:243], a[212:215], v[112:115], v[240:243]
    ds_read_b64_tr_b16 a[196:197], v3 offset:42368
    s_waitcnt lgkmcnt(7)
    v_mfma_f32_16x16x32_bf16 v[244:247], a[216:219], v[68:71], v[244:247]
    ds_read_b64_tr_b16 a[198:199], v3 offset:42880
    v_mfma_f32_16x16x32_bf16 v[244:247], a[220:223], v[80:83], v[244:247]
    buffer_load_dwordx4 a[52:55], v12, s[44:47], s10 offen offset:1024 sc1
    s_waitcnt lgkmcnt(6)
    v_mfma_f32_16x16x32_bf16 v[244:247], a[224:227], v[92:95], v[244:247]
    ds_read_b64_tr_b16 a[200:201], v3 offset:0
    s_waitcnt lgkmcnt(5)
    v_mfma_f32_16x16x32_bf16 v[244:247], a[228:231], v[104:107], v[244:247]
    s_mul_i32 s86, s3, 49152
    v_add_u32 v164, s86, v15
    v_mfma_f32_16x16x32_bf16 v[248:251], a[228:231], v[108:111], v[248:251]
    ds_read_b64_tr_b16 a[202:203], v3 offset:512
    v_add_u32 v165, 16384, v164
    v_mfma_f32_16x16x32_bf16 v[248:251], a[224:227], v[96:99], v[248:251]
    buffer_load_dwordx4 a[56:59], v12, s[44:47], s10 offen offset:2048 sc1
    v_mfma_f32_16x16x32_bf16 v[248:251], a[220:223], v[84:87], v[248:251]
    ds_read_b64_tr_b16 a[204:205], v3 offset:128
    v_add_u32 v166, 32768, v164
    v_mfma_f32_16x16x32_bf16 v[248:251], a[216:219], v[72:75], v[248:251]
    ds_read_b64_tr_b16 a[206:207], v3 offset:640
    v_mfma_f32_16x16x32_bf16 v[252:255], a[216:219], v[76:79], v[252:255]
    ds_read_b64_tr_b16 a[208:209], v3 offset:42272
    v_mfma_f32_16x16x32_bf16 v[252:255], a[220:223], v[88:91], v[252:255]
    buffer_load_dwordx4 a[60:63], v12, s[44:47], s10 offen offset:3072 sc1
    v_mfma_f32_16x16x32_bf16 v[252:255], a[224:227], v[100:103], v[252:255]
    ds_read_b64_tr_b16 a[210:211], v3 offset:42784
    v_mfma_f32_16x16x32_bf16 v[252:255], a[228:231], v[112:115], v[252:255]
    ds_read_b64_tr_b16 a[212:213], v3 offset:42400
    s_waitcnt lgkmcnt(6)
    v_mfma_f32_16x16x32_bf16 v[116:119], a[192:195], v[68:71], v[116:119]
    ds_read_b64_tr_b16 a[214:215], v3 offset:42912
    v_mfma_f32_16x16x32_bf16 v[116:119], a[196:199], v[80:83], v[116:119]
    s_add_u32 s10, s68, 53248
    buffer_load_dwordx4 a[64:67], v12, s[44:47], s10 offen offset:0 sc1
    s_waitcnt lgkmcnt(6)
    v_mfma_f32_16x16x32_bf16 v[116:119], a[200:203], v[92:95], v[116:119]
    ds_read_b64_tr_b16 a[216:217], v3 offset:32
    s_waitcnt lgkmcnt(5)
    v_mfma_f32_16x16x32_bf16 v[116:119], a[204:207], v[104:107], v[116:119]
    ds_read_b64_tr_b16 a[218:219], v3 offset:544
    v_mfma_f32_16x16x32_bf16 v[120:123], a[204:207], v[108:111], v[120:123]
    ds_read_b64_tr_b16 a[220:221], v3 offset:160
    v_mfma_f32_16x16x32_bf16 v[120:123], a[200:203], v[96:99], v[120:123]
    buffer_load_dwordx4 a[68:71], v12, s[44:47], s10 offen offset:1024 sc1
    v_mfma_f32_16x16x32_bf16 v[120:123], a[196:199], v[84:87], v[120:123]
    ds_read_b64_tr_b16 a[222:223], v3 offset:672
    v_mfma_f32_16x16x32_bf16 v[120:123], a[192:195], v[72:75], v[120:123]
    v_mfma_f32_16x16x32_bf16 v[124:127], a[192:195], v[76:79], v[124:127]
    v_mfma_f32_16x16x32_bf16 v[124:127], a[196:199], v[88:91], v[124:127]
    buffer_load_dwordx4 a[72:75], v12, s[44:47], s10 offen offset:2048 sc1
    v_mfma_f32_16x16x32_bf16 v[124:127], a[200:203], v[100:103], v[124:127]
    v_mfma_f32_16x16x32_bf16 v[124:127], a[204:207], v[112:115], v[124:127]
    s_waitcnt lgkmcnt(3)
    v_mfma_f32_16x16x32_bf16 v[128:131], a[208:211], v[68:71], v[128:131]
    s_waitcnt vmcnt(22) lgkmcnt(2)
    s_barrier
    v_mfma_f32_16x16x32_bf16 v[128:131], a[212:215], v[80:83], v[128:131]
    buffer_load_dwordx4 a[76:79], v12, s[44:47], s10 offen offset:3072 sc1
    v_mfma_f32_16x16x32_bf16 v[128:131], a[216:219], v[92:95], v[128:131]
    ds_read_b64_tr_b16 a[224:225], v3 offset:50688
    s_waitcnt lgkmcnt(1)
    v_mfma_f32_16x16x32_bf16 v[128:131], a[220:223], v[104:107], v[128:131]
    buffer_load_ubyte v14, v13, s[44:47], s16 offen offset:0 sc1
    v_mfma_f32_16x16x32_bf16 v[132:135], a[220:223], v[108:111], v[132:135]
    ds_read_b64_tr_b16 a[226:227], v3 offset:51200
    v_mfma_f32_16x16x32_bf16 v[132:135], a[216:219], v[96:99], v[132:135]
    s_add_u32 s10, s68, 57344
    buffer_load_dwordx4 a[80:83], v12, s[44:47], s10 offen offset:0 sc1
    v_mfma_f32_16x16x32_bf16 v[132:135], a[212:215], v[84:87], v[132:135]
    ds_read_b64_tr_b16 a[228:229], v3 offset:50816
    v_mfma_f32_16x16x32_bf16 v[132:135], a[208:211], v[72:75], v[132:135]
    ds_read_b64_tr_b16 a[230:231], v3 offset:51328
    v_mfma_f32_16x16x32_bf16 v[136:139], a[208:211], v[76:79], v[136:139]
    ds_read_b64_tr_b16 a[192:193], v3 offset:59136
    ds_read_b64_tr_b16 a[194:195], v3 offset:59648
    v_mfma_f32_16x16x32_bf16 v[136:139], a[212:215], v[88:91], v[136:139]
    ds_read_b64_tr_b16 a[196:197], v3 offset:59264
    ds_read_b64_tr_b16 a[198:199], v3 offset:59776
    v_mfma_f32_16x16x32_bf16 v[136:139], a[216:219], v[100:103], v[136:139]
    buffer_load_dwordx4 a[84:87], v12, s[44:47], s10 offen offset:1024 sc1
    v_mfma_f32_16x16x32_bf16 v[136:139], a[220:223], v[112:115], v[136:139]
    s_waitcnt lgkmcnt(6)
    v_mfma_f32_16x16x32_bf16 v[208:211], a[224:227], a[144:147], v[208:211]
    s_waitcnt vmcnt(25)
    s_waitcnt lgkmcnt(4)
    v_mfma_f32_16x16x32_bf16 v[208:211], a[228:231], a[156:159], v[208:211]
    s_waitcnt vmcnt(18)
    s_waitcnt lgkmcnt(2)
    v_mfma_f32_16x16x32_bf16 v[208:211], a[192:195], a[168:171], v[208:211]
    s_waitcnt vmcnt(13)
    s_waitcnt lgkmcnt(0)
    v_mfma_f32_16x16x32_bf16 v[208:211], a[196:199], a[180:183], v[208:211]
    buffer_load_dwordx4 a[88:91], v12, s[44:47], s10 offen offset:2048 sc1
    v_mfma_f32_16x16x32_bf16 v[212:215], a[196:199], a[184:187], v[212:215]
    ds_read_b64_tr_b16 a[200:201], v3 offset:50720
    v_mfma_f32_16x16x32_bf16 v[212:215], a[192:195], a[172:175], v[212:215]
    ds_read_b64_tr_b16 a[202:203], v3 offset:51232
    v_mfma_f32_16x16x32_bf16 v[212:215], a[228:231], a[160:163], v[212:215]
    ds_read_b64_tr_b16 a[204:205], v3 offset:50848
    v_mfma_f32_16x16x32_bf16 v[212:215], a[224:227], a[148:151], v[212:215]
    ds_read_b64_tr_b16 a[206:207], v3 offset:51360
    buffer_load_dwordx4 a[92:95], v12, s[44:47], s10 offen offset:3072 sc1
    v_mfma_f32_16x16x32_bf16 v[216:219], a[224:227], a[152:155], v[216:219]
    ds_read_b64_tr_b16 a[208:209], v3 offset:59168
    ds_read_b64_tr_b16 a[210:211], v3 offset:59680
    v_mfma_f32_16x16x32_bf16 v[216:219], a[228:231], a[164:167], v[216:219]
    ds_read_b64_tr_b16 a[212:213], v3 offset:59296
    ds_read_b64_tr_b16 a[214:215], v3 offset:59808
    v_mfma_f32_16x16x32_bf16 v[216:219], a[192:195], a[176:179], v[216:219]
    ds_read_b64_tr_b16 a[216:217], v2 offset:25344
    v_mfma_f32_16x16x32_bf16 v[216:219], a[196:199], a[188:191], v[216:219]
    ds_read_b64_tr_b16 a[218:219], v2 offset:25856
    s_waitcnt lgkmcnt(8)
    v_mfma_f32_16x16x32_bf16 v[220:223], a[200:203], a[144:147], v[220:223]
    ds_read_b64_tr_b16 a[220:221], v2 offset:25472
    s_waitcnt lgkmcnt(7)
    v_mfma_f32_16x16x32_bf16 v[220:223], a[204:207], a[156:159], v[220:223]
    ds_read_b64_tr_b16 a[222:223], v2 offset:25984
    s_waitcnt lgkmcnt(6)
    v_mfma_f32_16x16x32_bf16 v[220:223], a[208:211], a[168:171], v[220:223]
    ds_read_b64_tr_b16 a[224:225], v2 offset:33792
    s_waitcnt lgkmcnt(5)
    v_mfma_f32_16x16x32_bf16 v[220:223], a[212:215], a[180:183], v[220:223]
    ds_read_b64_tr_b16 a[226:227], v2 offset:34304
    v_mfma_f32_16x16x32_bf16 v[224:227], a[212:215], a[184:187], v[224:227]
    ds_read_b64_tr_b16 a[228:229], v2 offset:33920
    v_mfma_f32_16x16x32_bf16 v[224:227], a[208:211], a[172:175], v[224:227]
    ds_read_b64_tr_b16 a[230:231], v2 offset:34432
    v_mfma_f32_16x16x32_bf16 v[224:227], a[204:207], a[160:163], v[224:227]
    ds_read_b64_tr_b16 a[192:193], v2 offset:25376
    v_mfma_f32_16x16x32_bf16 v[224:227], a[200:203], a[148:151], v[224:227]
    ds_read_b64_tr_b16 a[194:195], v2 offset:25888
    v_mfma_f32_16x16x32_bf16 v[228:231], a[200:203], a[152:155], v[228:231]
    ds_read_b64_tr_b16 a[196:197], v2 offset:25504
    v_mfma_f32_16x16x32_bf16 v[228:231], a[204:207], a[164:167], v[228:231]
    ds_read_b64_tr_b16 a[198:199], v2 offset:26016
    v_mfma_f32_16x16x32_bf16 v[228:231], a[208:211], a[176:179], v[228:231]
    ds_read_b64_tr_b16 a[200:201], v2 offset:33824
    v_mfma_f32_16x16x32_bf16 v[228:231], a[212:215], a[188:191], v[228:231]
    s_waitcnt vmcnt(10)
    s_waitcnt lgkmcnt(8)
    v_mfma_f32_16x16x32_bf16 v[208:211], a[216:219], a[48:51], v[208:211]
    ds_read_b64_tr_b16 a[202:203], v2 offset:34336
    s_waitcnt vmcnt(7)
    v_mfma_f32_16x16x32_bf16 v[208:211], a[220:223], a[60:63], v[208:211]
    s_waitcnt vmcnt(3)
    s_waitcnt lgkmcnt(7)
    v_mfma_f32_16x16x32_bf16 v[208:211], a[224:227], a[72:75], v[208:211]
    s_waitcnt vmcnt(0)
    s_waitcnt lgkmcnt(6)
    v_mfma_f32_16x16x32_bf16 v[208:211], a[228:231], a[84:87], v[208:211]
    ds_read_b64_tr_b16 a[204:205], v2 offset:33952
    v_mfma_f32_16x16x32_bf16 v[212:215], a[228:231], a[88:91], v[212:215]
    ds_read_b64_tr_b16 a[206:207], v2 offset:34464
    v_mfma_f32_16x16x32_bf16 v[212:215], a[224:227], a[76:79], v[212:215]
    ds_read_b64_tr_b16 a[208:209], v3 offset:50752
    v_mfma_f32_16x16x32_bf16 v[212:215], a[220:223], a[64:67], v[212:215]
    ds_read_b64_tr_b16 a[210:211], v3 offset:51264
    v_mfma_f32_16x16x32_bf16 v[212:215], a[216:219], a[52:55], v[212:215]
    ds_read_b64_tr_b16 a[212:213], v3 offset:50880
    v_mfma_f32_16x16x32_bf16 v[216:219], a[216:219], a[56:59], v[216:219]
    ds_read_b64_tr_b16 a[214:215], v3 offset:51392
    v_mfma_f32_16x16x32_bf16 v[216:219], a[220:223], a[68:71], v[216:219]
    ds_read_b64_tr_b16 a[216:217], v3 offset:59200
    v_mfma_f32_16x16x32_bf16 v[216:219], a[224:227], a[80:83], v[216:219]
    ds_read_b64_tr_b16 a[218:219], v3 offset:59712
    v_mfma_f32_16x16x32_bf16 v[216:219], a[228:231], a[92:95], v[216:219]
    ds_read_b64_tr_b16 a[220:221], v3 offset:59328
    s_waitcnt lgkmcnt(9)
    v_mfma_f32_16x16x32_bf16 v[220:223], a[192:195], a[48:51], v[220:223]
    s_waitcnt lgkmcnt(8)
    s_barrier
    v_mfma_f32_16x16x32_bf16 v[220:223], a[196:199], a[60:63], v[220:223]
    ds_read_b64_tr_b16 a[222:223], v3 offset:59840
    v_mfma_f32_16x16x32_bf16 v[220:223], a[200:203], a[72:75], v[220:223]
    ds_read_b64_tr_b16 a[224:225], v3 offset:50784
    s_waitcnt lgkmcnt(8)
    v_mfma_f32_16x16x32_bf16 v[220:223], a[204:207], a[84:87], v[220:223]
    v_cmp_gt_u32 vcc, 64, v14
    s_and_b32 s87, vcc_lo, s18
    s_cbranch_scc1 K_PC
K_PC_ret:
    v_mfma_f32_16x16x32_bf16 v[224:227], a[204:207], a[88:91], v[224:227]
    ds_read_b64_tr_b16 a[226:227], v3 offset:51296
    v_mfma_f32_16x16x32_bf16 v[224:227], a[200:203], a[76:79], v[224:227]
    ds_read_b64_tr_b16 a[228:229], v3 offset:50912
    v_mfma_f32_16x16x32_bf16 v[224:227], a[196:199], a[64:67], v[224:227]
    ds_read_b64_tr_b16 a[230:231], v3 offset:51424
    v_cvt_pk_bf16_f32 v208, v208, v209
    v_mfma_f32_16x16x32_bf16 v[224:227], a[192:195], a[52:55], v[224:227]
    v_cvt_pk_bf16_f32 v209, v210, v211
    v_or_b32 v208, 1, v208
    v_mfma_f32_16x16x32_bf16 v[228:231], a[192:195], a[56:59], v[228:231]
    v_cvt_pk_bf16_f32 v210, v220, v221
    v_cvt_pk_bf16_f32 v211, v222, v223
    v_mfma_f32_16x16x32_bf16 v[228:231], a[196:199], a[68:71], v[228:231]
    buffer_store_dwordx4 v[208:211], v12, s[44:47], s69 offen offset:0 sc1
    v_mfma_f32_16x16x32_bf16 v[228:231], a[200:203], a[80:83], v[228:231]
    v_cvt_pk_bf16_f32 v212, v212, v213
    v_cvt_pk_bf16_f32 v213, v214, v215
    v_mfma_f32_16x16x32_bf16 v[228:231], a[204:207], a[92:95], v[228:231]
    v_or_b32 v212, 1, v212
    s_waitcnt lgkmcnt(3)
    v_mfma_f32_16x16x32_bf16 v[232:235], a[208:211], a[144:147], v[232:235]
    ds_read_b64_tr_b16 a[192:193], v3 offset:59232
    v_cvt_pk_bf16_f32 v214, v224, v225
    v_mfma_f32_16x16x32_bf16 v[232:235], a[212:215], a[156:159], v[232:235]
    ds_read_b64_tr_b16 a[194:195], v3 offset:59744
    v_cvt_pk_bf16_f32 v215, v226, v227
    v_mfma_f32_16x16x32_bf16 v[232:235], a[216:219], a[168:171], v[232:235]
    buffer_store_dwordx4 v[212:215], v12, s[44:47], s69 offen offset:1024 sc1
    v_mfma_f32_16x16x32_bf16 v[232:235], a[220:223], a[180:183], v[232:235]
    ds_read_b64_tr_b16 a[196:197], v3 offset:59360
    v_cvt_pk_bf16_f32 v216, v216, v217
    v_mfma_f32_16x16x32_bf16 v[236:239], a[220:223], a[184:187], v[236:239]
    ds_read_b64_tr_b16 a[198:199], v3 offset:59872
    v_cvt_pk_bf16_f32 v217, v218, v219
    v_mfma_f32_16x16x32_bf16 v[236:239], a[216:219], a[172:175], v[236:239]
    ds_read_b64_tr_b16 a[200:201], v2 offset:25408
    v_or_b32 v216, 1, v216
    v_mfma_f32_16x16x32_bf16 v[236:239], a[212:215], a[160:163], v[236:239]
    ds_read_b64_tr_b16 a[202:203], v2 offset:25920
    v_cvt_pk_bf16_f32 v218, v228, v229
    v_mfma_f32_16x16x32_bf16 v[236:239], a[208:211], a[148:151], v[236:239]
    ds_read_b64_tr_b16 a[204:205], v2 offset:25536
    v_cvt_pk_bf16_f32 v219, v230, v231
    v_mfma_f32_16x16x32_bf16 v[240:243], a[208:211], a[152:155], v[240:243]
    ds_read_b64_tr_b16 a[206:207], v2 offset:26048
    buffer_store_dwordx4 v[216:219], v12, s[44:47], s69 offen offset:2048 sc1
    v_mfma_f32_16x16x32_bf16 v[240:243], a[212:215], a[164:167], v[240:243]
    ds_read_b64_tr_b16 a[208:209], v2 offset:33856
    v_mfma_f32_16x16x32_bf16 v[240:243], a[216:219], a[176:179], v[240:243]
    ds_read_b64_tr_b16 a[210:211], v2 offset:34368
    v_mfma_f32_16x16x32_bf16 v[240:243], a[220:223], a[188:191], v[240:243]
    ds_read_b64_tr_b16 a[212:213], v2 offset:33984
    s_waitcnt lgkmcnt(9)
    v_mfma_f32_16x16x32_bf16 v[244:247], a[224:227], a[144:147], v[244:247]
    ds_read_b64_tr_b16 a[214:215], v2 offset:34496
    v_mfma_f32_16x16x32_bf16 v[244:247], a[228:231], a[156:159], v[244:247]
    ds_read_b64_tr_b16 a[216:217], v2 offset:25440
    v_mfma_f32_16x16x32_bf16 v[244:247], a[192:195], a[168:171], v[244:247]
    ds_read_b64_tr_b16 a[218:219], v2 offset:25952
    s_waitcnt lgkmcnt(9)
    v_mfma_f32_16x16x32_bf16 v[244:247], a[196:199], a[180:183], v[244:247]
    ds_read_b64_tr_b16 a[220:221], v2 offset:25568
    v_mfma_f32_16x16x32_bf16 v[248:251], a[196:199], a[184:187], v[248:251]
    ds_read_b64_tr_b16 a[222:223], v2 offset:26080
    v_mfma_f32_16x16x32_bf16 v[248:251], a[192:195], a[172:175], v[248:251]
    v_mfma_f32_16x16x32_bf16 v[248:251], a[228:231], a[160:163], v[248:251]
    v_mfma_f32_16x16x32_bf16 v[248:251], a[224:227], a[148:151], v[248:251]
    v_mfma_f32_16x16x32_bf16 v[252:255], a[224:227], a[152:155], v[252:255]
    ds_read_b64_tr_b16 a[224:225], v2 offset:33888
    v_mfma_f32_16x16x32_bf16 v[252:255], a[228:231], a[164:167], v[252:255]
    ds_read_b64_tr_b16 a[226:227], v2 offset:34400
    v_mfma_f32_16x16x32_bf16 v[252:255], a[192:195], a[176:179], v[252:255]
    ds_read_b64_tr_b16 a[228:229], v2 offset:34016
    v_mfma_f32_16x16x32_bf16 v[252:255], a[196:199], a[188:191], v[252:255]
    ds_read_b64_tr_b16 a[230:231], v2 offset:34528
    s_waitcnt lgkmcnt(6)
    v_mfma_f32_16x16x32_bf16 v[232:235], a[200:203], a[48:51], v[232:235]
    v_mfma_f32_16x16x32_bf16 v[232:235], a[204:207], a[60:63], v[232:235]
    v_mfma_f32_16x16x32_bf16 v[232:235], a[208:211], a[72:75], v[232:235]
    v_mfma_f32_16x16x32_bf16 v[232:235], a[212:215], a[84:87], v[232:235]
    v_mfma_f32_16x16x32_bf16 v[236:239], a[212:215], a[88:91], v[236:239]
    v_mfma_f32_16x16x32_bf16 v[236:239], a[208:211], a[76:79], v[236:239]
    v_mfma_f32_16x16x32_bf16 v[236:239], a[204:207], a[64:67], v[236:239]
    v_mfma_f32_16x16x32_bf16 v[236:239], a[200:203], a[52:55], v[236:239]
    v_mfma_f32_16x16x32_bf16 v[240:243], a[200:203], a[56:59], v[240:243]
    v_mfma_f32_16x16x32_bf16 v[240:243], a[204:207], a[68:71], v[240:243]
    v_mfma_f32_16x16x32_bf16 v[240:243], a[208:211], a[80:83], v[240:243]
    v_mfma_f32_16x16x32_bf16 v[240:243], a[212:215], a[92:95], v[240:243]
    v_mfma_f32_16x16x32_bf16 v[244:247], a[216:219], a[48:51], v[244:247]
    s_waitcnt lgkmcnt(0)
    s_barrier
    v_mfma_f32_16x16x32_bf16 v[244:247], a[220:223], a[60:63], v[244:247]
    ds_read_b64_tr_b16 a[192:193], v2 offset:42240
    v_mfma_f32_16x16x32_bf16 v[244:247], a[224:227], a[72:75], v[244:247]
    ds_read_b64_tr_b16 a[194:195], v2 offset:42752
    v_mfma_f32_16x16x32_bf16 v[244:247], a[228:231], a[84:87], v[244:247]
    ds_read_b64_tr_b16 a[196:197], v2 offset:42368
    v_mfma_f32_16x16x32_bf16 v[248:251], a[228:231], a[88:91], v[248:251]
    ds_read_b64_tr_b16 a[198:199], v2 offset:42880
    v_mfma_f32_16x16x32_bf16 v[248:251], a[224:227], a[76:79], v[248:251]
    ds_read_b64_tr_b16 a[200:201], v4 offset:0
    v_mfma_f32_16x16x32_bf16 v[248:251], a[220:223], a[64:67], v[248:251]
    ds_read_b64_tr_b16 a[202:203], v4 offset:512
    v_cvt_pk_bf16_f32 v232, v232, v233
    v_mfma_f32_16x16x32_bf16 v[248:251], a[216:219], a[52:55], v[248:251]
    ds_read_b64_tr_b16 a[204:205], v4 offset:128
    v_cvt_pk_bf16_f32 v233, v234, v235
    v_mfma_f32_16x16x32_bf16 v[252:255], a[216:219], a[56:59], v[252:255]
    ds_read_b64_tr_b16 a[206:207], v4 offset:640
    v_or_b32 v232, 1, v232
    v_mfma_f32_16x16x32_bf16 v[252:255], a[220:223], a[68:71], v[252:255]
    ds_read_b64_tr_b16 a[208:209], v2 offset:42272
    v_cvt_pk_bf16_f32 v234, v244, v245
    v_mfma_f32_16x16x32_bf16 v[252:255], a[224:227], a[80:83], v[252:255]
    ds_read_b64_tr_b16 a[210:211], v2 offset:42784
    v_cvt_pk_bf16_f32 v235, v246, v247
    v_mfma_f32_16x16x32_bf16 v[252:255], a[228:231], a[92:95], v[252:255]
    ds_read_b64_tr_b16 a[212:213], v2 offset:42400
    s_waitcnt lgkmcnt(9)
    v_mfma_f32_16x16x32_bf16 v[116:119], a[192:195], a[144:147], v[116:119]
    ds_read_b64_tr_b16 a[214:215], v2 offset:42912
    s_waitcnt lgkmcnt(8)
    v_mfma_f32_16x16x32_bf16 v[116:119], a[196:199], a[156:159], v[116:119]
    buffer_store_dwordx4 v[232:235], v12, s[44:47], s70 offen offset:0 sc1
    s_waitcnt lgkmcnt(6)
    v_mfma_f32_16x16x32_bf16 v[116:119], a[200:203], a[168:171], v[116:119]
    v_cvt_pk_bf16_f32 v236, v236, v237
    s_waitcnt lgkmcnt(4)
    v_mfma_f32_16x16x32_bf16 v[116:119], a[204:207], a[180:183], v[116:119]
    v_cvt_pk_bf16_f32 v237, v238, v239
    v_or_b32 v236, 1, v236
    v_mfma_f32_16x16x32_bf16 v[120:123], a[204:207], a[184:187], v[120:123]
    ds_read_b64_tr_b16 a[216:217], v4 offset:32
    v_cvt_pk_bf16_f32 v238, v248, v249
    v_mfma_f32_16x16x32_bf16 v[120:123], a[200:203], a[172:175], v[120:123]
    ds_read_b64_tr_b16 a[218:219], v4 offset:544
    v_cvt_pk_bf16_f32 v239, v250, v251
    v_mfma_f32_16x16x32_bf16 v[120:123], a[196:199], a[160:163], v[120:123]
    buffer_store_dwordx4 v[236:239], v12, s[44:47], s70 offen offset:1024 sc1
    v_mfma_f32_16x16x32_bf16 v[120:123], a[192:195], a[148:151], v[120:123]
    ds_read_b64_tr_b16 a[220:221], v4 offset:160
    v_cvt_pk_bf16_f32 v240, v240, v241
    v_mfma_f32_16x16x32_bf16 v[124:127], a[192:195], a[152:155], v[124:127]
    ds_read_b64_tr_b16 a[222:223], v4 offset:672
    v_cvt_pk_bf16_f32 v241, v242, v243
    v_mfma_f32_16x16x32_bf16 v[124:127], a[196:199], a[164:167], v[124:127]
    ds_read_b64_tr_b16 a[224:225], v4 offset:8448
    v_or_b32 v240, 1, v240
    v_mfma_f32_16x16x32_bf16 v[124:127], a[200:203], a[176:179], v[124:127]
    ds_read_b64_tr_b16 a[226:227], v4 offset:8960
    v_cvt_pk_bf16_f32 v242, v252, v253
    v_mfma_f32_16x16x32_bf16 v[124:127], a[204:207], a[188:191], v[124:127]
    ds_read_b64_tr_b16 a[228:229], v4 offset:8576
    s_waitcnt lgkmcnt(7)
    v_mfma_f32_16x16x32_bf16 v[128:131], a[208:211], a[144:147], v[128:131]
    ds_read_b64_tr_b16 a[230:231], v4 offset:9088
    v_cvt_pk_bf16_f32 v243, v254, v255
    v_mfma_f32_16x16x32_bf16 v[128:131], a[212:215], a[156:159], v[128:131]
    buffer_store_dwordx4 v[240:243], v12, s[44:47], s70 offen offset:2048 sc1
    s_waitcnt lgkmcnt(6)
    v_mfma_f32_16x16x32_bf16 v[128:131], a[216:219], a[168:171], v[128:131]
    ds_read_b64_tr_b16 a[192:193], v3 offset:16896
    s_waitcnt lgkmcnt(5)
    v_mfma_f32_16x16x32_bf16 v[128:131], a[220:223], a[180:183], v[128:131]
    ds_read_b64_tr_b16 a[194:195], v3 offset:17408
    v_mfma_f32_16x16x32_bf16 v[132:135], a[220:223], a[184:187], v[132:135]
    ds_read_b64_tr_b16 a[196:197], v3 offset:17024
    v_mfma_f32_16x16x32_bf16 v[132:135], a[216:219], a[172:175], v[132:135]
    ds_read_b64_tr_b16 a[198:199], v3 offset:17536
    v_mfma_f32_16x16x32_bf16 v[132:135], a[212:215], a[160:163], v[132:135]
    ds_read_b64_tr_b16 a[200:201], v4 offset:8480
    v_mfma_f32_16x16x32_bf16 v[132:135], a[208:211], a[148:151], v[132:135]
    ds_read_b64_tr_b16 a[202:203], v4 offset:8992
    v_mfma_f32_16x16x32_bf16 v[136:139], a[208:211], a[152:155], v[136:139]
    ds_read_b64_tr_b16 a[204:205], v4 offset:8608
    v_mfma_f32_16x16x32_bf16 v[136:139], a[212:215], a[164:167], v[136:139]
    ds_read_b64_tr_b16 a[206:207], v4 offset:9120
    v_mfma_f32_16x16x32_bf16 v[136:139], a[216:219], a[176:179], v[136:139]
    ds_read_b64_tr_b16 a[208:209], v3 offset:16928
    v_mfma_f32_16x16x32_bf16 v[136:139], a[220:223], a[188:191], v[136:139]
    ds_read_b64_tr_b16 a[210:211], v3 offset:17440
    s_waitcnt lgkmcnt(9)
    v_mfma_f32_16x16x32_bf16 v[116:119], a[224:227], a[48:51], v[116:119]
    ds_read_b64_tr_b16 a[212:213], v3 offset:17056
    v_mfma_f32_16x16x32_bf16 v[116:119], a[228:231], a[60:63], v[116:119]
    ds_read_b64_tr_b16 a[214:215], v3 offset:17568
    s_waitcnt lgkmcnt(9)
    v_mfma_f32_16x16x32_bf16 v[116:119], a[192:195], a[72:75], v[116:119]
    ds_read_b64_tr_b16 a[216:217], v2 offset:8512
    s_waitcnt lgkmcnt(9)
    v_mfma_f32_16x16x32_bf16 v[116:119], a[196:199], a[84:87], v[116:119]
    ds_read_b64_tr_b16 a[218:219], v2 offset:9024
    v_mfma_f32_16x16x32_bf16 v[120:123], a[196:199], a[88:91], v[120:123]
    ds_read_b64_tr_b16 a[220:221], v2 offset:8640
    v_mfma_f32_16x16x32_bf16 v[120:123], a[192:195], a[76:79], v[120:123]
    ds_read_b64_tr_b16 a[222:223], v2 offset:9152
    v_mfma_f32_16x16x32_bf16 v[120:123], a[228:231], a[64:67], v[120:123]
    v_mfma_f32_16x16x32_bf16 v[120:123], a[224:227], a[52:55], v[120:123]
    v_mfma_f32_16x16x32_bf16 v[124:127], a[224:227], a[56:59], v[124:127]
    ds_read_b64_tr_b16 a[224:225], v2 offset:16960
    v_mfma_f32_16x16x32_bf16 v[124:127], a[228:231], a[68:71], v[124:127]
    ds_read_b64_tr_b16 a[226:227], v2 offset:17472
    v_mfma_f32_16x16x32_bf16 v[124:127], a[192:195], a[80:83], v[124:127]
    ds_read_b64_tr_b16 a[228:229], v2 offset:17088
    v_mfma_f32_16x16x32_bf16 v[124:127], a[196:199], a[92:95], v[124:127]
    ds_read_b64_tr_b16 a[230:231], v2 offset:17600
    s_waitcnt lgkmcnt(7)
    v_mfma_f32_16x16x32_bf16 v[128:131], a[200:203], a[48:51], v[128:131]
    ds_read_b64_tr_b16 a[192:193], v2 offset:8544
    v_mfma_f32_16x16x32_bf16 v[128:131], a[204:207], a[60:63], v[128:131]
    ds_read_b64_tr_b16 a[194:195], v2 offset:9056
    v_mfma_f32_16x16x32_bf16 v[128:131], a[208:211], a[72:75], v[128:131]
    ds_read_b64_tr_b16 a[196:197], v2 offset:8672
    v_mfma_f32_16x16x32_bf16 v[128:131], a[212:215], a[84:87], v[128:131]
    ds_read_b64_tr_b16 a[198:199], v2 offset:9184
    v_mfma_f32_16x16x32_bf16 v[132:135], a[212:215], a[88:91], v[132:135]
    v_mfma_f32_16x16x32_bf16 v[132:135], a[208:211], a[76:79], v[132:135]
    v_mfma_f32_16x16x32_bf16 v[132:135], a[204:207], a[64:67], v[132:135]
    v_cvt_pk_bf16_f32 v116, v116, v117
    v_cvt_pk_bf16_f32 v117, v118, v119
    v_mfma_f32_16x16x32_bf16 v[132:135], a[200:203], a[52:55], v[132:135]
    v_or_b32 v116, 1, v116
    v_cvt_pk_bf16_f32 v118, v128, v129
    v_mfma_f32_16x16x32_bf16 v[136:139], a[200:203], a[56:59], v[136:139]
    ds_read_b64_tr_b16 a[200:201], v2 offset:16992
    v_cvt_pk_bf16_f32 v119, v130, v131
    v_mfma_f32_16x16x32_bf16 v[136:139], a[204:207], a[68:71], v[136:139]
    buffer_store_dwordx4 v[116:119], v12, s[44:47], s71 offen offset:0 sc1
    v_mfma_f32_16x16x32_bf16 v[136:139], a[208:211], a[80:83], v[136:139]
    v_cvt_pk_bf16_f32 v120, v120, v121
    v_cvt_pk_bf16_f32 v121, v122, v123
    v_mfma_f32_16x16x32_bf16 v[136:139], a[212:215], a[92:95], v[136:139]
    v_or_b32 v120, 1, v120
    s_waitcnt lgkmcnt(2)
    v_mfma_f32_16x16x32_bf16 v[140:143], a[216:219], a[96:99], v[140:143]
    ds_read_b64_tr_b16 a[202:203], v2 offset:17504
    v_cvt_pk_bf16_f32 v122, v132, v133
    v_mfma_f32_16x16x32_bf16 v[140:143], a[220:223], a[108:111], v[140:143]
    ds_read_b64_tr_b16 a[204:205], v2 offset:17120
    v_cvt_pk_bf16_f32 v123, v134, v135
    v_mfma_f32_16x16x32_bf16 v[140:143], a[224:227], a[120:123], v[140:143]
    buffer_store_dwordx4 v[120:123], v12, s[44:47], s71 offen offset:1024 sc1
    v_mfma_f32_16x16x32_bf16 v[140:143], a[228:231], a[132:135], v[140:143]
    ds_read_b64_tr_b16 a[206:207], v2 offset:17632
    v_cvt_pk_bf16_f32 v124, v124, v125
    v_mfma_f32_16x16x32_bf16 v[144:147], a[228:231], a[136:139], v[144:147]
    ds_read_b64_tr_b16 a[208:209], v2 offset:50752
    v_cvt_pk_bf16_f32 v125, v126, v127
    v_mfma_f32_16x16x32_bf16 v[144:147], a[224:227], a[124:127], v[144:147]
    ds_read_b64_tr_b16 a[210:211], v2 offset:51264
    v_or_b32 v124, 1, v124
    v_mfma_f32_16x16x32_bf16 v[144:147], a[220:223], a[112:115], v[144:147]
    ds_read_b64_tr_b16 a[212:213], v2 offset:50880
    v_cvt_pk_bf16_f32 v126, v136, v137
    v_mfma_f32_16x16x32_bf16 v[144:147], a[216:219], a[100:103], v[144:147]
    ds_read_b64_tr_b16 a[214:215], v2 offset:51392
    v_cvt_pk_bf16_f32 v127, v138, v139
    v_mfma_f32_16x16x32_bf16 v[148:151], a[216:219], a[104:107], v[148:151]
    buffer_store_dwordx4 v[124:127], v12, s[44:47], s71 offen offset:2048 sc1
    v_mfma_f32_16x16x32_bf16 v[148:151], a[220:223], a[116:119], v[148:151]
    ds_read_b64_tr_b16 a[216:217], v3 offset:8512
    v_mfma_f32_16x16x32_bf16 v[148:151], a[224:227], a[128:131], v[148:151]
    ds_read_b64_tr_b16 a[218:219], v3 offset:9024
    v_mfma_f32_16x16x32_bf16 v[148:151], a[228:231], a[140:143], v[148:151]
    ds_read_b64_tr_b16 a[220:221], v3 offset:8640
    v_mfma_f32_16x16x32_bf16 v[152:155], a[192:195], a[96:99], v[152:155]
    ds_read_b64_tr_b16 a[222:223], v3 offset:9152
    s_waitcnt lgkmcnt(8)
    v_mfma_f32_16x16x32_bf16 v[152:155], a[196:199], a[108:111], v[152:155]
    ds_read_b64_tr_b16 a[224:225], v2 offset:50784
    v_mfma_f32_16x16x32_bf16 v[152:155], a[200:203], a[120:123], v[152:155]
    ds_read_b64_tr_b16 a[226:227], v2 offset:51296
    v_mfma_f32_16x16x32_bf16 v[152:155], a[204:207], a[132:135], v[152:155]
    ds_read_b64_tr_b16 a[228:229], v2 offset:50912
    v_mfma_f32_16x16x32_bf16 v[156:159], a[204:207], a[136:139], v[156:159]
    ds_read_b64_tr_b16 a[230:231], v2 offset:51424
    v_mfma_f32_16x16x32_bf16 v[156:159], a[200:203], a[124:127], v[156:159]
    v_mfma_f32_16x16x32_bf16 v[156:159], a[196:199], a[112:115], v[156:159]
    v_mfma_f32_16x16x32_bf16 v[156:159], a[192:195], a[100:103], v[156:159]
    v_mfma_f32_16x16x32_bf16 v[160:163], a[192:195], a[104:107], v[160:163]
    ds_read_b64_tr_b16 a[192:193], v3 offset:8544
    v_mfma_f32_16x16x32_bf16 v[160:163], a[196:199], a[116:119], v[160:163]
    ds_read_b64_tr_b16 a[194:195], v3 offset:9056
    v_mfma_f32_16x16x32_bf16 v[160:163], a[200:203], a[128:131], v[160:163]
    ds_read_b64_tr_b16 a[196:197], v3 offset:8672
    v_mfma_f32_16x16x32_bf16 v[160:163], a[204:207], a[140:143], v[160:163]
    ds_read_b64_tr_b16 a[198:199], v3 offset:9184
    s_waitcnt lgkmcnt(6)
    v_mfma_f32_16x16x32_bf16 v[140:143], a[208:211], a[0:3], v[140:143]
    ds_read_b64_tr_b16 a[200:201], v3 offset:25408
    v_mfma_f32_16x16x32_bf16 v[140:143], a[212:215], a[12:15], v[140:143]
    ds_read_b64_tr_b16 a[202:203], v3 offset:25920
    v_mfma_f32_16x16x32_bf16 v[140:143], a[216:219], a[24:27], v[140:143]
    ds_read_b64_tr_b16 a[204:205], v3 offset:25536
    v_mfma_f32_16x16x32_bf16 v[140:143], a[220:223], a[36:39], v[140:143]
    ds_read_b64_tr_b16 a[206:207], v3 offset:26048
    v_mfma_f32_16x16x32_bf16 v[144:147], a[220:223], a[40:43], v[144:147]
    v_mfma_f32_16x16x32_bf16 v[144:147], a[216:219], a[28:31], v[144:147]
    v_mfma_f32_16x16x32_bf16 v[144:147], a[212:215], a[16:19], v[144:147]
    v_mfma_f32_16x16x32_bf16 v[144:147], a[208:211], a[4:7], v[144:147]
    v_mfma_f32_16x16x32_bf16 v[148:151], a[208:211], a[8:11], v[148:151]
    ds_read_b64_tr_b16 a[208:209], v3 offset:33856
    v_mfma_f32_16x16x32_bf16 v[148:151], a[212:215], a[20:23], v[148:151]
    ds_read_b64_tr_b16 a[210:211], v3 offset:34368
    v_mfma_f32_16x16x32_bf16 v[148:151], a[216:219], a[32:35], v[148:151]
    ds_read_b64_tr_b16 a[212:213], v3 offset:33984
    v_mfma_f32_16x16x32_bf16 v[148:151], a[220:223], a[44:47], v[148:151]
    ds_read_b64_tr_b16 a[214:215], v3 offset:34496
    v_mfma_f32_16x16x32_bf16 v[152:155], a[224:227], a[0:3], v[152:155]
    ds_read_b64_tr_b16 a[216:217], v3 offset:25440
    s_waitcnt lgkmcnt(5)
    v_mfma_f32_16x16x32_bf16 v[152:155], a[228:231], a[12:15], v[152:155]
    ds_read_b64_tr_b16 a[218:219], v3 offset:25952
    v_mfma_f32_16x16x32_bf16 v[152:155], a[192:195], a[24:27], v[152:155]
    ds_read_b64_tr_b16 a[220:221], v3 offset:25568
    v_mfma_f32_16x16x32_bf16 v[152:155], a[196:199], a[36:39], v[152:155]
    ds_read_b64_tr_b16 a[222:223], v3 offset:26080
    v_mfma_f32_16x16x32_bf16 v[156:159], a[196:199], a[40:43], v[156:159]
    v_mfma_f32_16x16x32_bf16 v[156:159], a[192:195], a[28:31], v[156:159]
    v_mfma_f32_16x16x32_bf16 v[156:159], a[228:231], a[16:19], v[156:159]
    v_mfma_f32_16x16x32_bf16 v[156:159], a[224:227], a[4:7], v[156:159]
    v_mfma_f32_16x16x32_bf16 v[160:163], a[224:227], a[8:11], v[160:163]
    ds_read_b64_tr_b16 a[224:225], v3 offset:33888
    v_mfma_f32_16x16x32_bf16 v[160:163], a[228:231], a[20:23], v[160:163]
    ds_read_b64_tr_b16 a[226:227], v3 offset:34400
    v_mfma_f32_16x16x32_bf16 v[160:163], a[192:195], a[32:35], v[160:163]
    ds_read_b64_tr_b16 a[228:229], v3 offset:34016
    v_mfma_f32_16x16x32_bf16 v[160:163], a[196:199], a[44:47], v[160:163]
    ds_read_b64_tr_b16 a[230:231], v3 offset:34528
    v_mfma_f32_16x16x32_bf16 v[140:143], a[200:203], v[20:23], v[140:143]
    s_add_u32 s10, s72, 0
    buffer_load_dwordx4 v[220:223], v12, s[44:47], s10 offen offset:0 sc1
    v_mfma_f32_16x16x32_bf16 v[140:143], a[204:207], v[32:35], v[140:143]
    ds_read_b64_tr_b16 a[192:193], v3 offset:42304
    s_waitcnt lgkmcnt(5)
    v_mfma_f32_16x16x32_bf16 v[140:143], a[208:211], v[44:47], v[140:143]
    ds_read_b64_tr_b16 a[194:195], v3 offset:42816
    v_mfma_f32_16x16x32_bf16 v[140:143], a[212:215], v[56:59], v[140:143]
    ds_read_b64_tr_b16 a[196:197], v3 offset:42432
    v_mfma_f32_16x16x32_bf16 v[144:147], a[212:215], v[60:63], v[144:147]
    ds_read_b64_tr_b16 a[198:199], v3 offset:42944
    v_mfma_f32_16x16x32_bf16 v[144:147], a[208:211], v[48:51], v[144:147]
    buffer_load_dwordx4 v[224:227], v12, s[44:47], s10 offen offset:1024 sc1
    v_mfma_f32_16x16x32_bf16 v[144:147], a[204:207], v[36:39], v[144:147]
    v_mfma_f32_16x16x32_bf16 v[144:147], a[200:203], v[24:27], v[144:147]
    v_mfma_f32_16x16x32_bf16 v[148:151], a[200:203], v[28:31], v[148:151]
    ds_read_b64_tr_b16 a[200:201], v3 offset:64
    v_mfma_f32_16x16x32_bf16 v[148:151], a[204:207], v[40:43], v[148:151]
    buffer_load_dwordx4 v[228:231], v12, s[44:47], s10 offen offset:2048 sc1
    v_mfma_f32_16x16x32_bf16 v[148:151], a[208:211], v[52:55], v[148:151]
    ds_read_b64_tr_b16 a[202:203], v3 offset:576
    v_mfma_f32_16x16x32_bf16 v[148:151], a[212:215], v[64:67], v[148:151]
    ds_read_b64_tr_b16 a[204:205], v3 offset:192
    v_mfma_f32_16x16x32_bf16 v[152:155], a[216:219], v[20:23], v[152:155]
    ds_read_b64_tr_b16 a[206:207], v3 offset:704
    v_mfma_f32_16x16x32_bf16 v[152:155], a[220:223], v[32:35], v[152:155]
    ds_read_b64_tr_b16 a[208:209], v3 offset:42336
    s_waitcnt lgkmcnt(5)
    v_mfma_f32_16x16x32_bf16 v[152:155], a[224:227], v[44:47], v[152:155]
    ds_read_b64_tr_b16 a[210:211], v3 offset:42848
    v_mfma_f32_16x16x32_bf16 v[152:155], a[228:231], v[56:59], v[152:155]
    ds_read_b64_tr_b16 a[212:213], v3 offset:42464
    v_mfma_f32_16x16x32_bf16 v[156:159], a[228:231], v[60:63], v[156:159]
    ds_read_b64_tr_b16 a[214:215], v3 offset:42976
    v_mfma_f32_16x16x32_bf16 v[156:159], a[224:227], v[48:51], v[156:159]
    v_mfma_f32_16x16x32_bf16 v[156:159], a[220:223], v[36:39], v[156:159]
    v_mfma_f32_16x16x32_bf16 v[156:159], a[216:219], v[24:27], v[156:159]
    v_mfma_f32_16x16x32_bf16 v[160:163], a[216:219], v[28:31], v[160:163]
    ds_read_b64_tr_b16 a[216:217], v3 offset:96
    v_mfma_f32_16x16x32_bf16 v[160:163], a[220:223], v[40:43], v[160:163]
    ds_read_b64_tr_b16 a[218:219], v3 offset:608
    v_mfma_f32_16x16x32_bf16 v[160:163], a[224:227], v[52:55], v[160:163]
    ds_read_b64_tr_b16 a[220:221], v3 offset:224
    v_mfma_f32_16x16x32_bf16 v[160:163], a[228:231], v[64:67], v[160:163]
    ds_read_b64_tr_b16 a[222:223], v3 offset:736
    v_mfma_f32_16x16x32_bf16 v[140:143], a[192:195], v[68:71], v[140:143]
    s_add_u32 s10, s72, 4096
    buffer_load_dwordx4 v[244:247], v12, s[44:47], s10 offen offset:0 sc1
    v_mfma_f32_16x16x32_bf16 v[140:143], a[196:199], v[80:83], v[140:143]
    ds_read_b64_tr_b16 a[224:225], v2 offset:42304
    s_waitcnt lgkmcnt(5)
    v_mfma_f32_16x16x32_bf16 v[140:143], a[200:203], v[92:95], v[140:143]
    ds_read_b64_tr_b16 a[226:227], v2 offset:42816
    v_mfma_f32_16x16x32_bf16 v[140:143], a[204:207], v[104:107], v[140:143]
    ds_read_b64_tr_b16 a[228:229], v2 offset:42432
    v_mfma_f32_16x16x32_bf16 v[144:147], a[204:207], v[108:111], v[144:147]
    ds_read_b64_tr_b16 a[230:231], v2 offset:42944
    v_mfma_f32_16x16x32_bf16 v[144:147], a[200:203], v[96:99], v[144:147]
    buffer_load_dwordx4 v[248:251], v12, s[44:47], s10 offen offset:1024 sc1
    v_mfma_f32_16x16x32_bf16 v[144:147], a[196:199], v[84:87], v[144:147]
    v_mfma_f32_16x16x32_bf16 v[144:147], a[192:195], v[72:75], v[144:147]
    v_mfma_f32_16x16x32_bf16 v[148:151], a[192:195], v[76:79], v[148:151]
    ds_read_b64_tr_b16 a[192:193], v4 offset:64
    v_mfma_f32_16x16x32_bf16 v[148:151], a[196:199], v[88:91], v[148:151]
    buffer_load_dwordx4 v[252:255], v12, s[44:47], s10 offen offset:2048 sc1
    v_mfma_f32_16x16x32_bf16 v[148:151], a[200:203], v[100:103], v[148:151]
    ds_read_b64_tr_b16 a[194:195], v4 offset:576
    v_mfma_f32_16x16x32_bf16 v[148:151], a[204:207], v[112:115], v[148:151]
    ds_read_b64_tr_b16 a[196:197], v4 offset:192
    v_mfma_f32_16x16x32_bf16 v[152:155], a[208:211], v[68:71], v[152:155]
    ds_read_b64_tr_b16 a[198:199], v4 offset:704
    v_mfma_f32_16x16x32_bf16 v[152:155], a[212:215], v[80:83], v[152:155]
    ds_read_b64_tr_b16 a[200:201], v2 offset:42336
    s_waitcnt lgkmcnt(5)
    v_mfma_f32_16x16x32_bf16 v[152:155], a[216:219], v[92:95], v[152:155]
    ds_read_b64_tr_b16 a[202:203], v2 offset:42848
    v_mfma_f32_16x16x32_bf16 v[152:155], a[220:223], v[104:107], v[152:155]
    ds_read_b64_tr_b16 a[204:205], v2 offset:42464
    v_mfma_f32_16x16x32_bf16 v[156:159], a[220:223], v[108:111], v[156:159]
    ds_read_b64_tr_b16 a[206:207], v2 offset:42976
    v_mfma_f32_16x16x32_bf16 v[156:159], a[216:219], v[96:99], v[156:159]
    v_mfma_f32_16x16x32_bf16 v[156:159], a[212:215], v[84:87], v[156:159]
    v_mfma_f32_16x16x32_bf16 v[156:159], a[208:211], v[72:75], v[156:159]
    v_mfma_f32_16x16x32_bf16 v[160:163], a[208:211], v[76:79], v[160:163]
    ds_read_b64_tr_b16 a[208:209], v4 offset:96
    v_mfma_f32_16x16x32_bf16 v[160:163], a[212:215], v[88:91], v[160:163]
    ds_read_b64_tr_b16 a[210:211], v4 offset:608
    v_mfma_f32_16x16x32_bf16 v[160:163], a[216:219], v[100:103], v[160:163]
    ds_read_b64_tr_b16 a[212:213], v4 offset:224
    v_mfma_f32_16x16x32_bf16 v[160:163], a[220:223], v[112:115], v[160:163]
    ds_read_b64_tr_b16 a[214:215], v4 offset:736
    v_mfma_f32_16x16x32_bf16 v[140:143], a[224:227], a[144:147], v[140:143]
    ds_read_b64_tr_b16 a[216:217], v4 offset:8512
    v_mfma_f32_16x16x32_bf16 v[140:143], a[228:231], a[156:159], v[140:143]
    ds_read_b64_tr_b16 a[218:219], v4 offset:9024
    s_waitcnt lgkmcnt(6)
    v_mfma_f32_16x16x32_bf16 v[140:143], a[192:195], a[168:171], v[140:143]
    ds_read_b64_tr_b16 a[220:221], v4 offset:8640
    v_mfma_f32_16x16x32_bf16 v[140:143], a[196:199], a[180:183], v[140:143]
    ds_read_b64_tr_b16 a[222:223], v4 offset:9152
    v_mfma_f32_16x16x32_bf16 v[144:147], a[196:199], a[184:187], v[144:147]
    v_mfma_f32_16x16x32_bf16 v[144:147], a[192:195], a[172:175], v[144:147]
    v_mfma_f32_16x16x32_bf16 v[144:147], a[228:231], a[160:163], v[144:147]
    v_mfma_f32_16x16x32_bf16 v[144:147], a[224:227], a[148:151], v[144:147]
    v_mfma_f32_16x16x32_bf16 v[148:151], a[224:227], a[152:155], v[148:151]
    ds_read_b64_tr_b16 a[224:225], v3 offset:16960
    v_mfma_f32_16x16x32_bf16 v[148:151], a[228:231], a[164:167], v[148:151]
    ds_read_b64_tr_b16 a[226:227], v3 offset:17472
    v_mfma_f32_16x16x32_bf16 v[148:151], a[192:195], a[176:179], v[148:151]
    ds_read_b64_tr_b16 a[228:229], v3 offset:17088
    v_mfma_f32_16x16x32_bf16 v[148:151], a[196:199], a[188:191], v[148:151]
    ds_read_b64_tr_b16 a[230:231], v3 offset:17600
    v_mfma_f32_16x16x32_bf16 v[152:155], a[200:203], a[144:147], v[152:155]
    s_add_u32 s10, s72, 8192
    buffer_load_dwordx4 v[128:131], v12, s[44:47], s10 offen offset:0 sc1
    v_mfma_f32_16x16x32_bf16 v[152:155], a[204:207], a[156:159], v[152:155]
    ds_read_b64_tr_b16 a[192:193], v4 offset:8544
    s_waitcnt lgkmcnt(5)
    v_mfma_f32_16x16x32_bf16 v[152:155], a[208:211], a[168:171], v[152:155]
    ds_read_b64_tr_b16 a[194:195], v4 offset:9056
    v_mfma_f32_16x16x32_bf16 v[152:155], a[212:215], a[180:183], v[152:155]
    ds_read_b64_tr_b16 a[196:197], v4 offset:8672
    v_mfma_f32_16x16x32_bf16 v[156:159], a[212:215], a[184:187], v[156:159]
    ds_read_b64_tr_b16 a[198:199], v4 offset:9184
    v_mfma_f32_16x16x32_bf16 v[156:159], a[208:211], a[172:175], v[156:159]
    buffer_load_dwordx4 v[132:135], v12, s[44:47], s10 offen offset:1024 sc1
    v_mfma_f32_16x16x32_bf16 v[156:159], a[204:207], a[160:163], v[156:159]
    v_mfma_f32_16x16x32_bf16 v[156:159], a[200:203], a[148:151], v[156:159]
    v_mfma_f32_16x16x32_bf16 v[160:163], a[200:203], a[152:155], v[160:163]
    ds_read_b64_tr_b16 a[200:201], v3 offset:16992
    v_mfma_f32_16x16x32_bf16 v[160:163], a[204:207], a[164:167], v[160:163]
    buffer_load_dwordx4 v[136:139], v12, s[44:47], s10 offen offset:2048 sc1
    v_mfma_f32_16x16x32_bf16 v[160:163], a[208:211], a[176:179], v[160:163]
    ds_read_b64_tr_b16 a[202:203], v3 offset:17504
    v_mfma_f32_16x16x32_bf16 v[160:163], a[212:215], a[188:191], v[160:163]
    ds_read_b64_tr_b16 a[204:205], v3 offset:17120
    v_mfma_f32_16x16x32_bf16 v[140:143], a[216:219], a[48:51], v[140:143]
    ds_read_b64_tr_b16 a[206:207], v3 offset:17632
    v_mfma_f32_16x16x32_bf16 v[140:143], a[220:223], a[60:63], v[140:143]
    s_waitcnt lgkmcnt(4)
    v_mfma_f32_16x16x32_bf16 v[140:143], a[224:227], a[72:75], v[140:143]
    v_mfma_f32_16x16x32_bf16 v[140:143], a[228:231], a[84:87], v[140:143]
    v_mfma_f32_16x16x32_bf16 v[144:147], a[228:231], a[88:91], v[144:147]
    v_mfma_f32_16x16x32_bf16 v[144:147], a[224:227], a[76:79], v[144:147]
    v_mfma_f32_16x16x32_bf16 v[144:147], a[220:223], a[64:67], v[144:147]
    v_mfma_f32_16x16x32_bf16 v[144:147], a[216:219], a[52:55], v[144:147]
    v_mfma_f32_16x16x32_bf16 v[148:151], a[216:219], a[56:59], v[148:151]
    v_mfma_f32_16x16x32_bf16 v[148:151], a[220:223], a[68:71], v[148:151]
    v_mfma_f32_16x16x32_bf16 v[148:151], a[224:227], a[80:83], v[148:151]
    v_mfma_f32_16x16x32_bf16 v[148:151], a[228:231], a[92:95], v[148:151]
    v_mfma_f32_16x16x32_bf16 v[152:155], a[192:195], a[48:51], v[152:155]
    v_mfma_f32_16x16x32_bf16 v[152:155], a[196:199], a[60:63], v[152:155]
    s_waitcnt lgkmcnt(0)
    v_mfma_f32_16x16x32_bf16 v[152:155], a[200:203], a[72:75], v[152:155]
    v_mfma_f32_16x16x32_bf16 v[152:155], a[204:207], a[84:87], v[152:155]
    v_mfma_f32_16x16x32_bf16 v[156:159], a[204:207], a[88:91], v[156:159]
    v_mfma_f32_16x16x32_bf16 v[156:159], a[200:203], a[76:79], v[156:159]
    v_mfma_f32_16x16x32_bf16 v[156:159], a[196:199], a[64:67], v[156:159]
    v_mfma_f32_16x16x32_bf16 v[156:159], a[192:195], a[52:55], v[156:159]
    v_mfma_f32_16x16x32_bf16 v[160:163], a[192:195], a[56:59], v[160:163]
    v_mfma_f32_16x16x32_bf16 v[160:163], a[196:199], a[68:71], v[160:163]
    s_waitcnt vmcnt(6)
    v_and_b32 v16, v220, v224
    v_and_b32 v17, 1, v228
    v_and_b32 v16, v16, v17
    v_cmp_eq_u32 vcc, 0, v16
    s_cbranch_vccnz K_PL0
K_PL0_ret:
    v_mfma_f32_16x16x32_bf16 v[160:163], a[200:203], a[80:83], v[160:163]
    v_mfma_f32_16x16x32_bf16 v[160:163], a[204:207], a[92:95], v[160:163]
    v_mfma_f32_16x16x32_bf16 v[140:143], a[248:251], v[220:223], v[140:143]
    v_mfma_f32_16x16x32_bf16 v[152:155], a[246:249], v[220:223], v[152:155]
    v_mfma_f32_16x16x32_bf16 v[144:147], a[248:251], v[224:227], v[144:147]
    v_mfma_f32_16x16x32_bf16 v[156:159], a[246:249], v[224:227], v[156:159]
    s_waitcnt vmcnt(3)
    v_and_b32 v16, v244, v248
    v_and_b32 v17, 1, v252
    v_and_b32 v16, v16, v17
    v_cmp_eq_u32 vcc, 0, v16
    s_cbranch_vccnz K_PL1
K_PL1_ret:
    v_mfma_f32_16x16x32_bf16 v[148:151], a[248:251], v[228:231], v[148:151]
    v_mfma_f32_16x16x32_bf16 v[160:163], a[246:249], v[228:231], v[160:163]
    v_mfma_f32_16x16x32_bf16 v[140:143], a[248:251], v[244:247], v[140:143]
    v_mfma_f32_16x16x32_bf16 v[152:155], a[246:249], v[244:247], v[152:155]
    v_mfma_f32_16x16x32_bf16 v[144:147], a[248:251], v[248:251], v[144:147]
    v_mfma_f32_16x16x32_bf16 v[156:159], a[246:249], v[248:251], v[156:159]
    s_waitcnt vmcnt(0)
    v_and_b32 v16, v128, v132
    v_and_b32 v17, 1, v136
    v_and_b32 v16, v16, v17
    v_cmp_eq_u32 vcc, 0, v16
    s_cbranch_vccnz K_PL2
K_PL2_ret:
    v_mfma_f32_16x16x32_bf16 v[148:151], a[248:251], v[252:255], v[148:151]
    v_mfma_f32_16x16x32_bf16 v[160:163], a[246:249], v[252:255], v[160:163]
    v_mfma_f32_16x16x32_bf16 v[140:143], a[248:251], v[128:131], v[140:143]
    v_mfma_f32_16x16x32_bf16 v[152:155], a[246:249], v[128:131], v[152:155]
    v_mfma_f32_16x16x32_bf16 v[144:147], a[248:251], v[132:135], v[144:147]
    v_mfma_f32_16x16x32_bf16 v[156:159], a[246:249], v[132:135], v[156:159]
    v_mfma_f32_16x16x32_bf16 v[148:151], a[248:251], v[136:139], v[148:151]
    v_mfma_f32_16x16x32_bf16 v[160:163], a[246:249], v[136:139], v[160:163]
    s_nop 2
    v_cvt_pk_bf16_f32 v208, v140, v141
    v_cvt_pk_bf16_f32 v210, v152, v153
    v_cvt_pk_bf16_f32 v209, v142, v143
    v_cvt_pk_bf16_f32 v211, v154, v155
    v_permlane16_swap_b32 v208, v210
    s_nop 0
    v_permlane16_swap_b32 v209, v211
    buffer_store_dwordx4 v[208:211], v164, s[52:55], 0 offen offset:0
    v_cvt_pk_bf16_f32 v212, v144, v145
    v_cvt_pk_bf16_f32 v214, v156, v157
    v_cvt_pk_bf16_f32 v213, v146, v147
    v_cvt_pk_bf16_f32 v215, v158, v159
    v_permlane16_swap_b32 v212, v214
    s_nop 0
    v_permlane16_swap_b32 v213, v215
    buffer_store_dwordx4 v[212:215], v165, s[52:55], 0 offen offset:0
    v_cvt_pk_bf16_f32 v216, v148, v149
    v_cvt_pk_bf16_f32 v218, v160, v161
    v_cvt_pk_bf16_f32 v217, v150, v151
    v_cvt_pk_bf16_f32 v219, v162, v163
    v_permlane16_swap_b32 v216, v218
    s_nop 0
    v_permlane16_swap_b32 v217, v219
    buffer_store_dwordx4 v[216:219], v166, s[52:55], 0 offen offset:0
K_END:
    s_endpgm
K_R0_0:
    s_call_b64 s[82:83], K_RARE2
    s_call_b64 s[82:83], K_RARB0
    s_branch K_R0_0_ret
K_R0_1:
    s_call_b64 s[82:83], K_RARE1
    s_call_b64 s[82:83], K_RARB1
    s_branch K_R0_1_ret
K_R0_2:
    s_call_b64 s[82:83], K_RARE0
    s_call_b64 s[82:83], K_RARB0
    s_branch K_R0_2_ret
K_R0_3:
    s_call_b64 s[82:83], K_RARE1
    s_call_b64 s[82:83], K_RARB1
    s_branch K_R0_3_ret
K_R0_4:
    s_call_b64 s[82:83], K_RARE0
    s_call_b64 s[82:83], K_RARB0
    s_branch K_R0_4_ret
K_R0_5:
    s_call_b64 s[82:83], K_RARE1
    s_call_b64 s[82:83], K_RARB1
    s_branch K_R0_5_ret
K_R0_6:
    s_call_b64 s[82:83], K_RARE0
    s_call_b64 s[82:83], K_RARB0
    s_branch K_R0_6_ret
K_R0_7:
    s_call_b64 s[82:83], K_RARE1
    s_call_b64 s[82:83], K_RARB1
    s_branch K_R0_7_ret
K_R0_8:
    s_call_b64 s[82:83], K_RARE0
    s_call_b64 s[82:83], K_RARB0
    s_branch K_R0_8_ret
K_R0_9:
    s_call_b64 s[82:83], K_RARE1
    s_call_b64 s[82:83], K_RARB1
    s_branch K_R0_9_ret
K_R0_10:
    s_call_b64 s[82:83], K_RARE0
    s_call_b64 s[82:83], K_RARB0
    s_branch K_R0_10_ret
K_R0_11:
    s_call_b64 s[82:83], K_RARE1
    s_call_b64 s[82:83], K_RARB1
    s_branch K_R0_11_ret
K_R0_12:
    s_call_b64 s[82:83], K_RARE0
    s_call_b64 s[82:83], K_RARB0
    s_branch K_R0_12_ret
K_R0_13:
    s_call_b64 s[82:83], K_RARE1
    s_call_b64 s[82:83], K_RARB1
    s_branch K_R0_13_ret
K_R0_14:
    s_call_b64 s[82:83], K_RARE0
    s_call_b64 s[82:83], K_RARB0
    s_branch K_R0_14_ret
K_R0_15:
    s_call_b64 s[82:83], K_RARE1
    s_branch K_R0_15_ret
K_R1_0:
    s_call_b64 s[82:83], K_RARE2
    s_call_b64 s[82:83], K_RARB0
    s_branch K_R1_0_ret
K_R1_1:
    s_call_b64 s[82:83], K_RARE1
    s_call_b64 s[82:83], K_RARB1
    s_branch K_R1_1_ret
K_R1_2:
    s_call_b64 s[82:83], K_RARE0
    s_call_b64 s[82:83], K_RARB0
    s_branch K_R1_2_ret
K_R1_3:
    s_call_b64 s[82:83], K_RARE1
    s_call_b64 s[82:83], K_RARB1
    s_branch K_R1_3_ret
K_R1_4:
    s_call_b64 s[82:83], K_RARE0
    s_call_b64 s[82:83], K_RARB0
    s_branch K_R1_4_ret
K_R1_5:
    s_call_b64 s[82:83], K_RARE1
    s_call_b64 s[82:83], K_RARB1
    s_branch K_R1_5_ret
K_R1_6:
    s_call_b64 s[82:83], K_RARE0
    s_call_b64 s[82:83], K_RARB0
    s_branch K_R1_6_ret
K_R1_7:
    s_call_b64 s[82:83], K_RARE1
    s_call_b64 s[82:83], K_RARB1
    s_branch K_R1_7_ret
K_R1_8:
    s_call_b64 s[82:83], K_RARE0
    s_call_b64 s[82:83], K_RARB0
    s_branch K_R1_8_ret
K_R1_9:
    s_call_b64 s[82:83], K_RARE1
    s_call_b64 s[82:83], K_RARB1
    s_branch K_R1_9_ret
K_R1_10:
    s_call_b64 s[82:83], K_RARE0
    s_call_b64 s[82:83], K_RARB0
    s_branch K_R1_10_ret
K_R1_11:
    s_call_b64 s[82:83], K_RARE1
    s_call_b64 s[82:83], K_RARB1
    s_branch K_R1_11_ret
K_R1_12:
    s_call_b64 s[82:83], K_RARE0
    s_call_b64 s[82:83], K_RARB0
    s_branch K_R1_12_ret
K_R1_13:
    s_call_b64 s[82:83], K_RARE1
    s_call_b64 s[82:83], K_RARB1
    s_branch K_R1_13_ret
K_R1_14:
    s_call_b64 s[82:83], K_RARE0
    s_call_b64 s[82:83], K_RARB0
    s_branch K_R1_14_ret
K_R1_15:
    s_call_b64 s[82:83], K_RARE1
    s_branch K_R1_15_ret
K_RARE0:
    s_nop 15
    v_max3_f32 v176, v116, v117, v118
    v_max3_f32 v180, v120, v121, v122
    v_max3_f32 v184, v124, v125, v126
    v_max3_f32 v176, v176, v119, v128
    v_max3_f32 v180, v180, v123, v132
    v_max3_f32 v184, v184, v127, v136
    v_max3_f32 v176, v176, v129, v130
    v_max3_f32 v180, v180, v133, v134
    v_max3_f32 v184, v184, v137, v138
    v_max3_f32 v176, v176, v131, 0
    v_max3_f32 v180, v180, v135, 0
    v_max3_f32 v184, v184, v139, 0
    v_mov_b32 v177, v176
    v_mov_b32 v181, v180
    v_mov_b32 v185, v184
    v_permlane16_swap_b32 v176, v177
    v_permlane16_swap_b32 v180, v181
    v_permlane16_swap_b32 v184, v185
    v_max_f32 v176, v176, v177
    v_max_f32 v180, v180, v181
    v_max_f32 v184, v184, v185
    v_mov_b32 v177, v176
    v_mov_b32 v181, v180
    v_mov_b32 v185, v184
    v_permlane32_swap_b32 v176, v177
    v_permlane32_swap_b32 v180, v181
    v_permlane32_swap_b32 v184, v185
    v_max_f32 v176, v176, v177
    v_max_f32 v180, v180, v181
    v_max_f32 v184, v184, v185
    v_exp_f32 v177, -v176
    s_nop 0
    v_mul_f32 v204, v204, v177
    v_mul_f32 v20, v20, v177
    v_mul_f32 v21, v21, v177
    v_mul_f32 v22, v22, v177
    v_mul_f32 v23, v23, v177
    v_mul_f32 v32, v32, v177
    v_mul_f32 v33, v33, v177
    v_mul_f32 v34, v34, v177
    v_mul_f32 v35, v35, v177
    v_mul_f32 v44, v44, v177
    v_mul_f32 v45, v45, v177
    v_mul_f32 v46, v46, v177
    v_mul_f32 v47, v47, v177
    v_mul_f32 v56, v56, v177
    v_mul_f32 v57, v57, v177
    v_mul_f32 v58, v58, v177
    v_mul_f32 v59, v59, v177
    v_mul_f32 v68, v68, v177
    v_mul_f32 v69, v69, v177
    v_mul_f32 v70, v70, v177
    v_mul_f32 v71, v71, v177
    v_mul_f32 v80, v80, v177
    v_mul_f32 v81, v81, v177
    v_mul_f32 v82, v82, v177
    v_mul_f32 v83, v83, v177
    v_mul_f32 v92, v92, v177
    v_mul_f32 v93, v93, v177
    v_mul_f32 v94, v94, v177
    v_mul_f32 v95, v95, v177
    v_mul_f32 v104, v104, v177
    v_mul_f32 v105, v105, v177
    v_mul_f32 v106, v106, v177
    v_mul_f32 v107, v107, v177
    v_sub_f32 v188, v188, v176
    v_sub_f32 v189, v189, v176
    v_sub_f32 v190, v190, v176
    v_sub_f32 v191, v191, v176
    v_sub_f32 v116, v116, v176
    v_sub_f32 v117, v117, v176
    v_sub_f32 v118, v118, v176
    v_sub_f32 v119, v119, v176
    v_sub_f32 v128, v128, v176
    v_sub_f32 v129, v129, v176
    v_sub_f32 v130, v130, v176
    v_sub_f32 v131, v131, v176
    v_exp_f32 v181, -v180
    s_nop 0
    v_mul_f32 v205, v205, v181
    v_mul_f32 v24, v24, v181
    v_mul_f32 v25, v25, v181
    v_mul_f32 v26, v26, v181
    v_mul_f32 v27, v27, v181
    v_mul_f32 v36, v36, v181
    v_mul_f32 v37, v37, v181
    v_mul_f32 v38, v38, v181
    v_mul_f32 v39, v39, v181
    v_mul_f32 v48, v48, v181
    v_mul_f32 v49, v49, v181
    v_mul_f32 v50, v50, v181
    v_mul_f32 v51, v51, v181
    v_mul_f32 v60, v60, v181
    v_mul_f32 v61, v61, v181
    v_mul_f32 v62, v62, v181
    v_mul_f32 v63, v63, v181
    v_mul_f32 v72, v72, v181
    v_mul_f32 v73, v73, v181
    v_mul_f32 v74, v74, v181
    v_mul_f32 v75, v75, v181
    v_mul_f32 v84, v84, v181
    v_mul_f32 v85, v85, v181
    v_mul_f32 v86, v86, v181
    v_mul_f32 v87, v87, v181
    v_mul_f32 v96, v96, v181
    v_mul_f32 v97, v97, v181
    v_mul_f32 v98, v98, v181
    v_mul_f32 v99, v99, v181
    v_mul_f32 v108, v108, v181
    v_mul_f32 v109, v109, v181
    v_mul_f32 v110, v110, v181
    v_mul_f32 v111, v111, v181
    v_sub_f32 v192, v192, v180
    v_sub_f32 v193, v193, v180
    v_sub_f32 v194, v194, v180
    v_sub_f32 v195, v195, v180
    v_sub_f32 v120, v120, v180
    v_sub_f32 v121, v121, v180
    v_sub_f32 v122, v122, v180
    v_sub_f32 v123, v123, v180
    v_sub_f32 v132, v132, v180
    v_sub_f32 v133, v133, v180
    v_sub_f32 v134, v134, v180
    v_sub_f32 v135, v135, v180
    v_exp_f32 v185, -v184
    s_nop 0
    v_mul_f32 v206, v206, v185
    v_mul_f32 v28, v28, v185
    v_mul_f32 v29, v29, v185
    v_mul_f32 v30, v30, v185
    v_mul_f32 v31, v31, v185
    v_mul_f32 v40, v40, v185
    v_mul_f32 v41, v41, v185
    v_mul_f32 v42, v42, v185
    v_mul_f32 v43, v43, v185
    v_mul_f32 v52, v52, v185
    v_mul_f32 v53, v53, v185
    v_mul_f32 v54, v54, v185
    v_mul_f32 v55, v55, v185
    v_mul_f32 v64, v64, v185
    v_mul_f32 v65, v65, v185
    v_mul_f32 v66, v66, v185
    v_mul_f32 v67, v67, v185
    v_mul_f32 v76, v76, v185
    v_mul_f32 v77, v77, v185
    v_mul_f32 v78, v78, v185
    v_mul_f32 v79, v79, v185
    v_mul_f32 v88, v88, v185
    v_mul_f32 v89, v89, v185
    v_mul_f32 v90, v90, v185
    v_mul_f32 v91, v91, v185
    v_mul_f32 v100, v100, v185
    v_mul_f32 v101, v101, v185
    v_mul_f32 v102, v102, v185
    v_mul_f32 v103, v103, v185
    v_mul_f32 v112, v112, v185
    v_mul_f32 v113, v113, v185
    v_mul_f32 v114, v114, v185
    v_mul_f32 v115, v115, v185
    v_sub_f32 v196, v196, v184
    v_sub_f32 v197, v197, v184
    v_sub_f32 v198, v198, v184
    v_sub_f32 v199, v199, v184
    v_sub_f32 v124, v124, v184
    v_sub_f32 v125, v125, v184
    v_sub_f32 v126, v126, v184
    v_sub_f32 v127, v127, v184
    v_sub_f32 v136, v136, v184
    v_sub_f32 v137, v137, v184
    v_sub_f32 v138, v138, v184
    v_sub_f32 v139, v139, v184
    v_exp_f32 v16, v116
    v_exp_f32 v17, v117
    v_exp_f32 v18, v118
    v_cvt_pk_bf16_f32 v164, v16, v17
    v_exp_f32 v19, v119
    v_exp_f32 v16, v120
    v_cvt_pk_bf16_f32 v165, v18, v19
    v_exp_f32 v17, v121
    v_exp_f32 v18, v122
    v_cvt_pk_bf16_f32 v168, v16, v17
    v_exp_f32 v19, v123
    v_exp_f32 v16, v124
    v_cvt_pk_bf16_f32 v169, v18, v19
    v_exp_f32 v17, v125
    v_exp_f32 v18, v126
    v_cvt_pk_bf16_f32 v172, v16, v17
    v_exp_f32 v19, v127
    v_exp_f32 v16, v128
    v_cvt_pk_bf16_f32 v173, v18, v19
    v_exp_f32 v17, v129
    v_exp_f32 v18, v130
    v_cvt_pk_bf16_f32 v166, v16, v17
    v_exp_f32 v19, v131
    v_exp_f32 v16, v132
    v_cvt_pk_bf16_f32 v167, v18, v19
    v_exp_f32 v17, v133
    v_exp_f32 v18, v134
    v_cvt_pk_bf16_f32 v170, v16, v17
    v_exp_f32 v19, v135
    v_exp_f32 v16, v136
    v_cvt_pk_bf16_f32 v171, v18, v19
    v_exp_f32 v17, v137
    v_exp_f32 v18, v138
    v_cvt_pk_bf16_f32 v174, v16, v17
    v_exp_f32 v19, v139
    s_nop 0
    v_cvt_pk_bf16_f32 v175, v18, v19
    v_mfma_f32_16x16x32_bf16 v[200:203], a[232:235], v[164:167], v[204:207]
    v_mfma_f32_16x16x32_bf16 v[200:203], a[236:239], v[168:171], v[200:203]
    v_mfma_f32_16x16x32_bf16 v[200:203], a[240:243], v[172:175], v[200:203]
    s_nop 9
    s_setpc_b64 s[82:83]
K_RARB0:
    v_sub_f32 v140, v140, v176
    v_sub_f32 v141, v141, v176
    v_sub_f32 v142, v142, v176
    v_sub_f32 v143, v143, v176
    v_sub_f32 v152, v152, v176
    v_sub_f32 v153, v153, v176
    v_sub_f32 v154, v154, v176
    v_sub_f32 v155, v155, v176
    v_sub_f32 v144, v144, v180
    v_sub_f32 v145, v145, v180
    v_sub_f32 v146, v146, v180
    v_sub_f32 v147, v147, v180
    v_sub_f32 v156, v156, v180
    v_sub_f32 v157, v157, v180
    v_sub_f32 v158, v158, v180
    v_sub_f32 v159, v159, v180
    v_sub_f32 v148, v148, v184
    v_sub_f32 v149, v149, v184
    v_sub_f32 v150, v150, v184
    v_sub_f32 v151, v151, v184
    v_sub_f32 v160, v160, v184
    v_sub_f32 v161, v161, v184
    v_sub_f32 v162, v162, v184
    v_sub_f32 v163, v163, v184
    s_nop 3
    s_setpc_b64 s[82:83]
K_RARE1:
    s_nop 15
    v_max3_f32 v164, v140, v141, v142
    v_max3_f32 v168, v144, v145, v146
    v_max3_f32 v172, v148, v149, v150
    v_max3_f32 v164, v164, v143, v152
    v_max3_f32 v168, v168, v147, v156
    v_max3_f32 v172, v172, v151, v160
    v_max3_f32 v164, v164, v153, v154
    v_max3_f32 v168, v168, v157, v158
    v_max3_f32 v172, v172, v161, v162
    v_max3_f32 v164, v164, v155, 0
    v_max3_f32 v168, v168, v159, 0
    v_max3_f32 v172, v172, v163, 0
    v_mov_b32 v165, v164
    v_mov_b32 v169, v168
    v_mov_b32 v173, v172
    v_permlane16_swap_b32 v164, v165
    v_permlane16_swap_b32 v168, v169
    v_permlane16_swap_b32 v172, v173
    v_max_f32 v164, v164, v165
    v_max_f32 v168, v168, v169
    v_max_f32 v172, v172, v173
    v_mov_b32 v165, v164
    v_mov_b32 v169, v168
    v_mov_b32 v173, v172
    v_permlane32_swap_b32 v164, v165
    v_permlane32_swap_b32 v168, v169
    v_permlane32_swap_b32 v172, v173
    v_max_f32 v164, v164, v165
    v_max_f32 v168, v168, v169
    v_max_f32 v172, v172, v173
    v_exp_f32 v165, -v164
    s_nop 0
    v_mul_f32 v200, v200, v165
    v_mul_f32 v20, v20, v165
    v_mul_f32 v21, v21, v165
    v_mul_f32 v22, v22, v165
    v_mul_f32 v23, v23, v165
    v_mul_f32 v32, v32, v165
    v_mul_f32 v33, v33, v165
    v_mul_f32 v34, v34, v165
    v_mul_f32 v35, v35, v165
    v_mul_f32 v44, v44, v165
    v_mul_f32 v45, v45, v165
    v_mul_f32 v46, v46, v165
    v_mul_f32 v47, v47, v165
    v_mul_f32 v56, v56, v165
    v_mul_f32 v57, v57, v165
    v_mul_f32 v58, v58, v165
    v_mul_f32 v59, v59, v165
    v_mul_f32 v68, v68, v165
    v_mul_f32 v69, v69, v165
    v_mul_f32 v70, v70, v165
    v_mul_f32 v71, v71, v165
    v_mul_f32 v80, v80, v165
    v_mul_f32 v81, v81, v165
    v_mul_f32 v82, v82, v165
    v_mul_f32 v83, v83, v165
    v_mul_f32 v92, v92, v165
    v_mul_f32 v93, v93, v165
    v_mul_f32 v94, v94, v165
    v_mul_f32 v95, v95, v165
    v_mul_f32 v104, v104, v165
    v_mul_f32 v105, v105, v165
    v_mul_f32 v106, v106, v165
    v_mul_f32 v107, v107, v165
    v_sub_f32 v188, v188, v164
    v_sub_f32 v189, v189, v164
    v_sub_f32 v190, v190, v164
    v_sub_f32 v191, v191, v164
    v_sub_f32 v140, v140, v164
    v_sub_f32 v141, v141, v164
    v_sub_f32 v142, v142, v164
    v_sub_f32 v143, v143, v164
    v_sub_f32 v152, v152, v164
    v_sub_f32 v153, v153, v164
    v_sub_f32 v154, v154, v164
    v_sub_f32 v155, v155, v164
    v_exp_f32 v169, -v168
    s_nop 0
    v_mul_f32 v201, v201, v169
    v_mul_f32 v24, v24, v169
    v_mul_f32 v25, v25, v169
    v_mul_f32 v26, v26, v169
    v_mul_f32 v27, v27, v169
    v_mul_f32 v36, v36, v169
    v_mul_f32 v37, v37, v169
    v_mul_f32 v38, v38, v169
    v_mul_f32 v39, v39, v169
    v_mul_f32 v48, v48, v169
    v_mul_f32 v49, v49, v169
    v_mul_f32 v50, v50, v169
    v_mul_f32 v51, v51, v169
    v_mul_f32 v60, v60, v169
    v_mul_f32 v61, v61, v169
    v_mul_f32 v62, v62, v169
    v_mul_f32 v63, v63, v169
    v_mul_f32 v72, v72, v169
    v_mul_f32 v73, v73, v169
    v_mul_f32 v74, v74, v169
    v_mul_f32 v75, v75, v169
    v_mul_f32 v84, v84, v169
    v_mul_f32 v85, v85, v169
    v_mul_f32 v86, v86, v169
    v_mul_f32 v87, v87, v169
    v_mul_f32 v96, v96, v169
    v_mul_f32 v97, v97, v169
    v_mul_f32 v98, v98, v169
    v_mul_f32 v99, v99, v169
    v_mul_f32 v108, v108, v169
    v_mul_f32 v109, v109, v169
    v_mul_f32 v110, v110, v169
    v_mul_f32 v111, v111, v169
    v_sub_f32 v192, v192, v168
    v_sub_f32 v193, v193, v168
    v_sub_f32 v194, v194, v168
    v_sub_f32 v195, v195, v168
    v_sub_f32 v144, v144, v168
    v_sub_f32 v145, v145, v168
    v_sub_f32 v146, v146, v168
    v_sub_f32 v147, v147, v168
    v_sub_f32 v156, v156, v168
    v_sub_f32 v157, v157, v168
    v_sub_f32 v158, v158, v168
    v_sub_f32 v159, v159, v168
    v_exp_f32 v173, -v172
    s_nop 0
    v_mul_f32 v202, v202, v173
    v_mul_f32 v28, v28, v173
    v_mul_f32 v29, v29, v173
    v_mul_f32 v30, v30, v173
    v_mul_f32 v31, v31, v173
    v_mul_f32 v40, v40, v173
    v_mul_f32 v41, v41, v173
    v_mul_f32 v42, v42, v173
    v_mul_f32 v43, v43, v173
    v_mul_f32 v52, v52, v173
    v_mul_f32 v53, v53, v173
    v_mul_f32 v54, v54, v173
    v_mul_f32 v55, v55, v173
    v_mul_f32 v64, v64, v173
    v_mul_f32 v65, v65, v173
    v_mul_f32 v66, v66, v173
    v_mul_f32 v67, v67, v173
    v_mul_f32 v76, v76, v173
    v_mul_f32 v77, v77, v173
    v_mul_f32 v78, v78, v173
    v_mul_f32 v79, v79, v173
    v_mul_f32 v88, v88, v173
    v_mul_f32 v89, v89, v173
    v_mul_f32 v90, v90, v173
    v_mul_f32 v91, v91, v173
    v_mul_f32 v100, v100, v173
    v_mul_f32 v101, v101, v173
    v_mul_f32 v102, v102, v173
    v_mul_f32 v103, v103, v173
    v_mul_f32 v112, v112, v173
    v_mul_f32 v113, v113, v173
    v_mul_f32 v114, v114, v173
    v_mul_f32 v115, v115, v173
    v_sub_f32 v196, v196, v172
    v_sub_f32 v197, v197, v172
    v_sub_f32 v198, v198, v172
    v_sub_f32 v199, v199, v172
    v_sub_f32 v148, v148, v172
    v_sub_f32 v149, v149, v172
    v_sub_f32 v150, v150, v172
    v_sub_f32 v151, v151, v172
    v_sub_f32 v160, v160, v172
    v_sub_f32 v161, v161, v172
    v_sub_f32 v162, v162, v172
    v_sub_f32 v163, v163, v172
    v_exp_f32 v16, v140
    v_exp_f32 v17, v141
    v_exp_f32 v18, v142
    v_cvt_pk_bf16_f32 v176, v16, v17
    v_exp_f32 v19, v143
    v_exp_f32 v16, v144
    v_cvt_pk_bf16_f32 v177, v18, v19
    v_exp_f32 v17, v145
    v_exp_f32 v18, v146
    v_cvt_pk_bf16_f32 v180, v16, v17
    v_exp_f32 v19, v147
    v_exp_f32 v16, v148
    v_cvt_pk_bf16_f32 v181, v18, v19
    v_exp_f32 v17, v149
    v_exp_f32 v18, v150
    v_cvt_pk_bf16_f32 v184, v16, v17
    v_exp_f32 v19, v151
    v_exp_f32 v16, v152
    v_cvt_pk_bf16_f32 v185, v18, v19
    v_exp_f32 v17, v153
    v_exp_f32 v18, v154
    v_cvt_pk_bf16_f32 v178, v16, v17
    v_exp_f32 v19, v155
    v_exp_f32 v16, v156
    v_cvt_pk_bf16_f32 v179, v18, v19
    v_exp_f32 v17, v157
    v_exp_f32 v18, v158
    v_cvt_pk_bf16_f32 v182, v16, v17
    v_exp_f32 v19, v159
    v_exp_f32 v16, v160
    v_cvt_pk_bf16_f32 v183, v18, v19
    v_exp_f32 v17, v161
    v_exp_f32 v18, v162
    v_cvt_pk_bf16_f32 v186, v16, v17
    v_exp_f32 v19, v163
    s_nop 0
    v_cvt_pk_bf16_f32 v187, v18, v19
    v_mfma_f32_16x16x32_bf16 v[204:207], a[232:235], v[176:179], v[200:203]
    v_mfma_f32_16x16x32_bf16 v[204:207], a[236:239], v[180:183], v[204:207]
    v_mfma_f32_16x16x32_bf16 v[204:207], a[240:243], v[184:187], v[204:207]
    s_nop 9
    s_setpc_b64 s[82:83]
K_RARB1:
    v_sub_f32 v116, v116, v164
    v_sub_f32 v117, v117, v164
    v_sub_f32 v118, v118, v164
    v_sub_f32 v119, v119, v164
    v_sub_f32 v128, v128, v164
    v_sub_f32 v129, v129, v164
    v_sub_f32 v130, v130, v164
    v_sub_f32 v131, v131, v164
    v_sub_f32 v120, v120, v168
    v_sub_f32 v121, v121, v168
    v_sub_f32 v122, v122, v168
    v_sub_f32 v123, v123, v168
    v_sub_f32 v132, v132, v168
    v_sub_f32 v133, v133, v168
    v_sub_f32 v134, v134, v168
    v_sub_f32 v135, v135, v168
    v_sub_f32 v124, v124, v172
    v_sub_f32 v125, v125, v172
    v_sub_f32 v126, v126, v172
    v_sub_f32 v127, v127, v172
    v_sub_f32 v136, v136, v172
    v_sub_f32 v137, v137, v172
    v_sub_f32 v138, v138, v172
    v_sub_f32 v139, v139, v172
    s_nop 3
    s_setpc_b64 s[82:83]
K_RARE2:
    s_nop 15
    v_max3_f32 v176, v116, v117, v118
    v_max3_f32 v180, v120, v121, v122
    v_max3_f32 v184, v124, v125, v126
    v_max3_f32 v176, v176, v119, v128
    v_max3_f32 v180, v180, v123, v132
    v_max3_f32 v184, v184, v127, v136
    v_max3_f32 v176, v176, v129, v130
    v_max3_f32 v180, v180, v133, v134
    v_max3_f32 v184, v184, v137, v138
    v_max3_f32 v176, v176, v131, 0
    v_max3_f32 v180, v180, v135, 0
    v_max3_f32 v184, v184, v139, 0
    v_mov_b32 v177, v176
    v_mov_b32 v181, v180
    v_mov_b32 v185, v184
    v_permlane16_swap_b32 v176, v177
    v_permlane16_swap_b32 v180, v181
    v_permlane16_swap_b32 v184, v185
    v_max_f32 v176, v176, v177
    v_max_f32 v180, v180, v181
    v_max_f32 v184, v184, v185
    v_mov_b32 v177, v176
    v_mov_b32 v181, v180
    v_mov_b32 v185, v184
    v_permlane32_swap_b32 v176, v177
    v_permlane32_swap_b32 v180, v181
    v_permlane32_swap_b32 v184, v185
    v_max_f32 v176, v176, v177
    v_max_f32 v180, v180, v181
    v_max_f32 v184, v184, v185
    v_exp_f32 v177, -v176
    s_nop 0
    v_mul_f32 v204, v204, v177
    v_sub_f32 v188, v188, v176
    v_sub_f32 v189, v189, v176
    v_sub_f32 v190, v190, v176
    v_sub_f32 v191, v191, v176
    v_sub_f32 v116, v116, v176
    v_sub_f32 v117, v117, v176
    v_sub_f32 v118, v118, v176
    v_sub_f32 v119, v119, v176
    v_sub_f32 v128, v128, v176
    v_sub_f32 v129, v129, v176
    v_sub_f32 v130, v130, v176
    v_sub_f32 v131, v131, v176
    v_exp_f32 v181, -v180
    s_nop 0
    v_mul_f32 v205, v205, v181
    v_sub_f32 v192, v192, v180
    v_sub_f32 v193, v193, v180
    v_sub_f32 v194, v194, v180
    v_sub_f32 v195, v195, v180
    v_sub_f32 v120, v120, v180
    v_sub_f32 v121, v121, v180
    v_sub_f32 v122, v122, v180
    v_sub_f32 v123, v123, v180
    v_sub_f32 v132, v132, v180
    v_sub_f32 v133, v133, v180
    v_sub_f32 v134, v134, v180
    v_sub_f32 v135, v135, v180
    v_exp_f32 v185, -v184
    s_nop 0
    v_mul_f32 v206, v206, v185
    v_sub_f32 v196, v196, v184
    v_sub_f32 v197, v197, v184
    v_sub_f32 v198, v198, v184
    v_sub_f32 v199, v199, v184
    v_sub_f32 v124, v124, v184
    v_sub_f32 v125, v125, v184
    v_sub_f32 v126, v126, v184
    v_sub_f32 v127, v127, v184
    v_sub_f32 v136, v136, v184
    v_sub_f32 v137, v137, v184
    v_sub_f32 v138, v138, v184
    v_sub_f32 v139, v139, v184
    v_exp_f32 v16, v116
    v_exp_f32 v17, v117
    v_exp_f32 v18, v118
    v_cvt_pk_bf16_f32 v164, v16, v17
    v_exp_f32 v19, v119
    v_exp_f32 v16, v120
    v_cvt_pk_bf16_f32 v165, v18, v19
    v_exp_f32 v17, v121
    v_exp_f32 v18, v122
    v_cvt_pk_bf16_f32 v168, v16, v17
    v_exp_f32 v19, v123
    v_exp_f32 v16, v124
    v_cvt_pk_bf16_f32 v169, v18, v19
    v_exp_f32 v17, v125
    v_exp_f32 v18, v126
    v_cvt_pk_bf16_f32 v172, v16, v17
    v_exp_f32 v19, v127
    v_exp_f32 v16, v128
    v_cvt_pk_bf16_f32 v173, v18, v19
    v_exp_f32 v17, v129
    v_exp_f32 v18, v130
    v_cvt_pk_bf16_f32 v166, v16, v17
    v_exp_f32 v19, v131
    v_exp_f32 v16, v132
    v_cvt_pk_bf16_f32 v167, v18, v19
    v_exp_f32 v17, v133
    v_exp_f32 v18, v134
    v_cvt_pk_bf16_f32 v170, v16, v17
    v_exp_f32 v19, v135
    v_exp_f32 v16, v136
    v_cvt_pk_bf16_f32 v171, v18, v19
    v_exp_f32 v17, v137
    v_exp_f32 v18, v138
    v_cvt_pk_bf16_f32 v174, v16, v17
    v_exp_f32 v19, v139
    s_nop 0
    v_cvt_pk_bf16_f32 v175, v18, v19
    v_mfma_f32_16x16x32_bf16 v[200:203], a[232:235], v[164:167], v[204:207]
    v_mfma_f32_16x16x32_bf16 v[200:203], a[236:239], v[168:171], v[200:203]
    v_mfma_f32_16x16x32_bf16 v[200:203], a[240:243], v[172:175], v[200:203]
    s_nop 9
    s_setpc_b64 s[82:83]
K_PX:
    s_mov_b32 s92, 20000
K_PX_loop:
    s_sleep 1
    buffer_load_ubyte v14, v13, s[48:51], s74 offen offset:0 sc1
    s_waitcnt vmcnt(0)
    v_cmp_gt_u32 vcc, 1, v14
    s_and_b32 s87, vcc_lo, s77
    s_cbranch_scc0 K_PX_ret
    s_sub_u32 s92, s92, 1
    s_cmp_lg_u32 s92, 0
    s_cbranch_scc1 K_PX_loop
    s_branch K_PX_ret
K_PA:
    s_mov_b32 s92, 20000
K_PA_loop:
    s_sleep 1
    buffer_load_ubyte v14, v13, s[44:47], s75 offen offset:0 sc1
    s_waitcnt vmcnt(0)
    v_cmp_gt_u32 vcc, 64, v14
    s_and_b32 s87, vcc_lo, s79
    s_cbranch_scc0 K_PA_ret
    s_sub_u32 s92, s92, 1
    s_cmp_lg_u32 s92, 0
    s_cbranch_scc1 K_PA_loop
    s_branch K_PA_ret
K_PB:
    s_mov_b32 s92, 20000
K_PB_loop:
    s_sleep 1
    buffer_load_ubyte v14, v13, s[44:47], s75 offen offset:0 sc1
    s_waitcnt vmcnt(0)
    v_cmp_gt_u32 vcc, 0xff, v14
    s_and_b32 s87, vcc_lo, s79
    s_cbranch_scc0 K_PB_ret
    s_sub_u32 s92, s92, 1
    s_cmp_lg_u32 s92, 0
    s_cbranch_scc1 K_PB_loop
    s_branch K_PB_ret
K_PC:
    s_mov_b32 s92, 20000
K_PC_loop:
    s_sleep 1
    buffer_load_ubyte v14, v13, s[44:47], s16 offen offset:0 sc1
    s_waitcnt vmcnt(0)
    v_cmp_gt_u32 vcc, 64, v14
    s_and_b32 s87, vcc_lo, s18
    s_cbranch_scc0 K_PC_ret
    s_sub_u32 s92, s92, 1
    s_cmp_lg_u32 s92, 0
    s_cbranch_scc1 K_PC_loop
    s_branch K_PC_ret
K_PL0:
    s_mov_b32 s92, 20000
K_PL0_loop:
    s_sleep 1
    s_add_u32 s86, s72, 0
    buffer_load_dwordx4 v[220:223], v12, s[44:47], s86 offen offset:0 sc1
    buffer_load_dwordx4 v[224:227], v12, s[44:47], s86 offen offset:1024 sc1
    buffer_load_dwordx4 v[228:231], v12, s[44:47], s86 offen offset:2048 sc1
    s_waitcnt vmcnt(0)
    v_and_b32 v16, v220, v224
    v_and_b32 v17, 1, v228
    v_and_b32 v16, v16, v17
    v_cmp_eq_u32 vcc, 0, v16
    s_cbranch_vccz K_PL0_ret
    s_sub_u32 s92, s92, 1
    s_cmp_lg_u32 s92, 0
    s_cbranch_scc1 K_PL0_loop
    s_branch K_PL0_ret
K_PL1:
    s_mov_b32 s92, 20000
K_PL1_loop:
    s_sleep 1
    s_add_u32 s86, s72, 4096
    buffer_load_dwordx4 v[244:247], v12, s[44:47], s86 offen offset:0 sc1
    buffer_load_dwordx4 v[248:251], v12, s[44:47], s86 offen offset:1024 sc1
    buffer_load_dwordx4 v[252:255], v12, s[44:47], s86 offen offset:2048 sc1
    s_waitcnt vmcnt(0)
    v_and_b32 v16, v244, v248
    v_and_b32 v17, 1, v252
    v_and_b32 v16, v16, v17
    v_cmp_eq_u32 vcc, 0, v16
    s_cbranch_vccz K_PL1_ret
    s_sub_u32 s92, s92, 1
    s_cmp_lg_u32 s92, 0
    s_cbranch_scc1 K_PL1_loop
    s_branch K_PL1_ret
K_PL2:
    s_mov_b32 s92, 20000
K_PL2_loop:
    s_sleep 1
    s_add_u32 s86, s72, 8192
    buffer_load_dwordx4 v[128:131], v12, s[44:47], s86 offen offset:0 sc1
    buffer_load_dwordx4 v[132:135], v12, s[44:47], s86 offen offset:1024 sc1
    buffer_load_dwordx4 v[136:139], v12, s[44:47], s86 offen offset:2048 sc1
    s_waitcnt vmcnt(0)
    v_and_b32 v16, v128, v132
    v_and_b32 v17, 1, v136
    v_and_b32 v16, v16, v17
    v_cmp_eq_u32 vcc, 0, v16
    s_cbranch_vccz K_PL2_ret
    s_sub_u32 s92, s92, 1
    s_cmp_lg_u32 s92, 0
    s_cbranch_scc1 K_PL2_loop
    s_branch K_PL2_ret
.p2align 8
.fill 8192, 4, 0xBF800000
.section .rodata,"a"
.p2align 6
.amdhsa_kernel standalone__gqa_block_cached__near_ridge_kernel
  .amdhsa_next_free_vgpr 512
  .amdhsa_next_free_sgpr 102
  .amdhsa_accum_offset 256
  .amdhsa_group_segment_fixed_size 0
  .amdhsa_kernarg_size 64
  .amdhsa_user_sgpr_count 2
  .amdhsa_user_sgpr_kernarg_segment_ptr 1
  .amdhsa_system_sgpr_workgroup_id_x 1
.end_amdhsa_kernel
```
